```python
import torch

def _softmax(x, axis=-1):
    return torch.softmax(x, dim=axis)

def _gelu(x):
    return torch.nn.functional.gelu(x, approximate='tanh')

def _silu(x):
    return torch.nn.functional.silu(x)

def _sigmoid(x):
    return torch.sigmoid(x)

def _layernorm(x, axis=-1, eps=1e-05):
    m = x.mean(dim=axis, keepdim=True)
    v = x.var(dim=axis, keepdim=True, unbiased=False)
    return (x - m) / torch.sqrt(v + eps)

def _scatter_add(tgt, idx, src, axis=0):
    return tgt.clone().index_add_(axis, idx, src)

def _segment_sum(src, seg, n):
    out = torch.zeros((n,) + src.shape[1:], dtype=src.dtype)
    return out.index_add_(0, seg, src)

def _pad(x, pw):
    flat = tuple((v for pair in reversed(pw) for v in pair))
    return torch.nn.functional.pad(x, flat)
kernel_name = 'standalone__ragged_sequences_varlen_flash_attn__ragged'

def setup_inputs():

    _w = lambda a: (lambda t: t.to(torch.bfloat16) if t.is_floating_point() else t)(torch.as_tensor(a))
    cu = torch.tensor([0, 1918, 2650, 4254, 4580, 5262, 6323, 6815, 7972], dtype=torch.int64)
    T = int(cu[-1])
    Hq, Hkv, D = (16, 8, 128)
    assert Hq % Hkv == 0
    return {'q': _w((lambda *s: torch.randn(*s, dtype=torch.bfloat16) * 0.8)(T, Hq, D)), 'k': _w((lambda *s: torch.randn(*s, dtype=torch.bfloat16) * 0.8)(T, Hkv, D)), 'v': _w((lambda *s: torch.randn(*s, dtype=torch.bfloat16) * 0.05)(T, Hkv, D)), 'cu': _w(cu)}

def reference(q, k, v, cu):
    T, Hq, D = q.shape
    Hkv = k.shape[1]
    rep = Hq // Hkv
    scale = D ** (-0.5)
    outs = []
    for i in range(len(cu) - 1):
        s, e = (int(cu[i]), int(cu[i + 1]))
        L = e - s
        qi = q[s:e].clone()
        ki = (lambda x, n, axis: torch.repeat_interleave(x, n, dim=axis))(k[s:e], rep, axis=1)
        vi = (lambda x, n, axis: torch.repeat_interleave(x, n, dim=axis))(v[s:e], rep, axis=1)
        logits = torch.einsum('qhd,khd->hqk', qi, ki) * scale
        ar = torch.arange(L)
        neg = (lambda x, dt: x.to(dt))(ar[None, :] > ar[:, None], logits.dtype) * -1000000000.0
        p = _softmax(logits + neg[None, :, :], axis=-1)
        outs.append(torch.einsum('hqk,khd->qhd', p, vi))
    return torch.concatenate(outs, axis=0)
```

```asm
; @launch grid=(256,1,1) block=(256,1,1) lds=163840
.amdgcn_target "amdgcn-amd-amdhsa--gfx950"

.macro QK d,a,b
v_mfma_f32_16x16x32_bf16 v[\d:\d+3], a[\a:\a+3], a[\b:\b+3], v[\d:\d+3]
.endm
.macro QZ d,a,b
v_mfma_f32_16x16x32_bf16 v[\d:\d+3], a[\a:\a+3], a[\b:\b+3], 0
.endm
.macro PV d,a,b
v_mfma_f32_16x16x32_bf16 v[\d:\d+3], a[\a:\a+3], v[\b:\b+3], v[\d:\d+3]
.endm
.macro LS d,a,b
v_mfma_f32_16x16x32_bf16 a[\d:\d+3], a[\a:\a+3], v[\b:\b+3], a[\d:\d+3]
.endm
.macro SM d,b
v_smfmac_f32_16x16x64_bf16 a[\d:\d+3], a[140:143], v[\b:\b+7], v246
.endm
.macro SC r
v_mul_f32 v\r, s28, v\r
.endm
.macro EX r
v_exp_f32 v\r, v\r
.endm
.macro EY d,r
v_exp_f32 v\d, v\r
.endm
.macro MW d,a
v_mov_b32_sdwa v\d, v\a dst_sel:WORD_0 dst_unused:UNUSED_PRESERVE src0_sel:WORD_1
.endm
.macro PS d
v_pk_mul_f32 v[\d:\d+1], v[\d:\d+1], s[28:29] op_sel_hi:[1,0]
.endm
.macro PZ d,a,b
v_mfma_f32_16x16x32_bf16 v[\d:\d+3], a[\a:\a+3], v[\b:\b+3], 0
.endm
.macro PH d,a,b
v_mfma_f32_16x16x16_bf16 v[\d:\d+3], a[\a:\a+1], v[\b:\b+1], v[\d:\d+3]
.endm
.macro CV d,a,b
v_cvt_pk_bf16_f32 v\d, v\a, v\b
.endm
.macro RK d,v,o
ds_read_b128 a[\d:\d+3], v\v offset:\o
.endm
.macro RV d,v,o
ds_read_b64_tr_b16 a[\d:\d+1], v\v offset:\o
.endm
.macro XE d,a,b
v_cndmask_b32_dpp v\d, v\a, v\b, vcc quad_perm:[0,0,2,2] row_mask:0xf bank_mask:0xf
.endm
.macro XO d,a,b
v_cndmask_b32_dpp v\d, v\a, v\b, vcc quad_perm:[1,1,3,3] row_mask:0xf bank_mask:0xf
.endm
.macro SW a,b
v_permlane16_swap_b32 v\a, v\b
.endm
.macro PM d,s,h
v_pk_mul_f32 v[\d:\d+1], v[\d:\d+1], v[\s:\s+1] op_sel:[0,\h] op_sel_hi:[1,\h]
.endm

.text
.globl standalone__ragged_sequences_varlen_flash_attn__ragged_kernel
.p2align 8
.type standalone__ragged_sequences_varlen_flash_attn__ragged_kernel,@function
standalone__ragged_sequences_varlen_flash_attn__ragged_kernel:

    s_cmp_ge_u32 s2, 256
    s_cbranch_scc1 L_idle
    s_load_dwordx2 s[8:9], s[0:1], 0
    s_getpc_b64 s[64:65]
L_pc:
    s_lshr_b32 s3, s2, 3
    s_lshl_b32 s6, s2, 2
    s_lshr_b32 s6, 0x10345612, s6
    s_and_b32 s6, s6, 7
    s_lshl3_add_u32 s6, s3, s6
    s_lshl_b32 s6, s6, 7
    s_add_u32 s6, s6, L_table-L_pc
    s_add_u32 s88, s64, s6
    s_addc_u32 s89, s65, 0
    s_load_dwordx16 s[40:55], s[88:89], 0
    s_load_dword s63, s[88:89], 92
    s_load_dwordx2 s[86:87], s[0:1], 8
    s_load_dwordx2 s[60:61], s[0:1], 16
    s_load_dwordx4 s[96:99], s[0:1], 32
    s_load_dwordx2 s[4:5], s[0:1], 48
    v_lshrrev_b32 v2, 2, v0
    v_lshl_add_u32 v2, s3, 6, v2
    v_min_u32 v2, (L_table-L_pc)/128, v2
    v_lshlrev_b32 v2, 7, v2
    global_load_dword v255, v2, s[64:65]
    v_lshlrev_b32 v244, 7, v0
    v_add_u32 v247, L_Z0-L_pc, v244
    v_lshrrev_b32 v1, 6, v0
    v_and_b32 v0, 63, v0
    v_readfirstlane_b32 s29, v1
    v_and_b32 v2, 3, v0
    v_bfe_u32 v3, v0, 2, 3
    v_lshrrev_b32 v4, 5, v0
    v_lshlrev_b32 v4, 6, v4
    s_lshl_b32 s37, s29, 11
    s_lshl_b32 s6, s29, 14
    s_and_b32 s7, s29, 1
    s_lshl_b32 s7, s7, 1
    v_lshl_add_u32 v5, v3, 11, v4
    v_add_u32 v5, s6, v5
    v_xor_b32 v6, s7, v2
    v_lshl_add_u32 v215, v6, 4, v5
    v_lshrrev_b32 v6, 2, v3
    v_lshlrev_b32 v6, 1, v6
    v_xor_b32 v6, v6, v2
    v_lshl_add_u32 v216, v6, 4, v5
    v_lshl_add_u32 v5, v3, 12, v4
    v_lshl_add_u32 v217, v2, 4, v5
    v_xor_b32 v6, 2, v2
    v_lshl_add_u32 v218, v6, 4, v5
    v_add_u32 v218, 0x8000, v218
    s_add_u32 s78, s6, 98304
    v_lshrrev_b32 v11, 1, v0
    v_lshl_add_u32 v11, s7, 4, v11
    v_lshlrev_b32 v11, 11, v11
    v_and_b32 v12, 1, v0
    v_lshl_add_u32 v11, v12, 7, v11
    s_and_b32 s3, s2, 7
    s_lshl_b32 s72, s3, 8
    s_lshl_b32 s3, s3, 5
    s_mov_b32 s11, 0x20000
    s_mov_b32 s15, 0x20000
    s_mov_b32 s19, 0x20000
    s_mov_b32 s23, 0x20000
    s_mov_b32 s27, 0x20000
    s_mov_b32 s33, 0x4000
    s_mov_b64 s[56:57], 0
    s_mov_b64 s[58:59], 0
    s_mov_b32 s6, 0x8000000
    s_mov_b32 s7, 0x20000
    s_add_u32 s3, s3, s29
    s_mov_b32 s31, s37
    s_waitcnt lgkmcnt(0)

    s_lshl1_add_u32 s40, s72, s40
    s_add_u32 s41, s41, s72
    s_lshl_b32 s91, s29, 16
    s_add_u32 s80, s40, s91
    s_and_b32 s10, s43, 0xfffff000
    s_add_u32 m0, s78, 0
    s_sub_u32 s81, s40, s91
    s_add_u32 s81, s81, 0x70000
    s_bfe_u32 s79, s43, 0x20008
    s_bitcmp1_b32 s43, 8
    s_cselect_b32 s82, 0x2000, 0
    s_mov_b32 s34, s41
    buffer_load_dwordx4 v217, s[8:11], s80 offen offset:0 nt lds
    s_add_u32 m0, s78, 896
    s_and_b32 s62, s42, 0xfffff800
    s_mov_b32 s93, s82
    s_add_u32 s94, s82, s37
    s_lshl_b32 s89, s82, 3
    s_add_u32 s89, s89, s34
    s_add_u32 s12, s86, s89
    s_addc_u32 s13, s87, 0
    buffer_load_dwordx4 v217, s[8:11], s80 offen offset:128 nt lds
    s_add_u32 m0, s78, 2048
    s_sub_u32 s14, s62, s89
    s_max_i32 s14, s14, 0
    s_add_u32 s20, s60, s89
    s_addc_u32 s21, s61, 0
    s_sub_u32 s22, s62, s89
    s_max_i32 s22, s22, 0
    buffer_load_dwordx4 v218, s[8:11], s80 offen offset:0 nt lds
    s_add_u32 m0, s78, 2944
    s_nop 0
    buffer_load_dwordx4 v218, s[8:11], s80 offen offset:128 nt lds
    s_mov_b32 s92, 0
    s_add_u32 m0, s94, 32768
    s_nop 0
    buffer_load_dwordx4 v215, s[12:15], s92 offen offset:0 lds
    s_add_u32 m0, s94, 33664
    s_nop 0
    buffer_load_dwordx4 v215, s[12:15], s92 offen offset:128 lds
    s_mov_b32 s92, 65536
    s_add_u32 m0, s94, 0
    s_nop 0
    buffer_load_dwordx4 v215, s[12:15], s92 offen offset:0 lds
    s_add_u32 m0, s94, 896
    s_nop 0
    buffer_load_dwordx4 v215, s[12:15], s92 offen offset:128 lds
    s_mov_b32 s92, 0
    s_add_u32 m0, s94, 49152
    s_nop 0
    buffer_load_dwordx4 v216, s[20:23], s92 offen offset:0 lds
    s_add_u32 m0, s94, 50048
    s_nop 0
    buffer_load_dwordx4 v216, s[20:23], s92 offen offset:128 lds

    s_mov_b64 s[74:75], s[8:9]
    s_mov_b64 s[24:25], s[96:97]
    s_mov_b64 s[0:1], s[98:99]
    s_lshl1_add_u32 s44, s72, s44
    s_add_u32 s45, s45, s72
    s_lshl1_add_u32 s48, s72, s48
    s_add_u32 s49, s49, s72
    s_lshl1_add_u32 s52, s72, s52
    s_add_u32 s53, s53, s72
    s_add_u32 s63, s63, s72
    s_mov_b32 s28, 0x3e0293ee
    s_mov_b32 s77, 0x3c000000
    s_mov_b32 s73, 0
    s_mov_b32 s76, 1
    v_lshrrev_b32 v3, 4, v0
    v_bfe_u32 v4, v0, 3, 1
    v_and_b32 v5, 7, v0
    v_lshlrev_b32 v6, 1, v4
    v_xor_b32 v6, v6, v3
    v_lshlrev_b32 v6, 4, v6
    v_lshl_add_u32 v6, v5, 6, v6
    v_lshl_add_u32 v6, v4, 11, v6
    v_add_u32 v212, s93, v6
    v_add_u32 v219, s78, v6
    v_lshrrev_b32 v4, 5, v0
    v_bfe_u32 v5, v0, 2, 3
    v_and_b32 v6, 1, v3
    v_lshlrev_b32 v7, 4, v2
    v_lshl_add_u32 v7, v5, 6, v7
    v_lshl_add_u32 v7, v4, 11, v7
    v_lshlrev_b32 v8, 5, v6
    v_xor_b32 v7, v8, v7
    v_add_u32 v213, 49152, v7
    v_add_u32 v213, s93, v213
    v_add_u32 v214, 0x10000, v216
    v_add_u32 v222, s78, v7
    v_lshl_add_u32 v223, v0, 4, s78
    v_lshrrev_b32 v8, 3, v0
    v_and_b32 v9, 7, v0
    v_lshlrev_b32 v9, 4, v9
    v_lshl_add_u32 v232, v8, 12, v9
    v_add_u32 v233, 0x8000, v232
    v_and_b32 v5, 15, v0
    v_lshlrev_b32 v234, 2, v5
    v_add_u32 v234, 0x4000000, v234
    v_lshlrev_b32 v7, 5, v4
    v_lshl_add_u32 v7, v6, 4, v7
    v_and_b32 v8, 1, v5
    v_lshl_add_u32 v7, v8, 6, v7
    v_and_b32 v8, 14, v5
    v_lshl_add_u32 v220, v8, 12, v7
    v_add_u32 v221, 0x1000, v220
    v_lshlrev_b32 v3, 2, v3
    v_sub_u32 v5, v5, v3
    v_add_u32 v245, s63, v11
    s_mov_b32 s63, 16326656
    v_mov_b32 v7, 0xff800000
    v_mov_b32 v6, 0x3f803f80
    v_cmp_eq_u32 vcc, 0, v2
    s_nop 1
    v_cndmask_b32 v13, 0, v6, vcc
    v_cmp_eq_u32 vcc, 2, v2
    v_lshrrev_b32 v14, 1, v2
    v_and_b32 v15, 1, v2
    v_cndmask_b32 v16, 0, v6, vcc
    v_cmp_eq_u32 vcc, v14, v4
    v_mul_u32_u24 v15, 0xaaaa, v15
    v_add_u32 v246, 0x4444, v15
    v_cndmask_b32 v17, 0, v6, vcc
    v_cmp_gt_i32 vcc, 0, v5
    v_accvgpr_write_b32 a144, v13
    v_accvgpr_write_b32 a136, v16
    v_accvgpr_write_b32 a140, v17
    v_cndmask_b32 v208, 0, v7, vcc
    v_cmp_gt_i32 vcc, 1, v5
    v_accvgpr_write_b32 a145, v13
    v_accvgpr_write_b32 a137, v16
    v_accvgpr_write_b32 a141, v17
    v_cndmask_b32 v209, 0, v7, vcc
    v_cmp_gt_i32 vcc, 2, v5
    v_accvgpr_write_b32 a146, v13
    v_accvgpr_write_b32 a138, v16
    v_accvgpr_write_b32 a142, v17
    v_cndmask_b32 v210, 0, v7, vcc
    v_cmp_gt_i32 vcc, 3, v5
    v_accvgpr_write_b32 a147, v13
    v_accvgpr_write_b32 a139, v16
    v_accvgpr_write_b32 a143, v17
    v_cndmask_b32 v211, 0, v7, vcc
    v_ashrrev_i32 v8, 31, v208
    v_ashrrev_i32 v9, 31, v209
    v_lshrrev_b32 v8, 16, v8
    v_lshl_or_b32 v8, v9, 16, v8
    v_not_b32 v253, v8
    v_ashrrev_i32 v8, 31, v210
    v_ashrrev_i32 v9, 31, v211
    v_lshrrev_b32 v8, 16, v8
    v_lshl_or_b32 v8, v9, 16, v8
    v_not_b32 v254, v8
    v_mov_b32 v8, 0x3f80
    v_mov_b32 v9, 0x3f800000
    v_cmp_eq_u32 vcc, 0, v5
    v_accvgpr_write_b32 a244, 0
    s_nop 0
    v_cndmask_b32 v10, 0, v8, vcc
    v_cmp_eq_u32 vcc, 1, v5
    v_accvgpr_write_b32 a245, 0
    s_nop 0
    v_cndmask_b32 v10, v10, v9, vcc
    v_accvgpr_write_b32 a246, v10
    v_cmp_eq_u32 vcc, 2, v5
    v_accvgpr_write_b32 a248, 0
    s_nop 0
    v_cndmask_b32 v10, 0, v8, vcc
    v_cmp_eq_u32 vcc, 3, v5
    v_accvgpr_write_b32 a249, 0
    s_nop 0
    v_cndmask_b32 v10, v10, v9, vcc
    v_accvgpr_write_b32 a247, v10
    s_mov_b32 vcc_lo, 0x55555555
    s_mov_b32 vcc_hi, 0x55555555
L_P0:
 s_add_u32 m0, s78, 3840
 s_nop 0
 buffer_load_dwordx4 v217, s[8:11], s80 offen offset:256 nt lds
 s_add_u32 m0, s78, 4736
 s_nop 0
 buffer_load_dwordx4 v217, s[8:11], s80 offen offset:384 nt lds
 s_add_u32 m0, s78, 5888
 s_nop 0
 buffer_load_dwordx4 v218, s[8:11], s80 offen offset:256 nt lds
 s_add_u32 m0, s78, 6784
 s_nop 0
 buffer_load_dwordx4 v218, s[8:11], s80 offen offset:384 nt lds
 s_mov_b32 s92, 131072
 s_add_u32 m0, s94, 8192
 s_nop 0
 buffer_load_dwordx4 v215, s[12:15], s92 offen offset:0 lds
 s_add_u32 m0, s94, 9088
 s_nop 0
 buffer_load_dwordx4 v215, s[12:15], s92 offen offset:128 lds
 s_mov_b32 s92, 65536
 s_add_u32 m0, s94, 57344
 s_nop 0
 buffer_load_dwordx4 v216, s[20:23], s92 offen offset:0 lds
 s_add_u32 m0, s94, 58240
 s_nop 0
 buffer_load_dwordx4 v216, s[20:23], s92 offen offset:128 lds
 s_mov_b32 s38, s80
 s_mov_b32 s39, s81
 s_and_b32 s26, s43, 0xfffff000
 s_and_b32 s30, s43, 0x3f
 s_bfe_u32 s83, s42, 0x20006
 s_and_b32 s89, s47, 0x100
 s_cselect_b32 s89, 0x10000, 0
 s_add_u32 s72, s45, s89
 s_waitcnt vmcnt(8)
 s_barrier
 RK 0,219,0
 RK 4,219,512
 RK 8,219,1024
 RK 12,219,1536
 RK 64,212,32768
 RK 68,212,33280
 RK 72,212,33792
 RK 76,212,34304
 s_waitcnt lgkmcnt(3)
 QZ 132,64,0
 s_add_u32 m0, s78, 8192
 RK 80,212,36864
 RK 84,212,37376
 s_waitcnt lgkmcnt(4)
 QK 132,68,4
 s_lshl_b32 s91, s29, 16
 RK 88,212,37888
 s_waitcnt lgkmcnt(4)
 QK 132,72,8
 s_add_u32 s80, s44, s91
 RK 92,212,38400
 s_waitcnt lgkmcnt(4)
 QK 132,76,12
 s_bfe_u32 s79, s47, 0x20008
 RK 148,212,0
 buffer_load_dwordx4 v217, s[8:11], s81 offen offset:0 nt lds
 s_add_u32 m0, s78, 9088
 RK 152,212,512
 s_bitcmp1_b32 s47, 8
 s_cselect_b32 s82, 0x2000, 0
 s_mov_b32 s96, s80
 RK 156,212,1024
 SC 132
 SC 133
 EX 132
 RK 160,212,1536
 RK 164,212,4096
 buffer_load_dwordx4 v217, s[8:11], s81 offen offset:128 nt lds
 EX 133
 RV 96,213,0
 RV 98,213,4096
 CV 192,132,133
 SC 134
 SC 135
 s_waitcnt lgkmcnt(7)
 QZ 148,92,12
 s_add_u32 s97, s80, 0x100
 RK 168,212,4608
 EX 134
 QK 148,88,8
 s_mov_b32 s100, s78
 RK 172,212,5120
 RV 100,213,8
 QK 148,84,4
 s_add_u32 m0, s78, 10240
 EX 135
 QK 148,80,0
 s_bfe_u32 s101, s43, 0x2000a
 RK 176,212,5632
 CV 193,134,135
 s_waitcnt lgkmcnt(10)
 QZ 136,148,0
 s_and_b32 s71, s42, 0x3f
 RV 102,213,4104
 RV 104,213,512
 s_waitcnt lgkmcnt(11)
 QK 136,152,4
 s_add_u32 s71, s71, s30
 buffer_load_dwordx4 v218, s[8:11], s81 offen offset:0 nt lds
 s_waitcnt lgkmcnt(10)
 QK 136,156,8
 s_add_u32 m0, s78, 11136
 RV 106,213,4608
 SC 148
 s_waitcnt lgkmcnt(10)
 QK 136,160,12
 s_sub_u32 s71, s71, s101
 RV 108,213,520
 SC 149
 RV 110,213,4616
 RV 112,213,1024
 buffer_load_dwordx4 v218, s[8:11], s81 offen offset:128 nt lds
 EX 148
 RV 114,213,5120
 RV 116,213,1032
 EX 149
 s_waitcnt lgkmcnt(8)
 QZ 152,176,12
 s_add_u32 s71, s71, 4
 RV 118,213,5128
 CV 194,148,149
 QK 152,172,8
 s_cmp_eq_u32 s46, 0
 RV 120,213,1536
 SC 150
 QK 152,168,4
 s_cselect_b32 s71, 0, s71
 RV 122,213,5632
 SC 151
 QK 152,164,0
 s_sub_u32 s90, 0x4000, s93
 RV 124,213,1544
 SC 136
 EX 150
 RV 126,213,5640
 EX 151
 SC 137
 CV 195,150,151
 EX 136
 EX 137
 v_mfma_f32_16x16x32_bf16 a[128:131], a[144:147], v[192:195], 0
 s_add_u32 s34, s34, 0x60000
 CV 176,136,137
 SC 138
 PZ 0,96,192
 s_waitcnt lgkmcnt(12)
 SC 139
 SC 152
 PZ 4,100,192
 s_waitcnt lgkmcnt(10)
 EX 138
 PZ 8,104,192
 s_waitcnt lgkmcnt(8)
 EX 139
 PZ 12,108,192
 s_waitcnt lgkmcnt(6)
 CV 177,138,139
 SC 153
 PZ 16,112,192
 s_waitcnt vmcnt(8) lgkmcnt(4)
 RK 16,219,4096
 SC 154
 PZ 20,116,192
 s_waitcnt lgkmcnt(3)
 RK 20,219,4608
 SC 155
 PZ 24,120,192
 s_add_u32 m0, s78, 12032
 RK 24,219,5120
 RK 28,219,5632
 s_waitcnt lgkmcnt(4)
 PZ 28,124,192
 buffer_load_dwordx4 v217, s[8:11], s81 offen offset:256 nt lds
 EX 152
 EX 153
 EX 154
 CV 178,152,153
 EX 155
 s_waitcnt lgkmcnt(3)
 QZ 136,64,16
 s_waitcnt lgkmcnt(2)
 CV 179,154,155
 QK 136,68,20
 s_add_u32 m0, s78, 12928
 s_waitcnt lgkmcnt(1)
 QK 136,72,24
 s_waitcnt lgkmcnt(0)
 buffer_load_dwordx4 v217, s[8:11], s81 offen offset:384 nt lds
 QK 136,76,28
 QZ 152,92,28
 s_add_u32 m0, s78, 14080
 QK 152,88,24
 buffer_load_dwordx4 v218, s[8:11], s81 offen offset:256 nt lds
 QK 152,84,20
 QK 152,80,16
 s_add_u32 m0, s78, 14976
 QZ 140,148,16
 buffer_load_dwordx4 v218, s[8:11], s81 offen offset:384 nt lds
 QK 140,152,20
 s_sub_u32 s81, s44, s91
 SC 136
 SC 137
 QK 140,156,24
 s_add_u32 s81, s81, 0x70000
 EX 136
 QK 140,160,28
 s_and_b32 s10, s47, 0xfffff000
 EX 137
 QZ 156,176,28
 s_mov_b32 s98, s81
 CV 196,136,137
 SC 138
 QK 156,172,24
 s_add_u32 s99, s81, 0x100
 SC 139
 SC 152
 QK 156,168,20
 EX 138
 QK 156,164,16
 s_waitcnt vmcnt(8)
 EX 139
 SC 153
 CV 197,138,139
 EX 152
 EX 153
 SC 154
 CV 198,152,153
 SC 155
 EX 154
 EX 155
 SC 140
 CV 199,154,155
 SC 141
 EX 140
 LS 128,136,196
 s_barrier
 PZ 32,96,196
 RK 212,212,8192
 SC 142
 PZ 36,100,196
 RK 216,212,8704
 SC 143
 PZ 40,104,196
 RK 220,212,9216
 SC 156
 PZ 44,108,196
 RK 224,212,9728
 SC 157
 PZ 48,112,196
 RK 228,212,12288
 SC 158
 PZ 52,116,196
 RK 232,212,12800
 SC 159
 PZ 56,120,196
 RK 236,212,13312
 RK 240,212,13824
 PZ 60,124,196
 s_waitcnt lgkmcnt(7)
 RV 180,213,8192
 EX 141
 EX 142
 QZ 128,212,0
 s_waitcnt lgkmcnt(7)
 RV 182,213,12288
 CV 180,140,141
 QK 128,216,4
 s_mov_b32 s92, 196608
 RV 184,213,8200
 RV 186,213,12296
 s_waitcnt lgkmcnt(9)
 QK 128,220,8
 s_add_u32 m0, s94, 16384
 EX 143
 s_waitcnt lgkmcnt(8)
 QK 128,224,12
 RV 188,213,8704
 CV 181,142,143
 RV 190,213,12800
 RV 192,213,8712
 buffer_load_dwordx4 v215, s[12:15], s92 offen offset:0 lds
 EX 156
 s_waitcnt lgkmcnt(7)
 QZ 144,240,12
 RV 194,213,12808
 SC 128
 QK 144,236,8
 s_add_u32 m0, s94, 17280
 RV 196,213,9216
 SC 129
 QK 144,232,4
 RV 198,213,13312
 SC 130
 QK 144,228,0
 RV 200,213,9224
 SC 131
 QZ 132,212,16
 RV 202,213,13320
 RV 204,213,9728
 QK 132,216,20
 buffer_load_dwordx4 v215, s[12:15], s92 offen offset:128 lds
 QK 132,220,24
 s_mov_b32 s92, 131072
 RV 206,213,13824
 SC 144
 QK 132,224,28
 s_add_u32 m0, s94, 65536
 RV 208,213,9736
 SC 145
 QZ 148,240,28
 RV 210,213,13832
 SC 146
 QK 148,236,24
 buffer_load_dwordx4 v216, s[20:23], s92 offen offset:0 lds
 QK 148,232,20
 s_add_u32 m0, s94, 66432
 EX 157
 QK 148,228,16
 CV 182,156,157
 SC 147
 EX 158
 buffer_load_dwordx4 v216, s[20:23], s92 offen offset:128 lds
 EX 159
 EX 128
 CV 183,158,159
 EX 129
 EX 130
 SM 128,176
 s_waitcnt lgkmcnt(14)
 CV 160,128,129
 PV 32,180,180
 EX 131
 PV 0,180,176
 s_waitcnt lgkmcnt(12)
 CV 161,130,131
 SC 132
 PV 4,184,176
 EX 144
 PV 36,184,180
 s_waitcnt lgkmcnt(10)
 EX 145
 PV 40,188,180
 CV 162,144,145
 SC 133
 PV 8,188,176
 s_waitcnt lgkmcnt(8)
 EX 146
 PV 12,192,176
 EX 147
 PV 44,192,180
 s_waitcnt lgkmcnt(6)
 CV 163,146,147
 SC 134
 PV 48,196,180
 s_waitcnt vmcnt(8)
 RK 32,219,8192
 SC 135
 PV 16,196,176
 s_waitcnt lgkmcnt(5)
 RK 36,219,8704
 SC 148
 PV 20,200,176
 RK 40,219,9216
 SC 149
 PV 52,200,180
 s_waitcnt lgkmcnt(5)
 RK 44,219,9728
 SC 150
 PV 56,204,180
 EX 132
 PV 24,204,176
 s_waitcnt lgkmcnt(4)
 EX 133
 PV 28,208,176
 CV 164,132,133
 SC 151
 PV 60,208,180
 s_waitcnt lgkmcnt(3)
 EX 134
 EX 135
 QZ 140,64,32
 s_waitcnt lgkmcnt(2)
 CV 165,134,135
 v_add_u32 v213, s90, v213
 QK 140,68,36
 s_waitcnt lgkmcnt(1)
 EX 148
 QK 140,72,40
 s_mov_b32 s92, 262144
 EX 149
 s_waitcnt lgkmcnt(0)
 QK 140,76,44
 s_add_u32 m0, s94, 24576
 EX 150
 QZ 156,92,44
 buffer_load_dwordx4 v215, s[12:15], s92 offen offset:0 lds
 QK 156,88,40
 EX 151
 QK 156,84,36
 s_add_u32 m0, s94, 25472
 SC 140
 SC 141
 QK 156,80,32
 buffer_load_dwordx4 v215, s[12:15], s92 offen offset:128 lds
 QZ 128,148,32
 EX 140
 QK 128,152,36
 EX 141
 QK 128,156,40
 s_mov_b32 s92, 196608
 CV 200,140,141
 SC 142
 QK 128,160,44
 s_add_u32 m0, s94, 73728
 SC 143
 SC 156
 QZ 144,176,44
 buffer_load_dwordx4 v216, s[20:23], s92 offen offset:0 lds
 QK 144,172,40
 EX 142
 QK 144,168,36
 s_add_u32 m0, s94, 74624
 EX 143
 QK 144,164,32
 buffer_load_dwordx4 v216, s[20:23], s92 offen offset:128 lds
 QZ 136,212,32
 CV 201,142,143
 SC 157
 QK 136,216,36
 EX 156
 QK 136,220,40
 EX 157
 QK 136,224,44
 CV 202,156,157
 SC 158
 QZ 152,240,44
 SC 159
 SC 128
 QK 152,236,40
 EX 158
 QK 152,232,36
 EX 159
 QK 152,228,32
 CV 203,158,159
 SC 129
 EX 128
 v_mfma_f32_16x16x32_bf16 a[132:135], a[144:147], v[200:203], 0
 EX 129
 PZ 64,96,200
 CV 184,128,129
 SC 130
 PZ 68,100,200
 SC 131
 SC 144
 PZ 72,104,200
 EX 130
 PZ 76,108,200
 EX 131
 PZ 80,112,200
 CV 185,130,131
 SC 145
 PZ 84,116,200
 EX 144
 PZ 88,120,200
 EX 145
 PZ 92,124,200
 CV 186,144,145
 SC 146
 SC 147
 EX 146
 EX 147
 CV 166,148,149
 CV 187,146,147
 CV 167,150,151
 SC 136
 LS 132,144,184
 SC 137
 SC 138
 PV 64,180,184
 s_waitcnt vmcnt(8)
 RK 48,219,12288
 SC 139
 PV 68,184,184
 RK 52,219,12800
 SC 152
 PV 72,188,184
 RK 56,219,13312
 SC 153
 PV 76,192,184
 RK 60,219,13824
 SC 154
 PV 80,196,184
 EX 136
 PV 84,200,184
 EX 137
 PV 88,204,184
 CV 168,136,137
 SC 155
 PV 92,208,184
 s_waitcnt lgkmcnt(3)
 EX 138
 EX 139
 QZ 128,64,48
 s_waitcnt lgkmcnt(2)
 EX 152
 QK 128,68,52
 s_waitcnt lgkmcnt(1)
 EX 153
 QK 128,72,56
 s_waitcnt lgkmcnt(0)
 CV 169,138,139
 CV 170,152,153
 QK 128,76,60
 EX 154
 QZ 144,92,60
 EX 155
 QK 144,88,56
 CV 171,154,155
 QK 144,84,52
 QK 144,80,48
 QZ 132,148,48
 SC 128
 SC 129
 QK 132,152,52
 EX 128
 QK 132,156,56
 EX 129
 QK 132,160,60
 CV 204,128,129
 SC 130
 QZ 148,176,60
 SC 131
 SC 144
 QK 148,172,56
 EX 130
 QK 148,168,52
 s_mov_b32 s92, 327680
 EX 131
 QK 148,164,48
 s_add_u32 m0, s94, 32768
 CV 205,130,131
 SC 145
 QZ 140,212,48
 buffer_load_dwordx4 v215, s[12:15], s92 offen offset:0 lds
 QK 140,216,52
 EX 144
 QK 140,220,56
 s_add_u32 m0, s94, 33664
 EX 145
 QK 140,224,60
 buffer_load_dwordx4 v215, s[12:15], s92 offen offset:128 lds
 QZ 156,240,60
 CV 206,144,145
 SC 146
 QK 156,236,56
 SC 147
 SC 132
 QK 156,232,52
 s_mov_b32 s92, 262144
 EX 146
 QK 156,228,48
 s_add_u32 m0, s94, 81920
 EX 147
 buffer_load_dwordx4 v216, s[20:23], s92 offen offset:0 lds
 CV 207,146,147
 SC 133
 EX 132
 LS 132,136,204
 EX 133
 PZ 96,96,204
 CV 188,132,133
 SC 134
 PZ 100,100,204
 s_add_u32 m0, s94, 82816
 SC 135
 SC 148
 PZ 104,104,204
 buffer_load_dwordx4 v216, s[20:23], s92 offen offset:128 lds
 PZ 108,108,204
 EX 134
 PZ 112,112,204
 s_waitcnt vmcnt(4)
 EX 135
 PZ 116,116,204
 s_cmp_eq_u32 s93, 0
 CV 189,134,135
 SC 149
 PZ 120,120,204
 s_cselect_b32 s88, 0xa000, 0
 EX 148
 PZ 124,124,204
 s_add_u32 s88, s88, s37
 EX 149
 s_mov_b32 s92, 393216
 s_add_u32 m0, s88, 0
 s_barrier
 buffer_load_dwordx4 v215, s[12:15], s92 offen offset:0 lds
 RK 64,212,16384
 RK 68,212,16896
 CV 190,148,149
 SC 150
 SC 151
 EX 150
 EX 151
 RK 72,212,17408
 RK 76,212,17920
 CV 191,150,151
 SC 140
 RK 80,212,20480
 LS 132,136,188
 RK 84,212,20992
 SC 141
 PV 96,180,188
 s_add_u32 m0, s88, 896
 RK 88,212,21504
 SC 142
 PV 100,184,188
 buffer_load_dwordx4 v215, s[12:15], s92 offen offset:128 lds
 PV 104,188,188
 RK 92,212,22016
 SC 143
 PV 108,192,188
 EX 140
 PV 112,196,188
 s_mov_b32 s92, 327680
 EX 141
 PV 116,200,188
 s_add_u32 m0, s88, 49152
 CV 172,140,141
 v_add_u32 v212, s90, v212
 PV 120,204,188
 buffer_load_dwordx4 v216, s[20:23], s92 offen offset:0 lds
 PV 124,208,188
 EX 142
 s_add_u32 m0, s88, 50048
 EX 143
 buffer_load_dwordx4 v216, s[20:23], s92 offen offset:128 lds
 CV 173,142,143
 s_waitcnt lgkmcnt(0)
 s_cmp_eq_u32 s93, 0
 s_cbranch_scc1 L_A
 s_mov_b32 s92, 458752
 s_add_u32 m0, s37, 8192
 s_add_u32 s34, s34, 0x20000
 buffer_load_dwordx4 v215, s[12:15], s92 offen offset:0 lds
 s_add_u32 m0, s37, 9088
 s_sub_u32 s71, s71, 1
 buffer_load_dwordx4 v215, s[12:15], s92 offen offset:128 lds
 s_mov_b32 s92, 393216
 s_add_u32 m0, s37, 57344
 s_sub_u32 s30, s30, 1
 buffer_load_dwordx4 v216, s[20:23], s92 offen offset:0 lds
 s_add_u32 m0, s37, 58240
 s_cmp_lg_u32 s30, 0
 buffer_load_dwordx4 v216, s[20:23], s92 offen offset:128 lds
 v_mov_b64 v[176:177], v[160:161]
 v_mov_b64 v[178:179], v[162:163]
 v_mov_b64 v[180:181], v[164:165]
 v_mov_b64 v[182:183], v[166:167]
 v_mov_b64 v[184:185], v[168:169]
 v_mov_b64 v[186:187], v[170:171]
 v_mov_b64 v[188:189], v[172:173]
 v_mov_b64 v[190:191], v[174:175]
 s_cbranch_scc1 L_B
 s_branch L_tail
L_idle:
 s_endpgm
.p2align 12
L_H0:
 QZ 128,64,0
 s_add_u32 s31, s33, s37
 RV 96,213,8192
 SC 156
 QK 128,68,4
 s_mov_b32 s34, s45
 RV 98,213,12288
 SC 157
 QK 128,72,8
 s_and_b32 s62, s46, 0xfffff800
 RV 100,213,8200
 SC 158
 QK 128,76,12
 s_add_u32 s35, s34, 0x10000
 RV 102,213,12296
 SC 159
 QZ 132,76,28
 s_add_u32 s12, s86, s35
 RV 104,213,8704
 EX 156
 QK 132,72,24
 s_addc_u32 s13, s87, 0
 RV 106,213,12800
 SC 128
 QK 132,68,20
 s_sub_u32 s14, s62, s35
 RV 108,213,8712
 SC 129
 QK 132,64,16
 s_max_i32 s14, s14, 0
 RV 110,213,12808
 SC 130
 QZ 136,64,32
 s_add_u32 m0, s31, 0
 RV 112,213,9216
 SC 131
 QK 136,68,36
 s_add_u32 s20, s60, s34
 RV 114,213,13312
 SC 132
 QK 136,72,40
 s_addc_u32 s21, s61, 0
 RV 116,213,9224
 SC 133
 QK 136,76,44
 s_sub_u32 s22, s62, s34
 RV 118,213,13320
 SC 134
 QZ 140,76,60
 s_max_i32 s22, s22, 0
 RV 120,213,9728
 SC 135
 QK 140,72,56
 s_add_u32 s34, s34, 0x20000
 RV 122,213,13824
 SC 136
 QK 140,68,52
 s_add_u32 s16, s86, s34
 RV 124,213,9736
 SC 137
 QK 140,64,48
 s_addc_u32 s17, s87, 0
 RV 126,213,13832
 SC 138
 QZ 144,80,0
 s_sub_u32 s18, s62, s34
 EX 157
 QK 144,84,4
 s_max_i32 s18, s18, 0
 CV 190,156,157
 SC 139
 QK 144,88,8
 s_cmp_eq_u32 s33, 0x8000
 EX 158
 QK 144,92,12
 s_cselect_b32 s32, -2, 1
 EX 159
 QZ 148,92,28
 s_lshl_b32 s32, s32, 14
 v_add_u32 v212, s32, v212
 v_add_u32 v213, s32, v213
 QK 148,88,24
 s_add_u32 s33, s33, s32
 CV 191,158,159
 SC 140
 QK 148,84,20
 s_cmp_eq_u32 s33, 0x8000
 EX 128
 QK 148,80,16
 s_cselect_b32 s32, -2, 1
 EX 129
 QZ 152,80,32
 s_waitcnt vmcnt(8) lgkmcnt(0)
 CV 160,128,129
 SC 141
 QK 152,84,36
 s_barrier
 QK 152,88,40
 s_lshl_b32 s32, s32, 14
 buffer_load_dwordx4 v215, s[12:15], 0 offen offset:0 lds
 SC 142
 QK 152,92,44
 s_add_u32 m0, s31, 896
 RK 148,212,0
 SC 143
 QZ 156,92,60
 s_add_u32 s35, s34, 0x10000
 RK 152,212,512
 SC 144
 QK 156,88,56
 s_lshl_b32 s76, s76, 1
 RK 156,212,1024
 SC 145
 QK 156,84,52
 s_mov_b64 s[40:41], s[44:45]
 RK 160,212,1536
 SC 146
 QK 156,80,48
 s_mov_b64 s[42:43], s[46:47]
 buffer_load_dwordx4 v215, s[12:15], 0 offen offset:128 lds
 SC 147
 SM 128,176
 s_add_u32 m0, s31, 49152
 RK 164,212,4096
 SC 148
 SM 132,184
 s_add_u32 s12, s86, s35
 RK 168,212,4608
 SC 149
 EX 130
 EX 131
 PS 152
 PS 154
 PS 156
 PS 158
 PV 96,96,188
 s_addc_u32 s13, s87, 0
 buffer_load_dwordx4 v216, s[20:23], 0 offen offset:0 lds
 CV 161,130,131
 PV 64,96,184
 s_add_u32 m0, s31, 50048
 RK 172,212,5120
 SC 150
 PV 32,96,180
 s_sub_u32 s14, s62, s35
 RK 176,212,5632
 SC 151
 PV 0,96,176
 s_max_i32 s14, s14, 0
 RV 180,213,0
 EX 132
 PV 4,100,176
 s_mov_b64 s[44:45], s[48:49]
 RV 182,213,4096
 EX 133
 PV 36,100,180
 s_mov_b64 s[46:47], s[50:51]
 buffer_load_dwordx4 v216, s[20:23], 0 offen offset:128 lds
 CV 164,132,133
 PV 68,100,184
 s_add_u32 m0, s31, 57344
 RV 184,213,8
 EX 134
 PV 100,100,188
 s_mov_b64 s[48:49], s[52:53]
 RV 186,213,4104
 EX 135
 PV 104,104,188
 s_mov_b64 s[50:51], s[54:55]
 RV 188,213,512
 CV 165,134,135
 PV 72,104,184
 s_mov_b64 s[52:53], s[56:57]
 buffer_load_dwordx4 v214, s[20:23], 0 offen offset:0 lds
 EX 136
 PV 40,104,180
 s_add_u32 m0, s31, 58240
 RV 190,213,4608
 EX 137
 PV 8,104,176
 s_mov_b64 s[54:55], s[58:59]
 RV 192,213,520
 CV 168,136,137
 PV 12,108,176
 s_and_b32 s26, s43, 0xfffff000
 RV 194,213,4616
 EX 138
 PV 44,108,180
 s_and_b32 s30, s43, 0x3f
 buffer_load_dwordx4 v214, s[20:23], 0 offen offset:128 lds
 EX 139
 PV 76,108,184
 s_add_u32 m0, s31, 8192
 RV 196,213,1024
 CV 169,138,139
 PV 108,108,188
 s_add_u32 s20, s60, s34
 RV 198,213,5120
 EX 140
 PV 112,112,188
 s_addc_u32 s21, s61, 0
 RV 200,213,1032
 EX 141
 PV 80,112,184
 s_sub_u32 s22, s62, s34
 buffer_load_dwordx4 v215, s[16:19], 0 offen offset:0 lds
 CV 172,140,141
 PV 48,112,180
 s_add_u32 m0, s31, 9088
 RV 202,213,5128
 EX 142
 PV 16,112,176
 s_add_u32 s31, s33, s37
 RV 204,213,1536
 EX 143
 PV 20,116,176
 s_max_i32 s22, s22, 0
 RV 206,213,5632
 CV 173,142,143
 PV 52,116,180
 s_add_u32 s34, s34, 0x20000
 buffer_load_dwordx4 v215, s[16:19], 0 offen offset:128 lds
 EX 144
 PV 84,116,184
 s_add_u32 m0, s31, 0
 RV 208,213,1544
 EX 145
 PV 116,116,188
 s_add_u32 s16, s86, s34
 RV 210,213,5640
 CV 162,144,145
 PV 120,120,188
 s_addc_u32 s17, s87, 0
 RK 212,212,8192
 EX 146
 PV 88,120,184
 s_sub_u32 s18, s62, s34
 RK 216,212,8704
 EX 147
 PV 56,120,180
 s_max_i32 s18, s18, 0
 RK 220,212,9216
 CV 163,146,147
 PV 24,120,176
 s_add_u32 s33, s33, s32
 RK 224,212,9728
 EX 148
 PV 28,124,176
 s_bfe_u32 s83, s42, 0x20006
 RK 228,212,12288
 EX 149
 PV 60,124,180
 s_and_b32 s89, s47, 0x100
 RK 232,212,12800
 CV 166,148,149
 PV 92,124,184
 s_cselect_b32 s89, 0x10000, 0
 RK 236,212,13312
 EX 150
 PV 124,124,188
 s_add_u32 s72, s45, s89
 RK 240,212,13824
 v_add_u32 v212, s32, v212
 s_waitcnt lgkmcnt(15)
 QZ 128,148,0
 s_waitcnt lgkmcnt(15)
 RV 96,213,8192
 EX 151
 QK 128,152,4
 s_waitcnt lgkmcnt(15)
 RV 98,213,12288
 CV 167,150,151
 QK 128,156,8
 s_waitcnt lgkmcnt(15)
 RV 100,213,8200
 EX 152
 QK 128,160,12
 RV 102,213,12296
 EX 153
 QZ 132,160,28
 RV 104,213,8704
 CV 170,152,153
 QK 132,156,24
 RV 106,213,12800
 EX 154
 QK 132,152,20
 RV 108,213,8712
 SC 128
 QK 132,148,16
 RV 110,213,12808
 SC 129
 QZ 136,148,32
 RV 112,213,9216
 SC 130
 QK 136,152,36
 RV 114,213,13312
 SC 131
 QK 136,156,40
 RV 116,213,9224
 SC 132
 QK 136,160,44
 RV 118,213,13320
 SC 133
 QZ 140,160,60
 RV 120,213,9728
 SC 134
 QK 140,156,56
 RV 122,213,13824
 SC 135
 QK 140,152,52
 RV 124,213,9736
 SC 136
 QK 140,148,48
 s_waitcnt lgkmcnt(15)
 RV 126,213,13832
 v_add_u32 v213, s32, v213
 QZ 144,164,0
 s_cmp_eq_u32 s33, 0x8000
 EX 155
 s_waitcnt lgkmcnt(15)
 QK 144,168,4
 s_cselect_b32 s32, -2, 1
 CV 171,154,155
 SC 137
 s_waitcnt lgkmcnt(15)
 QK 144,172,8
 s_lshl_b32 s32, s32, 14
 EX 156
 s_waitcnt lgkmcnt(15)
 QK 144,176,12
 s_add_u32 s82, s82, s32
 EX 157
 QZ 148,176,28
 CV 174,156,157
 SC 138
 QK 148,172,24
 EX 158
 QK 148,168,20
 EX 159
 QK 148,164,16
 s_waitcnt vmcnt(8) lgkmcnt(0)
 CV 175,158,159
 SC 139
 QZ 152,164,32
 s_barrier
 QK 152,168,36
 RK 148,212,0
 SC 140
 QK 152,172,40
 RK 152,212,512
 SC 141
 QK 152,176,44
 RK 156,212,1024
 SC 142
 QZ 156,176,60
 RK 160,212,1536
 SC 143
 QK 156,172,56
 RK 172,212,5120
 SC 144
 QK 156,168,52
 RK 168,212,4608
 SC 145
 QK 156,164,48
 RK 164,212,4096
 SC 146
 SM 128,160
 RK 176,212,5632
 SC 147
 SM 132,168
 buffer_load_dwordx4 v215, s[12:15], 0 offen offset:0 lds
 PV 96,180,172
 s_add_u32 m0, s31, 896
 EX 128
 EX 129
 EX 130
 PS 152
 PS 154
 PS 156
 PS 158
 PV 64,180,168
 CV 176,128,129
 SC 148
 PV 32,180,164
 buffer_load_dwordx4 v215, s[12:15], 0 offen offset:128 lds
 SC 149
 PV 0,180,160
 s_add_u32 m0, s31, 49152
 RV 180,213,0
 SC 150
 PV 4,184,160
 RV 182,213,4096
 SC 151
 PV 36,184,164
 EX 131
 PV 68,184,168
 EX 132
 PV 100,184,172
 RV 184,213,8
 CV 177,130,131
 PV 104,188,172
 RV 186,213,4104
 EX 133
 PV 72,188,168
 buffer_load_dwordx4 v216, s[20:23], 0 offen offset:0 lds
 CV 180,132,133
 PV 40,188,164
 s_add_u32 m0, s31, 50048
 EX 134
 PV 8,188,160
 RV 188,213,512
 EX 135
 PV 12,192,160
 RV 190,213,4608
 CV 181,134,135
 PV 44,192,164
 EX 136
 PV 76,192,168
 buffer_load_dwordx4 v216, s[20:23], 0 offen offset:128 lds
 EX 137
 PV 108,192,172
 s_add_u32 m0, s31, 57344
 RV 192,213,520
 CV 184,136,137
 PV 112,196,172
 RV 194,213,4616
 EX 138
 PV 80,196,168
 EX 139
 PV 48,196,164
 buffer_load_dwordx4 v214, s[20:23], 0 offen offset:0 lds
 CV 185,138,139
 PV 16,196,160
 s_add_u32 m0, s31, 58240
 RV 196,213,1024
 EX 140
 PV 20,200,160
 RV 198,213,5120
 EX 141
 PV 52,200,164
 EX 142
 PV 84,200,168
 buffer_load_dwordx4 v214, s[20:23], 0 offen offset:128 lds
 CV 188,140,141
 PV 116,200,172
 s_add_u32 m0, s31, 8192
 RV 200,213,1032
 EX 143
 PV 120,204,172
 RV 202,213,5128
 CV 189,142,143
 PV 88,204,168
 EX 144
 PV 56,204,164
 EX 145
 PV 24,204,160
 RV 204,213,1536
 CV 178,144,145
 PV 28,208,160
 RV 206,213,5632
 EX 146
 PV 60,208,164
 buffer_load_dwordx4 v215, s[16:19], 0 offen offset:0 lds
 EX 147
 PV 92,208,168
 s_add_u32 m0, s31, 9088
 EX 148
 PV 124,208,172
 s_add_u32 s31, s33, s37
 RV 208,213,1544
 CV 179,146,147
 QZ 128,212,0
 s_add_u32 s33, s33, s32
 RV 210,213,5640
 EX 149
 QK 128,216,4
 buffer_load_dwordx4 v215, s[16:19], 0 offen offset:128 lds
 CV 182,148,149
 QK 128,220,8
 EX 150
 QK 128,224,12
 EX 151
 QZ 132,224,28
 EX 152
 QK 132,220,24
 EX 153
 QK 132,216,20
 CV 183,150,151
 CV 186,152,153
 QK 132,212,16
 EX 154
 QZ 136,212,32
 EX 155
 QK 136,216,36
 CV 187,154,155
 SC 128
 QK 136,220,40
 EX 156
 QK 136,224,44
 EX 157
 QZ 140,224,60
 RK 224,212,9728
 CV 190,156,157
 QK 140,220,56
 RK 220,212,9216
 SC 129
 QK 140,216,52
 RK 216,212,8704
 SC 130
 QK 140,212,48
 RK 212,212,8192
 SC 131
 QZ 144,228,0
 EX 158
 QK 144,232,4
 EX 159
 QK 144,236,8
 CV 191,158,159
 SC 132
 QK 144,240,12
 EX 128
 QZ 148,240,28
 EX 129
 QK 148,236,24
 CV 160,128,129
 SC 133
 QK 148,232,20
 EX 130
 QK 148,228,16
 EX 131
 QZ 152,228,32
 CV 161,130,131
 SC 134
 QK 152,232,36
 EX 132
 QK 152,236,40
 EX 133
 QK 152,240,44
 CV 164,132,133
 SC 135
 QZ 156,240,60
 RK 240,212,13824
 SC 144
 QK 156,236,56
 RK 236,212,13312
 SC 145
 QK 156,232,52
 RK 232,212,12800
 SC 146
 QK 156,228,48
 RK 228,212,12288
 SC 147
 SM 128,176
 SC 148
 SM 132,184
 SC 149
 PV 96,96,188
 EX 134
 EX 135
 EX 144
 PS 152
 PS 154
 PS 156
 PS 158
 PV 64,96,184
 CV 165,134,135
 SC 150
 PV 32,96,180
 EX 145
 PV 0,96,176
 RV 96,213,8192
 CV 162,144,145
 PV 4,100,176
 RV 98,213,12288
 SC 151
 PV 36,100,180
 EX 146
 PV 68,100,184
 EX 147
 PV 100,100,188
 RV 100,213,8200
 CV 163,146,147
 PV 104,104,188
 RV 102,213,12296
 SC 136
 PV 72,104,184
 EX 148
 PV 40,104,180
 EX 149
 PV 8,104,176
 RV 104,213,8704
 CV 166,148,149
 PV 12,108,176
 RV 106,213,12800
 SC 137
 PV 44,108,180
 EX 150
 PV 76,108,184
 EX 151
 PV 108,108,188
 RV 108,213,8712
 CV 167,150,151
 PV 112,112,188
 RV 110,213,12808
 SC 138
 PV 80,112,184
 EX 136
 PV 48,112,180
 EX 137
 PV 16,112,176
 RV 112,213,9216
 CV 168,136,137
 PV 20,116,176
 RV 114,213,13312
 SC 139
 PV 52,116,180
 EX 138
 PV 84,116,184
 EX 139
 PV 116,116,188
 RV 116,213,9224
 CV 169,138,139
 PV 120,120,188
 RV 118,213,13320
 SC 140
 PV 88,120,184
 SC 141
 SC 142
 PV 56,120,180
 EX 140
 PV 24,120,176
 RV 120,213,9728
 SC 143
 PV 28,124,176
 RV 122,213,13824
 v_add_u32 v212, s82, v212
 PV 60,124,180
 EX 141
 PV 92,124,184
 EX 142
 PV 124,124,188
 s_waitcnt lgkmcnt(15)
 RV 124,213,9736
 CV 172,140,141
 QZ 128,148,0
 s_waitcnt lgkmcnt(15)
 RV 126,213,13832
 v_add_u32 v213, s32, v213
 QK 128,152,4
 s_waitcnt lgkmcnt(15)
 EX 143
 QK 128,156,8
 s_waitcnt lgkmcnt(15)
 EX 152
 QK 128,160,12
 EX 153
 QZ 132,160,28
 CV 173,142,143
 CV 170,152,153
 QK 132,156,24
 EX 154
 QK 132,152,20
 EX 155
 QK 132,148,16
 s_waitcnt lgkmcnt(15)
 CV 171,154,155
 SC 128
 QZ 144,164,0
 s_waitcnt vmcnt(8) lgkmcnt(0)
 RK 0,219,0
 SC 129
 QK 144,168,4
 s_barrier
 QK 144,172,8
 RK 4,219,512
 SC 130
 QK 144,176,12
 RK 8,219,1024
 SC 131
 QZ 148,176,28
 RK 12,219,1536
 SC 132
 QK 148,172,24
 RK 28,219,5632
 SC 133
 QK 148,168,20
 RK 24,219,5120
 SC 144
 QK 148,164,16
 RK 20,219,4608
 SC 145
 SM 128,160
 RK 16,219,4096
 SC 146
 PV 32,180,164
 RK 64,212,0
 SC 147
 EX 156
 EX 157
 PS 148
 PS 150
 PV 0,180,160
 RK 68,212,512
 CV 174,156,157
 PV 4,184,160
 RK 72,212,1024
 SC 134
 PV 36,184,164
 RK 76,212,1536
 SC 135
 PV 40,188,164
 RK 80,212,4096
 EX 158
 PV 8,188,160
 RK 84,212,4608
 EX 159
 PV 12,192,160
 RK 88,212,5120
 CV 175,158,159
 PV 44,192,164
 EX 128
 PV 48,196,164
 EX 129
 PV 16,196,160
 RK 92,212,5632
 CV 176,128,129
 PV 20,200,160
 EX 130
 PV 52,200,164
 EX 131
 PV 56,204,164
 EX 144
 PV 24,204,160
 EX 145
 PV 28,208,160
 CV 177,130,131
 CV 178,144,145
 PV 60,208,164
 EX 146
 QZ 136,148,32
 EX 147
 QK 136,152,36
 s_waitcnt lgkmcnt(0)
 EX 132
 QK 136,156,40
 EX 133
 QK 136,160,44
 CV 179,146,147
 CV 180,132,133
 QZ 140,160,60
 EX 134
 QK 140,156,56
 EX 135
 QK 140,152,52
 EX 148
 QK 140,148,48
 CV 181,134,135
 SC 136
 QZ 152,164,32
 RK 32,219,8192
 SC 137
 QK 152,168,36
 RK 36,219,8704
 SC 138
 QK 152,172,40
 RK 40,219,9216
 SC 139
 QK 152,176,44
 RK 44,219,9728
 SC 140
 QZ 156,176,60
 RK 60,219,13824
 SC 141
 QK 156,172,56
 RK 56,219,13312
 SC 142
 QK 156,168,52
 RK 52,219,12800
 SC 152
 QK 156,164,48
 RK 48,219,12288
 SC 153
 LS 128,144,176
 EX 149
 PV 0,96,176
 CV 182,148,149
 SC 154
 PV 4,100,176
 EX 150
 EX 151
 EX 136
 PS 156
 PS 158
 v_accvgpr_read_b32 v225, a128
 v_accvgpr_read_b32 v224, a129
 v_add_f32 v225, v224, v225
 CV 0,0,1
 CV 1,2,3
 CV 2,4,5
 CV 3,6,7
 PV 8,104,176
 buffer_store_dword v225, v234, s[4:7], s38 offen offset:0 sc1
 PV 12,108,176
 CV 183,150,151
 SC 155
 PV 16,112,176
 EX 137
 PV 20,116,176
 CV 184,136,137
 CV 8,8,9
 CV 9,10,11
 CV 10,12,13
 CV 11,14,15
 PV 24,120,176
 buffer_store_dwordx4 v[0:3], v232, s[4:7], s38 offen offset:0 sc1
 CV 16,16,17
 CV 17,18,19
 CV 18,20,21
 CV 19,22,23
 PV 28,124,176
 EX 138
 LS 128,136,180
 CV 24,24,25
 CV 25,26,27
 PV 32,96,180
 buffer_store_dwordx4 v[8:11], v232, s[4:7], s38 offen offset:128 sc1
 PV 36,100,180
 EX 139
 CV 26,28,29
 CV 27,30,31
 v_accvgpr_read_b32 v227, a130
 v_accvgpr_read_b32 v226, a131
 v_add_f32 v227, v226, v227
 CV 32,32,33
 CV 33,34,35
 CV 34,36,37
 CV 35,38,39
 PV 40,104,180
 buffer_store_dwordx4 v[16:19], v233, s[4:7], s38 offen offset:0 sc1
 PV 44,108,180
 CV 185,138,139
 SC 143
 PV 48,112,180
 EX 152
 PV 52,116,180
 EX 153
 CV 40,40,41
 CV 41,42,43
 CV 42,44,45
 CV 43,46,47
 PV 56,120,180
 buffer_store_dwordx4 v[24:27], v233, s[4:7], s38 offen offset:128 sc1
 PV 60,124,180
 CV 186,152,153
 CV 48,48,49
 LS 132,144,168
 EX 154
 PV 64,180,168
 EX 155
 PV 68,184,168
 buffer_store_dword v227, v234, s[4:7], s38 offen offset:64 sc1
 PV 72,188,168
 CV 187,154,155
 CV 49,50,51
 PV 76,192,168
 CV 50,52,53
 CV 51,54,55
 PV 80,196,168
 EX 140
 PV 84,200,168
 buffer_store_dwordx4 v[32:35], v232, s[4:7], s38 offen offset:256 sc1
 PV 88,204,168
 EX 141
 PV 92,208,168
 CV 56,56,57
 CV 57,58,59
 QZ 128,212,0
 CV 58,60,61
 CV 59,62,63
 QK 128,216,4
 buffer_store_dwordx4 v[40:43], v232, s[4:7], s38 offen offset:384 sc1
 QK 128,220,8
 EX 142
 QK 128,224,12
 EX 143
 QZ 132,224,28
 CV 188,140,141
 CV 189,142,143
 QK 132,220,24
 buffer_store_dwordx4 v[48:51], v233, s[4:7], s38 offen offset:256 sc1
 QK 132,216,20
 EX 156
 QK 132,212,16
 EX 157
 QZ 144,228,0
 CV 190,156,157
 SC 128
 QK 144,232,4
 buffer_store_dwordx4 v[56:59], v233, s[4:7], s38 offen offset:384 sc1
 QK 144,236,8
 s_mov_b32 s38, s80
 EX 158
 QK 144,240,12
 EX 159
 QZ 148,240,28
 CV 191,158,159
 SC 129
 QK 148,236,24
 EX 128
 QK 148,232,20
 EX 129
 QK 148,228,16
 CV 192,128,129
 SC 130
 LS 132,144,184
 SC 131
 SC 132
 PV 64,96,184
 EX 130
 PV 68,100,184
 EX 131
 SC 133
 CV 193,130,131
 v_accvgpr_read_b32 v229, a132
 PS 148
 PS 150
 v_accvgpr_read_b32 v228, a133
 v_add_f32 v229, v228, v229
 CV 64,64,65
 CV 65,66,67
 CV 66,68,69
 CV 67,70,71
 PV 72,104,184
 buffer_store_dword v229, v234, s[4:7], s39 offen offset:0 sc1
 PV 76,108,184
 EX 132
 PV 80,112,184
 EX 133
 PV 84,116,184
 CV 196,132,133
 SC 134
 CV 72,72,73
 CV 73,74,75
 CV 74,76,77
 CV 75,78,79
 CV 80,80,81
 CV 81,82,83
 CV 82,84,85
 CV 83,86,87
 PV 88,120,184
 buffer_store_dwordx4 v[64:67], v232, s[4:7], s39 offen offset:0 sc1
 PV 92,124,184
 SC 135
 SC 144
 LS 132,136,172
 EX 134
 PV 96,180,172
 EX 135
 CV 88,88,89
 CV 89,90,91
 CV 90,92,93
 CV 91,94,95
 PV 100,184,172
 buffer_store_dwordx4 v[72:75], v232, s[4:7], s39 offen offset:128 sc1
 PV 104,188,172
 CV 197,134,135
 SC 145
 PV 108,192,172
 EX 144
 PV 112,196,172
 EX 145
 PV 116,200,172
 buffer_store_dwordx4 v[80:83], v233, s[4:7], s39 offen offset:0 sc1
 PV 120,204,172
 CV 194,144,145
 SC 146
 PV 124,208,172
 EX 146
 LS 132,136,188
 EX 148
 PV 96,96,188
 buffer_store_dwordx4 v[88:91], v233, s[4:7], s39 offen offset:128 sc1
 PV 100,100,188
 EX 149
 PV 104,104,188
 SC 147
 CV 198,148,149
 v_accvgpr_read_b32 v231, a134
 v_accvgpr_read_b32 v230, a135
 v_add_f32 v231, v230, v231
 CV 96,96,97
 CV 97,98,99
 CV 98,100,101
 CV 99,102,103
 CV 104,104,105
 CV 105,106,107
 PV 108,108,188
 buffer_store_dword v231, v234, s[4:7], s39 offen offset:64 sc1
 PV 112,112,188
 EX 147
 PV 116,116,188
 EX 150
 PV 120,120,188
 EX 151
 PV 124,124,188
 s_waitcnt lgkmcnt(7)
 buffer_store_dwordx4 v[96:99], v232, s[4:7], s39 offen offset:256 sc1
 CV 106,108,109
 CV 107,110,111
 QZ 136,212,32
 s_waitcnt lgkmcnt(6)
 CV 112,112,113
 CV 113,114,115
 QK 136,216,36
 s_waitcnt lgkmcnt(5)
 CV 114,116,117
 CV 115,118,119
 QK 136,220,40
 s_waitcnt lgkmcnt(4)
 buffer_store_dwordx4 v[104:107], v232, s[4:7], s39 offen offset:384 sc1
 QK 136,224,44
 s_waitcnt lgkmcnt(3)
 CV 120,120,121
 CV 121,122,123
 QZ 140,224,60
 s_waitcnt lgkmcnt(2)
 CV 122,124,125
 CV 123,126,127
 QK 140,220,56
 s_waitcnt lgkmcnt(1)
 CV 195,146,147
 CV 199,150,151
 QK 140,216,52
 s_waitcnt lgkmcnt(0)
 buffer_store_dwordx4 v[112:115], v233, s[4:7], s39 offen offset:256 sc1
 QK 140,212,48
 SC 136
 SC 137
 QZ 152,228,32
 EX 136
 QK 152,232,36
 EX 137
 QK 152,236,40
 buffer_store_dwordx4 v[120:123], v233, s[4:7], s39 offen offset:384 sc1
 QK 152,240,44
 s_mov_b32 s39, s81
 CV 200,136,137
 SC 138
 QZ 156,240,60
 SC 139
 SC 140
 QK 156,236,56
 EX 138
 EX 139
 SC 141
 PS 152
 PS 154
 QK 156,232,52
 CV 201,138,139
 SC 142
 QK 156,228,48
 EX 140
 EX 141
 SC 143
 CV 204,140,141
 EX 142
 EX 143
 EX 152
 CV 205,142,143
 EX 153
 EX 154
 CV 202,152,153
 EX 155
 s_nop 0
 CV 203,154,155
 s_cmp_eq_u32 s79, 0
 s_cbranch_scc1 L_Fe
 s_cmp_eq_u32 s79, 1
 s_cbranch_scc1 L_Fo
 s_branch L_init
.p2align 12
.fill 720, 4, 0xbf800000
L_w0:
 QZ 136,64,32
 s_cmp_eq_u32 s33, 0x8000
 RV 96,213,8192
 v_add_u32 v251, L_w0-L_pc-0, v244
 QK 136,68,36
 s_cselect_b32 s32, -2, 1
 RV 98,213,12288
 SC 156
 QK 136,72,40
 s_lshl_b32 s32, s32, 14
 RV 100,213,8200
 v_add_u32 v212, s32, v212
 QK 136,76,44
 s_add_u32 s31, s33, s37
 RV 102,213,12296
 SC 157
 QZ 140,76,60
 s_add_u32 s33, s33, s32
 RV 104,213,8704
 SC 158
 QK 140,72,56
 s_add_u32 s31, s33, s37
 RV 106,213,12800
 SC 159
 QK 140,68,52
 RV 108,213,8712
 v_and_b32 v178, v253, v178
 QK 140,64,48
 RV 110,213,12808
 v_and_b32 v179, v254, v179
 QZ 152,80,32
 RV 112,213,9216
 v_and_b32 v182, v253, v182
 QK 152,84,36
 RV 114,213,13312
 v_and_b32 v183, v254, v183
 QK 152,88,40
 RV 116,213,9224
 SC 136
 QK 152,92,44
 RV 118,213,13320
 SC 137
 RV 120,213,9728
 RV 122,213,13824
 global_load_dword v255, v251, s[64:65]
 EX 156
 RV 124,213,9736
 RV 126,213,13832
 v_add_u32 v213, s32, v213
 EX 157
 s_waitcnt vmcnt(9)
 RK 64,223,0
 CV 190,156,157
 RK 68,223,1024
 EX 158
 EX 159
 RK 72,223,2048
 RK 76,223,3072
 CV 191,158,159
 QZ 156,92,60
 s_cmp_eq_u32 s33, 0x8000
 RK 92,223,7168
 SC 138
 QK 156,88,56
 s_cselect_b32 s32, -2, 1
 RK 88,223,6144
 SC 139
 QK 156,84,52
 s_lshl_b32 s32, s32, 14
 RK 84,223,5120
 SC 140
 QK 156,80,48
 s_add_u32 s33, s33, s32
 RK 80,223,4096
 SC 141
 EX 136
 s_waitcnt lgkmcnt(7)
 QK 0,246,64
 EX 137
 QK 4,244,64
 s_waitcnt lgkmcnt(6)
 RK 64,223,8192
 CV 168,136,137
 QK 12,244,68
 EX 138
 QK 8,246,68
 s_waitcnt lgkmcnt(6)
 RK 68,223,9216
 SC 142
 QK 16,246,72
 EX 139
 QK 20,244,72
 s_barrier
 s_waitcnt lgkmcnt(6)
 QK 28,244,76
 RK 148,212,0
 CV 169,138,139
 QK 24,246,76
 s_waitcnt lgkmcnt(3)
 RK 152,212,512
 SC 143
 QK 32,246,80
 RK 156,212,1024
 SC 152
 QK 36,244,80
 RK 160,212,1536
 SC 153
 QK 44,244,84
 RK 164,212,4096
 SC 154
 QK 40,246,84
 RK 168,212,4608
 SC 155
 QK 48,246,88
 RK 172,212,5120
 SC 156
 QK 52,244,88
 RK 176,212,5632
 SC 157
 QK 60,244,92
 RV 180,213,0
 SC 158
 QK 56,246,92
 RV 182,213,4096
 SC 159
 LS 128,144,176
 RV 184,213,8
 RV 186,213,4104
 PV 0,96,176
 RV 188,213,512
 EX 140
 PV 4,100,176
 RV 190,213,4608
 EX 141
 v_accvgpr_read_b32 v225, a128
 v_accvgpr_read_b32 v224, a129
 v_add_f32 v225, v224, v225
 v_add_f32 v225, v236, v225
 v_rcp_f32 v224, v225
 v_subrev_u32 v225, 0x21800000, v225
 PM 0,224,0
 PM 2,224,0
 PM 4,224,0
 PM 6,224,0
 PV 8,104,176
 RV 192,213,520
 CV 172,140,141
 PV 12,108,176
 RV 194,213,4616
 CV 0,0,1
 PV 16,112,176
 RV 196,213,1024
 CV 1,2,3
 EX 142
 EX 143
 PM 8,224,0
 PM 10,224,0
 PM 12,224,0
 PM 14,224,0
 PV 20,116,176
 RV 198,213,5120
 CV 173,142,143
 PV 24,120,176
 RV 200,213,1032
 CV 2,4,5
 PV 28,124,176
 RV 202,213,5128
 CV 3,6,7
 LS 128,136,180
 RV 204,213,1536
 CV 8,8,9
 PV 32,96,180
 RV 206,213,5632
 CV 9,10,11
 PV 36,100,180
 RV 208,213,1544
 CV 10,12,13
 v_accvgpr_read_b32 v227, a130
 v_accvgpr_read_b32 v226, a131
 v_add_f32 v227, v226, v227
 v_add_f32 v227, v237, v227
 v_rcp_f32 v226, v227
 v_subrev_u32 v227, 0x21800000, v227
 PV 40,104,180
 RV 210,213,5640
 CV 11,14,15
 PV 44,108,180
 RK 212,212,8192
 XE 4,8,0
 PV 48,112,180
 RK 216,212,8704
 XE 5,9,1
 PV 52,116,180
 RK 220,212,9216
 XE 6,10,2
 PV 56,120,180
 RK 224,212,9728
 XE 7,11,3
 PV 60,124,180
 s_not_b64 vcc, vcc
 RK 228,212,12288
 XO 8,0,8
 SM 132,184
 RK 232,212,12800
 XO 9,1,9
 PV 96,96,188
 RK 236,212,13312
 XO 10,2,10
 PV 64,96,184
 RK 240,212,13824
 XO 11,3,11
 PV 68,100,184
 RV 96,213,8192
 v_add_u32 v212, s32, v212
 PV 100,100,188
 RV 98,213,12288
 RV 100,213,8200
 PV 104,104,188
 RV 102,213,12296
 EX 152
 PV 72,104,184
 RV 104,213,8704
 EX 153
 PV 76,108,184
 RV 106,213,12800
 CV 170,152,153
 PV 108,108,188
 RV 108,213,8712
 EX 154
 PV 112,112,188
 RV 110,213,12808
 RK 72,223,10240
 PV 80,112,184
 buffer_store_dwordx4 v[4:7], v220, s[24:27], s38 offen offset:0 nt
 EX 155
 PM 16,224,0
 PM 18,224,0
 PM 20,224,0
 PM 22,224,0
 PM 24,224,0
 PM 26,224,0
 PM 28,224,0
 PM 30,224,0
 PV 84,116,184
 RV 112,213,9216
 CV 171,154,155
 PV 116,116,188
 RV 114,213,13312
 CV 16,16,17
 PV 120,120,188
 RV 116,213,9224
 CV 17,18,19
 PV 88,120,184
 RV 118,213,13320
 CV 18,20,21
 PV 92,124,184
 RV 120,213,9728
 CV 19,22,23
 PV 124,124,188
 s_waitcnt lgkmcnt(15)
 RV 122,213,13824
 CV 24,24,25
 QZ 136,148,32
 s_waitcnt lgkmcnt(15)
 RV 124,213,9736
 CV 25,26,27
 QK 136,152,36
 s_waitcnt lgkmcnt(15)
 RV 126,213,13832
 CV 26,28,29
 QK 136,156,40
 s_waitcnt lgkmcnt(15)
 RK 76,223,11264
 CV 27,30,31
 QK 136,160,44
 RK 80,223,12288
 XO 28,16,24
 QZ 140,160,60
 RK 84,223,13312
 XO 29,17,25
 QK 140,156,56
 RK 88,223,14336
 XO 30,18,26
 QK 140,152,52
 RK 92,223,15360
 SC 136
 QK 140,148,48
 s_waitcnt lgkmcnt(15)
 buffer_store_dwordx4 v[8:11], v221, s[24:27], s38 offen offset:0 nt
 QZ 152,164,32
 s_waitcnt lgkmcnt(15)
 EX 156
 QK 152,168,36
 s_waitcnt vmcnt(3) lgkmcnt(5)
 EX 157
 QK 152,172,40
 s_barrier
 QK 152,176,44
 RK 148,212,0
 CV 174,156,157
 EX 158
 EX 159
 SC 137
 CV 175,158,159
 QZ 156,176,60
 RK 152,212,512
 SC 138
 QK 156,172,56
 RK 156,212,1024
 SC 139
 QK 156,168,52
 RK 160,212,1536
 XO 31,19,27
 QK 156,164,48
 s_not_b64 vcc, vcc
 buffer_store_dwordx4 v[28:31], v221, s[24:27], s38 offen offset:128 nt
 EX 136
 PM 32,226,0
 PM 34,226,0
 PM 36,226,0
 PM 38,226,0
 PM 40,226,0
 PM 42,226,0
 PM 44,226,0
 PM 46,226,0
 PS 156
 PS 158
 QK 64,246,64
 EX 137
 QK 68,244,64
 CV 184,136,137
 SC 140
 QK 76,244,68
 EX 138
 QK 72,246,68
 EX 139
 QK 80,246,72
 CV 185,138,139
 SC 141
 QK 84,244,72
 s_waitcnt lgkmcnt(8)
 EX 140
 QK 92,244,76
 EX 141
 QK 88,246,76
 s_waitcnt lgkmcnt(7)
 CV 188,140,141
 SC 142
 QK 96,246,80
 SC 143
 XE 16,24,16
 QK 100,244,80
 s_waitcnt lgkmcnt(6)
 EX 142
 QK 108,244,84
 EX 143
 QK 104,246,84
 s_waitcnt lgkmcnt(5)
 CV 189,142,143
 XE 17,25,17
 QK 112,246,88
 XE 18,26,18
 XE 19,27,19
 QK 116,244,88
 s_waitcnt lgkmcnt(4)
 buffer_store_dwordx4 v[16:19], v220, s[24:27], s38 offen offset:128 nt
 QK 124,244,92
 SC 152
 SC 153
 QK 120,246,92
 EX 152
 SM 132,168
 SC 154
 PV 96,180,172
 EX 153
 PV 64,180,168
 CV 186,152,153
 SC 155
 PV 68,184,168
 EX 154
 PV 100,184,172
 EX 155
 PV 104,188,172
 CV 187,154,155
 CV 32,32,33
 PV 72,188,168
 EX 156
 PV 76,192,168
 EX 157
 PV 108,192,172
 CV 190,156,157
 CV 33,34,35
 PV 112,196,172
 EX 158
 PV 80,196,168
 EX 159
 PV 84,200,168
 CV 191,158,159
 CV 34,36,37
 PV 116,200,172
 CV 35,38,39
 CV 40,40,41
 PV 120,204,172
 CV 41,42,43
 CV 42,44,45
 PV 88,204,168
 CV 43,46,47
 XE 36,40,32
 PV 92,208,168
 XE 37,41,33
 XE 38,42,34
 PV 124,208,172
 XE 39,43,35
 v_add_u32 v213, s32, v213
 QZ 136,212,32
 s_not_b64 vcc, vcc
 buffer_store_dwordx4 v[36:39], v220, s[24:27], s38 offen offset:256 nt
 XO 40,32,40
 PM 48,226,0
 PM 50,226,0
 PM 52,226,0
 PM 54,226,0
 PM 56,226,0
 PM 58,226,0
 PM 60,226,0
 PM 62,226,0
 QK 136,216,36
 RV 180,213,0
 XO 41,33,41
 QK 136,220,40
 RV 182,213,4096
 XO 42,34,42
 QK 136,224,44
 RV 184,213,8
 XO 43,35,43
 QZ 140,224,60
 RV 186,213,4104
 CV 48,48,49
 QK 140,220,56
 buffer_store_dwordx4 v[40:43], v221, s[24:27], s38 offen offset:256 nt
 QK 140,216,52
 RV 188,213,512
 CV 49,50,51
 QK 140,212,48
 RV 190,213,4608
 CV 50,52,53
 QZ 152,228,32
 RV 192,213,520
 CV 51,54,55
 QK 152,232,36
 RV 194,213,4616
 CV 56,56,57
 QK 152,236,40
 RV 196,213,1024
 CV 57,58,59
 QK 152,240,44
 RV 198,213,5120
 CV 58,60,61
 QZ 156,240,60
 RV 200,213,1032
 CV 59,62,63
 QK 156,236,56
 RV 202,213,5128
 XO 60,48,56
 QK 156,232,52
 RV 204,213,1536
 XO 61,49,57
 QK 156,228,48
 RV 206,213,5632
 XO 62,50,58
 SM 132,184
 RV 208,213,1544
 XO 63,51,59
 PV 96,96,188
 s_not_b64 vcc, vcc
 buffer_store_dwordx4 v[60:63], v221, s[24:27], s38 offen offset:384 nt
 XE 48,56,48
 PS 156
 PS 158
 PV 64,96,184
 RV 210,213,5640
 XE 49,57,49
 PV 68,100,184
 RV 96,213,8192
 XE 50,58,50
 PV 100,100,188
 RV 100,213,8200
 XE 51,59,51
 PV 104,104,188
 SC 136
 SC 137
 PV 72,104,184
 RV 104,213,8704
 SC 138
 PV 76,108,184
 buffer_store_dwordx4 v[48:51], v220, s[24:27], s38 offen offset:384 nt
 PV 108,108,188
 RV 108,213,8712
 SC 139
 PV 112,112,188
 EX 136
 PV 80,112,184
 RV 112,213,9216
 SC 152
 PV 84,116,184
 EX 137
 PV 116,116,188
 RV 116,213,9224
 CV 168,136,137
 PV 120,120,188
 EX 138
 PV 88,120,184
 RV 120,213,9728
 SC 153
 PV 92,124,184
 EX 139
 PV 124,124,188
 s_waitcnt lgkmcnt(15)
 RV 124,213,9736
 CV 169,138,139
 v_mfma_f32_16x16x32_bf16 v[136:139], a[148:151], a[32:35], v[208:211]
 s_waitcnt lgkmcnt(15)
 EX 152
 QK 136,152,36
 s_waitcnt lgkmcnt(15)
 EX 153
 QK 136,156,40
 s_waitcnt lgkmcnt(15)
 CV 170,152,153
 SC 154
 QK 136,160,44
 SC 155
 SC 140
 EX 154
 EX 155
 SC 141
 CV 171,154,155
 EX 140
 EX 141
 LS 132,144,168
 s_waitcnt lgkmcnt(15)
 CV 172,140,141
 SC 142
 PV 64,180,168
 s_waitcnt lgkmcnt(15)
 SC 143
 SC 136
 PV 68,184,168
 s_waitcnt lgkmcnt(15)
 EX 142
 PV 72,188,168
 s_waitcnt lgkmcnt(15)
 EX 143
 PV 76,192,168
 s_waitcnt lgkmcnt(14)
 CV 173,142,143
 SC 137
 PV 80,196,168
 s_waitcnt lgkmcnt(12)
 EX 136
 PV 84,200,168
 s_waitcnt lgkmcnt(10)
 EX 137
 PV 88,204,168
 s_waitcnt lgkmcnt(8)
 CV 184,136,137
 SC 138
 PV 92,208,168
 EX 138
 v_mfma_f32_16x16x32_bf16 v[140:143], a[148:151], a[48:51], v[208:211]
 EX 156
 QK 140,152,52
 EX 157
 QK 140,156,56
 SC 139
 CV 174,156,157
 QK 140,160,60
 EX 139
 EX 158
 CV 185,138,139
 EX 159
 s_nop 0
 v_mfma_f32_16x16x16_bf16 a[132:135], a[144:145], v[184:185], a[132:135]
 s_waitcnt lgkmcnt(7)
 CV 175,158,159
 PH 64,96,184
 s_waitcnt lgkmcnt(6)
 PH 68,100,184
 s_waitcnt lgkmcnt(5)
 SC 140
 SC 141
 SC 142
 PH 72,104,184
 EX 140
 v_accvgpr_read_b32 v229, a132
 v_accvgpr_read_b32 v228, a133
 v_add_f32 v229, v228, v229
 v_add_f32 v229, v238, v229
 v_rcp_f32 v228, v229
 v_subrev_u32 v229, 0x21800000, v229
 PM 64,228,0
 PM 66,228,0
 PM 68,228,0
 PM 70,228,0
 PM 72,228,0
 PM 74,228,0
 v_max3_u32 v225, v225, v227, v229
 s_waitcnt lgkmcnt(4)
 PH 76,108,184
 s_waitcnt lgkmcnt(3)
 CV 64,64,65
 CV 65,66,67
 CV 66,68,69
 PH 80,112,184
 s_waitcnt lgkmcnt(2)
 CV 67,70,71
 CV 72,72,73
 CV 73,74,75
 PH 84,116,184
 XE 68,72,64
 XE 69,73,65
 SC 143
 EX 141
 EX 142
 PM 76,228,0
 PM 78,228,0
 s_waitcnt lgkmcnt(1)
 PH 88,120,184
 s_waitcnt lgkmcnt(0)
 CV 74,76,77
 CV 75,78,79
 CV 188,140,141
 PH 92,124,184
 XE 70,74,66
 EX 143
 LS 132,136,172
 XE 71,75,67
 CV 189,142,143
 PV 96,180,172
 s_not_b64 vcc, vcc
 buffer_store_dwordx4 v[68:71], v220, s[24:27], s39 offen offset:0 nt
 XO 72,64,72
 PM 80,228,0
 PM 82,228,0
 PM 84,228,0
 PM 86,228,0
 PM 88,228,0
 PM 90,228,0
 PM 92,228,0
 PM 94,228,0
 PV 100,184,172
 XO 73,65,73
 XO 74,66,74
 PV 104,188,172
 XO 75,67,75
 CV 80,80,81
 PV 108,192,172
 CV 81,82,83
 CV 82,84,85
 PV 112,196,172
 CV 83,86,87
 CV 88,88,89
 PV 116,200,172
 buffer_store_dwordx4 v[72:75], v221, s[24:27], s39 offen offset:0 nt
 PV 120,204,172
 CV 89,90,91
 CV 90,92,93
 PV 124,208,172
 CV 91,94,95
 XO 92,80,88
 v_mfma_f32_16x16x16_bf16 a[132:135], a[136:137], v[188:189], a[132:135]
 XO 93,81,89
 XO 94,82,90
 XO 95,83,91
 PH 96,96,188
 s_not_b64 vcc, vcc
 XE 80,88,80
 XE 81,89,81
 PH 100,100,188
 XE 82,90,82
 XE 83,91,83
 v_accvgpr_read_b32 v231, a134
 v_accvgpr_read_b32 v230, a135
 v_add_f32 v231, v230, v231
 v_add_f32 v231, v239, v231
 v_rcp_f32 v230, v231
 v_subrev_u32 v231, 0x21800000, v231
 v_max_u32 v225, v225, v231
 v_cmp_le_u32 s[84:85], s77, v225
 PH 104,104,188
 buffer_store_dwordx4 v[92:95], v221, s[24:27], s39 offen offset:128 nt
 PM 96,230,0
 PM 98,230,0
 PM 100,230,0
 PM 102,230,0
 PH 108,108,188
 CV 96,96,97
 CV 97,98,99
 CV 98,100,101
 CV 99,102,103
 PM 104,230,0
 PM 106,230,0
 PH 112,112,188
 CV 104,104,105
 CV 105,106,107
 PM 108,230,0
 PM 110,230,0
 PH 116,116,188
 buffer_store_dwordx4 v[80:83], v220, s[24:27], s39 offen offset:128 nt
 PH 120,120,188
 s_cmp_lg_u64 s[84:85], 0
 CV 106,108,109
 CV 107,110,111
 PH 124,124,188
 s_cselect_b32 s92, s76, 0
 XE 100,104,96
 XE 101,105,97
 XE 102,106,98
 XE 103,107,99
 s_not_b64 vcc, vcc
 XO 104,96,104
 XO 105,97,105
 XO 106,98,106
 XO 107,99,107
 s_or_b32 s73, s73, s92
 s_lshl_b32 s76, s76, 1
 buffer_store_dwordx4 v[100:103], v220, s[24:27], s39 offen offset:256 nt
 PM 112,230,0
 PM 114,230,0
 PM 116,230,0
 PM 118,230,0
 CV 112,112,113
 CV 113,114,115
 CV 114,116,117
 CV 115,118,119
 PM 120,230,0
 PM 122,230,0
 PM 124,230,0
 PM 126,230,0
 CV 120,120,121
 CV 121,122,123
 CV 122,124,125
 CV 123,126,127
 XO 124,112,120
 XO 125,113,121
 XO 126,114,122
 XO 127,115,123
 s_not_b64 vcc, vcc
 XE 112,120,112
 XE 113,121,113
 XE 114,122,114
 XE 115,123,115
 buffer_store_dwordx4 v[104:107], v221, s[24:27], s39 offen offset:256 nt
 buffer_store_dwordx4 v[124:127], v221, s[24:27], s39 offen offset:384 nt
 buffer_store_dwordx4 v[112:115], v220, s[24:27], s39 offen offset:384 nt
 s_cmp_lg_u32 s73, 0
 s_cbranch_scc1 L_hop
 s_endpgm
.p2align 12
.fill 720, 4, 0xbf800000
L_w1:
 v_mfma_f32_16x16x32_bf16 v[128:131], a[64:67], a[0:3], v[208:211]
 s_cmp_eq_u32 s33, 0x8000
 RV 96,213,8192
 v_add_u32 v251, L_w1-L_pc-8192, v244
 QK 128,68,4
 s_cselect_b32 s32, -2, 1
 RV 98,213,12288
 SC 156
 QK 128,72,8
 s_lshl_b32 s32, s32, 14
 RV 100,213,8200
 v_add_u32 v212, s32, v212
 QK 128,76,12
 s_add_u32 s31, s33, s37
 RV 102,213,12296
 SC 157
 v_mfma_f32_16x16x32_bf16 v[132:135], a[76:79], a[28:31], v[208:211]
 s_add_u32 s33, s33, s32
 RV 104,213,8704
 SC 158
 QK 132,72,24
 s_add_u32 s31, s33, s37
 RV 106,213,12800
 SC 159
 QK 132,68,20
 RV 108,213,8712
 SC 128
 QK 132,64,16
 RV 110,213,12808
 SC 129
 QZ 136,64,32
 RV 112,213,9216
 SC 130
 QK 136,68,36
 RV 114,213,13312
 SC 131
 QK 136,72,40
 RV 116,213,9224
 SC 132
 QK 136,76,44
 RV 118,213,13320
 SC 133
 QZ 140,76,60
 RV 120,213,9728
 SC 134
 QK 140,72,56
 RV 122,213,13824
 SC 135
 QK 140,68,52
 RV 124,213,9736
 SC 136
 QK 140,64,48
 RV 126,213,13832
 v_add_u32 v213, s32, v213
 QZ 152,80,32
 s_cmp_eq_u32 s33, 0x8000
 global_load_dword v255, v251, s[64:65]
 SC 137
 QK 152,84,36
 s_cselect_b32 s32, -2, 1
 s_waitcnt vmcnt(9)
 RK 64,223,0
 SC 138
 QK 152,88,40
 s_lshl_b32 s32, s32, 14
 RK 68,223,1024
 SC 139
 QK 152,92,44
 s_add_u32 s33, s33, s32
 RK 72,223,2048
 SC 140
 EX 156
 EX 157
 EX 158
 CV 190,156,157
 EX 159
 EX 136
 CV 191,158,159
 QZ 156,92,60
 RK 76,223,3072
 SC 141
 QK 156,88,56
 s_waitcnt lgkmcnt(4)
 RK 88,223,6144
 SC 142
 QK 156,84,52
 s_barrier
 QK 156,80,48
 RK 148,212,0
 SC 143
 SM 128,176
 RK 152,212,512
 SC 152
 SM 132,184
 RK 156,212,1024
 SC 153
 PV 96,96,188
 RK 160,212,1536
 SC 154
 PV 64,96,184
 RK 164,212,4096
 SC 155
 PV 32,96,180
 RK 168,212,4608
 SC 156
 PV 0,96,176
 RK 172,212,5120
 SC 157
 PV 4,100,176
 RK 176,212,5632
 SC 158
 PV 36,100,180
 RV 180,213,0
 SC 159
 PV 68,100,184
 RV 182,213,4096
 RV 184,213,8
 PV 100,100,188
 RV 186,213,4104
 EX 137
 PV 104,104,188
 RV 188,213,512
 CV 168,136,137
 PV 72,104,184
 RV 190,213,4608
 EX 138
 PV 40,104,180
 RV 192,213,520
 EX 139
 PV 8,104,176
 RV 194,213,4616
 CV 169,138,139
 PV 12,108,176
 RV 196,213,1024
 RV 198,213,5120
 PV 44,108,180
 EX 140
 PV 76,108,184
 RV 200,213,1032
 RV 202,213,5128
 PV 108,108,188
 EX 141
 PV 112,112,188
 RV 204,213,1536
 CV 172,140,141
 PV 80,112,184
 RV 206,213,5632
 RV 208,213,1544
 PV 48,112,180
 EX 142
 PV 16,112,176
 RV 210,213,5640
 RK 212,212,8192
 PV 20,116,176
 EX 143
 PV 52,116,180
 RK 216,212,8704
 CV 173,142,143
 PV 84,116,184
 RK 220,212,9216
 RK 224,212,9728
 PV 116,116,188
 EX 152
 PV 120,120,188
 RK 228,212,12288
 RK 232,212,12800
 PV 88,120,184
 EX 153
 PV 56,120,180
 RK 236,212,13312
 CV 170,152,153
 PV 24,120,176
 RK 240,212,13824
 v_add_u32 v212, s32, v212
 PV 28,124,176
 RV 96,213,8192
 RV 98,213,12288
 PV 60,124,180
 EX 154
 PV 92,124,184
 RV 100,213,8200
 RV 102,213,12296
 PV 124,124,188
 s_waitcnt lgkmcnt(15)
 EX 155
 QZ 136,148,32
 s_waitcnt lgkmcnt(15)
 RV 104,213,8704
 CV 171,154,155
 QK 136,152,36
 s_waitcnt lgkmcnt(15)
 RV 106,213,12800
 RV 108,213,8712
 QK 136,156,40
 s_waitcnt lgkmcnt(15)
 EX 156
 QK 136,160,44
 RV 110,213,12808
 RV 112,213,9216
 QZ 140,160,60
 EX 157
 QK 140,156,56
 RV 114,213,13312
 CV 174,156,157
 QK 140,152,52
 RV 116,213,9224
 RV 118,213,13320
 QK 140,148,48
 s_waitcnt lgkmcnt(15)
 EX 158
 QZ 152,164,32
 s_waitcnt lgkmcnt(15)
 RV 120,213,9728
 RV 122,213,13824
 QK 152,168,36
 s_waitcnt lgkmcnt(15)
 EX 159
 QK 152,172,40
 s_waitcnt lgkmcnt(15)
 RV 124,213,9736
 CV 175,158,159
 QK 152,176,44
 RV 126,213,13832
 v_add_u32 v213, s32, v213
 QZ 156,176,60
 RK 80,223,4096
 RK 84,223,5120
 QK 156,172,56
 EX 128
 QK 156,168,52
 EX 129
 QK 156,164,48
 RK 92,223,7168
 CV 160,128,129
 QK 0,246,64
 EX 130
 QK 4,244,64
 EX 131
 QK 12,244,68
 RK 64,223,8192
 CV 161,130,131
 EX 132
 EX 133
 PS 136
 PS 138
 PS 140
 PS 142
 PS 152
 PS 154
 PS 156
 PS 158
 QK 8,246,68
 RK 68,223,9216
 CV 164,132,133
 QK 16,246,72
 EX 134
 QK 20,244,72
 EX 135
 QK 28,244,76
 RK 72,223,10240
 CV 165,134,135
 QK 24,246,76
 s_waitcnt lgkmcnt(5)
 EX 136
 QK 32,246,80
 EX 137
 QK 36,244,80
 s_waitcnt lgkmcnt(4)
 RK 76,223,11264
 CV 184,136,137
 QK 44,244,84
 EX 138
 QK 40,246,84
 RK 80,223,12288
 RK 84,223,13312
 QK 48,246,88
 EX 139
 QK 52,244,88
 s_waitcnt lgkmcnt(6)
 RK 88,223,14336
 CV 185,138,139
 QK 60,244,92
 s_waitcnt vmcnt(1)
 EX 152
 QK 56,246,92
 s_barrier
 v_mfma_f32_16x16x16_bf16 a[128:131], a[144:145], v[160:161], a[128:131]
 EX 153
 EX 154
 PH 0,180,160
 RK 92,223,15360
 EX 155
 PH 4,184,160
 CV 186,152,153
 EX 140
 v_accvgpr_read_b32 v225, a128
 v_accvgpr_read_b32 v224, a129
 v_add_f32 v225, v224, v225
 v_add_f32 v225, v236, v225
 v_rcp_f32 v224, v225
 v_subrev_u32 v225, 0x21800000, v225
 PM 0,224,0
 PM 2,224,0
 PM 4,224,0
 PM 6,224,0
 PH 8,188,160
 CV 0,0,1
 CV 1,2,3
 CV 2,4,5
 PH 12,192,160
 CV 3,6,7
 EX 141
 PH 16,196,160
 CV 187,154,155
 EX 142
 CV 188,140,141
 EX 143
 PM 8,224,0
 PM 10,224,0
 PM 12,224,0
 PM 14,224,0
 PH 20,200,160
 CV 8,8,9
 CV 9,10,11
 CV 10,12,13
 PH 24,204,160
 CV 11,14,15
 XE 4,8,0
 XE 5,9,1
 PH 28,208,160
 XE 6,10,2
 XE 7,11,3
 CV 189,142,143
 v_mfma_f32_16x16x16_bf16 a[128:131], a[136:137], v[164:165], a[128:131]
 buffer_store_dwordx4 v[4:7], v220, s[24:27], s38 offen offset:0 nt
 EX 156
 PM 16,224,0
 PM 18,224,0
 PM 20,224,0
 PM 22,224,0
 PM 24,224,0
 PM 26,224,0
 PM 28,224,0
 PM 30,224,0
 v_accvgpr_read_b32 v227, a130
 v_accvgpr_read_b32 v226, a131
 v_add_f32 v227, v226, v227
 v_add_f32 v227, v237, v227
 v_rcp_f32 v226, v227
 v_subrev_u32 v227, 0x21800000, v227
 PH 32,180,164
 CV 16,16,17
 CV 17,18,19
 CV 18,20,21
 PH 36,184,164
 CV 19,22,23
 EX 157
 PH 40,188,164
 CV 24,24,25
 CV 25,26,27
 CV 26,28,29
 PH 44,192,164
 CV 27,30,31
 EX 158
 PH 48,196,164
 EX 159
 CV 190,156,157
 PH 52,200,164
 CV 191,158,159
 PH 56,204,164
 PH 60,208,164
 SM 132,168
 s_not_b64 vcc, vcc
 XO 8,0,8
 PV 96,180,172
 XO 9,1,9
 XO 10,2,10
 PV 64,180,168
 RV 180,213,0
 XO 11,3,11
 PV 68,184,168
 buffer_store_dwordx4 v[8:11], v221, s[24:27], s38 offen offset:0 nt
 PV 100,184,172
 RV 182,213,4096
 XO 28,16,24
 PV 104,188,172
 RV 184,213,8
 XO 29,17,25
 PV 72,188,168
 RV 186,213,4104
 XO 30,18,26
 PV 76,192,168
 RV 188,213,512
 XO 31,19,27
 PV 108,192,172
 s_not_b64 vcc, vcc
 RV 190,213,4608
 XE 16,24,16
 PV 112,196,172
 RV 192,213,520
 XE 17,25,17
 PV 80,196,168
 buffer_store_dwordx4 v[28:31], v221, s[24:27], s38 offen offset:128 nt
 XE 18,26,18
 PM 32,226,0
 PM 34,226,0
 PM 36,226,0
 PM 38,226,0
 PM 40,226,0
 PM 42,226,0
 PM 44,226,0
 PM 46,226,0
 PV 84,200,168
 RV 194,213,4616
 XE 19,27,19
 PV 116,200,172
 RV 196,213,1024
 CV 32,32,33
 PV 120,204,172
 RV 198,213,5120
 CV 33,34,35
 PV 88,204,168
 RV 200,213,1032
 CV 34,36,37
 PV 92,208,168
 buffer_store_dwordx4 v[16:19], v220, s[24:27], s38 offen offset:128 nt
 PV 124,208,172
 s_waitcnt lgkmcnt(15)
 RV 202,213,5128
 CV 35,38,39
 QK 64,246,64
 RV 204,213,1536
 CV 40,40,41
 QK 68,244,64
 s_waitcnt lgkmcnt(15)
 RV 206,213,5632
 CV 41,42,43
 QK 76,244,68
 RV 208,213,1544
 CV 42,44,45
 QK 72,246,68
 s_waitcnt lgkmcnt(15)
 RV 210,213,5640
 CV 43,46,47
 QK 80,246,72
 XE 36,40,32
 XE 37,41,33
 QK 84,244,72
 s_waitcnt lgkmcnt(15)
 XE 38,42,34
 XE 39,43,35
 QK 92,244,76
 s_not_b64 vcc, vcc
 buffer_store_dwordx4 v[36:39], v220, s[24:27], s38 offen offset:256 nt
 QK 88,246,76
 s_waitcnt lgkmcnt(15)
 XO 40,32,40
 XO 41,33,41
 QK 96,246,80
 XO 42,34,42
 XO 43,35,43
 QK 100,244,80
 s_waitcnt lgkmcnt(15)
 v_mul_f32 v48, v226, v48
 v_mul_f32 v49, v226, v49
 QK 108,244,84
 v_mul_f32 v50, v226, v50
 v_mul_f32 v51, v226, v51
 QK 104,246,84
 s_waitcnt lgkmcnt(15)
 v_mul_f32 v52, v226, v52
 v_mul_f32 v53, v226, v53
 QK 112,246,88
 v_mul_f32 v54, v226, v54
 v_mul_f32 v55, v226, v55
 QK 116,244,88
 s_waitcnt lgkmcnt(15)
 buffer_store_dwordx4 v[40:43], v221, s[24:27], s38 offen offset:256 nt
 QK 124,244,92
 CV 48,48,49
 CV 49,50,51
 QK 120,246,92
 CV 50,52,53
 CV 51,54,55
 QZ 136,212,32
 v_mul_f32 v56, v226, v56
 v_mul_f32 v57, v226, v57
 QK 136,216,36
 v_mul_f32 v58, v226, v58
 v_mul_f32 v59, v226, v59
 QK 136,220,40
 v_mul_f32 v60, v226, v60
 v_mul_f32 v61, v226, v61
 QK 136,224,44
 v_mul_f32 v62, v226, v62
 v_mul_f32 v63, v226, v63
 v_mfma_f32_16x16x32_bf16 v[152:155], a[240:243], a[44:47], v[208:211]
 CV 56,56,57
 CV 57,58,59
 QK 152,236,40
 CV 58,60,61
 CV 59,62,63
 QK 152,232,36
 XO 60,48,56
 XO 61,49,57
 QK 152,228,32
 XO 62,50,58
 XO 63,51,59
 QZ 140,212,48
 s_not_b64 vcc, vcc
 buffer_store_dwordx4 v[60:63], v221, s[24:27], s38 offen offset:384 nt
 QK 140,216,52
 XE 48,56,48
 XE 49,57,49
 XE 50,58,50
 XE 51,59,51
 PS 136
 PS 138
 PS 152
 PS 154
 QK 140,220,56
 EX 136
 QK 140,224,60
 EX 137
 v_mfma_f32_16x16x32_bf16 v[156:159], a[240:243], a[60:63], v[208:211]
 EX 138
 QK 156,236,56
 buffer_store_dwordx4 v[48:51], v220, s[24:27], s38 offen offset:384 nt
 QK 156,232,52
 EX 139
 QK 156,228,48
 CV 168,136,137
 CV 169,138,139
 LS 132,144,184
 EX 152
 PV 64,96,184
 EX 153
 PV 68,100,184
 EX 154
 CV 170,152,153
 EX 155
 PS 140
 PS 142
 PS 156
 PS 158
 PV 72,104,184
 EX 140
 PV 76,108,184
 EX 141
 PV 80,112,184
 CV 171,154,155
 CV 172,140,141
 PV 84,116,184
 EX 142
 PV 88,120,184
 EX 143
 PV 92,124,184
 EX 156
 LS 132,144,168
 s_waitcnt lgkmcnt(14)
 EX 157
 PV 64,180,168
 s_waitcnt lgkmcnt(12)
 CV 173,142,143
 CV 174,156,157
 PV 68,184,168
 s_waitcnt lgkmcnt(10)
 EX 158
 PV 72,188,168
 EX 159
 v_accvgpr_read_b32 v229, a132
 v_accvgpr_read_b32 v228, a133
 v_add_f32 v229, v228, v229
 v_add_f32 v229, v238, v229
 v_rcp_f32 v228, v229
 v_subrev_u32 v229, 0x21800000, v229
 PM 64,228,0
 PM 66,228,0
 PM 68,228,0
 PM 70,228,0
 PM 72,228,0
 PM 74,228,0
 v_max3_u32 v225, v225, v227, v229
 s_waitcnt lgkmcnt(8)
 PV 76,192,168
 s_waitcnt lgkmcnt(6)
 CV 64,64,65
 CV 65,66,67
 PV 80,196,168
 s_waitcnt lgkmcnt(4)
 CV 66,68,69
 CV 67,70,71
 PV 84,200,168
 CV 72,72,73
 CV 73,74,75
 CV 175,158,159
 XE 68,72,64
 XE 69,73,65
 PM 76,228,0
 PM 78,228,0
 s_waitcnt lgkmcnt(2)
 PV 88,204,168
 s_waitcnt lgkmcnt(0)
 CV 74,76,77
 CV 75,78,79
 PV 92,208,168
 XE 70,74,66
 XE 71,75,67
 LS 132,136,188
 s_not_b64 vcc, vcc
 buffer_store_dwordx4 v[68:71], v220, s[24:27], s39 offen offset:0 nt
 XO 72,64,72
 PM 80,228,0
 PM 82,228,0
 PM 84,228,0
 PM 86,228,0
 PM 88,228,0
 PM 90,228,0
 PM 92,228,0
 PM 94,228,0
 PV 96,96,188
 XO 73,65,73
 XO 74,66,74
 PV 100,100,188
 XO 75,67,75
 CV 80,80,81
 PV 104,104,188
 CV 81,82,83
 CV 82,84,85
 PV 108,108,188
 CV 83,86,87
 CV 88,88,89
 PV 112,112,188
 buffer_store_dwordx4 v[72:75], v221, s[24:27], s39 offen offset:0 nt
 PV 116,116,188
 CV 89,90,91
 CV 90,92,93
 PV 120,120,188
 CV 91,94,95
 XO 92,80,88
 PV 124,124,188
 XO 93,81,89
 XO 94,82,90
 LS 132,136,172
 XO 95,83,91
 PV 96,180,172
 s_not_b64 vcc, vcc
 XE 80,88,80
 XE 81,89,81
 PV 100,184,172
 XE 82,90,82
 XE 83,91,83
 v_accvgpr_read_b32 v231, a134
 v_accvgpr_read_b32 v230, a135
 v_add_f32 v231, v230, v231
 v_add_f32 v231, v239, v231
 v_rcp_f32 v230, v231
 v_subrev_u32 v231, 0x21800000, v231
 v_max_u32 v225, v225, v231
 v_cmp_le_u32 s[84:85], s77, v225
 PV 104,188,172
 buffer_store_dwordx4 v[92:95], v221, s[24:27], s39 offen offset:128 nt
 PM 96,230,0
 PM 98,230,0
 PM 100,230,0
 PM 102,230,0
 PV 108,192,172
 s_cmp_lg_u64 s[84:85], 0
 CV 96,96,97
 CV 97,98,99
 CV 98,100,101
 CV 99,102,103
 PM 104,230,0
 PM 106,230,0
 PV 112,196,172
 s_cselect_b32 s92, s76, 0
 CV 104,104,105
 CV 105,106,107
 PM 108,230,0
 PM 110,230,0
 PV 116,200,172
 s_or_b32 s73, s73, s92
 buffer_store_dwordx4 v[80:83], v220, s[24:27], s39 offen offset:128 nt
 PV 120,204,172
 s_lshl_b32 s76, s76, 1
 CV 106,108,109
 CV 107,110,111
 PV 124,208,172
 XE 100,104,96
 XE 101,105,97
 XE 102,106,98
 XE 103,107,99
 s_not_b64 vcc, vcc
 XO 104,96,104
 XO 105,97,105
 XO 106,98,106
 XO 107,99,107
 buffer_store_dwordx4 v[100:103], v220, s[24:27], s39 offen offset:256 nt
 PM 112,230,0
 PM 114,230,0
 PM 116,230,0
 PM 118,230,0
 CV 112,112,113
 CV 113,114,115
 CV 114,116,117
 CV 115,118,119
 PM 120,230,0
 PM 122,230,0
 PM 124,230,0
 PM 126,230,0
 CV 120,120,121
 CV 121,122,123
 CV 122,124,125
 CV 123,126,127
 XO 124,112,120
 XO 125,113,121
 XO 126,114,122
 XO 127,115,123
 s_not_b64 vcc, vcc
 XE 112,120,112
 XE 113,121,113
 XE 114,122,114
 XE 115,123,115
 buffer_store_dwordx4 v[104:107], v221, s[24:27], s39 offen offset:256 nt
 buffer_store_dwordx4 v[124:127], v221, s[24:27], s39 offen offset:384 nt
 buffer_store_dwordx4 v[112:115], v220, s[24:27], s39 offen offset:384 nt
 s_cmp_lg_u32 s73, 0
 s_cbranch_scc1 L_hop
 s_endpgm
.p2align 12
.fill 720, 4, 0xbf800000
L_w2:
 QZ 128,64,0
 s_cmp_eq_u32 s33, 0x8000
 RV 96,213,8192
 v_add_u32 v251, L_w2-L_pc-16384, v244
 QK 128,68,4
 s_cselect_b32 s32, -2, 1
 RV 98,213,12288
 SC 156
 QK 128,72,8
 s_lshl_b32 s32, s32, 14
 RV 100,213,8200
 v_add_u32 v212, s32, v212
 QK 128,76,12
 s_add_u32 s31, s33, s37
 RV 102,213,12296
 SC 157
 QZ 132,76,28
 s_add_u32 s33, s33, s32
 RV 104,213,8704
 SC 158
 QK 132,72,24
 s_add_u32 s31, s33, s37
 RV 106,213,12800
 SC 159
 QK 132,68,20
 RV 108,213,8712
 SC 128
 QK 132,64,16
 RV 110,213,12808
 SC 129
 QZ 136,64,32
 RV 112,213,9216
 SC 130
 QK 136,68,36
 RV 114,213,13312
 SC 131
 QK 136,72,40
 RV 116,213,9224
 SC 132
 QK 136,76,44
 RV 118,213,13320
 SC 133
 QZ 140,76,60
 RV 120,213,9728
 SC 134
 QK 140,72,56
 RV 122,213,13824
 SC 135
 QK 140,68,52
 RV 124,213,9736
 SC 136
 QK 140,64,48
 RV 126,213,13832
 v_add_u32 v213, s32, v213
 v_mfma_f32_16x16x32_bf16 v[144:147], a[80:83], a[0:3], v[208:211]
 s_cmp_eq_u32 s33, 0x8000
 global_load_dword v255, v251, s[64:65]
 SC 137
 QK 144,84,4
 s_cselect_b32 s32, -2, 1
 s_waitcnt vmcnt(9)
 RK 64,223,0
 SC 138
 QK 144,88,8
 s_lshl_b32 s32, s32, 14
 RK 68,223,1024
 SC 139
 QK 144,92,12
 s_add_u32 s33, s33, s32
 RK 72,223,2048
 SC 140
 v_mfma_f32_16x16x32_bf16 v[148:151], a[92:95], a[28:31], v[208:211]
 RK 76,223,3072
 SC 141
 QK 148,88,24
 EX 156
 QK 148,84,20
 EX 157
 QK 148,80,16
 CV 190,156,157
 SC 142
 QZ 152,80,32
 EX 158
 QK 152,84,36
 EX 159
 QK 152,88,40
 CV 191,158,159
 SC 143
 QK 152,92,44
 EX 136
 QZ 156,92,60
 s_waitcnt lgkmcnt(4)
 RK 92,223,7168
 SC 144
 QK 156,88,56
 s_barrier
 QK 156,84,52
 RK 148,212,0
 SC 152
 QK 156,80,48
 RK 152,212,512
 SC 153
 SM 128,176
 RK 156,212,1024
 SC 154
 SM 132,184
 RK 160,212,1536
 SC 155
 PV 96,96,188
 RK 164,212,4096
 SC 156
 PV 64,96,184
 RK 168,212,4608
 SC 157
 PV 32,96,180
 RK 172,212,5120
 SC 158
 PV 0,96,176
 RK 176,212,5632
 SC 159
 PV 4,100,176
 RV 180,213,0
 SC 145
 PV 36,100,180
 RV 182,213,4096
 SC 146
 PV 68,100,184
 RV 184,213,8
 SC 147
 PV 100,100,188
 RV 186,213,4104
 SC 148
 PV 104,104,188
 RV 188,213,512
 SC 149
 PV 72,104,184
 RV 190,213,4608
 SC 150
 PV 40,104,180
 RV 192,213,520
 SC 151
 PV 8,104,176
 RV 194,213,4616
 RV 196,213,1024
 PV 12,108,176
 RV 198,213,5120
 EX 137
 PV 44,108,180
 RV 200,213,1032
 CV 168,136,137
 PV 76,108,184
 RV 202,213,5128
 EX 138
 PV 108,108,188
 RV 204,213,1536
 EX 139
 PV 112,112,188
 RV 206,213,5632
 CV 169,138,139
 PV 80,112,184
 RV 208,213,1544
 RV 210,213,5640
 PV 48,112,180
 EX 140
 PV 16,112,176
 RK 212,212,8192
 RK 216,212,8704
 PV 20,116,176
 EX 141
 PV 52,116,180
 RK 220,212,9216
 CV 172,140,141
 PV 84,116,184
 RK 224,212,9728
 v_add_u32 v212, s32, v212
 PV 116,116,188
 RV 96,213,8192
 RV 98,213,12288
 PV 120,120,188
 EX 142
 PV 88,120,184
 RV 100,213,8200
 RV 102,213,12296
 PV 56,120,180
 EX 143
 PV 24,120,176
 RV 104,213,8704
 CV 173,142,143
 PV 28,124,176
 RV 106,213,12800
 RV 108,213,8712
 PV 60,124,180
 EX 152
 PV 92,124,184
 RV 110,213,12808
 RV 112,213,9216
 PV 124,124,188
 s_waitcnt lgkmcnt(15)
 EX 153
 QZ 136,148,32
 s_waitcnt lgkmcnt(15)
 RV 114,213,13312
 CV 170,152,153
 QK 136,152,36
 s_waitcnt lgkmcnt(15)
 RV 116,213,9224
 RV 118,213,13320
 QK 136,156,40
 s_waitcnt lgkmcnt(15)
 EX 154
 QK 136,160,44
 RV 120,213,9728
 RV 122,213,13824
 QZ 140,160,60
 EX 155
 QK 140,156,56
 RV 124,213,9736
 CV 171,154,155
 QK 140,152,52
 RV 126,213,13832
 v_add_u32 v213, s32, v213
 QK 140,148,48
 s_waitcnt lgkmcnt(15)
 RK 80,223,4096
 RK 84,223,5120
 QZ 152,164,32
 s_waitcnt lgkmcnt(15)
 EX 156
 QK 152,168,36
 s_waitcnt lgkmcnt(15)
 EX 157
 QK 152,172,40
 s_waitcnt lgkmcnt(15)
 RK 88,223,6144
 CV 174,156,157
 QK 152,176,44
 EX 158
 EX 159
 EX 128
 CV 175,158,159
 QZ 156,176,60
 EX 129
 QK 156,172,56
 EX 130
 QK 156,168,52
 EX 131
 QK 156,164,48
 CV 160,128,129
 CV 161,130,131
 QK 0,246,64
 EX 144
 QK 4,244,64
 EX 145
 QK 12,244,68
 RK 64,223,8192
 CV 162,144,145
 EX 146
 EX 147
 PS 136
 PS 138
 PS 140
 PS 142
 PS 152
 PS 154
 PS 156
 PS 158
 QK 8,246,68
 RK 68,223,9216
 CV 163,146,147
 QK 16,246,72
 EX 132
 QK 20,244,72
 EX 133
 QK 28,244,76
 RK 72,223,10240
 CV 164,132,133
 QK 24,246,76
 s_waitcnt lgkmcnt(5)
 EX 134
 QK 32,246,80
 EX 135
 QK 36,244,80
 s_waitcnt lgkmcnt(4)
 RK 76,223,11264
 CV 165,134,135
 QK 44,244,84
 EX 148
 QK 40,246,84
 s_waitcnt vmcnt(1)
 RK 80,223,12288
 RK 84,223,13312
 s_waitcnt lgkmcnt(6)
 QK 48,246,88
 s_barrier
 QK 52,244,88
 EX 149
 QK 60,244,92
 RK 88,223,14336
 CV 166,148,149
 QK 56,246,92
 EX 150
 LS 128,144,160
 EX 151
 PV 0,180,160
 RK 92,223,15360
 CV 167,150,151
 PV 4,184,160
 EX 136
 PV 8,188,160
 EX 137
 v_accvgpr_read_b32 v225, a128
 v_accvgpr_read_b32 v224, a129
 v_add_f32 v225, v224, v225
 v_add_f32 v225, v236, v225
 v_rcp_f32 v224, v225
 v_subrev_u32 v225, 0x21800000, v225
 PM 0,224,0
 PM 2,224,0
 PM 4,224,0
 PM 6,224,0
 PM 8,224,0
 PM 10,224,0
 PV 12,192,160
 CV 0,0,1
 CV 1,2,3
 PV 16,196,160
 CV 2,4,5
 CV 3,6,7
 PV 20,200,160
 CV 8,8,9
 CV 9,10,11
 CV 184,136,137
 XE 4,8,0
 XE 5,9,1
 PM 12,224,0
 PM 14,224,0
 PV 24,204,160
 CV 10,12,13
 CV 11,14,15
 PV 28,208,160
 EX 138
 LS 128,136,164
 XE 6,10,2
 XE 7,11,3
 PV 32,180,164
 s_not_b64 vcc, vcc
 buffer_store_dwordx4 v[4:7], v220, s[24:27], s38 offen offset:0 nt
 XO 8,0,8
 PM 16,224,0
 PM 18,224,0
 PM 20,224,0
 PM 22,224,0
 PM 24,224,0
 PM 26,224,0
 PM 28,224,0
 PM 30,224,0
 v_accvgpr_read_b32 v227, a130
 v_accvgpr_read_b32 v226, a131
 v_add_f32 v227, v226, v227
 v_add_f32 v227, v237, v227
 v_rcp_f32 v226, v227
 v_subrev_u32 v227, 0x21800000, v227
 PV 36,184,164
 XO 9,1,9
 XO 10,2,10
 PV 40,188,164
 XO 11,3,11
 CV 16,16,17
 PV 44,192,164
 buffer_store_dwordx4 v[8:11], v221, s[24:27], s38 offen offset:0 nt
 PV 48,196,164
 CV 17,18,19
 CV 18,20,21
 PV 52,200,164
 CV 19,22,23
 CV 24,24,25
 PV 56,204,164
 EX 139
 PV 60,208,164
 CV 25,26,27
 CV 26,28,29
 SM 132,168
 CV 27,30,31
 PV 96,180,172
 XO 28,16,24
 XO 29,17,25
 PV 64,180,168
 RV 180,213,0
 XO 30,18,26
 PV 68,184,168
 XO 31,19,27
 CV 185,138,139
 PV 100,184,172
 s_not_b64 vcc, vcc
 buffer_store_dwordx4 v[28:31], v221, s[24:27], s38 offen offset:128 nt
 XE 16,24,16
 PM 32,226,0
 PM 34,226,0
 PM 36,226,0
 PM 38,226,0
 PM 40,226,0
 PM 42,226,0
 PM 44,226,0
 PM 46,226,0
 PV 104,188,172
 RV 184,213,8
 XE 17,25,17
 PV 72,188,168
 RV 188,213,512
 XE 18,26,18
 PV 76,192,168
 XE 19,27,19
 CV 32,32,33
 PV 108,192,172
 RV 192,213,520
 CV 33,34,35
 PV 112,196,172
 buffer_store_dwordx4 v[16:19], v220, s[24:27], s38 offen offset:128 nt
 PV 80,196,168
 RV 196,213,1024
 CV 34,36,37
 PV 84,200,168
 CV 35,38,39
 CV 40,40,41
 PV 116,200,172
 RV 200,213,1032
 CV 41,42,43
 PV 120,204,172
 CV 42,44,45
 CV 43,46,47
 PV 88,204,168
 RV 204,213,1536
 XE 36,40,32
 PV 92,208,168
 XE 37,41,33
 XE 38,42,34
 PV 124,208,172
 s_waitcnt lgkmcnt(14)
 RV 208,213,1544
 XE 39,43,35
 QK 64,246,64
 s_not_b64 vcc, vcc
 buffer_store_dwordx4 v[36:39], v220, s[24:27], s38 offen offset:256 nt
 XO 40,32,40
 PM 48,226,0
 PM 50,226,0
 PM 52,226,0
 PM 54,226,0
 PM 56,226,0
 PM 58,226,0
 PM 60,226,0
 PM 62,226,0
 QK 68,244,64
 s_waitcnt lgkmcnt(14)
 XO 41,33,41
 XO 42,34,42
 QK 76,244,68
 XO 43,35,43
 CV 48,48,49
 QK 72,246,68
 s_waitcnt lgkmcnt(13)
 CV 49,50,51
 CV 50,52,53
 QK 80,246,72
 CV 51,54,55
 CV 56,56,57
 QK 84,244,72
 s_waitcnt lgkmcnt(12)
 buffer_store_dwordx4 v[40:43], v221, s[24:27], s38 offen offset:256 nt
 QK 92,244,76
 EX 140
 QK 88,246,76
 s_waitcnt lgkmcnt(11)
 EX 141
 QK 96,246,80
 CV 57,58,59
 CV 58,60,61
 QK 100,244,80
 s_waitcnt lgkmcnt(10)
 CV 59,62,63
 XO 60,48,56
 QK 108,244,84
 XO 61,49,57
 XO 62,50,58
 QK 104,246,84
 s_waitcnt lgkmcnt(9)
 XO 63,51,59
 CV 188,140,141
 QK 112,246,88
 s_not_b64 vcc, vcc
 buffer_store_dwordx4 v[60:63], v221, s[24:27], s38 offen offset:384 nt
 QK 116,244,88
 s_waitcnt lgkmcnt(8)
 XE 48,56,48
 XE 49,57,49
 QK 124,244,92
 XE 50,58,50
 XE 51,59,51
 QK 120,246,92
 EX 142
 v_mfma_f32_16x16x32_bf16 v[136:139], a[212:215], a[32:35], v[208:211]
 EX 143
 QK 136,216,36
 EX 152
 QK 136,220,40
 EX 153
 QK 136,224,44
 buffer_store_dwordx4 v[48:51], v220, s[24:27], s38 offen offset:384 nt
 CV 189,142,143
 v_mfma_f32_16x16x32_bf16 v[140:143], a[212:215], a[48:51], v[208:211]
 EX 154
 QK 140,216,52
 EX 155
 QK 140,220,56
 CV 186,152,153
 CV 187,154,155
 EX 156
 EX 157
 PS 136
 PS 138
 QK 140,224,60
 EX 136
 LS 132,144,184
 EX 137
 PV 64,96,184
 CV 168,136,137
 CV 190,156,157
 PV 68,100,184
 EX 138
 EX 139
 EX 158
 PS 140
 PS 142
 PV 72,104,184
 EX 159
 PV 76,108,184
 CV 169,138,139
 CV 191,158,159
 PV 80,112,184
 EX 140
 PV 84,116,184
 EX 141
 PV 88,120,184
 EX 142
 PV 92,124,184
 EX 143
 v_mfma_f32_16x16x16_bf16 a[132:135], a[144:145], v[168:169], a[132:135]
 s_waitcnt lgkmcnt(7)
 CV 172,140,141
 CV 173,142,143
 PH 64,180,168
 s_waitcnt lgkmcnt(6)
 PH 68,184,168
 s_waitcnt lgkmcnt(5)
 PH 72,188,168
 s_waitcnt lgkmcnt(4)
 PH 76,192,168
 s_waitcnt lgkmcnt(3)
 PH 80,196,168
 s_waitcnt lgkmcnt(2)
 PH 84,200,168
 v_accvgpr_read_b32 v229, a132
 v_accvgpr_read_b32 v228, a133
 v_add_f32 v229, v228, v229
 v_add_f32 v229, v238, v229
 v_rcp_f32 v228, v229
 v_subrev_u32 v229, 0x21800000, v229
 PM 64,228,0
 PM 66,228,0
 PM 68,228,0
 PM 70,228,0
 PM 72,228,0
 PM 74,228,0
 PM 76,228,0
 PM 78,228,0
 v_max3_u32 v225, v225, v227, v229
 s_waitcnt lgkmcnt(1)
 PH 88,204,168
 s_waitcnt lgkmcnt(0)
 CV 64,64,65
 CV 65,66,67
 CV 66,68,69
 PH 92,208,168
 CV 67,70,71
 CV 72,72,73
 CV 73,74,75
 LS 132,136,188
 CV 74,76,77
 CV 75,78,79
 PV 96,96,188
 XE 68,72,64
 XE 69,73,65
 PV 100,100,188
 XE 70,74,66
 XE 71,75,67
 PV 104,104,188
 s_not_b64 vcc, vcc
 buffer_store_dwordx4 v[68:71], v220, s[24:27], s39 offen offset:0 nt
 XO 72,64,72
 PM 80,228,0
 PM 82,228,0
 PM 84,228,0
 PM 86,228,0
 PM 88,228,0
 PM 90,228,0
 PM 92,228,0
 PM 94,228,0
 PV 108,108,188
 XO 73,65,73
 XO 74,66,74
 PV 112,112,188
 XO 75,67,75
 CV 80,80,81
 PV 116,116,188
 CV 81,82,83
 CV 82,84,85
 PV 120,120,188
 CV 83,86,87
 CV 88,88,89
 PV 124,124,188
 buffer_store_dwordx4 v[72:75], v221, s[24:27], s39 offen offset:0 nt
 v_mfma_f32_16x16x16_bf16 a[132:135], a[136:137], v[172:173], a[132:135]
 CV 89,90,91
 CV 90,92,93
 CV 91,94,95
 PH 96,180,172
 XO 92,80,88
 XO 93,81,89
 XO 94,82,90
 PH 100,184,172
 XO 95,83,91
 v_accvgpr_read_b32 v231, a134
 v_accvgpr_read_b32 v230, a135
 v_add_f32 v231, v230, v231
 v_add_f32 v231, v239, v231
 v_rcp_f32 v230, v231
 v_subrev_u32 v231, 0x21800000, v231
 v_max_u32 v225, v225, v231
 v_cmp_le_u32 s[84:85], s77, v225
 PH 104,188,172
 s_not_b64 vcc, vcc
 XE 80,88,80
 XE 81,89,81
 PH 108,192,172
 buffer_store_dwordx4 v[92:95], v221, s[24:27], s39 offen offset:128 nt
 XE 82,90,82
 XE 83,91,83
 PM 96,230,0
 PM 98,230,0
 PM 100,230,0
 PM 102,230,0
 PM 104,230,0
 PM 106,230,0
 PM 108,230,0
 PM 110,230,0
 PH 112,196,172
 CV 96,96,97
 CV 97,98,99
 CV 98,100,101
 PH 116,200,172
 CV 99,102,103
 CV 104,104,105
 CV 105,106,107
 PH 120,204,172
 s_cmp_lg_u64 s[84:85], 0
 CV 106,108,109
 CV 107,110,111
 PH 124,208,172
 s_cselect_b32 s92, s76, 0
 buffer_store_dwordx4 v[80:83], v220, s[24:27], s39 offen offset:128 nt
 XE 100,104,96
 XE 101,105,97
 XE 102,106,98
 XE 103,107,99
 s_not_b64 vcc, vcc
 XO 104,96,104
 XO 105,97,105
 XO 106,98,106
 XO 107,99,107
 s_or_b32 s73, s73, s92
 s_lshl_b32 s76, s76, 1
 buffer_store_dwordx4 v[100:103], v220, s[24:27], s39 offen offset:256 nt
 PM 112,230,0
 PM 114,230,0
 PM 116,230,0
 PM 118,230,0
 CV 112,112,113
 CV 113,114,115
 CV 114,116,117
 CV 115,118,119
 PM 120,230,0
 PM 122,230,0
 PM 124,230,0
 PM 126,230,0
 CV 120,120,121
 CV 121,122,123
 CV 122,124,125
 CV 123,126,127
 XO 124,112,120
 XO 125,113,121
 XO 126,114,122
 XO 127,115,123
 s_not_b64 vcc, vcc
 XE 112,120,112
 XE 113,121,113
 XE 114,122,114
 XE 115,123,115
 buffer_store_dwordx4 v[104:107], v221, s[24:27], s39 offen offset:256 nt
 buffer_store_dwordx4 v[124:127], v221, s[24:27], s39 offen offset:384 nt
 buffer_store_dwordx4 v[112:115], v220, s[24:27], s39 offen offset:384 nt
 s_cmp_lg_u32 s73, 0
 s_cbranch_scc1 L_hop
 s_endpgm
.p2align 12
.fill 720, 4, 0xbf800000
L_w3:
 QZ 128,64,0
 s_cmp_eq_u32 s33, 0x8000
 RV 96,213,8192
 v_add_u32 v251, L_w3-L_pc-24576, v244
 QK 128,68,4
 s_cselect_b32 s32, -2, 1
 RV 98,213,12288
 SC 156
 QK 128,72,8
 s_lshl_b32 s32, s32, 14
 RV 100,213,8200
 v_add_u32 v212, s32, v212
 QK 128,76,12
 s_add_u32 s31, s33, s37
 RV 102,213,12296
 SC 157
 QZ 132,76,28
 s_add_u32 s33, s33, s32
 RV 104,213,8704
 SC 158
 QK 132,72,24
 s_add_u32 s31, s33, s37
 RV 106,213,12800
 SC 159
 QK 132,68,20
 RV 108,213,8712
 SC 128
 QK 132,64,16
 RV 110,213,12808
 SC 129
 QZ 136,64,32
 RV 112,213,9216
 SC 130
 QK 136,68,36
 RV 114,213,13312
 SC 131
 QK 136,72,40
 RV 116,213,9224
 SC 132
 QK 136,76,44
 RV 118,213,13320
 SC 133
 QZ 140,76,60
 RV 120,213,9728
 SC 134
 QK 140,72,56
 RV 122,213,13824
 SC 135
 QK 140,68,52
 RV 124,213,9736
 SC 136
 QK 140,64,48
 RV 126,213,13832
 v_add_u32 v213, s32, v213
 QZ 144,80,0
 s_cmp_eq_u32 s33, 0x8000
 global_load_dword v255, v251, s[64:65]
 SC 137
 QK 144,84,4
 s_cselect_b32 s32, -2, 1
 s_waitcnt vmcnt(9)
 RK 64,223,0
 SC 138
 QK 144,88,8
 s_lshl_b32 s32, s32, 14
 RK 68,223,1024
 SC 139
 QK 144,92,12
 s_add_u32 s33, s33, s32
 RK 72,223,2048
 SC 140
 QZ 148,92,28
 RK 76,223,3072
 SC 141
 QK 148,88,24
 EX 156
 QK 148,84,20
 EX 157
 QK 148,80,16
 CV 190,156,157
 SC 144
 QZ 152,80,32
 EX 158
 QK 152,84,36
 EX 159
 QK 152,88,40
 CV 191,158,159
 SC 145
 QK 152,92,44
 EX 128
 QZ 156,92,60
 s_waitcnt lgkmcnt(4)
 RK 92,223,7168
 SC 146
 QK 156,88,56
 s_barrier
 QK 156,84,52
 RK 148,212,0
 SC 147
 QK 156,80,48
 RK 152,212,512
 SC 148
 SM 128,176
 RK 156,212,1024
 SC 149
 SM 132,184
 RK 160,212,1536
 SC 150
 EX 129
 EX 130
 PS 152
 PS 154
 PS 156
 PS 158
 PV 96,96,188
 RK 164,212,4096
 CV 160,128,129
 PV 64,96,184
 RK 168,212,4608
 SC 151
 PV 32,96,180
 RK 172,212,5120
 SC 142
 PV 0,96,176
 RK 176,212,5632
 SC 143
 PV 4,100,176
 RV 180,213,0
 v_add_u32 v212, s32, v212
 PV 36,100,180
 RV 182,213,4096
 RV 184,213,8
 PV 68,100,184
 RV 186,213,4104
 EX 131
 PV 100,100,188
 RV 188,213,512
 CV 161,130,131
 PV 104,104,188
 RV 190,213,4608
 EX 132
 PV 72,104,184
 RV 192,213,520
 EX 133
 PV 40,104,180
 RV 194,213,4616
 CV 164,132,133
 PV 8,104,176
 RV 196,213,1024
 RV 198,213,5120
 PV 12,108,176
 EX 134
 PV 44,108,180
 RV 200,213,1032
 RV 202,213,5128
 PV 76,108,184
 EX 135
 PV 108,108,188
 RV 204,213,1536
 CV 165,134,135
 PV 112,112,188
 RV 206,213,5632
 RV 208,213,1544
 PV 80,112,184
 EX 144
 PV 48,112,180
 RV 210,213,5640
 RV 96,213,8192
 PV 16,112,176
 EX 145
 PV 20,116,176
 RV 98,213,12288
 CV 162,144,145
 PV 52,116,180
 RV 100,213,8200
 RV 102,213,12296
 PV 84,116,184
 EX 146
 PV 116,116,188
 RV 104,213,8704
 RV 106,213,12800
 PV 120,120,188
 EX 147
 PV 88,120,184
 RV 108,213,8712
 CV 163,146,147
 PV 56,120,180
 RV 110,213,12808
 RV 112,213,9216
 PV 24,120,176
 EX 148
 PV 28,124,176
 RV 114,213,13312
 RV 116,213,9224
 PV 60,124,180
 EX 149
 PV 92,124,184
 RV 118,213,13320
 CV 166,148,149
 PV 124,124,188
 s_waitcnt lgkmcnt(15)
 RV 120,213,9728
 RV 122,213,13824
 v_mfma_f32_16x16x32_bf16 v[128:131], a[148:151], a[0:3], v[208:211]
 s_waitcnt lgkmcnt(15)
 EX 150
 QK 128,152,4
 s_waitcnt lgkmcnt(15)
 RV 124,213,9736
 RV 126,213,13832
 QK 128,156,8
 s_waitcnt lgkmcnt(15)
 EX 151
 QK 128,160,12
 RK 80,223,4096
 CV 167,150,151
 v_mfma_f32_16x16x32_bf16 v[132:135], a[160:163], a[28:31], v[208:211]
 RK 84,223,5120
 v_add_u32 v213, s32, v213
 QK 132,156,24
 EX 136
 QK 132,152,20
 RK 88,223,6144
 SC 128
 QK 132,148,16
 SC 129
 SC 130
 SM 128,160
 s_waitcnt lgkmcnt(15)
 SC 131
 PV 32,180,164
 EX 128
 PV 0,180,160
 s_waitcnt lgkmcnt(15)
 EX 129
 PV 4,184,160
 CV 176,128,129
 SC 132
 PV 36,184,164
 s_waitcnt lgkmcnt(15)
 EX 130
 PV 40,188,164
 EX 131
 PV 8,188,160
 s_waitcnt lgkmcnt(15)
 CV 177,130,131
 SC 133
 PV 12,192,160
 EX 132
 PV 44,192,164
 s_waitcnt lgkmcnt(15)
 EX 133
 PV 48,196,164
 CV 180,132,133
 SC 134
 PV 16,196,160
 s_waitcnt lgkmcnt(15)
 EX 134
 PV 20,200,160
 EX 137
 PV 52,200,164
 s_waitcnt lgkmcnt(15)
 SC 135
 CV 168,136,137
 PV 56,204,164
 EX 135
 PV 24,204,160
 s_waitcnt lgkmcnt(15)
 EX 138
 PV 28,208,160
 EX 139
 PV 60,208,164
 CV 181,134,135
 CV 169,138,139
 QK 0,246,64
 EX 140
 QK 4,244,64
 s_waitcnt vmcnt(1) lgkmcnt(3)
 EX 141
 QK 12,244,68
 s_barrier
 QK 8,246,68
 RK 64,223,8192
 CV 172,140,141
 QK 16,246,72
 EX 142
 QK 20,244,72
 RK 68,223,9216
 RK 72,223,10240
 QK 28,244,76
 EX 143
 QK 24,246,76
 s_waitcnt lgkmcnt(5)
 RK 76,223,11264
 CV 173,142,143
 QK 32,246,80
 EX 152
 QK 36,244,80
 s_waitcnt lgkmcnt(5)
 EX 153
 QK 44,244,84
 RK 80,223,12288
 CV 170,152,153
 QK 40,246,84
 s_waitcnt lgkmcnt(5)
 EX 154
 QK 48,246,88
 EX 155
 QK 52,244,88
 RK 84,223,13312
 CV 171,154,155
 QK 60,244,92
 EX 156
 QK 56,246,92
 RK 88,223,14336
 RK 92,223,15360
 v_mfma_f32_16x16x16_bf16 a[128:131], a[144:145], v[176:177], a[128:131]
 EX 157
 EX 158
 PH 0,96,176
 EX 159
 CV 174,156,157
 PH 4,100,176
 CV 175,158,159
 PH 8,104,176
 v_accvgpr_read_b32 v225, a128
 v_accvgpr_read_b32 v224, a129
 v_add_f32 v225, v224, v225
 v_add_f32 v225, v236, v225
 v_rcp_f32 v224, v225
 v_subrev_u32 v225, 0x21800000, v225
 PM 0,224,0
 PM 2,224,0
 PM 4,224,0
 PM 6,224,0
 PM 8,224,0
 PM 10,224,0
 PH 12,108,176
 CV 0,0,1
 CV 1,2,3
 CV 2,4,5
 PH 16,112,176
 CV 3,6,7
 CV 8,8,9
 CV 9,10,11
 PH 20,116,176
 XE 4,8,0
 XE 5,9,1
 PM 12,224,0
 PM 14,224,0
 PH 24,120,176
 CV 10,12,13
 CV 11,14,15
 PH 28,124,176
 XE 6,10,2
 XE 7,11,3
 v_mfma_f32_16x16x16_bf16 a[128:131], a[136:137], v[180:181], a[128:131]
 s_not_b64 vcc, vcc
 buffer_store_dwordx4 v[4:7], v220, s[24:27], s38 offen offset:0 nt
 XO 8,0,8
 PM 16,224,0
 PM 18,224,0
 PM 20,224,0
 PM 22,224,0
 PM 24,224,0
 PM 26,224,0
 PM 28,224,0
 PM 30,224,0
 v_accvgpr_read_b32 v227, a130
 v_accvgpr_read_b32 v226, a131
 v_add_f32 v227, v226, v227
 v_add_f32 v227, v237, v227
 v_rcp_f32 v226, v227
 v_subrev_u32 v227, 0x21800000, v227
 PH 32,96,180
 XO 9,1,9
 XO 10,2,10
 XO 11,3,11
 PH 36,100,180
 CV 16,16,17
 CV 17,18,19
 CV 18,20,21
 PH 40,104,180
 buffer_store_dwordx4 v[8:11], v221, s[24:27], s38 offen offset:0 nt
 PH 44,108,180
 CV 19,22,23
 CV 24,24,25
 CV 25,26,27
 PH 48,112,180
 CV 26,28,29
 CV 27,30,31
 XO 28,16,24
 PH 52,116,180
 XO 29,17,25
 XO 30,18,26
 XO 31,19,27
 PH 56,120,180
 s_not_b64 vcc, vcc
 XE 16,24,16
 XE 17,25,17
 PH 60,124,180
 XE 18,26,18
 XE 19,27,19
 QZ 136,148,32
 QK 136,152,36
 buffer_store_dwordx4 v[28:31], v221, s[24:27], s38 offen offset:128 nt
 PM 32,226,0
 PM 34,226,0
 PM 36,226,0
 PM 38,226,0
 PM 40,226,0
 PM 42,226,0
 PM 44,226,0
 PM 46,226,0
 QK 136,156,40
 CV 32,32,33
 CV 33,34,35
 QK 136,160,44
 CV 34,36,37
 CV 35,38,39
 QZ 140,160,60
 CV 40,40,41
 CV 41,42,43
 QK 140,156,56
 CV 42,44,45
 CV 43,46,47
 QK 140,152,52
 buffer_store_dwordx4 v[16:19], v220, s[24:27], s38 offen offset:128 nt
 QK 140,148,48
 XE 36,40,32
 XE 37,41,33
 v_mfma_f32_16x16x32_bf16 v[152:155], a[164:167], a[32:35], v[208:211]
 XE 38,42,34
 XE 39,43,35
 QK 152,168,36
 s_not_b64 vcc, vcc
 XO 40,32,40
 XO 41,33,41
 QK 152,172,40
 XO 42,34,42
 XO 43,35,43
 QK 152,176,44
 SC 136
 SC 137
 v_mfma_f32_16x16x32_bf16 v[156:159], a[176:179], a[60:63], v[208:211]
 EX 136
 QK 156,172,56
 buffer_store_dwordx4 v[36:39], v220, s[24:27], s38 offen offset:256 nt
 EX 137
 PM 48,226,0
 PM 50,226,0
 PM 52,226,0
 PM 54,226,0
 PM 56,226,0
 PM 58,226,0
 PM 60,226,0
 PM 62,226,0
 QK 156,168,52
 CV 48,48,49
 CV 49,50,51
 QK 156,164,48
 s_waitcnt lgkmcnt(7)
 CV 50,52,53
 CV 51,54,55
 QK 64,246,64
 CV 56,56,57
 CV 57,58,59
 QK 68,244,64
 s_waitcnt lgkmcnt(6)
 buffer_store_dwordx4 v[40:43], v221, s[24:27], s38 offen offset:256 nt
 QK 76,244,68
 CV 58,60,61
 CV 59,62,63
 XO 60,48,56
 XO 61,49,57
 XO 62,50,58
 PS 156
 PS 158
 QK 72,246,68
 s_waitcnt lgkmcnt(5)
 XO 63,51,59
 CV 184,136,137
 QK 80,246,72
 s_not_b64 vcc, vcc
 XE 48,56,48
 XE 49,57,49
 QK 84,244,72
 s_waitcnt lgkmcnt(4)
 XE 50,58,50
 XE 51,59,51
 QK 92,244,76
 SC 138
 SC 139
 QK 88,246,76
 s_waitcnt lgkmcnt(3)
 buffer_store_dwordx4 v[60:63], v221, s[24:27], s38 offen offset:384 nt
 QK 96,246,80
 EX 138
 QK 100,244,80
 s_waitcnt lgkmcnt(2)
 EX 139
 QK 108,244,84
 CV 185,138,139
 SC 152
 QK 104,246,84
 s_waitcnt lgkmcnt(1)
 SC 153
 SC 154
 QK 112,246,88
 EX 152
 QK 116,244,88
 s_waitcnt lgkmcnt(0)
 EX 153
 QK 124,244,92
 buffer_store_dwordx4 v[48:51], v220, s[24:27], s38 offen offset:384 nt
 QK 120,246,92
 CV 186,152,153
 SC 155
 LS 132,144,168
 EX 154
 PV 64,180,168
 EX 155
 PV 68,184,168
 CV 187,154,155
 SC 140
 PV 72,188,168
 SC 141
 SC 142
 PV 76,192,168
 EX 140
 PV 80,196,168
 EX 141
 PV 84,200,168
 CV 188,140,141
 SC 143
 PV 88,204,168
 EX 142
 PV 92,208,168
 EX 143
 LS 132,144,184
 EX 156
 PV 64,96,184
 EX 157
 PV 68,100,184
 CV 189,142,143
 CV 190,156,157
 PV 72,104,184
 EX 158
 v_accvgpr_read_b32 v229, a132
 v_accvgpr_read_b32 v228, a133
 v_add_f32 v229, v228, v229
 v_add_f32 v229, v238, v229
 v_rcp_f32 v228, v229
 v_subrev_u32 v229, 0x21800000, v229
 PM 64,228,0
 PM 66,228,0
 PM 68,228,0
 PM 70,228,0
 PM 72,228,0
 PM 74,228,0
 v_max3_u32 v225, v225, v227, v229
 PV 76,108,184
 CV 64,64,65
 CV 65,66,67
 PV 80,112,184
 CV 66,68,69
 CV 67,70,71
 PV 84,116,184
 EX 159
 PV 88,120,184
 CV 72,72,73
 CV 73,74,75
 CV 191,158,159
 XE 68,72,64
 XE 69,73,65
 PM 76,228,0
 PM 78,228,0
 PV 92,124,184
 CV 74,76,77
 CV 75,78,79
 LS 132,136,172
 XE 70,74,66
 XE 71,75,67
 PV 96,180,172
 s_not_b64 vcc, vcc
 buffer_store_dwordx4 v[68:71], v220, s[24:27], s39 offen offset:0 nt
 XO 72,64,72
 PM 80,228,0
 PM 82,228,0
 PM 84,228,0
 PM 86,228,0
 PM 88,228,0
 PM 90,228,0
 PM 92,228,0
 PM 94,228,0
 PV 100,184,172
 XO 73,65,73
 XO 74,66,74
 PV 104,188,172
 XO 75,67,75
 CV 80,80,81
 PV 108,192,172
 CV 81,82,83
 CV 82,84,85
 PV 112,196,172
 CV 83,86,87
 CV 88,88,89
 PV 116,200,172
 buffer_store_dwordx4 v[72:75], v221, s[24:27], s39 offen offset:0 nt
 PV 120,204,172
 CV 89,90,91
 CV 90,92,93
 PV 124,208,172
 CV 91,94,95
 XO 92,80,88
 LS 132,136,188
 XO 93,81,89
 XO 94,82,90
 PV 96,96,188
 XO 95,83,91
 PV 100,100,188
 s_not_b64 vcc, vcc
 XE 80,88,80
 XE 81,89,81
 v_accvgpr_read_b32 v231, a134
 v_accvgpr_read_b32 v230, a135
 v_add_f32 v231, v230, v231
 v_add_f32 v231, v239, v231
 v_rcp_f32 v230, v231
 v_subrev_u32 v231, 0x21800000, v231
 v_max_u32 v225, v225, v231
 v_cmp_le_u32 s[84:85], s77, v225
 PV 104,104,188
 buffer_store_dwordx4 v[92:95], v221, s[24:27], s39 offen offset:128 nt
 XE 82,90,82
 PM 96,230,0
 PM 98,230,0
 PM 100,230,0
 PM 102,230,0
 PV 108,108,188
 s_cmp_lg_u64 s[84:85], 0
 XE 83,91,83
 CV 96,96,97
 CV 97,98,99
 CV 98,100,101
 CV 99,102,103
 PM 104,230,0
 PM 106,230,0
 PM 108,230,0
 PM 110,230,0
 PV 112,112,188
 s_cselect_b32 s92, s76, 0
 CV 104,104,105
 CV 105,106,107
 PV 116,116,188
 s_or_b32 s73, s73, s92
 CV 106,108,109
 CV 107,110,111
 PV 120,120,188
 s_lshl_b32 s76, s76, 1
 buffer_store_dwordx4 v[80:83], v220, s[24:27], s39 offen offset:128 nt
 PV 124,124,188
 XE 100,104,96
 XE 101,105,97
 XE 102,106,98
 XE 103,107,99
 s_not_b64 vcc, vcc
 XO 104,96,104
 XO 105,97,105
 XO 106,98,106
 XO 107,99,107
 v_mul_f32 v112, v230, v112
 v_mul_f32 v113, v230, v113
 v_mul_f32 v114, v230, v114
 v_mul_f32 v115, v230, v115
 v_mul_f32 v116, v230, v116
 v_mul_f32 v117, v230, v117
 v_mul_f32 v118, v230, v118
 v_mul_f32 v119, v230, v119
 CV 112,112,113
 CV 113,114,115
 CV 114,116,117
 CV 115,118,119
 v_mul_f32 v120, v230, v120
 buffer_store_dwordx4 v[100:103], v220, s[24:27], s39 offen offset:256 nt
 v_mul_f32 v121, v230, v121
 v_mul_f32 v122, v230, v122
 v_mul_f32 v123, v230, v123
 v_mul_f32 v124, v230, v124
 v_mul_f32 v125, v230, v125
 v_mul_f32 v126, v230, v126
 v_mul_f32 v127, v230, v127
 CV 120,120,121
 CV 121,122,123
 CV 122,124,125
 CV 123,126,127
 XO 124,112,120
 XO 125,113,121
 XO 126,114,122
 XO 127,115,123
 s_not_b64 vcc, vcc
 XE 112,120,112
 XE 113,121,113
 XE 114,122,114
 XE 115,123,115
 buffer_store_dwordx4 v[104:107], v221, s[24:27], s39 offen offset:256 nt
 buffer_store_dwordx4 v[124:127], v221, s[24:27], s39 offen offset:384 nt
 buffer_store_dwordx4 v[112:115], v220, s[24:27], s39 offen offset:384 nt
 s_cmp_lg_u32 s73, 0
 s_cbranch_scc1 L_hop
 s_endpgm
.p2align 12
L_T0:
 v_mfma_f32_16x16x32_bf16 v[128:131], a[64:67], a[0:3], v[208:211]
 s_add_u32 s31, s33, s37
 RV 96,213,8192
 SC 156
 QK 128,68,4
 s_mov_b32 s34, s45
 RV 98,213,12288
 SC 157
 QK 128,72,8
 s_and_b32 s62, s46, 0xfffff800
 RV 100,213,8200
 SC 158
 QK 128,76,12
 s_add_u32 s35, s34, 0x10000
 RV 102,213,12296
 SC 159
 v_mfma_f32_16x16x32_bf16 v[132:135], a[76:79], a[28:31], v[208:211]
 s_add_u32 s12, s86, s35
 RV 104,213,8704
 RV 106,213,12800
 QK 132,72,24
 s_addc_u32 s13, s87, 0
 RV 108,213,8712
 EX 156
 QK 132,68,20
 s_sub_u32 s14, s62, s35
 RV 110,213,12808
 EX 157
 QK 132,64,16
 s_max_i32 s14, s14, 0
 RV 112,213,9216
 CV 190,156,157
 QZ 136,64,32
 s_add_u32 m0, s31, 0
 RV 114,213,13312
 EX 158
 QK 136,68,36
 s_add_u32 s20, s60, s34
 RV 116,213,9224
 RV 118,213,13320
 QK 136,72,40
 s_addc_u32 s21, s61, 0
 EX 159
 QK 136,76,44
 s_sub_u32 s22, s62, s34
 RV 120,213,9728
 CV 191,158,159
 QZ 140,76,60
 s_max_i32 s22, s22, 0
 RV 122,213,13824
 RV 124,213,9736
 QK 140,72,56
 s_add_u32 s34, s34, 0x20000
 QK 140,68,52
 s_add_u32 s16, s86, s34
 RV 126,213,13832
 s_waitcnt vmcnt(8)
 RK 0,219,0
 QK 140,64,48
 s_addc_u32 s17, s87, 0
 QZ 152,80,32
 s_sub_u32 s18, s62, s34
 RK 4,219,512
 RK 8,219,1024
 QK 152,84,36
 s_max_i32 s18, s18, 0
 QK 152,88,40
 s_cmp_eq_u32 s33, 0x8000
 RK 12,219,1536
 RK 28,219,5632
 PS 128
 PS 130
 PS 132
 PS 134
 PS 136
 PS 138
 PS 140
 PS 142
 QK 152,92,44
 s_cselect_b32 s32, -2, 1
 RK 24,219,5120
 RK 20,219,4608
 QZ 156,92,60
 s_waitcnt lgkmcnt(7)
 EX 128
 QK 156,88,56
 s_barrier
 QK 156,84,52
 s_lshl_b32 s32, s32, 14
 buffer_load_dwordx4 v215, s[12:15], 0 offen offset:0 lds
 v_add_u32 v212, s32, v212
 QK 156,80,48
 s_add_u32 m0, s31, 896
 RK 148,212,0
 v_add_u32 v213, s32, v213
 SM 128,176
 s_add_u32 s33, s33, s32
 RK 152,212,512
 RK 156,212,1024
 SM 132,184
 s_cmp_eq_u32 s33, 0x8000
 RK 160,212,1536
 EX 129
 EX 130
 PS 152
 PS 154
 PS 156
 PS 158
 PV 96,96,188
 s_cselect_b32 s32, -2, 1
 buffer_load_dwordx4 v215, s[12:15], 0 offen offset:128 lds
 CV 160,128,129
 PV 64,96,184
 s_add_u32 m0, s31, 49152
 RK 164,212,4096
 RK 168,212,4608
 PV 32,96,180
 s_lshl_b32 s32, s32, 14
 RK 172,212,5120
 EX 131
 PV 0,96,176
 s_cmp_eq_u32 s79, 2
 RK 176,212,5632
 CV 161,130,131
 PV 4,100,176
 s_cselect_b32 s95, 1, 0
 RV 180,213,0
 v_mul_u32_u24 v235, s95, v247
 PV 36,100,180
 s_add_u32 s35, s34, 0x10000
 RV 182,213,4096
 buffer_load_dwordx4 v216, s[20:23], 0 offen offset:0 lds
 PV 68,100,184
 s_add_u32 m0, s31, 50048
 RV 184,213,8
 EX 132
 PV 100,100,188
 s_add_u32 s12, s86, s35
 RV 186,213,4104
 EX 133
 PV 104,104,188
 s_addc_u32 s13, s87, 0
 RV 188,213,512
 CV 164,132,133
 PV 72,104,184
 s_sub_u32 s14, s62, s35
 RV 190,213,4608
 RV 192,213,520
 PV 40,104,180
 s_max_i32 s14, s14, 0
 EX 134
 PV 8,104,176
 s_mov_b64 s[40:41], s[44:45]
 buffer_load_dwordx4 v216, s[20:23], 0 offen offset:128 lds
 RV 194,213,4616
 PV 12,108,176
 s_add_u32 m0, s31, 57344
 RV 196,213,1024
 RV 198,213,5120
 PV 44,108,180
 s_mov_b64 s[42:43], s[46:47]
 EX 135
 PV 76,108,184
 s_mov_b64 s[44:45], s[48:49]
 RV 200,213,1032
 CV 165,134,135
 PV 108,108,188
 s_mov_b64 s[46:47], s[50:51]
 RV 202,213,5128
 RV 204,213,1536
 PV 112,112,188
 s_mov_b64 s[48:49], s[52:53]
 EX 136
 PV 80,112,184
 s_mov_b64 s[50:51], s[54:55]
 buffer_load_dwordx4 v214, s[20:23], 0 offen offset:0 lds
 RV 206,213,5632
 PV 48,112,180
 s_add_u32 m0, s31, 58240
 RV 208,213,1544
 RV 210,213,5640
 PV 16,112,176
 s_mov_b64 s[52:53], s[56:57]
 EX 137
 PV 20,116,176
 s_mov_b64 s[54:55], s[58:59]
 RK 212,212,8192
 CV 168,136,137
 PV 52,116,180
 s_and_b32 s30, s43, 0x3f
 RK 216,212,8704
 RK 220,212,9216
 PV 84,116,184
 s_bfe_u32 s83, s42, 0x20006
 EX 138
 PV 116,116,188
 s_and_b32 s89, s47, 0x100
 buffer_load_dwordx4 v214, s[20:23], 0 offen offset:128 lds
 RK 224,212,9728
 PV 120,120,188
 s_cselect_b32 s89, 0x10000, 0
 RK 228,212,12288
 RK 232,212,12800
 PV 88,120,184
 s_add_u32 m0, s31, 8192
 EX 139
 PV 56,120,180
 s_add_u32 s20, s60, s34
 RK 236,212,13312
 CV 169,138,139
 PV 24,120,176
 s_addc_u32 s21, s61, 0
 RK 240,212,13824
 v_add_u32 v212, s32, v212
 PV 28,124,176
 s_sub_u32 s22, s62, s34
 RV 96,213,8192
 RV 98,213,12288
 PV 60,124,180
 s_max_i32 s22, s22, 0
 buffer_load_dwordx4 v215, s[16:19], 0 offen offset:0 lds
 RV 100,213,8200
 PV 92,124,184
 s_add_u32 m0, s31, 9088
 EX 140
 PV 124,124,188
 s_add_u32 s31, s33, s37
 RV 102,213,12296
 RV 104,213,8704
 v_mfma_f32_16x16x16_bf16 a[128:131], a[144:145], v[160:161], a[128:131]
 s_add_u32 s34, s34, 0x20000
 EX 141
 v_mfma_f32_16x16x16_bf16 a[128:131], a[136:137], v[164:165], a[128:131]
 s_waitcnt lgkmcnt(15)
 RV 106,213,12800
 EX 142
 PH 32,180,164
 RV 108,213,8712
 EX 143
 PH 0,180,160
 buffer_load_dwordx4 v215, s[16:19], 0 offen offset:128 lds
 CV 172,140,141
 CV 173,142,143
 v_accvgpr_read_b32 v225, a128
 v_accvgpr_read_b32 v224, a129
 v_add_f32 v225, v224, v225
 v_rcp_f32 v224, v225
 v_subrev_u32 v225, 0x21800000, v225
 PM 0,224,0
 PM 2,224,0
 v_accvgpr_read_b32 v227, a130
 v_accvgpr_read_b32 v226, a131
 v_add_f32 v227, v226, v227
 v_rcp_f32 v226, v227
 v_subrev_u32 v227, 0x21800000, v227
 s_waitcnt lgkmcnt(15)
 PH 4,184,160
 s_add_u32 m0, s31, 0
 RV 110,213,12808
 CV 0,0,1
 PH 36,184,164
 s_add_u32 s16, s86, s34
 RV 112,213,9216
 CV 1,2,3
 s_waitcnt lgkmcnt(15)
 PH 40,188,164
 s_addc_u32 s17, s87, 0
 RV 114,213,13312
 RV 116,213,9224
 EX 152
 EX 153
 PM 4,224,0
 PM 6,224,0
 PH 8,188,160
 s_sub_u32 s18, s62, s34
 RV 118,213,13320
 CV 170,152,153
 s_waitcnt lgkmcnt(15)
 PH 12,192,160
 s_max_i32 s18, s18, 0
 RV 120,213,9728
 CV 2,4,5
 PH 44,192,164
 RV 122,213,13824
 EX 154
 EX 155
 EX 156
 PM 8,224,0
 PM 10,224,0
 PM 12,224,0
 PM 14,224,0
 s_waitcnt lgkmcnt(15)
 PH 48,196,164
 RV 124,213,9736
 CV 171,154,155
 CV 3,6,7
 PH 16,196,160
 s_waitcnt lgkmcnt(15)
 RV 126,213,13832
 v_add_u32 v213, s32, v213
 CV 8,8,9
 PH 20,200,160
 global_load_dword v255, v235, s[64:65]
 EX 157
 PH 52,200,164
 s_waitcnt lgkmcnt(15)
 RK 16,219,4096
 CV 174,156,157
 CV 9,10,11
 PH 56,204,164
 EX 158
 CV 10,12,13
 PH 24,204,160
 s_waitcnt lgkmcnt(15)
 EX 159
 CV 11,14,15
 PH 28,208,160
 CV 175,158,159
 XE 4,8,0
 XE 5,9,1
 PH 60,208,164
 XE 6,10,2
 XE 7,11,3
 QZ 136,148,32
 s_not_b64 vcc, vcc
 buffer_store_dwordx4 v[4:7], v220, s[24:27], s38 offen offset:0 nt
 XO 8,0,8
 PM 16,224,0
 PM 18,224,0
 PM 20,224,0
 PM 22,224,0
 PM 24,224,0
 PM 26,224,0
 PM 28,224,0
 PM 30,224,0
 QK 136,152,36
 s_waitcnt vmcnt(10) lgkmcnt(1)
 XO 9,1,9
 XO 10,2,10
 QK 136,156,40
 s_barrier
 QK 136,160,44
 s_add_u32 s33, s33, s32
 XO 11,3,11
 CV 16,16,17
 QZ 140,160,60
 s_cmp_eq_u32 s33, 0x8000
 RK 160,212,1536
 CV 17,18,19
 QK 140,156,56
 s_cselect_b32 s32, -2, 1
 RK 156,212,1024
 CV 18,20,21
 QK 140,152,52
 s_lshl_b32 s32, s32, 14
 RK 152,212,512
 CV 19,22,23
 QK 140,148,48
 s_add_u32 s82, s82, s32
 RK 148,212,0
 CV 24,24,25
 QZ 152,164,32
 s_add_u32 s72, s45, s89
 buffer_load_dwordx4 v215, s[12:15], 0 offen offset:0 lds
 CV 25,26,27
 QK 152,168,36
 s_add_u32 m0, s31, 896
 CV 26,28,29
 CV 27,30,31
 XO 28,16,24
 XO 29,17,25
 XO 30,18,26
 PS 136
 PS 138
 PS 140
 PS 142
 QK 152,172,40
 EX 136
 QK 152,176,44
 EX 137
 QZ 156,176,60
 RK 176,212,5632
 CV 184,136,137
 QK 156,172,56
 RK 172,212,5120
 XO 31,19,27
 QK 156,168,52
 s_not_b64 vcc, vcc
 RK 168,212,4608
 XE 16,24,16
 QK 156,164,48
 RK 164,212,4096
 XE 17,25,17
 SM 132,168
 buffer_load_dwordx4 v215, s[12:15], 0 offen offset:128 lds
 PV 96,180,172
 s_add_u32 m0, s31, 49152
 EX 138
 PV 64,180,168
 RV 180,213,0
 XE 18,26,18
 EX 139
 EX 140
 PS 152
 PS 154
 PS 156
 PS 158
 PV 68,184,168
 RV 182,213,4096
 CV 185,138,139
 PV 100,184,172
 RV 184,213,8
 XE 19,27,19
 PV 104,188,172
 RV 186,213,4104
 buffer_load_dwordx4 v216, s[20:23], 0 offen offset:0 lds
 PV 72,188,168
 s_add_u32 m0, s31, 50048
 RV 188,213,512
 RV 190,213,4608
 PV 76,192,168
 EX 141
 PV 108,192,172
 RV 192,213,520
 CV 188,140,141
 PV 112,196,172
 RV 194,213,4616
 EX 142
 PV 80,196,168
 RV 196,213,1024
 RV 198,213,5120
 PV 84,200,168
 buffer_load_dwordx4 v216, s[20:23], 0 offen offset:128 lds
 EX 143
 PV 116,200,172
 s_add_u32 m0, s31, 57344
 RV 200,213,1032
 CV 189,142,143
 PV 120,204,172
 RV 202,213,5128
 EX 152
 PV 88,204,168
 RV 204,213,1536
 RV 206,213,5632
 PV 92,208,168
 EX 153
 PV 124,208,172
 RV 208,213,1544
 CV 186,152,153
 QZ 136,212,32
 RV 210,213,5640
 buffer_load_dwordx4 v214, s[20:23], 0 offen offset:0 lds
 QK 136,216,36
 s_add_u32 m0, s31, 58240
 EX 154
 QK 136,220,40
 EX 155
 QK 136,224,44
 EX 156
 QZ 140,224,60
 RK 224,212,9728
 CV 187,154,155
 QK 140,220,56
 RK 220,212,9216
 EX 157
 QK 140,216,52
 RK 216,212,8704
 CV 190,156,157
 QK 140,212,48
 RK 212,212,8192
 buffer_load_dwordx4 v214, s[20:23], 0 offen offset:128 lds
 QZ 152,228,32
 s_add_u32 m0, s31, 8192
 EX 158
 QK 152,232,36
 EX 159
 QK 152,236,40
 CV 191,158,159
 PS 136
 PS 138
 PS 140
 PS 142
 QK 152,240,44
 buffer_load_dwordx4 v215, s[16:19], 0 offen offset:0 lds
 EX 136
 QZ 156,240,60
 s_add_u32 m0, s31, 9088
 RK 240,212,13824
 EX 137
 QK 156,236,56
 s_add_u32 s31, s33, s37
 RK 236,212,13312
 CV 168,136,137
 QK 156,232,52
 s_add_u32 s33, s33, s32
 RK 232,212,12800
 EX 138
 QK 156,228,48
 RK 228,212,12288
 v_add_u32 v212, s82, v212
 SM 132,184
 buffer_load_dwordx4 v215, s[16:19], 0 offen offset:128 lds
 PV 96,96,188
 EX 139
 PV 64,96,184
 RV 96,213,8192
 CV 169,138,139
 EX 140
 EX 141
 PS 152
 PS 154
 PS 156
 PS 158
 PV 68,100,184
 RV 98,213,12288
 CV 172,140,141
 PV 100,100,188
 RV 100,213,8200
 RV 102,213,12296
 PV 104,104,188
 buffer_store_dwordx4 v[8:11], v221, s[24:27], s38 offen offset:0 nt
 PV 72,104,184
 RV 104,213,8704
 RV 106,213,12800
 PV 76,108,184
 EX 142
 PV 108,108,188
 RV 108,213,8712
 RV 110,213,12808
 PV 112,112,188
 EX 143
 PV 80,112,184
 RV 112,213,9216
 CV 173,142,143
 PV 84,116,184
 RV 114,213,13312
 EX 152
 PV 116,116,188
 RV 116,213,9224
 RV 118,213,13320
 PV 120,120,188
 EX 153
 PV 88,120,184
 RV 120,213,9728
 CV 170,152,153
 PV 92,124,184
 RV 122,213,13824
 EX 154
 PV 124,124,188
 s_waitcnt lgkmcnt(15)
 RV 124,213,9736
 RV 126,213,13832
 QZ 136,148,32
 buffer_store_dwordx4 v[28:31], v221, s[24:27], s38 offen offset:128 nt
 EX 155
 PM 32,226,0
 PM 34,226,0
 PM 36,226,0
 PM 38,226,0
 PM 40,226,0
 PM 42,226,0
 PM 44,226,0
 PM 46,226,0
 QK 136,152,36
 CV 32,32,33
 CV 33,34,35
 QK 136,156,40
 CV 34,36,37
 CV 35,38,39
 QK 136,160,44
 CV 40,40,41
 CV 41,42,43
 QZ 140,160,60
 CV 42,44,45
 CV 43,46,47
 QK 140,156,56
 XE 36,40,32
 XE 37,41,33
 QK 140,152,52
 XE 38,42,34
 XE 39,43,35
 QK 140,148,48
 s_not_b64 vcc, vcc
 buffer_store_dwordx4 v[16:19], v220, s[24:27], s38 offen offset:128 nt
 XO 40,32,40
 XO 41,33,41
 XO 42,34,42
 XO 43,35,43
 CV 171,154,155
 s_waitcnt lgkmcnt(15)
 v_mfma_f32_16x16x32_bf16 v[152:155], a[164:167], a[32:35], v[208:211]
 RK 32,219,8192
 v_add_u32 v213, s32, v213
 EX 156
 EX 157
 PS 136
 PS 138
 PS 140
 PS 142
 QK 152,168,36
 RK 36,219,8704
 CV 174,156,157
 QK 152,172,40
 EX 158
 QK 152,176,44
 RK 40,219,9216
 RK 44,219,9728
 EX 159
 EX 136
 CV 175,158,159
 v_mfma_f32_16x16x32_bf16 v[156:159], a[176:179], a[60:63], v[208:211]
 buffer_store_dwordx4 v[36:39], v220, s[24:27], s38 offen offset:256 nt
 EX 137
 PM 48,226,0
 PM 50,226,0
 PM 52,226,0
 PM 54,226,0
 PM 56,226,0
 PM 58,226,0
 PM 60,226,0
 PM 62,226,0
 QK 156,172,56
 RK 60,219,13824
 CV 48,48,49
 QK 156,168,52
 RK 56,219,13312
 CV 49,50,51
 QK 156,164,48
 RK 52,219,12800
 CV 50,52,53
 SM 132,168
 s_waitcnt lgkmcnt(15)
 RK 48,219,12288
 CV 51,54,55
 PV 96,180,172
 CV 56,56,57
 CV 57,58,59
 CV 58,60,61
 CV 59,62,63
 XO 60,48,56
 PS 152
 PS 154
 PS 156
 PS 158
 PV 64,180,168
 s_waitcnt vmcnt(14) lgkmcnt(8)
 buffer_store_dwordx4 v[40:43], v221, s[24:27], s38 offen offset:256 nt
 PV 68,184,168
 s_barrier
 PV 100,184,172
 RK 64,212,0
 XO 61,49,57
 PV 104,188,172
 RK 68,212,512
 XO 62,50,58
 PV 72,188,168
 RK 72,212,1024
 XO 63,51,59
 PV 76,192,168
 s_not_b64 vcc, vcc
 RK 76,212,1536
 XE 48,56,48
 PV 108,192,172
 RK 80,212,4096
 XE 49,57,49
 PV 112,196,172
 RK 84,212,4608
 XE 50,58,50
 PV 80,196,168
 RK 88,212,5120
 XE 51,59,51
 PV 84,200,168
 buffer_store_dwordx4 v[60:63], v221, s[24:27], s38 offen offset:384 nt
 PV 116,200,172
 RK 92,212,5632
 CV 184,136,137
 PV 120,204,172
 EX 138
 PV 88,204,168
 EX 139
 PV 92,208,168
 EX 152
 PV 124,208,172
 EX 153
 QZ 128,212,0
 CV 185,138,139
 CV 186,152,153
 QK 128,216,4
 EX 154
 QK 128,220,8
 EX 155
 QK 128,224,12
 s_waitcnt lgkmcnt(0)
 buffer_store_dwordx4 v[48:51], v220, s[24:27], s38 offen offset:384 nt
 QZ 132,224,28
 s_mov_b32 s38, s80
 EX 140
 QK 132,220,24
 EX 141
 QK 132,216,20
 CV 187,154,155
 CV 188,140,141
 QK 132,212,16
 EX 142
 QZ 144,228,0
 EX 143
 QK 144,232,4
 EX 156
 QK 144,236,8
 EX 157
 QK 144,240,12
 CV 189,142,143
 CV 190,156,157
 EX 158
 EX 159
 PS 128
 PS 130
 PS 132
 PS 134
 QZ 148,240,28
 EX 128
 QK 148,236,24
 EX 129
 QK 148,232,20
 CV 191,158,159
 CV 192,128,129
 QK 148,228,16
 EX 130
 LS 132,144,184
 EX 131
 PV 64,96,184
 EX 132
 PV 68,100,184
 EX 133
 PV 72,104,184
 CV 193,130,131
 CV 196,132,133
 v_accvgpr_read_b32 v229, a132
 v_accvgpr_read_b32 v228, a133
 v_add_f32 v229, v228, v229
 PS 144
 PS 146
 PS 148
 PS 150
 v_rcp_f32 v228, v229
 v_subrev_u32 v229, 0x21800000, v229
 PM 64,228,0
 PM 66,228,0
 PM 68,228,0
 PM 70,228,0
 PM 72,228,0
 PM 74,228,0
 v_max3_u32 v225, v225, v227, v229
 PV 76,108,184
 CV 64,64,65
 CV 65,66,67
 PV 80,112,184
 CV 66,68,69
 CV 67,70,71
 PV 84,116,184
 EX 134
 PV 88,120,184
 EX 135
 CV 72,72,73
 CV 73,74,75
 CV 197,134,135
 PM 76,228,0
 PM 78,228,0
 PV 92,124,184
 CV 74,76,77
 CV 75,78,79
 LS 132,136,188
 XE 68,72,64
 XE 69,73,65
 PV 96,96,188
 XE 70,74,66
 XE 71,75,67
 PV 100,100,188
 s_not_b64 vcc, vcc
 buffer_store_dwordx4 v[68:71], v220, s[24:27], s39 offen offset:0 nt
 v_accvgpr_read_b32 v231, a134
 PM 80,228,0
 PM 82,228,0
 PM 84,228,0
 PM 86,228,0
 PM 88,228,0
 PM 90,228,0
 PM 92,228,0
 PM 94,228,0
 v_accvgpr_read_b32 v230, a135
 v_add_f32 v231, v230, v231
 v_rcp_f32 v230, v231
 v_subrev_u32 v231, 0x21800000, v231
 v_max_u32 v225, v225, v231
 v_cmp_le_u32 s[84:85], s77, v225
 PV 104,104,188
 XO 72,64,72
 XO 73,65,73
 PV 108,108,188
 s_cmp_lg_u64 s[84:85], 0
 XO 74,66,74
 XO 75,67,75
 PV 112,112,188
 s_cselect_b32 s92, s76, 0
 CV 80,80,81
 CV 81,82,83
 PV 116,116,188
 s_or_b32 s73, s73, s92
 CV 82,84,85
 CV 83,86,87
 PV 120,120,188
 s_lshl_b32 s76, s76, 1
 buffer_store_dwordx4 v[72:75], v221, s[24:27], s39 offen offset:0 nt
 PV 124,124,188
 CV 88,88,89
 CV 89,90,91
 QZ 136,212,32
 CV 90,92,93
 CV 91,94,95
 QK 136,216,36
 XO 92,80,88
 XO 93,81,89
 QK 136,220,40
 XO 94,82,90
 XO 95,83,91
 QK 136,224,44
 s_not_b64 vcc, vcc
 XE 80,88,80
 XE 81,89,81
 QZ 140,224,60
 XE 82,90,82
 XE 83,91,83
 QK 140,220,56
 v_mul_f32 v112, v230, v112
 v_mul_f32 v113, v230, v113
 QK 140,216,52
 v_mul_f32 v114, v230, v114
 v_mul_f32 v115, v230, v115
 QK 140,212,48
 buffer_store_dwordx4 v[92:95], v221, s[24:27], s39 offen offset:128 nt
 v_mul_f32 v116, v230, v116
 PM 96,230,0
 PM 98,230,0
 PM 100,230,0
 PM 102,230,0
 PM 104,230,0
 PM 106,230,0
 PM 108,230,0
 PM 110,230,0
 PS 136
 PS 138
 PS 140
 PS 142
 QZ 152,228,32
 CV 96,96,97
 CV 97,98,99
 QK 152,232,36
 CV 98,100,101
 CV 99,102,103
 QK 152,236,40
 CV 104,104,105
 CV 105,106,107
 QK 152,240,44
 CV 106,108,109
 CV 107,110,111
 QZ 156,240,60
 XE 100,104,96
 XE 101,105,97
 QK 156,236,56
 buffer_store_dwordx4 v[80:83], v220, s[24:27], s39 offen offset:128 nt
 QK 156,232,52
 XE 102,106,98
 XE 103,107,99
 v_mul_f32 v117, v230, v117
 v_mul_f32 v118, v230, v118
 v_mul_f32 v119, v230, v119
 PS 152
 PS 154
 QK 156,228,48
 s_not_b64 vcc, vcc
 XO 104,96,104
 XO 105,97,105
 XO 106,98,106
 XO 107,99,107
 CV 112,112,113
 CV 113,114,115
 CV 114,116,117
 CV 115,118,119
 v_mul_f32 v120, v230, v120
 v_mul_f32 v121, v230, v121
 v_mul_f32 v122, v230, v122
 v_mul_f32 v123, v230, v123
 v_mul_f32 v124, v230, v124
 v_mul_f32 v125, v230, v125
 v_mul_f32 v126, v230, v126
 v_mul_f32 v127, v230, v127
 CV 120,120,121
 CV 121,122,123
 CV 122,124,125
 CV 123,126,127
 XO 124,112,120
 XO 125,113,121
 XO 126,114,122
 buffer_store_dwordx4 v[100:103], v220, s[24:27], s39 offen offset:256 nt
 XO 127,115,123
 s_not_b64 vcc, vcc
 XE 112,120,112
 XE 113,121,113
 XE 114,122,114
 XE 115,123,115
 EX 144
 EX 145
 EX 146
 CV 194,144,145
 EX 147
 EX 148
 CV 195,146,147
 EX 149
 EX 150
 CV 198,148,149
 EX 151
 EX 136
 CV 199,150,151
 EX 137
 EX 138
 CV 200,136,137
 EX 139
 buffer_store_dwordx4 v[104:107], v221, s[24:27], s39 offen offset:256 nt
 CV 201,138,139
 EX 140
 EX 141
 EX 142
 CV 204,140,141
 EX 143
 EX 152
 CV 205,142,143
 EX 153
 EX 154
 CV 202,152,153
 EX 155
 buffer_store_dwordx4 v[124:127], v221, s[24:27], s39 offen offset:384 nt
 CV 203,154,155
 buffer_store_dwordx4 v[112:115], v220, s[24:27], s39 offen offset:384 nt
 s_mov_b32 s39, s81
 s_and_b32 s26, s43, 0xfffff000
 s_cmp_eq_u32 s79, 0
 s_cbranch_scc1 L_Fe
 s_cmp_eq_u32 s79, 1
 s_cbranch_scc1 L_Fo
 s_cmp_eq_u32 s79, 2
 s_cbranch_scc0 L_init
 s_bitcmp1_b32 s43, 7
 s_cbranch_scc0 L_Z0
 s_branch L_z0
.p2align 12
L_T1:
 QZ 128,64,0
 s_add_u32 s31, s33, s37
 RV 96,213,8192
 SC 156
 QK 128,68,4
 s_mov_b32 s34, s45
 RV 98,213,12288
 SC 157
 QK 128,72,8
 s_and_b32 s62, s46, 0xfffff800
 RV 100,213,8200
 SC 158
 QK 128,76,12
 s_add_u32 s35, s34, 0x10000
 RV 102,213,12296
 SC 159
 QZ 132,76,28
 s_add_u32 s12, s86, s35
 RV 104,213,8704
 RV 106,213,12800
 QK 132,72,24
 s_addc_u32 s13, s87, 0
 RV 108,213,8712
 EX 156
 QK 132,68,20
 s_sub_u32 s14, s62, s35
 RV 110,213,12808
 EX 157
 QK 132,64,16
 s_max_i32 s14, s14, 0
 RV 112,213,9216
 CV 190,156,157
 QZ 136,64,32
 s_add_u32 m0, s31, 0
 RV 114,213,13312
 EX 158
 QK 136,68,36
 s_add_u32 s20, s60, s34
 RV 116,213,9224
 RV 118,213,13320
 QK 136,72,40
 s_addc_u32 s21, s61, 0
 EX 159
 QK 136,76,44
 s_sub_u32 s22, s62, s34
 RV 120,213,9728
 CV 191,158,159
 QZ 140,76,60
 s_max_i32 s22, s22, 0
 RV 122,213,13824
 RV 124,213,9736
 QK 140,72,56
 s_add_u32 s34, s34, 0x20000
 QK 140,68,52
 s_add_u32 s16, s86, s34
 RV 126,213,13832
 QK 140,64,48
 s_addc_u32 s17, s87, 0
 v_mfma_f32_16x16x32_bf16 v[144:147], a[80:83], a[0:3], v[208:211]
 s_sub_u32 s18, s62, s34
 s_waitcnt vmcnt(8)
 RK 0,219,0
 QK 144,84,4
 s_max_i32 s18, s18, 0
 RK 4,219,512
 QK 144,88,8
 s_cmp_eq_u32 s33, 0x8000
 RK 8,219,1024
 PS 128
 PS 130
 PS 132
 PS 134
 PS 136
 PS 138
 PS 140
 PS 142
 QK 144,92,12
 s_cselect_b32 s32, -2, 1
 EX 128
 v_mfma_f32_16x16x32_bf16 v[148:151], a[92:95], a[28:31], v[208:211]
 s_waitcnt lgkmcnt(3)
 RK 12,219,1536
 RK 28,219,5632
 QK 148,88,24
 s_barrier
 QK 148,84,20
 s_lshl_b32 s32, s32, 14
 buffer_load_dwordx4 v215, s[12:15], 0 offen offset:0 lds
 v_add_u32 v212, s32, v212
 QK 148,80,16
 s_add_u32 m0, s31, 896
 RK 148,212,0
 v_add_u32 v213, s32, v213
 QZ 152,80,32
 s_add_u32 s33, s33, s32
 RK 152,212,512
 RK 156,212,1024
 QK 152,84,36
 s_cmp_eq_u32 s33, 0x8000
 RK 160,212,1536
 EX 129
 QK 152,88,40
 s_cselect_b32 s32, -2, 1
 RK 164,212,4096
 CV 160,128,129
 QK 152,92,44
 s_lshl_b32 s32, s32, 14
 RK 168,212,4608
 buffer_load_dwordx4 v215, s[12:15], 0 offen offset:128 lds
 QZ 156,92,60
 s_add_u32 m0, s31, 49152
 RK 172,212,5120
 EX 130
 QK 156,88,56
 s_cmp_eq_u32 s79, 2
 RK 176,212,5632
 EX 131
 QK 156,84,52
 s_cselect_b32 s95, 1, 0
 RV 180,213,0
 v_mul_u32_u24 v235, s95, v247
 QK 156,80,48
 s_add_u32 s35, s34, 0x10000
 RV 182,213,4096
 CV 161,130,131
 SM 128,176
 s_add_u32 s12, s86, s35
 RV 184,213,8
 buffer_load_dwordx4 v216, s[20:23], 0 offen offset:0 lds
 SM 132,184
 s_addc_u32 s13, s87, 0
 RV 186,213,4104
 RV 188,213,512
 EX 132
 EX 133
 PS 144
 PS 146
 PS 148
 PS 150
 PS 152
 PS 154
 PS 156
 PS 158
 PV 96,96,188
 s_add_u32 m0, s31, 50048
 RV 190,213,4608
 CV 164,132,133
 PV 64,96,184
 s_sub_u32 s14, s62, s35
 buffer_load_dwordx4 v216, s[20:23], 0 offen offset:128 lds
 RV 192,213,520
 PV 32,96,180
 s_add_u32 m0, s31, 57344
 RV 194,213,4616
 RV 196,213,1024
 PV 0,96,176
 s_max_i32 s14, s14, 0
 EX 134
 PV 4,100,176
 s_mov_b64 s[40:41], s[44:45]
 RV 198,213,5120
 RV 200,213,1032
 PV 36,100,180
 s_mov_b64 s[42:43], s[46:47]
 EX 135
 PV 68,100,184
 s_mov_b64 s[44:45], s[48:49]
 RV 202,213,5128
 CV 165,134,135
 PV 100,100,188
 s_mov_b64 s[46:47], s[50:51]
 buffer_load_dwordx4 v214, s[20:23], 0 offen offset:0 lds
 RV 204,213,1536
 PV 104,104,188
 s_add_u32 m0, s31, 58240
 RV 206,213,5632
 RV 208,213,1544
 PV 72,104,184
 s_mov_b64 s[48:49], s[52:53]
 EX 144
 PV 40,104,180
 s_mov_b64 s[50:51], s[54:55]
 RV 210,213,5640
 RK 212,212,8192
 PV 8,104,176
 s_mov_b64 s[52:53], s[56:57]
 EX 145
 PV 12,108,176
 s_mov_b64 s[54:55], s[58:59]
 RK 216,212,8704
 CV 162,144,145
 PV 44,108,180
 s_and_b32 s30, s43, 0x3f
 buffer_load_dwordx4 v214, s[20:23], 0 offen offset:128 lds
 RK 220,212,9216
 PV 76,108,184
 s_add_u32 m0, s31, 8192
 RK 224,212,9728
 RK 228,212,12288
 PV 108,108,188
 s_add_u32 s20, s60, s34
 EX 146
 PV 112,112,188
 s_addc_u32 s21, s61, 0
 RK 232,212,12800
 RK 236,212,13312
 PV 80,112,184
 s_sub_u32 s22, s62, s34
 EX 147
 PV 48,112,180
 s_max_i32 s22, s22, 0
 RK 240,212,13824
 v_add_u32 v212, s32, v212
 PV 16,112,176
 s_add_u32 s34, s34, 0x20000
 buffer_load_dwordx4 v215, s[16:19], 0 offen offset:0 lds
 CV 163,146,147
 PV 20,116,176
 s_add_u32 m0, s31, 9088
 RV 96,213,8192
 RV 98,213,12288
 PV 52,116,180
 s_add_u32 s31, s33, s37
 RV 100,213,8200
 EX 148
 PV 84,116,184
 s_add_u32 s33, s33, s32
 RV 102,213,12296
 EX 149
 PV 116,116,188
 s_bfe_u32 s83, s42, 0x20006
 RV 104,213,8704
 CV 166,148,149
 PV 120,120,188
 s_and_b32 s89, s47, 0x100
 buffer_load_dwordx4 v215, s[16:19], 0 offen offset:128 lds
 RV 106,213,12800
 PV 88,120,184
 s_cselect_b32 s89, 0x10000, 0
 RV 108,213,8712
 EX 150
 PV 56,120,180
 s_add_u32 m0, s31, 0
 RV 110,213,12808
 RV 112,213,9216
 PV 24,120,176
 s_add_u32 s16, s86, s34
 EX 151
 PV 28,124,176
 s_addc_u32 s17, s87, 0
 RV 114,213,13312
 CV 167,150,151
 PV 60,124,180
 s_sub_u32 s18, s62, s34
 RV 116,213,9224
 RV 118,213,13320
 PV 92,124,184
 s_max_i32 s18, s18, 0
 global_load_dword v255, v235, s[64:65]
 RV 120,213,9728
 PV 124,124,188
 s_add_u32 s72, s45, s89
 EX 136
 SM 128,160
 s_waitcnt lgkmcnt(15)
 RV 122,213,13824
 RV 124,213,9736
 PV 32,180,164
 EX 137
 PV 0,180,160
 s_waitcnt lgkmcnt(15)
 RV 126,213,13832
 v_add_u32 v213, s32, v213
 PV 4,184,160
 s_cmp_eq_u32 s33, 0x8000
 RK 24,219,5120
 CV 168,136,137
 PV 36,184,164
 s_cselect_b32 s32, -2, 1
 RK 20,219,4608
 v_accvgpr_read_b32 v225, a128
 v_accvgpr_read_b32 v224, a129
 v_add_f32 v225, v224, v225
 v_rcp_f32 v224, v225
 v_subrev_u32 v225, 0x21800000, v225
 PM 0,224,0
 PM 2,224,0
 PM 4,224,0
 PM 6,224,0
 v_accvgpr_read_b32 v227, a130
 v_accvgpr_read_b32 v226, a131
 v_add_f32 v227, v226, v227
 v_rcp_f32 v226, v227
 v_subrev_u32 v227, 0x21800000, v227
 s_waitcnt lgkmcnt(15)
 PV 40,188,164
 s_lshl_b32 s32, s32, 14
 RK 16,219,4096
 CV 0,0,1
 PV 8,188,160
 s_add_u32 s82, s82, s32
 EX 138
 s_waitcnt lgkmcnt(15)
 PV 12,192,160
 EX 139
 PV 44,192,164
 s_waitcnt lgkmcnt(15)
 CV 169,138,139
 CV 1,2,3
 PV 48,196,164
 EX 140
 EX 141
 EX 142
 PM 8,224,0
 PM 10,224,0
 PM 12,224,0
 PM 14,224,0
 PV 16,196,160
 s_waitcnt lgkmcnt(15)
 CV 172,140,141
 CV 2,4,5
 PV 20,200,160
 EX 143
 PV 52,200,164
 s_waitcnt lgkmcnt(15)
 CV 173,142,143
 CV 3,6,7
 PV 56,204,164
 s_waitcnt vmcnt(9) lgkmcnt(3)
 EX 152
 PV 24,204,160
 s_barrier
 PV 28,208,160
 buffer_load_dwordx4 v215, s[12:15], 0 offen offset:0 lds
 CV 8,8,9
 PV 60,208,164
 s_add_u32 m0, s31, 896
 EX 153
 QZ 136,148,32
 CV 170,152,153
 CV 9,10,11
 QK 136,152,36
 EX 154
 QK 136,156,40
 EX 155
 QK 136,160,44
 CV 171,154,155
 CV 10,12,13
 QZ 140,160,60
 RK 160,212,1536
 CV 11,14,15
 QK 140,156,56
 RK 156,212,1024
 XE 4,8,0
 QK 140,152,52
 RK 152,212,512
 XE 5,9,1
 QK 140,148,48
 RK 148,212,0
 XE 6,10,2
 QZ 152,164,32
 buffer_load_dwordx4 v215, s[12:15], 0 offen offset:128 lds
 XE 7,11,3
 QK 152,168,36
 s_add_u32 m0, s31, 49152
 EX 156
 EX 157
 EX 158
 PS 136
 PS 138
 PS 140
 PS 142
 QK 152,172,40
 s_not_b64 vcc, vcc
 CV 174,156,157
 XO 8,0,8
 QK 152,176,44
 EX 159
 buffer_load_dwordx4 v216, s[20:23], 0 offen offset:0 lds
 s_add_u32 m0, s31, 50048
 CV 175,158,159
 QZ 156,176,60
 EX 136
 QK 156,172,56
 EX 137
 QK 156,168,52
 CV 184,136,137
 XO 9,1,9
 QK 156,164,48
 EX 138
 SM 132,168
 buffer_load_dwordx4 v216, s[20:23], 0 offen offset:128 lds
 PV 96,180,172
 s_add_u32 m0, s31, 57344
 EX 139
 PV 64,180,168
 RV 180,213,0
 CV 185,138,139
 XO 10,2,10
 XO 11,3,11
 EX 140
 PS 152
 PS 154
 PS 156
 PS 158
 PV 68,184,168
 RV 182,213,4096
 v_mul_f32 v48, v226, v48
 PV 100,184,172
 RV 184,213,8
 v_mul_f32 v49, v226, v49
 PV 104,188,172
 RV 186,213,4104
 v_mul_f32 v50, v226, v50
 PV 72,188,168
 RV 188,213,512
 v_mul_f32 v51, v226, v51
 PV 76,192,168
 RV 190,213,4608
 v_mul_f32 v52, v226, v52
 PV 108,192,172
 RV 192,213,520
 v_mul_f32 v53, v226, v53
 PV 112,196,172
 RV 194,213,4616
 v_mul_f32 v54, v226, v54
 PV 80,196,168
 RV 196,213,1024
 v_mul_f32 v55, v226, v55
 PV 84,200,168
 RV 198,213,5120
 CV 48,48,49
 PV 116,200,172
 RV 200,213,1032
 CV 49,50,51
 PV 120,204,172
 RV 202,213,5128
 CV 50,52,53
 PV 88,204,168
 RV 204,213,1536
 CV 51,54,55
 PV 92,208,168
 RV 206,213,5632
 v_mul_f32 v56, v226, v56
 PV 124,208,172
 RV 208,213,1544
 v_mul_f32 v57, v226, v57
 QZ 136,212,32
 RV 210,213,5640
 v_mul_f32 v58, v226, v58
 QK 136,216,36
 buffer_load_dwordx4 v214, s[20:23], 0 offen offset:0 lds
 v_mul_f32 v59, v226, v59
 QK 136,220,40
 s_add_u32 m0, s31, 58240
 EX 141
 QK 136,224,44
 CV 188,140,141
 v_mul_f32 v60, v226, v60
 EX 142
 EX 143
 EX 152
 CV 189,142,143
 QZ 140,224,60
 RK 224,212,9728
 v_mul_f32 v61, v226, v61
 QK 140,220,56
 RK 220,212,9216
 v_mul_f32 v62, v226, v62
 QK 140,216,52
 RK 216,212,8704
 v_mul_f32 v63, v226, v63
 QK 140,212,48
 RK 212,212,8192
 CV 56,56,57
 buffer_load_dwordx4 v214, s[20:23], 0 offen offset:128 lds
 s_add_u32 m0, s31, 8192
 EX 153
 EX 154
 CV 186,152,153
 EX 155
 EX 156
 CV 187,154,155
 QZ 152,228,32
 EX 157
 EX 158
 CV 190,156,157
 PS 136
 PS 138
 PS 140
 PS 142
 QK 152,232,36
 buffer_load_dwordx4 v215, s[16:19], 0 offen offset:0 lds
 CV 57,58,59
 QK 152,236,40
 s_add_u32 m0, s31, 9088
 EX 159
 QK 152,240,44
 s_add_u32 s31, s33, s37
 CV 191,158,159
 CV 58,60,61
 QZ 156,240,60
 s_add_u32 s33, s33, s32
 RK 240,212,13824
 CV 59,62,63
 QK 156,236,56
 RK 236,212,13312
 EX 136
 QK 156,232,52
 RK 232,212,12800
 buffer_load_dwordx4 v215, s[16:19], 0 offen offset:128 lds
 QK 156,228,48
 RK 228,212,12288
 v_add_u32 v212, s82, v212
 SM 132,184
 EX 137
 PV 96,96,188
 EX 138
 PV 64,96,184
 RV 96,213,8192
 CV 168,136,137
 EX 139
 EX 140
 PS 152
 PS 154
 PS 156
 PS 158
 PV 68,100,184
 buffer_store_dwordx4 v[4:7], v220, s[24:27], s38 offen offset:0 nt
 CV 169,138,139
 PM 16,224,0
 PM 18,224,0
 PM 20,224,0
 PM 22,224,0
 PM 24,224,0
 PM 26,224,0
 PM 28,224,0
 PM 30,224,0
 PV 100,100,188
 RV 100,213,8200
 CV 16,16,17
 PV 104,104,188
 CV 17,18,19
 CV 18,20,21
 PV 72,104,184
 RV 104,213,8704
 CV 19,22,23
 PV 76,108,184
 EX 152
 PV 108,108,188
 RV 108,213,8712
 CV 24,24,25
 PV 112,112,188
 EX 153
 PV 80,112,184
 RV 112,213,9216
 CV 25,26,27
 PV 84,116,184
 buffer_store_dwordx4 v[8:11], v221, s[24:27], s38 offen offset:0 nt
 PV 116,116,188
 RV 116,213,9224
 CV 26,28,29
 PV 120,120,188
 CV 27,30,31
 XO 28,16,24
 PV 88,120,184
 RV 120,213,9728
 XO 29,17,25
 PV 92,124,184
 XO 30,18,26
 XO 31,19,27
 PV 124,124,188
 s_not_b64 vcc, vcc
 RV 124,213,9736
 XE 16,24,16
 s_waitcnt lgkmcnt(15)
 v_mfma_f32_16x16x32_bf16 v[136:139], a[148:151], a[32:35], v[208:211]
 RK 32,219,8192
 XE 17,25,17
 QK 136,152,36
 RK 36,219,8704
 XE 18,26,18
 QK 136,156,40
 RK 40,219,9216
 XE 19,27,19
 QK 136,160,44
 buffer_store_dwordx4 v[28:31], v221, s[24:27], s38 offen offset:128 nt
 CV 170,152,153
 PM 32,226,0
 PM 34,226,0
 PM 36,226,0
 PM 38,226,0
 PM 40,226,0
 PM 42,226,0
 PM 44,226,0
 PM 46,226,0
 PS 136
 PS 138
 CV 32,32,33
 CV 33,34,35
 CV 34,36,37
 CV 35,38,39
 CV 40,40,41
 CV 41,42,43
 CV 42,44,45
 CV 43,46,47
 XE 36,40,32
 XE 37,41,33
 XE 38,42,34
 XE 39,43,35
 s_not_b64 vcc, vcc
 XO 40,32,40
 XO 41,33,41
 XO 42,34,42
 XO 43,35,43
 EX 154
 EX 155
 XO 60,48,56
 CV 171,154,155
 buffer_store_dwordx4 v[16:19], v220, s[24:27], s38 offen offset:128 nt
 RK 44,219,9728
 LS 132,144,168
 s_waitcnt lgkmcnt(15)
 XO 61,49,57
 XO 62,50,58
 PV 64,180,168
 s_waitcnt lgkmcnt(15)
 XO 63,51,59
 v_add_u32 v213, s32, v213
 PV 68,184,168
 s_not_b64 vcc, vcc
 EX 141
 s_waitcnt lgkmcnt(15)
 PV 72,188,168
 s_waitcnt vmcnt(13) lgkmcnt(4)
 CV 172,140,141
 XE 48,56,48
 PV 76,192,168
 s_barrier
 PV 80,196,168
 RK 64,212,0
 XE 49,57,49
 PV 84,200,168
 RK 68,212,512
 XE 50,58,50
 PV 88,204,168
 RK 72,212,1024
 XE 51,59,51
 PV 92,208,168
 buffer_store_dwordx4 v[36:39], v220, s[24:27], s38 offen offset:256 nt
 RK 76,212,1536
 RK 80,212,4096
 EX 142
 EX 143
 EX 136
 CV 173,142,143
 v_mfma_f32_16x16x32_bf16 v[140:143], a[148:151], a[48:51], v[208:211]
 RK 48,219,12288
 RK 84,212,4608
 QK 140,152,52
 RK 52,219,12800
 EX 137
 QK 140,156,56
 RK 56,219,13312
 CV 184,136,137
 QK 140,160,60
 RK 60,219,13824
 EX 138
 QZ 128,212,0
 RK 88,212,5120
 EX 139
 QK 128,216,4
 buffer_store_dwordx4 v[40:43], v221, s[24:27], s38 offen offset:256 nt
 QK 128,220,8
 RK 92,212,5632
 CV 185,138,139
 EX 156
 EX 157
 PS 140
 PS 142
 QK 128,224,12
 EX 158
 QZ 132,224,28
 EX 159
 QK 132,220,24
 CV 174,156,157
 CV 175,158,159
 QK 132,216,20
 EX 140
 QK 132,212,16
 EX 141
 QZ 144,228,0
 EX 142
 QK 144,232,4
 s_waitcnt lgkmcnt(0)
 buffer_store_dwordx4 v[60:63], v221, s[24:27], s38 offen offset:384 nt
 QK 144,236,8
 EX 143
 CV 188,140,141
 CV 189,142,143
 PS 128
 PS 130
 PS 132
 PS 134
 QK 144,240,12
 EX 128
 QZ 148,240,28
 EX 129
 QK 148,236,24
 EX 130
 QK 148,232,20
 EX 131
 QK 148,228,16
 CV 192,128,129
 CV 193,130,131
 v_mfma_f32_16x16x16_bf16 a[132:135], a[144:145], v[184:185], a[132:135]
 EX 132
 EX 133
 PH 64,96,184
 buffer_store_dwordx4 v[48:51], v220, s[24:27], s38 offen offset:384 nt
 PH 68,100,184
 EX 134
 CV 196,132,133
 EX 135
 v_accvgpr_read_b32 v229, a132
 PS 144
 PS 146
 PS 148
 PS 150
 v_accvgpr_read_b32 v228, a133
 v_add_f32 v229, v228, v229
 v_rcp_f32 v228, v229
 v_subrev_u32 v229, 0x21800000, v229
 PM 64,228,0
 PM 66,228,0
 PM 68,228,0
 PM 70,228,0
 v_max3_u32 v225, v225, v227, v229
 PH 72,104,184
 CV 64,64,65
 CV 65,66,67
 CV 66,68,69
 PH 76,108,184
 CV 67,70,71
 EX 144
 PH 80,112,184
 EX 145
 CV 197,134,135
 CV 194,144,145
 EX 146
 PM 72,228,0
 PM 74,228,0
 PM 76,228,0
 PM 78,228,0
 PH 84,116,184
 EX 147
 CV 72,72,73
 PH 88,120,184
 CV 73,74,75
 CV 74,76,77
 CV 75,78,79
 PH 92,124,184
 XE 68,72,64
 XE 69,73,65
 XE 70,74,66
 LS 132,136,172
 s_mov_b32 s38, s80
 XE 71,75,67
 CV 195,146,147
 PV 96,180,172
 s_not_b64 vcc, vcc
 buffer_store_dwordx4 v[68:71], v220, s[24:27], s39 offen offset:0 nt
 XO 72,64,72
 PM 80,228,0
 PM 82,228,0
 PM 84,228,0
 PM 86,228,0
 PM 88,228,0
 PM 90,228,0
 PM 92,228,0
 PM 94,228,0
 PV 100,184,172
 XO 73,65,73
 XO 74,66,74
 PV 104,188,172
 XO 75,67,75
 CV 80,80,81
 PV 108,192,172
 CV 81,82,83
 CV 82,84,85
 PV 112,196,172
 CV 83,86,87
 CV 88,88,89
 PV 116,200,172
 EX 148
 PV 120,204,172
 EX 149
 PV 124,208,172
 buffer_store_dwordx4 v[72:75], v221, s[24:27], s39 offen offset:0 nt
 v_mfma_f32_16x16x16_bf16 a[132:135], a[136:137], v[188:189], a[132:135]
 CV 89,90,91
 CV 90,92,93
 CV 91,94,95
 PH 96,96,188
 XO 92,80,88
 XO 93,81,89
 XO 94,82,90
 PH 100,100,188
 XO 95,83,91
 v_accvgpr_read_b32 v231, a134
 v_accvgpr_read_b32 v230, a135
 v_add_f32 v231, v230, v231
 v_rcp_f32 v230, v231
 v_subrev_u32 v231, 0x21800000, v231
 v_max_u32 v225, v225, v231
 v_cmp_le_u32 s[84:85], s77, v225
 PH 104,104,188
 s_not_b64 vcc, vcc
 XE 80,88,80
 XE 81,89,81
 PH 108,108,188
 XE 82,90,82
 XE 83,91,83
 CV 198,148,149
 PH 112,112,188
 EX 150
 EX 151
 PH 116,116,188
 CV 199,150,151
 PH 120,120,188
 buffer_store_dwordx4 v[92:95], v221, s[24:27], s39 offen offset:128 nt
 PM 96,230,0
 PM 98,230,0
 PM 100,230,0
 PM 102,230,0
 PM 104,230,0
 PM 106,230,0
 PM 108,230,0
 PM 110,230,0
 PH 124,124,188
 CV 96,96,97
 CV 97,98,99
 CV 98,100,101
 QZ 136,212,32
 s_cmp_lg_u64 s[84:85], 0
 CV 99,102,103
 CV 104,104,105
 QK 136,216,36
 s_cselect_b32 s92, s76, 0
 CV 105,106,107
 CV 106,108,109
 QK 136,220,40
 s_or_b32 s73, s73, s92
 CV 107,110,111
 XE 100,104,96
 QK 136,224,44
 s_lshl_b32 s76, s76, 1
 XE 101,105,97
 XE 102,106,98
 QZ 140,224,60
 XE 103,107,99
 v_mul_f32 v112, v230, v112
 QK 140,220,56
 s_not_b64 vcc, vcc
 buffer_store_dwordx4 v[80:83], v220, s[24:27], s39 offen offset:128 nt
 QK 140,216,52
 XO 104,96,104
 XO 105,97,105
 QK 140,212,48
 XO 106,98,106
 XO 107,99,107
 QZ 152,228,32
 v_mul_f32 v113, v230, v113
 v_mul_f32 v114, v230, v114
 QK 152,232,36
 v_mul_f32 v115, v230, v115
 v_mul_f32 v116, v230, v116
 v_mul_f32 v117, v230, v117
 v_mul_f32 v118, v230, v118
 v_mul_f32 v119, v230, v119
 PS 136
 PS 138
 PS 140
 PS 142
 QK 152,236,40
 CV 112,112,113
 CV 113,114,115
 QK 152,240,44
 CV 114,116,117
 CV 115,118,119
 QZ 156,240,60
 v_mul_f32 v120, v230, v120
 v_mul_f32 v121, v230, v121
 QK 156,236,56
 buffer_store_dwordx4 v[100:103], v220, s[24:27], s39 offen offset:256 nt
 QK 156,232,52
 v_mul_f32 v122, v230, v122
 v_mul_f32 v123, v230, v123
 v_mul_f32 v124, v230, v124
 v_mul_f32 v125, v230, v125
 v_mul_f32 v126, v230, v126
 PS 152
 PS 154
 QK 156,228,48
 v_mul_f32 v127, v230, v127
 CV 120,120,121
 CV 121,122,123
 CV 122,124,125
 CV 123,126,127
 XO 124,112,120
 XO 125,113,121
 XO 126,114,122
 XO 127,115,123
 s_not_b64 vcc, vcc
 XE 112,120,112
 XE 113,121,113
 XE 114,122,114
 XE 115,123,115
 EX 136
 EX 137
 EX 138
 CV 200,136,137
 EX 139
 buffer_store_dwordx4 v[104:107], v221, s[24:27], s39 offen offset:256 nt
 CV 201,138,139
 EX 140
 EX 141
 EX 142
 CV 204,140,141
 EX 143
 EX 152
 CV 205,142,143
 EX 153
 EX 154
 CV 202,152,153
 EX 155
 buffer_store_dwordx4 v[124:127], v221, s[24:27], s39 offen offset:384 nt
 CV 203,154,155
 buffer_store_dwordx4 v[112:115], v220, s[24:27], s39 offen offset:384 nt
 s_mov_b32 s39, s81
 s_and_b32 s26, s43, 0xfffff000
 s_cmp_eq_u32 s79, 0
 s_cbranch_scc1 L_Fe
 s_cmp_eq_u32 s79, 1
 s_cbranch_scc1 L_Fo
 s_cmp_eq_u32 s79, 2
 s_cbranch_scc0 L_init
 s_bitcmp1_b32 s43, 7
 s_cbranch_scc0 L_Z1
 s_branch L_z1
.p2align 12
L_T2:
 QZ 128,64,0
 s_add_u32 s31, s33, s37
 RV 96,213,8192
 SC 156
 QK 128,68,4
 s_mov_b32 s34, s45
 RV 98,213,12288
 SC 157
 QK 128,72,8
 s_and_b32 s62, s46, 0xfffff800
 RV 100,213,8200
 SC 158
 QK 128,76,12
 s_add_u32 s35, s34, 0x10000
 RV 102,213,12296
 SC 159
 QZ 132,76,28
 s_add_u32 s12, s86, s35
 RV 104,213,8704
 RV 106,213,12800
 QK 132,72,24
 s_addc_u32 s13, s87, 0
 RV 108,213,8712
 SC 128
 QK 132,68,20
 s_sub_u32 s14, s62, s35
 RV 110,213,12808
 SC 129
 QK 132,64,16
 s_max_i32 s14, s14, 0
 RV 112,213,9216
 SC 130
 QZ 136,64,32
 s_add_u32 m0, s31, 0
 RV 114,213,13312
 SC 131
 QK 136,68,36
 s_add_u32 s20, s60, s34
 RV 116,213,9224
 SC 132
 QK 136,72,40
 s_addc_u32 s21, s61, 0
 RV 118,213,13320
 SC 133
 QK 136,76,44
 s_sub_u32 s22, s62, s34
 RV 120,213,9728
 SC 134
 QZ 140,76,60
 s_max_i32 s22, s22, 0
 RV 122,213,13824
 SC 135
 QK 140,72,56
 s_add_u32 s34, s34, 0x20000
 RV 124,213,9736
 SC 136
 QK 140,68,52
 s_add_u32 s16, s86, s34
 RV 126,213,13832
 SC 137
 QK 140,64,48
 s_addc_u32 s17, s87, 0
 EX 156
 QZ 144,80,0
 s_sub_u32 s18, s62, s34
 EX 157
 QK 144,84,4
 s_max_i32 s18, s18, 0
 CV 190,156,157
 SC 138
 QK 144,88,8
 s_cmp_eq_u32 s33, 0x8000
 EX 158
 QK 144,92,12
 s_cselect_b32 s32, -2, 1
 EX 159
 QZ 148,92,28
 s_lshl_b32 s32, s32, 14
 v_add_u32 v212, s32, v212
 v_add_u32 v213, s32, v213
 QK 148,88,24
 s_add_u32 s33, s33, s32
 CV 191,158,159
 SC 139
 QK 148,84,20
 s_cmp_eq_u32 s33, 0x8000
 EX 128
 QK 148,80,16
 s_cselect_b32 s32, -2, 1
 EX 129
 QZ 152,80,32
 s_waitcnt vmcnt(8) lgkmcnt(0)
 CV 160,128,129
 SC 140
 QK 152,84,36
 s_barrier
 QK 152,88,40
 s_lshl_b32 s32, s32, 14
 buffer_load_dwordx4 v215, s[12:15], 0 offen offset:0 lds
 SC 141
 QK 152,92,44
 s_add_u32 m0, s31, 896
 RK 148,212,0
 SC 142
 QZ 156,92,60
 s_cmp_eq_u32 s79, 2
 RK 152,212,512
 SC 143
 QK 156,88,56
 s_cselect_b32 s95, 1, 0
 RK 156,212,1024
 v_mul_u32_u24 v235, s95, v247
 QK 156,84,52
 s_add_u32 s35, s34, 0x10000
 RK 160,212,1536
 SC 152
 QK 156,80,48
 s_mov_b64 s[40:41], s[44:45]
 RK 164,212,4096
 SC 153
 SM 128,176
 s_mov_b64 s[42:43], s[46:47]
 RK 168,212,4608
 SC 154
 SM 132,184
 s_mov_b64 s[44:45], s[48:49]
 RK 172,212,5120
 SC 155
 PV 96,96,188
 s_mov_b64 s[46:47], s[50:51]
 buffer_load_dwordx4 v215, s[12:15], 0 offen offset:128 lds
 SC 156
 PV 64,96,184
 s_add_u32 m0, s31, 49152
 RK 176,212,5632
 SC 157
 PV 32,96,180
 s_add_u32 s12, s86, s35
 RV 180,213,0
 SC 158
 PV 0,96,176
 s_addc_u32 s13, s87, 0
 RV 182,213,4096
 SC 159
 PV 4,100,176
 s_sub_u32 s14, s62, s35
 RV 184,213,8
 SC 144
 PV 36,100,180
 s_max_i32 s14, s14, 0
 RV 186,213,4104
 SC 145
 PV 68,100,184
 s_mov_b64 s[48:49], s[52:53]
 buffer_load_dwordx4 v216, s[20:23], 0 offen offset:0 lds
 SC 146
 PV 100,100,188
 s_add_u32 m0, s31, 50048
 RV 188,213,512
 SC 147
 PV 104,104,188
 s_mov_b64 s[50:51], s[54:55]
 RV 190,213,4608
 SC 148
 PV 72,104,184
 s_mov_b64 s[52:53], s[56:57]
 RV 192,213,520
 SC 149
 PV 40,104,180
 s_mov_b64 s[54:55], s[58:59]
 RV 194,213,4616
 SC 150
 PV 8,104,176
 s_and_b32 s30, s43, 0x3f
 RV 196,213,1024
 SC 151
 PV 12,108,176
 s_bfe_u32 s83, s42, 0x20006
 buffer_load_dwordx4 v216, s[20:23], 0 offen offset:128 lds
 RV 198,213,5120
 PV 44,108,180
 s_add_u32 m0, s31, 57344
 RV 200,213,1032
 RV 202,213,5128
 PV 76,108,184
 s_and_b32 s89, s47, 0x100
 EX 130
 PV 108,108,188
 s_cselect_b32 s89, 0x10000, 0
 RV 204,213,1536
 RV 206,213,5632
 PV 112,112,188
 s_add_u32 s72, s45, s89
 EX 131
 PV 80,112,184
 RV 208,213,1544
 CV 161,130,131
 PV 48,112,180
 buffer_load_dwordx4 v214, s[20:23], 0 offen offset:0 lds
 RV 210,213,5640
 PV 16,112,176
 s_add_u32 m0, s31, 58240
 RK 212,212,8192
 RK 216,212,8704
 PV 20,116,176
 EX 132
 PV 52,116,180
 RK 220,212,9216
 RK 224,212,9728
 PV 84,116,184
 EX 133
 PV 116,116,188
 RK 228,212,12288
 CV 164,132,133
 PV 120,120,188
 buffer_load_dwordx4 v214, s[20:23], 0 offen offset:128 lds
 RK 232,212,12800
 PV 88,120,184
 s_add_u32 m0, s31, 8192
 RK 236,212,13312
 RK 240,212,13824
 PV 56,120,180
 s_add_u32 s20, s60, s34
 EX 134
 PV 24,120,176
 s_addc_u32 s21, s61, 0
 RV 96,213,8192
 v_add_u32 v212, s32, v212
 PV 28,124,176
 s_sub_u32 s22, s62, s34
 RV 98,213,12288
 RV 100,213,8200
 PV 60,124,180
 s_max_i32 s22, s22, 0
 EX 135
 PV 92,124,184
 s_add_u32 s34, s34, 0x20000
 buffer_load_dwordx4 v215, s[16:19], 0 offen offset:0 lds
 CV 165,134,135
 PV 124,124,188
 s_add_u32 m0, s31, 9088
 RV 102,213,12296
 RV 104,213,8704
 s_waitcnt lgkmcnt(15)
 v_mfma_f32_16x16x32_bf16 v[128:131], a[148:151], a[0:3], v[208:211]
 s_add_u32 s31, s33, s37
 RV 106,213,12800
 EX 136
 s_waitcnt lgkmcnt(15)
 QK 128,152,4
 s_add_u32 s33, s33, s32
 RV 108,213,8712
 EX 137
 s_waitcnt lgkmcnt(15)
 QK 128,156,8
 s_waitcnt lgkmcnt(15)
 RV 110,213,12808
 CV 168,136,137
 QK 128,160,12
 buffer_load_dwordx4 v215, s[16:19], 0 offen offset:128 lds
 RV 112,213,9216
 v_mfma_f32_16x16x32_bf16 v[132:135], a[160:163], a[28:31], v[208:211]
 s_add_u32 m0, s31, 0
 RV 114,213,13312
 EX 138
 QK 132,156,24
 s_add_u32 s16, s86, s34
 RV 116,213,9224
 SC 128
 QK 132,152,20
 s_addc_u32 s17, s87, 0
 RV 118,213,13320
 SC 129
 QK 132,148,16
 s_sub_u32 s18, s62, s34
 RV 120,213,9728
 SC 130
 RV 122,213,13824
 RV 124,213,9736
 global_load_dword v255, v235, s[64:65]
 s_max_i32 s18, s18, 0
 EX 139
 RV 126,213,13832
 RK 0,219,0
 v_add_u32 v213, s32, v213
 CV 169,138,139
 QZ 136,148,32
 s_cmp_eq_u32 s33, 0x8000
 RK 4,219,512
 SC 131
 QK 136,152,36
 s_cselect_b32 s32, -2, 1
 RK 8,219,1024
 SC 132
 QK 136,156,40
 s_lshl_b32 s32, s32, 14
 RK 12,219,1536
 SC 133
 QK 136,160,44
 s_add_u32 s82, s82, s32
 RK 28,219,5632
 SC 134
 EX 140
 EX 141
 EX 142
 CV 172,140,141
 EX 143
 EX 152
 CV 173,142,143
 QZ 140,160,60
 RK 24,219,5120
 SC 135
 QK 140,156,56
 RK 20,219,4608
 SC 136
 QK 140,152,52
 RK 16,219,4096
 SC 137
 QK 140,148,48
 EX 153
 EX 154
 CV 170,152,153
 EX 155
 EX 156
 CV 171,154,155
 s_waitcnt lgkmcnt(15)
 QZ 152,164,32
 s_waitcnt lgkmcnt(15)
 EX 157
 QK 152,168,36
 s_waitcnt lgkmcnt(15)
 CV 174,156,157
 SC 138
 QK 152,172,40
 s_waitcnt vmcnt(9) lgkmcnt(8)
 EX 158
 QK 152,176,44
 s_barrier
 buffer_load_dwordx4 v215, s[12:15], 0 offen offset:0 lds
 s_add_u32 m0, s31, 896
 EX 159
 EX 144
 CV 175,158,159
 QZ 156,176,60
 EX 145
 QK 156,172,56
 CV 162,144,145
 SC 139
 QK 156,168,52
 EX 146
 QK 156,164,48
 EX 147
 buffer_load_dwordx4 v215, s[12:15], 0 offen offset:128 lds
 s_add_u32 m0, s31, 49152
 CV 163,146,147
 EX 148
 EX 149
 EX 150
 CV 166,148,149
 EX 151
 EX 128
 CV 167,150,151
 EX 129
 EX 130
 SM 128,160
 buffer_load_dwordx4 v216, s[20:23], 0 offen offset:0 lds
 PV 32,180,164
 s_add_u32 m0, s31, 50048
 CV 176,128,129
 SC 152
 PV 0,180,160
 EX 131
 PV 4,184,160
 CV 177,130,131
 SC 153
 PV 36,184,164
 EX 132
 PV 40,188,164
 EX 133
 PV 8,188,160
 buffer_load_dwordx4 v216, s[20:23], 0 offen offset:128 lds
 CV 180,132,133
 PV 12,192,160
 s_add_u32 m0, s31, 57344
 EX 134
 PV 44,192,164
 EX 135
 PV 48,196,164
 CV 181,134,135
 SC 154
 PV 16,196,160
 EX 136
 PV 20,200,160
 EX 137
 PV 52,200,164
 buffer_load_dwordx4 v214, s[20:23], 0 offen offset:0 lds
 CV 184,136,137
 PV 56,204,164
 s_add_u32 m0, s31, 58240
 EX 138
 PV 24,204,160
 EX 139
 PV 28,208,160
 CV 185,138,139
 SC 155
 PV 60,208,164
 EX 152
 v_mfma_f32_16x16x16_bf16 a[128:131], a[144:145], v[176:177], a[128:131]
 EX 153
 SC 140
 PH 0,96,176
 buffer_load_dwordx4 v214, s[20:23], 0 offen offset:128 lds
 CV 186,152,153
 SC 141
 PH 4,100,176
 s_add_u32 m0, s31, 8192
 v_accvgpr_read_b32 v225, a128
 v_accvgpr_read_b32 v224, a129
 v_add_f32 v225, v224, v225
 v_rcp_f32 v224, v225
 v_subrev_u32 v225, 0x21800000, v225
 PM 0,224,0
 PM 2,224,0
 PM 4,224,0
 PM 6,224,0
 PH 8,104,176
 CV 0,0,1
 CV 1,2,3
 CV 2,4,5
 PH 12,108,176
 CV 3,6,7
 EX 154
 PH 16,112,176
 buffer_load_dwordx4 v215, s[16:19], 0 offen offset:0 lds
 EX 155
 EX 140
 CV 187,154,155
 PM 8,224,0
 PM 10,224,0
 PM 12,224,0
 PM 14,224,0
 PH 20,116,176
 s_add_u32 m0, s31, 9088
 CV 8,8,9
 CV 9,10,11
 PH 24,120,176
 CV 10,12,13
 CV 11,14,15
 XE 4,8,0
 PH 28,124,176
 XE 5,9,1
 XE 6,10,2
 XE 7,11,3
 v_mfma_f32_16x16x16_bf16 a[128:131], a[136:137], v[180:181], a[128:131]
 buffer_load_dwordx4 v215, s[16:19], 0 offen offset:128 lds
 EX 141
 PH 32,96,180
 CV 188,140,141
 SC 142
 SC 143
 PH 36,100,180
 s_not_b64 vcc, vcc
 XO 8,0,8
 XO 9,1,9
 v_accvgpr_read_b32 v227, a130
 v_accvgpr_read_b32 v226, a131
 v_add_f32 v227, v226, v227
 v_rcp_f32 v226, v227
 v_subrev_u32 v227, 0x21800000, v227
 PH 40,104,180
 XO 10,2,10
 XO 11,3,11
 SC 156
 PH 44,108,180
 buffer_store_dwordx4 v[4:7], v220, s[24:27], s38 offen offset:0 nt
 EX 142
 PM 16,224,0
 PM 18,224,0
 PM 20,224,0
 PM 22,224,0
 PM 24,224,0
 PM 26,224,0
 PM 28,224,0
 PM 30,224,0
 PH 48,112,180
 CV 16,16,17
 CV 17,18,19
 CV 18,20,21
 PH 52,116,180
 CV 19,22,23
 CV 24,24,25
 CV 25,26,27
 PH 56,120,180
 CV 26,28,29
 CV 27,30,31
 XO 28,16,24
 PH 60,124,180
 XO 29,17,25
 XO 30,18,26
 XO 31,19,27
 SM 132,168
 s_not_b64 vcc, vcc
 XE 16,24,16
 PV 96,180,172
 s_add_u32 s31, s33, s37
 XE 17,25,17
 XE 18,26,18
 PV 64,180,168
 s_add_u32 s33, s33, s32
 RV 180,213,0
 XE 19,27,19
 PV 68,184,168
 RV 182,213,4096
 SC 157
 PV 100,184,172
 RV 184,213,8
 SC 158
 PV 104,188,172
 RV 186,213,4104
 SC 159
 PV 72,188,168
 RV 188,213,512
 RV 190,213,4608
 PV 76,192,168
 buffer_store_dwordx4 v[8:11], v221, s[24:27], s38 offen offset:0 nt
 PV 108,192,172
 RV 192,213,520
 RV 194,213,4616
 PV 112,196,172
 EX 143
 PV 80,196,168
 RV 196,213,1024
 CV 189,142,143
 PV 84,200,168
 RV 198,213,5120
 EX 156
 PV 116,200,172
 RV 200,213,1032
 RV 202,213,5128
 PV 120,204,172
 EX 157
 PV 88,204,168
 RV 204,213,1536
 CV 190,156,157
 PV 92,208,168
 RV 206,213,5632
 EX 158
 PV 124,208,172
 RV 208,213,1544
 RV 210,213,5640
 QZ 136,212,32
 buffer_store_dwordx4 v[28:31], v221, s[24:27], s38 offen offset:128 nt
 EX 159
 PM 32,226,0
 PM 34,226,0
 PM 36,226,0
 PM 38,226,0
 PM 40,226,0
 PM 42,226,0
 PM 44,226,0
 PM 46,226,0
 QK 136,216,36
 CV 32,32,33
 CV 33,34,35
 QK 136,220,40
 CV 34,36,37
 CV 35,38,39
 QK 136,224,44
 CV 40,40,41
 CV 41,42,43
 v_mfma_f32_16x16x32_bf16 v[152:155], a[240:243], a[44:47], v[208:211]
 RK 44,219,9728
 CV 42,44,45
 QK 152,236,40
 RK 40,219,9216
 CV 43,46,47
 XE 36,40,32
 XE 37,41,33
 XE 38,42,34
 PS 136
 PS 138
 QK 152,232,36
 buffer_store_dwordx4 v[16:19], v220, s[24:27], s38 offen offset:128 nt
 QK 152,228,32
 RK 32,219,8192
 XE 39,43,35
 QZ 140,212,48
 s_not_b64 vcc, vcc
 RK 212,212,8192
 XO 40,32,40
 QK 140,216,52
 RK 216,212,8704
 XO 41,33,41
 XO 42,34,42
 XO 43,35,43
 CV 191,158,159
 PS 152
 PS 154
 QK 140,220,56
 RK 220,212,9216
 v_add_u32 v213, s32, v213
 QK 140,224,60
 RK 224,212,9728
 RK 36,219,8704
 v_mfma_f32_16x16x32_bf16 v[156:159], a[240:243], a[60:63], v[208:211]
 RK 240,212,13824
 EX 136
 QK 156,236,56
 RK 236,212,13312
 EX 137
 EX 138
 PS 140
 PS 142
 QK 156,232,52
 RK 232,212,12800
 CV 168,136,137
 QK 156,228,48
 RK 228,212,12288
 v_add_u32 v212, s82, v212
 LS 132,144,184
 buffer_store_dwordx4 v[36:39], v220, s[24:27], s38 offen offset:256 nt
 EX 139
 PM 48,226,0
 PM 50,226,0
 PM 52,226,0
 PM 54,226,0
 PM 56,226,0
 PM 58,226,0
 PM 60,226,0
 PM 62,226,0
 PS 156
 PS 158
 PV 64,96,184
 RK 60,219,13824
 CV 48,48,49
 PV 68,100,184
 RK 56,219,13312
 CV 49,50,51
 PV 72,104,184
 RK 52,219,12800
 CV 50,52,53
 PV 76,108,184
 s_waitcnt vmcnt(14) lgkmcnt(3)
 RK 48,219,12288
 CV 51,54,55
 PV 80,112,184
 s_barrier
 PV 84,116,184
 buffer_store_dwordx4 v[40:43], v221, s[24:27], s38 offen offset:256 nt
 PV 88,120,184
 RK 64,212,0
 CV 56,56,57
 PV 92,124,184
 RK 68,212,512
 CV 57,58,59
 QZ 128,212,0
 RK 72,212,1024
 CV 58,60,61
 QK 128,216,4
 RK 76,212,1536
 CV 59,62,63
 QK 128,220,8
 RK 80,212,4096
 XO 60,48,56
 QK 128,224,12
 RK 84,212,4608
 XO 61,49,57
 QZ 132,224,28
 RK 88,212,5120
 XO 62,50,58
 QK 132,220,24
 RK 92,212,5632
 XO 63,51,59
 QK 132,216,20
 s_not_b64 vcc, vcc
 buffer_store_dwordx4 v[60:63], v221, s[24:27], s38 offen offset:384 nt
 QK 132,212,16
 XE 48,56,48
 XE 49,57,49
 QZ 144,228,0
 XE 50,58,50
 XE 51,59,51
 QK 144,232,4
 EX 152
 QK 144,236,8
 EX 153
 CV 169,138,139
 CV 170,152,153
 EX 154
 PS 128
 PS 130
 PS 132
 PS 134
 QK 144,240,12
 s_waitcnt lgkmcnt(0)
 EX 155
 QZ 148,240,28
 EX 140
 QK 148,236,24
 buffer_store_dwordx4 v[48:51], v220, s[24:27], s38 offen offset:384 nt
 QK 148,232,20
 s_mov_b32 s38, s80
 EX 141
 QK 148,228,16
 CV 171,154,155
 CV 172,140,141
 EX 142
 LS 132,144,168
 EX 143
 PV 64,180,168
 EX 156
 PV 68,184,168
 EX 157
 CV 173,142,143
 CV 174,156,157
 EX 158
 PS 144
 PS 146
 PS 148
 PS 150
 v_accvgpr_read_b32 v229, a132
 v_accvgpr_read_b32 v228, a133
 v_add_f32 v229, v228, v229
 v_rcp_f32 v228, v229
 v_subrev_u32 v229, 0x21800000, v229
 PM 64,228,0
 PM 66,228,0
 PM 68,228,0
 PM 70,228,0
 v_max3_u32 v225, v225, v227, v229
 PV 72,188,168
 EX 159
 PV 76,192,168
 CV 64,64,65
 CV 65,66,67
 PV 80,196,168
 CV 66,68,69
 CV 67,70,71
 PV 84,200,168
 EX 128
 CV 175,158,159
 EX 129
 PM 72,228,0
 PM 74,228,0
 PM 76,228,0
 PM 78,228,0
 PV 88,204,168
 CV 72,72,73
 CV 73,74,75
 PV 92,208,168
 CV 74,76,77
 CV 75,78,79
 LS 132,136,188
 XE 68,72,64
 XE 69,73,65
 PV 96,96,188
 XE 70,74,66
 XE 71,75,67
 PV 100,100,188
 s_not_b64 vcc, vcc
 buffer_store_dwordx4 v[68:71], v220, s[24:27], s39 offen offset:0 nt
 XO 72,64,72
 PM 80,228,0
 PM 82,228,0
 PM 84,228,0
 PM 86,228,0
 PM 88,228,0
 PM 90,228,0
 PM 92,228,0
 PM 94,228,0
 PV 104,104,188
 XO 73,65,73
 XO 74,66,74
 PV 108,108,188
 XO 75,67,75
 CV 80,80,81
 PV 112,112,188
 CV 81,82,83
 CV 82,84,85
 PV 116,116,188
 CV 83,86,87
 CV 88,88,89
 PV 120,120,188
 CV 89,90,91
 CV 90,92,93
 PV 124,124,188
 CV 91,94,95
 XO 92,80,88
 LS 132,136,172
 buffer_store_dwordx4 v[72:75], v221, s[24:27], s39 offen offset:0 nt
 PV 96,180,172
 XO 93,81,89
 XO 94,82,90
 PV 100,184,172
 XO 95,83,91
 CV 192,128,129
 PV 104,188,172
 s_not_b64 vcc, vcc
 XE 80,88,80
 XE 81,89,81
 v_accvgpr_read_b32 v231, a134
 v_accvgpr_read_b32 v230, a135
 v_add_f32 v231, v230, v231
 v_rcp_f32 v230, v231
 v_subrev_u32 v231, 0x21800000, v231
 v_max_u32 v225, v225, v231
 v_cmp_le_u32 s[84:85], s77, v225
 PV 108,192,172
 XE 82,90,82
 XE 83,91,83
 PV 112,196,172
 s_cmp_lg_u64 s[84:85], 0
 EX 130
 PV 116,200,172
 s_cselect_b32 s92, s76, 0
 EX 131
 PV 120,204,172
 s_or_b32 s73, s73, s92
 buffer_store_dwordx4 v[92:95], v221, s[24:27], s39 offen offset:128 nt
 CV 193,130,131
 PM 96,230,0
 PM 98,230,0
 PM 100,230,0
 PM 102,230,0
 PM 104,230,0
 PM 106,230,0
 PM 108,230,0
 PM 110,230,0
 PV 124,208,172
 s_lshl_b32 s76, s76, 1
 CV 96,96,97
 CV 97,98,99
 QZ 136,212,32
 CV 98,100,101
 CV 99,102,103
 QK 136,216,36
 EX 132
 QK 136,220,40
 EX 133
 QK 136,224,44
 CV 104,104,105
 CV 105,106,107
 QZ 140,224,60
 CV 106,108,109
 CV 107,110,111
 QK 140,220,56
 buffer_store_dwordx4 v[80:83], v220, s[24:27], s39 offen offset:128 nt
 QK 140,216,52
 XE 100,104,96
 XE 101,105,97
 QK 140,212,48
 XE 102,106,98
 XE 103,107,99
 QZ 152,228,32
 s_not_b64 vcc, vcc
 XO 104,96,104
 XO 105,97,105
 QK 152,232,36
 XO 106,98,106
 XO 107,99,107
 CV 196,132,133
 EX 134
 PS 136
 PS 138
 PS 140
 PS 142
 QK 152,236,40
 EX 135
 QK 152,240,44
 EX 144
 QZ 156,240,60
 EX 145
 QK 156,236,56
 buffer_store_dwordx4 v[100:103], v220, s[24:27], s39 offen offset:256 nt
 CV 197,134,135
 PM 112,230,0
 PM 114,230,0
 PM 116,230,0
 PM 118,230,0
 PM 120,230,0
 PM 122,230,0
 PM 124,230,0
 PM 126,230,0
 PS 152
 PS 154
 QK 156,232,52
 CV 112,112,113
 CV 113,114,115
 QK 156,228,48
 CV 114,116,117
 CV 115,118,119
 CV 120,120,121
 CV 121,122,123
 CV 122,124,125
 CV 123,126,127
 XO 124,112,120
 XO 125,113,121
 XO 126,114,122
 XO 127,115,123
 s_not_b64 vcc, vcc
 XE 112,120,112
 XE 113,121,113
 XE 114,122,114
 XE 115,123,115
 CV 194,144,145
 EX 146
 buffer_store_dwordx4 v[104:107], v221, s[24:27], s39 offen offset:256 nt
 EX 147
 EX 148
 CV 195,146,147
 EX 149
 EX 150
 CV 198,148,149
 EX 151
 EX 136
 CV 199,150,151
 EX 137
 EX 138
 CV 200,136,137
 EX 139
 EX 140
 CV 201,138,139
 EX 141
 EX 142
 CV 204,140,141
 EX 143
 EX 152
 buffer_store_dwordx4 v[124:127], v221, s[24:27], s39 offen offset:384 nt
 CV 205,142,143
 EX 153
 EX 154
 CV 202,152,153
 EX 155
 buffer_store_dwordx4 v[112:115], v220, s[24:27], s39 offen offset:384 nt
 CV 203,154,155
 s_mov_b32 s39, s81
 s_and_b32 s26, s43, 0xfffff000
 s_cmp_eq_u32 s79, 0
 s_cbranch_scc1 L_Fe
 s_cmp_eq_u32 s79, 1
 s_cbranch_scc1 L_Fo
 s_cmp_eq_u32 s79, 2
 s_cbranch_scc0 L_init
 s_bitcmp1_b32 s43, 7
 s_cbranch_scc0 L_Z2
 s_branch L_z2
.p2align 12
L_T3:
 QZ 128,64,0
 s_add_u32 s31, s33, s37
 RV 96,213,8192
 SC 156
 QK 128,68,4
 s_mov_b32 s34, s45
 RV 98,213,12288
 SC 157
 QK 128,72,8
 s_and_b32 s62, s46, 0xfffff800
 RV 100,213,8200
 SC 158
 QK 128,76,12
 s_add_u32 s35, s34, 0x10000
 RV 102,213,12296
 SC 159
 QZ 132,76,28
 s_add_u32 s12, s86, s35
 RV 104,213,8704
 RV 106,213,12800
 QK 132,72,24
 s_addc_u32 s13, s87, 0
 RV 108,213,8712
 SC 128
 QK 132,68,20
 s_sub_u32 s14, s62, s35
 RV 110,213,12808
 SC 129
 QK 132,64,16
 s_max_i32 s14, s14, 0
 RV 112,213,9216
 SC 130
 QZ 136,64,32
 s_add_u32 m0, s31, 0
 RV 114,213,13312
 SC 131
 QK 136,68,36
 s_add_u32 s20, s60, s34
 RV 116,213,9224
 SC 132
 QK 136,72,40
 s_addc_u32 s21, s61, 0
 RV 118,213,13320
 SC 133
 QK 136,76,44
 s_sub_u32 s22, s62, s34
 RV 120,213,9728
 SC 134
 QZ 140,76,60
 s_max_i32 s22, s22, 0
 RV 122,213,13824
 SC 135
 QK 140,72,56
 s_add_u32 s34, s34, 0x20000
 RV 124,213,9736
 SC 136
 QK 140,68,52
 s_add_u32 s16, s86, s34
 RV 126,213,13832
 SC 137
 QK 140,64,48
 s_addc_u32 s17, s87, 0
 EX 156
 QZ 144,80,0
 s_sub_u32 s18, s62, s34
 EX 157
 QK 144,84,4
 s_max_i32 s18, s18, 0
 CV 190,156,157
 SC 138
 QK 144,88,8
 s_cmp_eq_u32 s33, 0x8000
 EX 158
 QK 144,92,12
 s_cselect_b32 s32, -2, 1
 EX 159
 QZ 148,92,28
 s_lshl_b32 s32, s32, 14
 v_add_u32 v212, s32, v212
 v_add_u32 v213, s32, v213
 QK 148,88,24
 s_add_u32 s33, s33, s32
 CV 191,158,159
 SC 144
 QK 148,84,20
 s_cmp_eq_u32 s33, 0x8000
 EX 128
 QK 148,80,16
 s_cselect_b32 s32, -2, 1
 EX 129
 QZ 152,80,32
 s_waitcnt vmcnt(8) lgkmcnt(0)
 CV 160,128,129
 SC 145
 QK 152,84,36
 s_barrier
 QK 152,88,40
 s_lshl_b32 s32, s32, 14
 buffer_load_dwordx4 v215, s[12:15], 0 offen offset:0 lds
 SC 146
 QK 152,92,44
 s_add_u32 m0, s31, 896
 RK 148,212,0
 SC 147
 QZ 156,92,60
 s_cmp_eq_u32 s79, 2
 RK 152,212,512
 SC 148
 QK 156,88,56
 s_cselect_b32 s95, 1, 0
 RK 156,212,1024
 v_mul_u32_u24 v235, s95, v247
 QK 156,84,52
 s_add_u32 s35, s34, 0x10000
 RK 160,212,1536
 SC 149
 QK 156,80,48
 s_mov_b64 s[40:41], s[44:45]
 RK 164,212,4096
 SC 150
 SM 128,176
 s_mov_b64 s[42:43], s[46:47]
 RK 168,212,4608
 SC 151
 SM 132,184
 s_mov_b64 s[44:45], s[48:49]
 RK 172,212,5120
 SC 139
 PV 96,96,188
 s_mov_b64 s[46:47], s[50:51]
 buffer_load_dwordx4 v215, s[12:15], 0 offen offset:128 lds
 SC 140
 PV 64,96,184
 s_add_u32 m0, s31, 49152
 RK 176,212,5632
 SC 141
 PV 32,96,180
 s_add_u32 s12, s86, s35
 RV 180,213,0
 SC 142
 PV 0,96,176
 s_addc_u32 s13, s87, 0
 RV 182,213,4096
 SC 143
 PV 4,100,176
 s_sub_u32 s14, s62, s35
 RV 184,213,8
 SC 152
 PV 36,100,180
 s_max_i32 s14, s14, 0
 RV 186,213,4104
 SC 153
 PV 68,100,184
 s_mov_b64 s[48:49], s[52:53]
 buffer_load_dwordx4 v216, s[20:23], 0 offen offset:0 lds
 SC 154
 PV 100,100,188
 s_add_u32 m0, s31, 50048
 RV 188,213,512
 SC 155
 PV 104,104,188
 s_mov_b64 s[50:51], s[54:55]
 RV 190,213,4608
 SC 156
 PV 72,104,184
 s_mov_b64 s[52:53], s[56:57]
 RV 192,213,520
 SC 157
 PV 40,104,180
 s_mov_b64 s[54:55], s[58:59]
 RV 194,213,4616
 SC 158
 PV 8,104,176
 s_and_b32 s30, s43, 0x3f
 RV 196,213,1024
 SC 159
 PV 12,108,176
 s_bfe_u32 s83, s42, 0x20006
 buffer_load_dwordx4 v216, s[20:23], 0 offen offset:128 lds
 RV 198,213,5120
 PV 44,108,180
 s_add_u32 m0, s31, 57344
 RV 200,213,1032
 RV 202,213,5128
 PV 76,108,184
 s_and_b32 s89, s47, 0x100
 EX 130
 PV 108,108,188
 s_cselect_b32 s89, 0x10000, 0
 RV 204,213,1536
 RV 206,213,5632
 PV 112,112,188
 s_add_u32 s72, s45, s89
 EX 131
 PV 80,112,184
 RV 208,213,1544
 CV 161,130,131
 PV 48,112,180
 buffer_load_dwordx4 v214, s[20:23], 0 offen offset:0 lds
 RV 210,213,5640
 PV 16,112,176
 s_add_u32 m0, s31, 58240
 RK 212,212,8192
 RK 216,212,8704
 PV 20,116,176
 EX 132
 PV 52,116,180
 RK 220,212,9216
 RK 224,212,9728
 PV 84,116,184
 EX 133
 PV 116,116,188
 RV 96,213,8192
 v_add_u32 v212, s32, v212
 PV 120,120,188
 buffer_load_dwordx4 v214, s[20:23], 0 offen offset:128 lds
 CV 164,132,133
 PV 88,120,184
 s_add_u32 m0, s31, 8192
 RV 98,213,12288
 RV 100,213,8200
 PV 56,120,180
 s_add_u32 s20, s60, s34
 RV 102,213,12296
 EX 134
 PV 24,120,176
 s_addc_u32 s21, s61, 0
 RV 104,213,8704
 EX 135
 PV 28,124,176
 s_sub_u32 s22, s62, s34
 RV 106,213,12800
 CV 165,134,135
 PV 60,124,180
 s_max_i32 s22, s22, 0
 buffer_load_dwordx4 v215, s[16:19], 0 offen offset:0 lds
 RV 108,213,8712
 PV 92,124,184
 s_add_u32 m0, s31, 9088
 RV 110,213,12808
 EX 144
 PV 124,124,188
 s_add_u32 s31, s33, s37
 RV 112,213,9216
 RV 114,213,13312
 s_waitcnt lgkmcnt(15)
 QZ 128,148,0
 s_add_u32 s34, s34, 0x20000
 EX 145
 s_waitcnt lgkmcnt(15)
 QK 128,152,4
 s_add_u32 s33, s33, s32
 RV 116,213,9224
 CV 162,144,145
 s_waitcnt lgkmcnt(15)
 QK 128,156,8
 s_waitcnt lgkmcnt(15)
 RV 118,213,13320
 buffer_load_dwordx4 v215, s[16:19], 0 offen offset:128 lds
 QK 128,160,12
 s_add_u32 m0, s31, 0
 RV 120,213,9728
 RV 122,213,13824
 QZ 132,160,28
 s_add_u32 s16, s86, s34
 EX 146
 QK 132,156,24
 s_addc_u32 s17, s87, 0
 RV 124,213,9736
 RV 126,213,13832
 QK 132,152,20
 s_sub_u32 s18, s62, s34
 EX 147
 QK 132,148,16
 s_max_i32 s18, s18, 0
 v_add_u32 v213, s32, v213
 CV 163,146,147
 s_waitcnt lgkmcnt(15)
 v_mfma_f32_16x16x32_bf16 v[144:147], a[164:167], a[0:3], v[208:211]
 s_cmp_eq_u32 s33, 0x8000
 global_load_dword v255, v235, s[64:65]
 RK 0,219,0
 s_waitcnt lgkmcnt(15)
 QK 144,168,4
 s_cselect_b32 s32, -2, 1
 EX 148
 EX 149
 EX 150
 PS 128
 PS 130
 PS 132
 PS 134
 s_waitcnt lgkmcnt(15)
 QK 144,172,8
 s_lshl_b32 s32, s32, 14
 RK 4,219,512
 CV 166,148,149
 s_waitcnt lgkmcnt(15)
 QK 144,176,12
 s_add_u32 s82, s82, s32
 RK 8,219,1024
 RK 12,219,1536
 EX 151
 EX 136
 CV 167,150,151
 v_mfma_f32_16x16x32_bf16 v[148:151], a[176:179], a[28:31], v[208:211]
 EX 137
 QK 148,172,24
 RK 28,219,5632
 CV 168,136,137
 QK 148,168,20
 RK 24,219,5120
 RK 20,219,4608
 QK 148,164,16
 EX 138
 EX 139
 EX 140
 CV 169,138,139
 QZ 136,148,32
 EX 141
 QK 136,152,36
 RK 16,219,4096
 CV 172,140,141
 EX 142
 EX 143
 PS 144
 PS 146
 PS 148
 PS 150
 QK 136,156,40
 EX 152
 QK 136,160,44
 EX 153
 s_waitcnt vmcnt(9) lgkmcnt(8)
 CV 173,142,143
 QZ 140,160,60
 s_barrier
 QK 140,156,56
 RK 228,212,12288
 CV 170,152,153
 QK 140,152,52
 RK 232,212,12800
 RK 236,212,13312
 QK 140,148,48
 RK 240,212,13824
 buffer_load_dwordx4 v215, s[12:15], 0 offen offset:0 lds
 s_add_u32 m0, s31, 896
 EX 154
 EX 155
 EX 156
 CV 171,154,155
 QZ 152,164,32
 EX 157
 EX 158
 CV 174,156,157
 PS 136
 PS 138
 PS 140
 PS 142
 QK 152,168,36
 buffer_load_dwordx4 v215, s[12:15], 0 offen offset:128 lds
 EX 159
 QK 152,172,40
 s_add_u32 m0, s31, 49152
 EX 128
 QK 152,176,44
 EX 129
 CV 175,158,159
 QZ 156,176,60
 EX 130
 QK 156,172,56
 EX 131
 QK 156,168,52
 buffer_load_dwordx4 v216, s[20:23], 0 offen offset:0 lds
 CV 176,128,129
 QK 156,164,48
 s_add_u32 m0, s31, 50048
 EX 132
 SM 128,160
 CV 177,130,131
 SM 132,168
 EX 133
 PV 96,180,172
 EX 134
 CV 180,132,133
 EX 135
 PS 152
 PS 154
 PS 156
 PS 158
 PV 64,180,168
 buffer_load_dwordx4 v216, s[20:23], 0 offen offset:128 lds
 CV 181,134,135
 PV 32,180,164
 s_add_u32 m0, s31, 57344
 EX 144
 PV 0,180,160
 RV 180,213,0
 EX 145
 PV 4,184,160
 EX 146
 PV 36,184,164
 EX 147
 PV 68,184,168
 CV 178,144,145
 CV 179,146,147
 PV 100,184,172
 RV 184,213,8
 buffer_load_dwordx4 v214, s[20:23], 0 offen offset:0 lds
 PV 104,188,172
 s_add_u32 m0, s31, 58240
 EX 148
 PV 72,188,168
 EX 149
 PV 40,188,164
 EX 150
 PV 8,188,160
 RV 188,213,512
 CV 182,148,149
 PV 12,192,160
 EX 151
 PV 44,192,164
 buffer_load_dwordx4 v214, s[20:23], 0 offen offset:128 lds
 CV 183,150,151
 PV 76,192,168
 s_add_u32 m0, s31, 8192
 EX 136
 PV 108,192,172
 RV 192,213,520
 EX 137
 PV 112,196,172
 EX 138
 PV 80,196,168
 EX 139
 PV 48,196,164
 CV 184,136,137
 CV 185,138,139
 PV 16,196,160
 RV 196,213,1024
 buffer_load_dwordx4 v215, s[16:19], 0 offen offset:0 lds
 PV 20,200,160
 s_add_u32 m0, s31, 9088
 EX 140
 PV 52,200,164
 s_add_u32 s31, s33, s37
 EX 141
 PV 84,200,168
 s_add_u32 s33, s33, s32
 EX 142
 PV 116,200,172
 RV 200,213,1032
 CV 188,140,141
 PV 120,204,172
 EX 143
 PV 88,204,168
 buffer_load_dwordx4 v215, s[16:19], 0 offen offset:128 lds
 CV 189,142,143
 PV 56,204,164
 EX 152
 PV 24,204,160
 RV 204,213,1536
 EX 153
 PV 28,208,160
 EX 154
 PV 60,208,164
 EX 155
 PV 92,208,168
 CV 186,152,153
 CV 187,154,155
 PV 124,208,172
 RV 208,213,1544
 v_add_u32 v213, s32, v213
 SM 128,176
 EX 156
 PV 32,96,180
 EX 157
 PV 0,96,176
 EX 158
 PV 4,100,176
 EX 159
 PV 36,100,180
 CV 190,156,157
 CV 191,158,159
 PV 40,104,180
 PV 8,104,176
 v_accvgpr_read_b32 v225, a128
 v_accvgpr_read_b32 v224, a129
 v_add_f32 v225, v224, v225
 v_rcp_f32 v224, v225
 v_subrev_u32 v225, 0x21800000, v225
 PM 0,224,0
 PM 2,224,0
 PM 4,224,0
 PM 6,224,0
 PM 8,224,0
 PM 10,224,0
 v_accvgpr_read_b32 v227, a130
 v_accvgpr_read_b32 v226, a131
 v_add_f32 v227, v226, v227
 v_rcp_f32 v226, v227
 v_subrev_u32 v227, 0x21800000, v227
 PV 12,108,176
 CV 0,0,1
 CV 1,2,3
 PV 44,108,180
 CV 2,4,5
 CV 3,6,7
 PV 48,112,180
 CV 8,8,9
 CV 9,10,11
 PM 12,224,0
 PM 14,224,0
 PV 16,112,176
 CV 10,12,13
 CV 11,14,15
 PV 20,116,176
 XE 4,8,0
 XE 5,9,1
 PV 52,116,180
 XE 6,10,2
 XE 7,11,3
 PV 56,120,180
 s_not_b64 vcc, vcc
 buffer_store_dwordx4 v[4:7], v220, s[24:27], s38 offen offset:0 nt
 XO 8,0,8
 PM 16,224,0
 PM 18,224,0
 PM 20,224,0
 PM 22,224,0
 PV 24,120,176
 XO 9,1,9
 XO 10,2,10
 PV 28,124,176
 XO 11,3,11
 CV 16,16,17
 PV 60,124,180
 CV 17,18,19
 CV 18,20,21
 CV 19,22,23
 PM 24,224,0
 PM 26,224,0
 PM 28,224,0
 PM 30,224,0
 v_mfma_f32_16x16x32_bf16 v[136:139], a[212:215], a[32:35], v[208:211]
 RK 32,219,8192
 CV 24,24,25
 QK 136,216,36
 RK 36,219,8704
 CV 25,26,27
 QK 136,220,40
 buffer_store_dwordx4 v[8:11], v221, s[24:27], s38 offen offset:0 nt
 QK 136,224,44
 RK 40,219,9216
 CV 26,28,29
 v_mfma_f32_16x16x32_bf16 v[140:143], a[224:227], a[60:63], v[208:211]
 RK 224,212,9728
 CV 27,30,31
 QK 140,220,56
 RK 220,212,9216
 XO 28,16,24
 QK 140,216,52
 RK 216,212,8704
 XO 29,17,25
 QK 140,212,48
 RK 212,212,8192
 XO 30,18,26
 SM 132,184
 RK 44,219,9728
 XO 31,19,27
 PV 96,96,188
 s_not_b64 vcc, vcc
 RK 60,219,13824
 XE 16,24,16
 XE 17,25,17
 XE 18,26,18
 XE 19,27,19
 PS 136
 PS 138
 PS 140
 PS 142
 PV 64,96,184
 buffer_store_dwordx4 v[28:31], v221, s[24:27], s38 offen offset:128 nt
 EX 136
 PM 32,226,0
 PM 34,226,0
 PM 36,226,0
 PM 38,226,0
 PM 40,226,0
 PM 42,226,0
 PM 44,226,0
 PM 46,226,0
 PV 68,100,184
 RK 56,219,13312
 CV 32,32,33
 PV 100,100,188
 RK 52,219,12800
 CV 33,34,35
 PV 104,104,188
 RK 48,219,12288
 CV 34,36,37
 PV 72,104,184
 CV 35,38,39
 CV 40,40,41
 PV 76,108,184
 CV 41,42,43
 CV 42,44,45
 PV 108,108,188
 CV 43,46,47
 XE 36,40,32
 PV 112,112,188
 buffer_store_dwordx4 v[16:19], v220, s[24:27], s38 offen offset:128 nt
 PV 80,112,184
 XE 37,41,33
 XE 38,42,34
 PV 84,116,184
 XE 39,43,35
 v_add_u32 v212, s82, v212
 PV 116,116,188
 s_waitcnt vmcnt(13) lgkmcnt(5)
 EX 137
 PV 120,120,188
 s_barrier
 PV 88,120,184
 s_not_b64 vcc, vcc
 RK 64,212,0
 XO 40,32,40
 PV 92,124,184
 RK 68,212,512
 XO 41,33,41
 PV 124,124,188
 RK 72,212,1024
 XO 42,34,42
 QZ 128,212,0
 RK 76,212,1536
 XO 43,35,43
 QK 128,216,4
 buffer_store_dwordx4 v[36:39], v220, s[24:27], s38 offen offset:256 nt
 CV 168,136,137
 PM 48,226,0
 PM 50,226,0
 PM 52,226,0
 PM 54,226,0
 PM 56,226,0
 PM 58,226,0
 PM 60,226,0
 PM 62,226,0
 QK 128,220,8
 RK 80,212,4096
 CV 48,48,49
 QK 128,224,12
 RK 84,212,4608
 CV 49,50,51
 QZ 132,224,28
 RK 88,212,5120
 CV 50,52,53
 QK 132,220,24
 RK 92,212,5632
 CV 51,54,55
 QK 132,216,20
 EX 138
 QK 132,212,16
 EX 139
 QZ 144,228,0
 buffer_store_dwordx4 v[40:43], v221, s[24:27], s38 offen offset:256 nt
 QK 144,232,4
 CV 56,56,57
 CV 57,58,59
 QK 144,236,8
 CV 58,60,61
 CV 59,62,63
 XO 60,48,56
 XO 61,49,57
 XO 62,50,58
 PS 128
 PS 130
 PS 132
 PS 134
 QK 144,240,12
 s_waitcnt lgkmcnt(0)
 XO 63,51,59
 CV 169,138,139
 QZ 148,240,28
 s_not_b64 vcc, vcc
 XE 48,56,48
 XE 49,57,49
 QK 148,236,24
 XE 50,58,50
 XE 51,59,51
 QK 148,232,20
 EX 140
 QK 148,228,16
 EX 141
 v_mfma_f32_16x16x16_bf16 a[132:135], a[144:145], v[168:169], a[132:135]
 buffer_store_dwordx4 v[60:63], v221, s[24:27], s38 offen offset:384 nt
 PH 64,180,168
 EX 142
 CV 172,140,141
 PH 68,184,168
 EX 143
 EX 128
 CV 173,142,143
 v_accvgpr_read_b32 v229, a132
 PS 144
 PS 146
 PS 148
 PS 150
 v_accvgpr_read_b32 v228, a133
 v_add_f32 v229, v228, v229
 v_rcp_f32 v228, v229
 v_subrev_u32 v229, 0x21800000, v229
 PM 64,228,0
 PM 66,228,0
 PM 68,228,0
 PM 70,228,0
 v_max3_u32 v225, v225, v227, v229
 PH 72,188,168
 EX 129
 CV 64,64,65
 PH 76,192,168
 CV 65,66,67
 CV 66,68,69
 CV 67,70,71
 PH 80,196,168
 buffer_store_dwordx4 v[48:51], v220, s[24:27], s38 offen offset:384 nt
 CV 192,128,129
 EX 130
 PM 72,228,0
 PM 74,228,0
 PM 76,228,0
 PM 78,228,0
 PH 84,200,168
 EX 131
 CV 72,72,73
 PH 88,204,168
 CV 73,74,75
 CV 74,76,77
 CV 75,78,79
 PH 92,208,168
 XE 68,72,64
 XE 69,73,65
 XE 70,74,66
 v_mfma_f32_16x16x16_bf16 a[132:135], a[136:137], v[172:173], a[132:135]
 XE 71,75,67
 EX 132
 PH 96,180,172
 s_not_b64 vcc, vcc
 XO 72,64,72
 XO 73,65,73
 PH 100,184,172
 XO 74,66,74
 XO 75,67,75
 v_accvgpr_read_b32 v231, a134
 v_accvgpr_read_b32 v230, a135
 v_add_f32 v231, v230, v231
 v_rcp_f32 v230, v231
 v_subrev_u32 v231, 0x21800000, v231
 v_max_u32 v225, v225, v231
 v_cmp_le_u32 s[84:85], s77, v225
 PH 104,188,172
 buffer_store_dwordx4 v[68:71], v220, s[24:27], s39 offen offset:0 nt
 CV 193,130,131
 EX 133
 PM 80,228,0
 PM 82,228,0
 PM 84,228,0
 PM 86,228,0
 PM 88,228,0
 PM 90,228,0
 PM 92,228,0
 PM 94,228,0
 PH 108,192,172
 CV 80,80,81
 CV 81,82,83
 CV 82,84,85
 PH 112,196,172
 CV 83,86,87
 CV 88,88,89
 CV 89,90,91
 PH 116,200,172
 CV 90,92,93
 CV 91,94,95
 XO 92,80,88
 PH 120,204,172
 XO 93,81,89
 XO 94,82,90
 XO 95,83,91
 PH 124,208,172
 s_not_b64 vcc, vcc
 XE 80,88,80
 XE 81,89,81
 QZ 136,212,32
 s_cmp_lg_u64 s[84:85], 0
 XE 82,90,82
 XE 83,91,83
 QK 136,216,36
 s_cselect_b32 s92, s76, 0
 buffer_store_dwordx4 v[72:75], v221, s[24:27], s39 offen offset:0 nt
 QK 136,220,40
 s_or_b32 s73, s73, s92
 EX 134
 QK 136,224,44
 s_lshl_b32 s76, s76, 1
 EX 135
 QZ 140,224,60
 s_mov_b32 s38, s80
 CV 196,132,133
 CV 197,134,135
 QK 140,220,56
 EX 144
 QK 140,216,52
 EX 145
 QK 140,212,48
 EX 146
 QZ 152,228,32
 EX 147
 QK 152,232,36
 CV 194,144,145
 CV 195,146,147
 QK 152,236,40
 buffer_store_dwordx4 v[92:95], v221, s[24:27], s39 offen offset:128 nt
 EX 148
 PM 96,230,0
 PM 98,230,0
 PM 100,230,0
 PM 102,230,0
 PM 104,230,0
 PM 106,230,0
 PM 108,230,0
 PM 110,230,0
 PS 136
 PS 138
 PS 140
 PS 142
 QK 152,240,44
 CV 96,96,97
 CV 97,98,99
 QZ 156,240,60
 CV 98,100,101
 CV 99,102,103
 QK 156,236,56
 EX 149
 QK 156,232,52
 CV 104,104,105
 CV 105,106,107
 CV 106,108,109
 CV 107,110,111
 XE 100,104,96
 PS 152
 PS 154
 QK 156,228,48
 buffer_store_dwordx4 v[80:83], v220, s[24:27], s39 offen offset:128 nt
 XE 101,105,97
 XE 102,106,98
 XE 103,107,99
 s_not_b64 vcc, vcc
 XO 104,96,104
 XO 105,97,105
 XO 106,98,106
 XO 107,99,107
 CV 198,148,149
 EX 150
 EX 151
 EX 136
 CV 199,150,151
 EX 137
 EX 138
 CV 200,136,137
 EX 139
 EX 140
 CV 201,138,139
 EX 141
 EX 142
 CV 204,140,141
 EX 143
 EX 152
 buffer_store_dwordx4 v[100:103], v220, s[24:27], s39 offen offset:256 nt
 PM 112,230,0
 PM 114,230,0
 PM 116,230,0
 PM 118,230,0
 CV 112,112,113
 CV 113,114,115
 CV 114,116,117
 CV 115,118,119
 PM 120,230,0
 PM 122,230,0
 PM 124,230,0
 PM 126,230,0
 CV 120,120,121
 CV 121,122,123
 CV 122,124,125
 CV 123,126,127
 XO 124,112,120
 XO 125,113,121
 XO 126,114,122
 XO 127,115,123
 s_not_b64 vcc, vcc
 XE 112,120,112
 XE 113,121,113
 XE 114,122,114
 XE 115,123,115
 CV 205,142,143
 EX 153
 EX 154
 CV 202,152,153
 EX 155
 buffer_store_dwordx4 v[104:107], v221, s[24:27], s39 offen offset:256 nt
 CV 203,154,155
 buffer_store_dwordx4 v[124:127], v221, s[24:27], s39 offen offset:384 nt
 buffer_store_dwordx4 v[112:115], v220, s[24:27], s39 offen offset:384 nt
 s_mov_b32 s39, s81
 s_and_b32 s26, s43, 0xfffff000
 s_cmp_eq_u32 s79, 0
 s_cbranch_scc1 L_Fe
 s_cmp_eq_u32 s79, 1
 s_cbranch_scc1 L_Fo
 s_cmp_eq_u32 s79, 2
 s_cbranch_scc0 L_init
 s_bitcmp1_b32 s43, 7
 s_cbranch_scc0 L_Z3
 s_branch L_z3
.p2align 12
L_t0:
 QZ 136,64,32
 s_add_u32 s31, s33, s37
 RV 96,213,8192
 SC 156
 QK 136,68,36
 s_mov_b32 s34, s45
 RV 98,213,12288
 SC 157
 QK 136,72,40
 s_and_b32 s62, s46, 0xfffff800
 RV 100,213,8200
 SC 158
 QK 136,76,44
 s_add_u32 s35, s34, 0x10000
 RV 102,213,12296
 SC 159
 QZ 140,76,60
 s_add_u32 s12, s86, s35
 RV 104,213,8704
 v_and_b32 v178, v253, v178
 QK 140,72,56
 s_addc_u32 s13, s87, 0
 RV 106,213,12800
 v_and_b32 v179, v254, v179
 QK 140,68,52
 s_sub_u32 s14, s62, s35
 RV 108,213,8712
 v_and_b32 v182, v253, v182
 QK 140,64,48
 s_max_i32 s14, s14, 0
 RV 110,213,12808
 v_and_b32 v183, v254, v183
 QZ 152,80,32
 s_add_u32 m0, s31, 0
 RV 112,213,9216
 RV 114,213,13312
 QK 152,84,36
 s_add_u32 s20, s60, s34
 RV 116,213,9224
 RV 118,213,13320
 EX 156
 EX 157
 PS 136
 PS 138
 PS 140
 PS 142
 QK 152,88,40
 s_addc_u32 s21, s61, 0
 RV 120,213,9728
 CV 190,156,157
 QK 152,92,44
 s_sub_u32 s22, s62, s34
 RV 122,213,13824
 RV 124,213,9736
 RV 126,213,13832
 s_max_i32 s22, s22, 0
 s_add_u32 s34, s34, 0x20000
 s_waitcnt vmcnt(8)
 RK 0,219,0
 s_add_u32 s16, s86, s34
 s_addc_u32 s17, s87, 0
 RK 4,219,512
 s_sub_u32 s18, s62, s34
 s_max_i32 s18, s18, 0
 RK 8,219,1024
 s_cmp_eq_u32 s33, 0x8000
 s_cselect_b32 s32, -2, 1
 RK 12,219,1536
 s_lshl_b32 s32, s32, 14
 v_add_u32 v212, s32, v212
 v_add_u32 v213, s32, v213
 s_add_u32 s33, s33, s32
 s_cmp_eq_u32 s33, 0x8000
 s_cselect_b32 s32, -2, 1
 s_lshl_b32 s32, s32, 14
 s_cmp_eq_u32 s79, 2
 s_cselect_b32 s95, 1, 0
 v_mul_u32_u24 v235, s95, v247
 global_load_dword v255, v235, s[64:65]
 RK 28,219,5632
 RK 24,219,5120
 RK 20,219,4608
 s_add_u32 s35, s34, 0x10000
 EX 158
 EX 159
 EX 136
 CV 191,158,159
 QZ 156,92,60
 s_mov_b64 s[40:41], s[44:45]
 EX 137
 QK 156,88,56
 s_waitcnt lgkmcnt(7)
 RK 16,219,4096
 CV 168,136,137
 QK 156,84,52
 s_barrier
 QK 156,80,48
 s_mov_b64 s[42:43], s[46:47]
 buffer_load_dwordx4 v215, s[12:15], 0 offen offset:0 lds
 RK 148,212,0
 SM 128,176
 s_add_u32 m0, s31, 896
 RK 152,212,512
 RK 156,212,1024
 PV 32,96,180
 s_mov_b64 s[44:45], s[48:49]
 RK 160,212,1536
 RK 164,212,4096
 EX 138
 EX 139
 PS 152
 PS 154
 PS 156
 PS 158
 v_accvgpr_read_b32 v225, a128
 v_accvgpr_read_b32 v224, a129
 v_add_f32 v225, v224, v225
 v_rcp_f32 v224, v225
 v_subrev_u32 v225, 0x21800000, v225
 v_accvgpr_read_b32 v227, a130
 v_accvgpr_read_b32 v226, a131
 v_add_f32 v227, v226, v227
 v_rcp_f32 v226, v227
 v_subrev_u32 v227, 0x21800000, v227
 PV 0,96,176
 s_mov_b64 s[46:47], s[50:51]
 buffer_load_dwordx4 v215, s[12:15], 0 offen offset:128 lds
 CV 169,138,139
 PV 4,100,176
 s_add_u32 m0, s31, 49152
 RK 168,212,4608
 RK 172,212,5120
 PV 36,100,180
 s_add_u32 s12, s86, s35
 RK 176,212,5632
 RV 180,213,0
 EX 140
 EX 141
 PM 0,224,0
 PM 2,224,0
 PM 4,224,0
 PM 6,224,0
 PV 40,104,180
 s_addc_u32 s13, s87, 0
 buffer_load_dwordx4 v216, s[20:23], 0 offen offset:0 lds
 CV 172,140,141
 PV 8,104,176
 s_add_u32 m0, s31, 50048
 RV 182,213,4096
 CV 0,0,1
 PV 12,108,176
 s_sub_u32 s14, s62, s35
 RV 184,213,8
 CV 1,2,3
 PV 44,108,180
 s_max_i32 s14, s14, 0
 RV 186,213,4104
 CV 2,4,5
 EX 142
 EX 143
 PM 8,224,0
 PM 10,224,0
 PM 12,224,0
 PM 14,224,0
 PV 48,112,180
 s_mov_b64 s[48:49], s[52:53]
 buffer_load_dwordx4 v216, s[20:23], 0 offen offset:128 lds
 CV 173,142,143
 PV 16,112,176
 s_add_u32 m0, s31, 57344
 RV 188,213,512
 CV 3,6,7
 PV 20,116,176
 s_mov_b64 s[50:51], s[54:55]
 RV 190,213,4608
 CV 8,8,9
 PV 52,116,180
 s_mov_b64 s[52:53], s[56:57]
 RV 192,213,520
 CV 9,10,11
 PV 56,120,180
 s_mov_b64 s[54:55], s[58:59]
 RV 194,213,4616
 CV 10,12,13
 PV 24,120,176
 s_and_b32 s30, s43, 0x3f
 buffer_load_dwordx4 v214, s[20:23], 0 offen offset:0 lds
 CV 11,14,15
 PV 28,124,176
 s_add_u32 m0, s31, 58240
 RV 196,213,1024
 XE 4,8,0
 PV 60,124,180
 s_bfe_u32 s83, s42, 0x20006
 RV 198,213,5120
 XE 5,9,1
 SM 132,184
 s_and_b32 s89, s47, 0x100
 RV 200,213,1032
 XE 6,10,2
 PV 96,96,188
 s_cselect_b32 s89, 0x10000, 0
 RV 202,213,5128
 XE 7,11,3
 PV 64,96,184
 s_not_b64 vcc, vcc
 buffer_load_dwordx4 v214, s[20:23], 0 offen offset:128 lds
 XO 8,0,8
 PV 68,100,184
 s_add_u32 m0, s31, 8192
 RV 204,213,1536
 XO 9,1,9
 PV 100,100,188
 s_add_u32 s20, s60, s34
 RV 206,213,5632
 XO 10,2,10
 PV 104,104,188
 s_addc_u32 s21, s61, 0
 RV 208,213,1544
 XO 11,3,11
 PV 72,104,184
 s_sub_u32 s22, s62, s34
 RV 210,213,5640
 RK 212,212,8192
 PV 76,108,184
 s_max_i32 s22, s22, 0
 buffer_load_dwordx4 v215, s[16:19], 0 offen offset:0 lds
 RK 216,212,8704
 PV 108,108,188
 s_add_u32 m0, s31, 9088
 RK 220,212,9216
 RK 224,212,9728
 PV 112,112,188
 s_add_u32 s31, s33, s37
 RK 228,212,12288
 EX 152
 PV 80,112,184
 s_add_u32 s34, s34, 0x20000
 RK 232,212,12800
 RK 236,212,13312
 PV 84,116,184
 s_add_u32 s33, s33, s32
 RK 240,212,13824
 v_add_u32 v212, s32, v212
 PV 116,116,188
 s_add_u32 s72, s45, s89
 buffer_load_dwordx4 v215, s[16:19], 0 offen offset:128 lds
 RV 96,213,8192
 PV 120,120,188
 s_add_u32 m0, s31, 0
 RV 98,213,12288
 RV 100,213,8200
 PV 88,120,184
 s_add_u32 s16, s86, s34
 RV 102,213,12296
 EX 153
 PV 92,124,184
 s_addc_u32 s17, s87, 0
 RV 104,213,8704
 CV 170,152,153
 PV 124,124,188
 s_sub_u32 s18, s62, s34
 RV 106,213,12800
 RV 108,213,8712
 s_waitcnt lgkmcnt(15)
 QZ 136,148,32
 s_max_i32 s18, s18, 0
 RV 110,213,12808
 RV 112,213,9216
 s_waitcnt lgkmcnt(15)
 QK 136,152,36
 s_waitcnt lgkmcnt(15)
 RV 114,213,13312
 EX 154
 QK 136,156,40
 s_waitcnt lgkmcnt(15)
 RV 116,213,9224
 RV 118,213,13320
 QK 136,160,44
 RV 120,213,9728
 EX 155
 QZ 140,160,60
 RV 122,213,13824
 CV 171,154,155
 QK 140,156,56
 RV 124,213,9736
 RV 126,213,13832
 QK 140,152,52
 buffer_store_dwordx4 v[4:7], v220, s[24:27], s38 offen offset:0 nt
 v_add_u32 v213, s32, v213
 PM 16,224,0
 PM 18,224,0
 PM 20,224,0
 PM 22,224,0
 PM 24,224,0
 PM 26,224,0
 PM 28,224,0
 PM 30,224,0
 QK 140,148,48
 s_cmp_eq_u32 s33, 0x8000
 EX 156
 s_waitcnt lgkmcnt(15)
 QZ 152,164,32
 s_cselect_b32 s32, -2, 1
 EX 157
 s_waitcnt lgkmcnt(15)
 QK 152,168,36
 s_lshl_b32 s32, s32, 14
 CV 174,156,157
 CV 16,16,17
 EX 158
 EX 159
 PS 136
 PS 138
 PS 140
 PS 142
 s_waitcnt lgkmcnt(15)
 QK 152,172,40
 s_waitcnt vmcnt(10) lgkmcnt(0)
 CV 175,158,159
 CV 17,18,19
 QK 152,176,44
 s_barrier
 QZ 156,176,60
 s_add_u32 s82, s82, s32
 RK 148,212,0
 CV 18,20,21
 QK 156,172,56
 RK 152,212,512
 CV 19,22,23
 QK 156,168,52
 RK 156,212,1024
 CV 24,24,25
 QK 156,164,48
 RK 160,212,1536
 CV 25,26,27
 SM 132,168
 buffer_load_dwordx4 v215, s[12:15], 0 offen offset:0 lds
 PV 96,180,172
 s_add_u32 m0, s31, 896
 EX 136
 PV 64,180,168
 RV 180,213,0
 CV 26,28,29
 EX 137
 EX 138
 PS 152
 PS 154
 PS 156
 PS 158
 PV 68,184,168
 RV 182,213,4096
 CV 184,136,137
 PV 100,184,172
 RV 184,213,8
 CV 27,30,31
 PV 104,188,172
 RV 186,213,4104
 XO 28,16,24
 PV 72,188,168
 RV 188,213,512
 XO 29,17,25
 PV 76,192,168
 RV 190,213,4608
 XO 30,18,26
 PV 108,192,172
 RV 192,213,520
 XO 31,19,27
 PV 112,196,172
 s_not_b64 vcc, vcc
 RV 194,213,4616
 XE 16,24,16
 PV 80,196,168
 RV 196,213,1024
 XE 17,25,17
 PV 84,200,168
 RV 198,213,5120
 XE 18,26,18
 PV 116,200,172
 RV 200,213,1032
 XE 19,27,19
 PV 120,204,172
 RV 202,213,5128
 buffer_load_dwordx4 v215, s[12:15], 0 offen offset:128 lds
 PV 88,204,168
 s_add_u32 m0, s31, 49152
 RV 204,213,1536
 RV 206,213,5632
 PV 92,208,168
 EX 139
 PV 124,208,172
 RV 208,213,1544
 CV 185,138,139
 QZ 136,212,32
 RV 210,213,5640
 EX 140
 QK 136,216,36
 buffer_load_dwordx4 v216, s[20:23], 0 offen offset:0 lds
 EX 141
 QK 136,220,40
 s_add_u32 m0, s31, 50048
 EX 142
 QK 136,224,44
 EX 143
 CV 188,140,141
 CV 189,142,143
 QZ 140,224,60
 RK 224,212,9728
 EX 152
 QK 140,220,56
 RK 220,212,9216
 buffer_load_dwordx4 v216, s[20:23], 0 offen offset:128 lds
 QK 140,216,52
 s_add_u32 m0, s31, 57344
 RK 216,212,8704
 EX 153
 QK 140,212,48
 RK 212,212,8192
 CV 186,152,153
 EX 154
 EX 155
 EX 156
 CV 187,154,155
 QZ 152,228,32
 buffer_load_dwordx4 v214, s[20:23], 0 offen offset:0 lds
 EX 157
 EX 158
 PS 136
 PS 138
 PS 140
 PS 142
 QK 152,232,36
 s_add_u32 m0, s31, 58240
 EX 159
 QK 152,236,40
 CV 190,156,157
 CV 191,158,159
 QK 152,240,44
 buffer_load_dwordx4 v214, s[20:23], 0 offen offset:128 lds
 EX 136
 QZ 156,240,60
 s_add_u32 m0, s31, 8192
 RK 240,212,13824
 EX 137
 QK 156,236,56
 RK 236,212,13312
 CV 168,136,137
 QK 156,232,52
 RK 232,212,12800
 EX 138
 QK 156,228,48
 RK 228,212,12288
 v_add_u32 v212, s82, v212
 SM 132,184
 buffer_load_dwordx4 v215, s[16:19], 0 offen offset:0 lds
 PV 96,96,188
 s_add_u32 m0, s31, 9088
 EX 139
 PV 64,96,184
 s_add_u32 s31, s33, s37
 RV 96,213,8192
 CV 169,138,139
 EX 140
 EX 141
 PS 152
 PS 154
 PS 156
 PS 158
 PV 68,100,184
 s_add_u32 s33, s33, s32
 buffer_load_dwordx4 v215, s[16:19], 0 offen offset:128 lds
 CV 172,140,141
 PV 100,100,188
 RV 100,213,8200
 EX 142
 PV 104,104,188
 EX 143
 PV 72,104,184
 RV 104,213,8704
 CV 173,142,143
 PV 76,108,184
 EX 152
 PV 108,108,188
 RV 108,213,8712
 EX 153
 PV 112,112,188
 buffer_store_dwordx4 v[8:11], v221, s[24:27], s38 offen offset:0 nt
 PV 80,112,184
 RV 112,213,9216
 CV 170,152,153
 PV 84,116,184
 EX 154
 PV 116,116,188
 RV 116,213,9224
 EX 155
 PV 120,120,188
 EX 156
 PV 88,120,184
 RV 120,213,9728
 CV 171,154,155
 PV 92,124,184
 EX 157
 PV 124,124,188
 s_waitcnt lgkmcnt(15)
 RV 124,213,9736
 CV 174,156,157
 v_mfma_f32_16x16x32_bf16 v[136:139], a[148:151], a[32:35], v[208:211]
 s_waitcnt lgkmcnt(15)
 RK 32,219,8192
 v_add_u32 v213, s32, v213
 QK 136,152,36
 buffer_store_dwordx4 v[28:31], v221, s[24:27], s38 offen offset:128 nt
 EX 158
 PM 32,226,0
 PM 34,226,0
 PM 36,226,0
 PM 38,226,0
 PM 40,226,0
 PM 42,226,0
 PM 44,226,0
 PM 46,226,0
 s_waitcnt lgkmcnt(15)
 QK 136,156,40
 s_waitcnt lgkmcnt(15)
 RK 36,219,8704
 CV 32,32,33
 QK 136,160,44
 RK 40,219,9216
 CV 33,34,35
 v_mfma_f32_16x16x32_bf16 v[140:143], a[148:151], a[48:51], v[208:211]
 RK 44,219,9728
 CV 34,36,37
 QK 140,152,52
 RK 52,219,12800
 CV 35,38,39
 CV 40,40,41
 CV 41,42,43
 CV 42,44,45
 PS 136
 PS 138
 QK 140,156,56
 RK 56,219,13312
 CV 43,46,47
 QK 140,160,60
 s_waitcnt vmcnt(11) lgkmcnt(6)
 buffer_store_dwordx4 v[16:19], v220, s[24:27], s38 offen offset:128 nt
 LS 132,144,168
 s_barrier
 PV 64,180,168
 RK 60,219,13824
 XE 36,40,32
 PV 68,184,168
 RK 48,219,12288
 XE 37,41,33
 XE 38,42,34
 XE 39,43,35
 EX 136
 PS 140
 PS 142
 PV 72,188,168
 s_not_b64 vcc, vcc
 RK 64,212,0
 XO 40,32,40
 PV 76,192,168
 RK 68,212,512
 XO 41,33,41
 PV 80,196,168
 RK 72,212,1024
 XO 42,34,42
 PV 84,200,168
 buffer_store_dwordx4 v[36:39], v220, s[24:27], s38 offen offset:256 nt
 XO 43,35,43
 PM 48,226,0
 PM 50,226,0
 PM 52,226,0
 PM 54,226,0
 PM 56,226,0
 PM 58,226,0
 PM 60,226,0
 PM 62,226,0
 PV 88,204,168
 RK 76,212,1536
 CV 48,48,49
 PV 92,208,168
 RK 80,212,4096
 CV 49,50,51
 QZ 128,212,0
 RK 84,212,4608
 CV 50,52,53
 QK 128,216,4
 RK 88,212,5120
 CV 51,54,55
 QK 128,220,8
 RK 92,212,5632
 CV 56,56,57
 QK 128,224,12
 EX 137
 QZ 132,224,28
 buffer_store_dwordx4 v[40:43], v221, s[24:27], s38 offen offset:256 nt
 QK 132,220,24
 CV 57,58,59
 CV 58,60,61
 QK 132,216,20
 CV 59,62,63
 XO 60,48,56
 QK 132,212,16
 XO 61,49,57
 XO 62,50,58
 QZ 144,228,0
 XO 63,51,59
 CV 184,136,137
 QK 144,232,4
 s_not_b64 vcc, vcc
 XE 48,56,48
 XE 49,57,49
 XE 50,58,50
 XE 51,59,51
 EX 138
 PS 128
 PS 130
 PS 132
 PS 134
 QK 144,236,8
 s_waitcnt lgkmcnt(0)
 EX 139
 QK 144,240,12
 buffer_store_dwordx4 v[60:63], v221, s[24:27], s38 offen offset:384 nt
 QZ 148,240,28
 EX 159
 QK 148,236,24
 CV 185,138,139
 CV 175,158,159
 QK 148,232,20
 EX 140
 QK 148,228,16
 EX 141
 v_mfma_f32_16x16x16_bf16 a[132:135], a[144:145], v[184:185], a[132:135]
 EX 142
 CV 188,140,141
 PH 64,96,184
 EX 143
 EX 128
 PH 68,100,184
 EX 129
 CV 189,142,143
 v_accvgpr_read_b32 v229, a132
 v_accvgpr_read_b32 v228, a133
 v_add_f32 v229, v228, v229
 PS 144
 PS 146
 PS 148
 PS 150
 v_rcp_f32 v228, v229
 v_subrev_u32 v229, 0x21800000, v229
 PM 64,228,0
 PM 66,228,0
 PM 68,228,0
 PM 70,228,0
 v_max3_u32 v225, v225, v227, v229
 PH 72,104,184
 buffer_store_dwordx4 v[48:51], v220, s[24:27], s38 offen offset:384 nt
 PH 76,108,184
 CV 64,64,65
 CV 65,66,67
 CV 66,68,69
 PH 80,112,184
 CV 67,70,71
 EX 130
 CV 192,128,129
 EX 131
 PM 72,228,0
 PM 74,228,0
 PM 76,228,0
 PM 78,228,0
 PH 84,116,184
 CV 72,72,73
 CV 73,74,75
 CV 74,76,77
 PH 88,120,184
 CV 75,78,79
 XE 68,72,64
 XE 69,73,65
 PH 92,124,184
 XE 70,74,66
 XE 71,75,67
 CV 193,130,131
 LS 132,136,172
 s_not_b64 vcc, vcc
 XO 72,64,72
 XO 73,65,73
 PV 96,180,172
 s_mov_b32 s38, s80
 XO 74,66,74
 XO 75,67,75
 PV 100,184,172
 buffer_store_dwordx4 v[68:71], v220, s[24:27], s39 offen offset:0 nt
 EX 132
 PM 80,228,0
 PM 82,228,0
 PM 84,228,0
 PM 86,228,0
 PM 88,228,0
 PM 90,228,0
 PM 92,228,0
 PM 94,228,0
 PV 104,188,172
 CV 80,80,81
 CV 81,82,83
 PV 108,192,172
 CV 82,84,85
 CV 83,86,87
 PV 112,196,172
 EX 133
 PV 116,200,172
 CV 88,88,89
 CV 89,90,91
 PV 120,204,172
 CV 90,92,93
 CV 91,94,95
 PV 124,208,172
 XO 92,80,88
 XO 93,81,89
 v_mfma_f32_16x16x16_bf16 a[132:135], a[136:137], v[188:189], a[132:135]
 buffer_store_dwordx4 v[72:75], v221, s[24:27], s39 offen offset:0 nt
 PH 96,96,188
 XO 94,82,90
 XO 95,83,91
 CV 196,132,133
 PH 100,100,188
 s_not_b64 vcc, vcc
 XE 80,88,80
 XE 81,89,81
 v_accvgpr_read_b32 v231, a134
 v_accvgpr_read_b32 v230, a135
 v_add_f32 v231, v230, v231
 v_rcp_f32 v230, v231
 v_subrev_u32 v231, 0x21800000, v231
 v_max_u32 v225, v225, v231
 v_cmp_le_u32 s[84:85], s77, v225
 PH 104,104,188
 XE 82,90,82
 EX 134
 PH 108,108,188
 EX 135
 XE 83,91,83
 PH 112,112,188
 EX 144
 CV 197,134,135
 PH 116,116,188
 EX 145
 EX 146
 PH 120,120,188
 buffer_store_dwordx4 v[92:95], v221, s[24:27], s39 offen offset:128 nt
 CV 194,144,145
 EX 147
 PM 96,230,0
 PM 98,230,0
 PM 100,230,0
 PM 102,230,0
 PM 104,230,0
 PM 106,230,0
 PM 108,230,0
 PM 110,230,0
 PH 124,124,188
 CV 96,96,97
 CV 97,98,99
 CV 98,100,101
 QZ 136,212,32
 s_cmp_lg_u64 s[84:85], 0
 CV 99,102,103
 CV 104,104,105
 QK 136,216,36
 s_cselect_b32 s92, s76, 0
 CV 105,106,107
 CV 106,108,109
 QK 136,220,40
 s_or_b32 s73, s73, s92
 CV 107,110,111
 XE 100,104,96
 QK 136,224,44
 s_lshl_b32 s76, s76, 1
 XE 101,105,97
 XE 102,106,98
 QZ 140,224,60
 XE 103,107,99
 CV 195,146,147
 QK 140,220,56
 s_not_b64 vcc, vcc
 buffer_store_dwordx4 v[80:83], v220, s[24:27], s39 offen offset:128 nt
 QK 140,216,52
 XO 104,96,104
 XO 105,97,105
 QK 140,212,48
 XO 106,98,106
 XO 107,99,107
 QZ 152,228,32
 EX 148
 QK 152,232,36
 EX 149
 QK 152,236,40
 EX 150
 CV 198,148,149
 EX 151
 PS 136
 PS 138
 PS 140
 PS 142
 QK 152,240,44
 EX 136
 QZ 156,240,60
 EX 137
 QK 156,236,56
 buffer_store_dwordx4 v[100:103], v220, s[24:27], s39 offen offset:256 nt
 CV 199,150,151
 PM 112,230,0
 PM 114,230,0
 PM 116,230,0
 PM 118,230,0
 PM 120,230,0
 PM 122,230,0
 PM 124,230,0
 PM 126,230,0
 PS 152
 PS 154
 QK 156,232,52
 CV 112,112,113
 CV 113,114,115
 QK 156,228,48
 CV 114,116,117
 CV 115,118,119
 CV 120,120,121
 CV 121,122,123
 CV 122,124,125
 CV 123,126,127
 XO 124,112,120
 XO 125,113,121
 XO 126,114,122
 XO 127,115,123
 s_not_b64 vcc, vcc
 XE 112,120,112
 XE 113,121,113
 XE 114,122,114
 XE 115,123,115
 CV 200,136,137
 EX 138
 buffer_store_dwordx4 v[104:107], v221, s[24:27], s39 offen offset:256 nt
 EX 139
 EX 140
 CV 201,138,139
 EX 141
 EX 142
 CV 204,140,141
 EX 143
 EX 152
 CV 205,142,143
 EX 153
 EX 154
 CV 202,152,153
 EX 155
 buffer_store_dwordx4 v[124:127], v221, s[24:27], s39 offen offset:384 nt
 CV 203,154,155
 buffer_store_dwordx4 v[112:115], v220, s[24:27], s39 offen offset:384 nt
 s_mov_b32 s39, s81
 s_and_b32 s26, s43, 0xfffff000
 s_cmp_eq_u32 s79, 0
 s_cbranch_scc1 L_Fe
 s_cmp_eq_u32 s79, 1
 s_cbranch_scc1 L_Fo
 s_cmp_eq_u32 s79, 2
 s_cbranch_scc0 L_init
 s_bitcmp1_b32 s43, 7
 s_cbranch_scc0 L_Z0
 s_branch L_z0
.p2align 12
L_t1:
 v_mfma_f32_16x16x32_bf16 v[128:131], a[64:67], a[0:3], v[208:211]
 s_add_u32 s31, s33, s37
 RV 96,213,8192
 SC 156
 QK 128,68,4
 s_mov_b32 s34, s45
 RV 98,213,12288
 SC 157
 QK 128,72,8
 s_and_b32 s62, s46, 0xfffff800
 RV 100,213,8200
 SC 158
 QK 128,76,12
 s_add_u32 s35, s34, 0x10000
 RV 102,213,12296
 SC 159
 v_mfma_f32_16x16x32_bf16 v[132:135], a[76:79], a[28:31], v[208:211]
 s_add_u32 s12, s86, s35
 RV 104,213,8704
 RV 106,213,12800
 QK 132,72,24
 s_addc_u32 s13, s87, 0
 RV 108,213,8712
 RV 110,213,12808
 QK 132,68,20
 s_sub_u32 s14, s62, s35
 RV 112,213,9216
 EX 156
 QK 132,64,16
 s_max_i32 s14, s14, 0
 RV 114,213,13312
 RV 116,213,9224
 QZ 136,64,32
 s_add_u32 m0, s31, 0
 RV 118,213,13320
 EX 157
 QK 136,68,36
 s_add_u32 s20, s60, s34
 RV 120,213,9728
 CV 190,156,157
 QK 136,72,40
 s_addc_u32 s21, s61, 0
 RV 122,213,13824
 RV 124,213,9736
 QK 136,76,44
 s_sub_u32 s22, s62, s34
 RV 126,213,13832
 EX 158
 QZ 140,76,60
 s_max_i32 s22, s22, 0
 s_waitcnt vmcnt(8)
 RK 0,219,0
 RK 4,219,512
 QK 140,72,56
 s_add_u32 s34, s34, 0x20000
 RK 8,219,1024
 EX 159
 QK 140,68,52
 s_add_u32 s16, s86, s34
 RK 12,219,1536
 CV 191,158,159
 QK 140,64,48
 s_addc_u32 s17, s87, 0
 RK 28,219,5632
 RK 24,219,5120
 QZ 152,80,32
 s_sub_u32 s18, s62, s34
 RK 20,219,4608
 RK 16,219,4096
 QK 152,84,36
 s_max_i32 s18, s18, 0
 PS 128
 PS 130
 PS 132
 PS 134
 PS 136
 PS 138
 PS 140
 PS 142
 QK 152,88,40
 s_cmp_eq_u32 s33, 0x8000
 EX 128
 QK 152,92,44
 s_cselect_b32 s32, -2, 1
 EX 129
 QZ 156,92,60
 s_waitcnt lgkmcnt(8)
 EX 130
 QK 156,88,56
 s_barrier
 QK 156,84,52
 s_lshl_b32 s32, s32, 14
 buffer_load_dwordx4 v215, s[12:15], 0 offen offset:0 lds
 v_add_u32 v212, s32, v212
 QK 156,80,48
 s_add_u32 m0, s31, 896
 RK 148,212,0
 v_add_u32 v213, s32, v213
 SM 128,176
 s_add_u32 s33, s33, s32
 RK 152,212,512
 CV 160,128,129
 SM 132,184
 s_cmp_eq_u32 s33, 0x8000
 RK 156,212,1024
 RK 160,212,1536
 EX 131
 EX 132
 PS 152
 PS 154
 PS 156
 PS 158
 PV 96,96,188
 s_cselect_b32 s32, -2, 1
 buffer_load_dwordx4 v215, s[12:15], 0 offen offset:128 lds
 CV 161,130,131
 PV 64,96,184
 s_add_u32 m0, s31, 49152
 RK 164,212,4096
 RK 168,212,4608
 PV 32,96,180
 s_lshl_b32 s32, s32, 14
 RK 172,212,5120
 RK 176,212,5632
 PV 0,96,176
 s_cmp_eq_u32 s79, 2
 RV 180,213,0
 EX 133
 PV 4,100,176
 s_cselect_b32 s95, 1, 0
 RV 182,213,4096
 v_mul_u32_u24 v235, s95, v247
 PV 36,100,180
 s_add_u32 s35, s34, 0x10000
 buffer_load_dwordx4 v216, s[20:23], 0 offen offset:0 lds
 CV 164,132,133
 PV 68,100,184
 s_add_u32 m0, s31, 50048
 RV 184,213,8
 RV 186,213,4104
 PV 100,100,188
 s_add_u32 s12, s86, s35
 RV 188,213,512
 RV 190,213,4608
 PV 104,104,188
 s_addc_u32 s13, s87, 0
 RV 192,213,520
 EX 134
 PV 72,104,184
 s_sub_u32 s14, s62, s35
 RV 194,213,4616
 buffer_load_dwordx4 v216, s[20:23], 0 offen offset:128 lds
 PV 40,104,180
 s_add_u32 m0, s31, 57344
 RV 196,213,1024
 RV 198,213,5120
 PV 8,104,176
 s_max_i32 s14, s14, 0
 RV 200,213,1032
 EX 135
 PV 12,108,176
 s_mov_b64 s[40:41], s[44:45]
 RV 202,213,5128
 CV 165,134,135
 PV 44,108,180
 s_mov_b64 s[42:43], s[46:47]
 RV 204,213,1536
 RV 206,213,5632
 PV 76,108,184
 s_mov_b64 s[44:45], s[48:49]
 buffer_load_dwordx4 v214, s[20:23], 0 offen offset:0 lds
 RV 208,213,1544
 PV 108,108,188
 s_add_u32 m0, s31, 58240
 RV 210,213,5640
 RK 212,212,8192
 PV 112,112,188
 s_mov_b64 s[46:47], s[50:51]
 RK 216,212,8704
 EX 136
 PV 80,112,184
 s_mov_b64 s[48:49], s[52:53]
 RK 220,212,9216
 RK 224,212,9728
 PV 48,112,180
 s_mov_b64 s[50:51], s[54:55]
 RK 228,212,12288
 buffer_load_dwordx4 v214, s[20:23], 0 offen offset:128 lds
 PV 16,112,176
 s_add_u32 m0, s31, 8192
 RK 232,212,12800
 RK 236,212,13312
 PV 20,116,176
 s_add_u32 s20, s60, s34
 RK 240,212,13824
 v_add_u32 v212, s32, v212
 PV 52,116,180
 s_addc_u32 s21, s61, 0
 RV 96,213,8192
 EX 137
 PV 84,116,184
 s_sub_u32 s22, s62, s34
 RV 98,213,12288
 CV 168,136,137
 PV 116,116,188
 s_max_i32 s22, s22, 0
 buffer_load_dwordx4 v215, s[16:19], 0 offen offset:0 lds
 RV 100,213,8200
 PV 120,120,188
 s_add_u32 m0, s31, 9088
 RV 102,213,12296
 RV 104,213,8704
 PV 88,120,184
 s_add_u32 s31, s33, s37
 RV 106,213,12800
 RV 108,213,8712
 PV 56,120,180
 s_add_u32 s34, s34, 0x20000
 RV 110,213,12808
 EX 138
 PV 24,120,176
 s_add_u32 s33, s33, s32
 RV 112,213,9216
 buffer_load_dwordx4 v215, s[16:19], 0 offen offset:128 lds
 PV 28,124,176
 s_add_u32 m0, s31, 0
 RV 114,213,13312
 RV 116,213,9224
 PV 60,124,180
 s_add_u32 s16, s86, s34
 RV 118,213,13320
 EX 139
 PV 92,124,184
 s_addc_u32 s17, s87, 0
 RV 120,213,9728
 CV 169,138,139
 PV 124,124,188
 s_sub_u32 s18, s62, s34
 RV 122,213,13824
 RV 124,213,9736
 v_mfma_f32_16x16x16_bf16 a[128:131], a[144:145], v[160:161], a[128:131]
 s_max_i32 s18, s18, 0
 RV 126,213,13832
 v_add_u32 v213, s32, v213
 v_mfma_f32_16x16x16_bf16 a[128:131], a[136:137], v[164:165], a[128:131]
 s_waitcnt lgkmcnt(15)
 global_load_dword v255, v235, s[64:65]
 EX 140
 PH 32,180,164
 EX 141
 EX 142
 PH 0,180,160
 EX 143
 CV 172,140,141
 v_accvgpr_read_b32 v225, a128
 v_accvgpr_read_b32 v224, a129
 v_add_f32 v225, v224, v225
 v_rcp_f32 v224, v225
 v_subrev_u32 v225, 0x21800000, v225
 v_accvgpr_read_b32 v227, a130
 PM 0,224,0
 PM 2,224,0
 v_accvgpr_read_b32 v226, a131
 v_add_f32 v227, v226, v227
 v_rcp_f32 v226, v227
 v_subrev_u32 v227, 0x21800000, v227
 s_waitcnt lgkmcnt(15)
 PH 4,184,160
 CV 173,142,143
 EX 152
 PH 36,184,164
 s_waitcnt lgkmcnt(15)
 EX 153
 CV 0,0,1
 PH 40,188,164
 CV 170,152,153
 EX 154
 EX 155
 CV 1,2,3
 PM 4,224,0
 PM 6,224,0
 PH 8,188,160
 s_waitcnt lgkmcnt(15)
 CV 171,154,155
 CV 2,4,5
 CV 3,6,7
 PH 12,192,160
 EX 156
 EX 157
 PH 44,192,164
 EX 158
 CV 174,156,157
 EX 159
 PM 8,224,0
 PM 10,224,0
 PM 12,224,0
 PM 14,224,0
 s_waitcnt lgkmcnt(15)
 PH 48,196,164
 CV 8,8,9
 CV 9,10,11
 CV 10,12,13
 PH 16,196,160
 s_waitcnt lgkmcnt(15)
 CV 11,14,15
 XE 4,8,0
 XE 5,9,1
 PH 20,200,160
 XE 6,10,2
 XE 7,11,3
 CV 175,158,159
 PH 52,200,164
 buffer_store_dwordx4 v[4:7], v220, s[24:27], s38 offen offset:0 nt
 v_mul_f32 v48, v226, v48
 v_mul_f32 v49, v226, v49
 PM 16,224,0
 PM 18,224,0
 PM 20,224,0
 PM 22,224,0
 s_waitcnt lgkmcnt(15)
 PH 56,204,164
 s_waitcnt vmcnt(10) lgkmcnt(0)
 CV 16,16,17
 CV 17,18,19
 PH 24,204,160
 s_barrier
 PH 28,208,160
 CV 18,20,21
 CV 19,22,23
 v_mul_f32 v50, v226, v50
 PH 60,208,164
 v_mul_f32 v51, v226, v51
 v_mul_f32 v52, v226, v52
 v_mul_f32 v53, v226, v53
 v_mul_f32 v54, v226, v54
 v_mul_f32 v55, v226, v55
 CV 48,48,49
 PM 24,224,0
 PM 26,224,0
 PM 28,224,0
 PM 30,224,0
 QZ 136,148,32
 s_not_b64 vcc, vcc
 XO 8,0,8
 XO 9,1,9
 QK 136,152,36
 s_cmp_eq_u32 s33, 0x8000
 buffer_load_dwordx4 v215, s[12:15], 0 offen offset:0 lds
 XO 10,2,10
 QK 136,156,40
 s_cselect_b32 s32, -2, 1
 XO 11,3,11
 CV 24,24,25
 QK 136,160,44
 s_add_u32 m0, s31, 896
 CV 25,26,27
 CV 26,28,29
 QZ 140,160,60
 s_lshl_b32 s32, s32, 14
 CV 27,30,31
 XO 28,16,24
 QK 140,156,56
 s_add_u32 s82, s82, s32
 XO 29,17,25
 XO 30,18,26
 QK 140,152,52
 s_mov_b64 s[52:53], s[56:57]
 buffer_load_dwordx4 v215, s[12:15], 0 offen offset:128 lds
 XO 31,19,27
 QK 140,148,48
 s_add_u32 m0, s31, 49152
 CV 49,50,51
 CV 50,52,53
 QZ 152,164,32
 s_not_b64 vcc, vcc
 XE 16,24,16
 XE 17,25,17
 QK 152,168,36
 s_mov_b64 s[54:55], s[58:59]
 XE 18,26,18
 XE 19,27,19
 CV 51,54,55
 v_mul_f32 v56, v226, v56
 v_mul_f32 v57, v226, v57
 PS 136
 PS 138
 PS 140
 PS 142
 QK 152,172,40
 s_and_b32 s30, s43, 0x3f
 buffer_load_dwordx4 v216, s[20:23], 0 offen offset:0 lds
 v_mul_f32 v58, v226, v58
 QK 152,176,44
 s_add_u32 m0, s31, 50048
 EX 136
 QZ 156,176,60
 s_bfe_u32 s83, s42, 0x20006
 EX 137
 QK 156,172,56
 s_and_b32 s89, s47, 0x100
 CV 184,136,137
 v_mul_f32 v59, v226, v59
 QK 156,168,52
 s_cselect_b32 s89, 0x10000, 0
 EX 138
 QK 156,164,48
 s_add_u32 s72, s45, s89
 buffer_load_dwordx4 v216, s[20:23], 0 offen offset:128 lds
 v_mul_f32 v60, v226, v60
 SM 132,168
 s_add_u32 m0, s31, 57344
 v_mul_f32 v61, v226, v61
 PV 96,180,172
 EX 139
 EX 140
 CV 185,138,139
 PS 152
 PS 154
 PS 156
 PS 158
 PV 64,180,168
 RV 180,213,0
 v_mul_f32 v62, v226, v62
 PV 68,184,168
 RV 182,213,4096
 v_mul_f32 v63, v226, v63
 PV 100,184,172
 RV 184,213,8
 CV 56,56,57
 PV 104,188,172
 RV 186,213,4104
 CV 57,58,59
 PV 72,188,168
 RV 188,213,512
 CV 58,60,61
 PV 76,192,168
 RV 190,213,4608
 CV 59,62,63
 PV 108,192,172
 RV 192,213,520
 RV 194,213,4616
 PV 112,196,172
 buffer_load_dwordx4 v214, s[20:23], 0 offen offset:0 lds
 EX 141
 PV 80,196,168
 s_add_u32 m0, s31, 58240
 RV 196,213,1024
 CV 188,140,141
 PV 84,200,168
 RV 198,213,5120
 EX 142
 PV 116,200,172
 RV 200,213,1032
 RV 202,213,5128
 PV 120,204,172
 buffer_load_dwordx4 v214, s[20:23], 0 offen offset:128 lds
 EX 143
 PV 88,204,168
 s_add_u32 m0, s31, 8192
 RV 204,213,1536
 CV 189,142,143
 PV 92,208,168
 RV 206,213,5632
 EX 152
 PV 124,208,172
 RV 208,213,1544
 RV 210,213,5640
 QZ 136,212,32
 buffer_load_dwordx4 v215, s[16:19], 0 offen offset:0 lds
 v_add_u32 v213, s32, v213
 QK 136,216,36
 s_add_u32 m0, s31, 9088
 EX 153
 QK 136,220,40
 s_add_u32 s31, s33, s37
 EX 154
 QK 136,224,44
 s_add_u32 s33, s33, s32
 EX 155
 QZ 140,224,60
 RK 224,212,9728
 CV 186,152,153
 QK 140,220,56
 RK 220,212,9216
 CV 187,154,155
 QK 140,216,52
 RK 216,212,8704
 buffer_load_dwordx4 v215, s[16:19], 0 offen offset:128 lds
 QK 140,212,48
 RK 212,212,8192
 EX 156
 v_mfma_f32_16x16x32_bf16 v[152:155], a[228:231], a[32:35], v[208:211]
 EX 157
 QK 152,232,36
 RK 32,219,8192
 CV 190,156,157
 QK 152,236,40
 RK 36,219,8704
 RK 40,219,9216
 EX 158
 EX 159
 PS 136
 PS 138
 PS 140
 PS 142
 QK 152,240,44
 buffer_store_dwordx4 v[8:11], v221, s[24:27], s38 offen offset:0 nt
 RK 44,219,9728
 CV 191,158,159
 v_mfma_f32_16x16x32_bf16 v[156:159], a[240:243], a[60:63], v[208:211]
 RK 240,212,13824
 RK 60,219,13824
 QK 156,236,56
 RK 236,212,13312
 RK 56,219,13312
 QK 156,232,52
 RK 232,212,12800
 EX 136
 QK 156,228,48
 RK 228,212,12288
 v_add_u32 v212, s82, v212
 SM 132,184
 RK 52,219,12800
 RK 48,219,12288
 PV 96,96,188
 EX 137
 PV 64,96,184
 EX 138
 CV 168,136,137
 EX 139
 PS 152
 PS 154
 PS 156
 PS 158
 PV 68,100,184
 buffer_store_dwordx4 v[28:31], v221, s[24:27], s38 offen offset:128 nt
 CV 169,138,139
 PM 32,226,0
 PM 34,226,0
 PM 36,226,0
 PM 38,226,0
 PM 40,226,0
 PM 42,226,0
 PM 44,226,0
 PM 46,226,0
 PV 100,100,188
 CV 32,32,33
 CV 33,34,35
 PV 104,104,188
 CV 34,36,37
 CV 35,38,39
 PV 72,104,184
 EX 152
 PV 76,108,184
 EX 153
 PV 108,108,188
 CV 40,40,41
 CV 41,42,43
 PV 112,112,188
 s_waitcnt vmcnt(12) lgkmcnt(2)
 CV 42,44,45
 CV 43,46,47
 PV 80,112,184
 s_barrier
 PV 84,116,184
 buffer_store_dwordx4 v[16:19], v220, s[24:27], s38 offen offset:128 nt
 PV 116,116,188
 RK 64,212,0
 XE 36,40,32
 PV 120,120,188
 RK 68,212,512
 XE 37,41,33
 PV 88,120,184
 RK 72,212,1024
 XE 38,42,34
 PV 92,124,184
 RK 76,212,1536
 XE 39,43,35
 PV 124,124,188
 s_not_b64 vcc, vcc
 RK 80,212,4096
 XO 40,32,40
 QZ 128,212,0
 RK 84,212,4608
 XO 41,33,41
 QK 128,216,4
 RK 88,212,5120
 XO 42,34,42
 QK 128,220,8
 RK 92,212,5632
 XO 43,35,43
 QK 128,224,12
 buffer_store_dwordx4 v[36:39], v220, s[24:27], s38 offen offset:256 nt
 QZ 132,224,28
 XO 60,48,56
 XO 61,49,57
 QK 132,220,24
 XO 62,50,58
 XO 63,51,59
 QK 132,216,20
 s_not_b64 vcc, vcc
 XE 48,56,48
 XE 49,57,49
 QK 132,212,16
 XE 50,58,50
 XE 51,59,51
 QZ 144,228,0
 EX 154
 QK 144,232,4
 EX 155
 QK 144,236,8
 s_waitcnt lgkmcnt(0)
 CV 170,152,153
 CV 171,154,155
 EX 140
 EX 141
 PS 128
 PS 130
 PS 132
 PS 134
 QK 144,240,12
 buffer_store_dwordx4 v[40:43], v221, s[24:27], s38 offen offset:256 nt
 QZ 148,240,28
 EX 142
 QK 148,236,24
 EX 143
 QK 148,232,20
 CV 172,140,141
 CV 173,142,143
 QK 148,228,16
 EX 156
 LS 132,144,168
 EX 157
 PV 64,180,168
 EX 158
 PV 68,184,168
 EX 159
 PV 72,188,168
 CV 174,156,157
 CV 175,158,159
 v_accvgpr_read_b32 v229, a132
 v_accvgpr_read_b32 v228, a133
 v_add_f32 v229, v228, v229
 PS 144
 PS 146
 PS 148
 PS 150
 v_rcp_f32 v228, v229
 v_subrev_u32 v229, 0x21800000, v229
 v_max3_u32 v225, v225, v227, v229
 PV 76,192,168
 buffer_store_dwordx4 v[60:63], v221, s[24:27], s38 offen offset:384 nt
 EX 128
 PM 64,228,0
 PM 66,228,0
 PM 68,228,0
 PM 70,228,0
 PM 72,228,0
 PM 74,228,0
 PM 76,228,0
 PM 78,228,0
 PV 80,196,168
 CV 64,64,65
 CV 65,66,67
 PV 84,200,168
 CV 66,68,69
 CV 67,70,71
 PV 88,204,168
 EX 129
 PV 92,208,168
 CV 72,72,73
 CV 73,74,75
 LS 132,136,172
 CV 74,76,77
 CV 75,78,79
 PV 96,180,172
 XE 68,72,64
 XE 69,73,65
 PV 100,184,172
 buffer_store_dwordx4 v[48:51], v220, s[24:27], s38 offen offset:384 nt
 PV 104,188,172
 s_mov_b32 s38, s80
 XE 70,74,66
 XE 71,75,67
 v_accvgpr_read_b32 v231, a134
 v_accvgpr_read_b32 v230, a135
 v_add_f32 v231, v230, v231
 v_rcp_f32 v230, v231
 v_subrev_u32 v231, 0x21800000, v231
 v_max_u32 v225, v225, v231
 v_cmp_le_u32 s[84:85], s77, v225
 PV 108,192,172
 s_not_b64 vcc, vcc
 XO 72,64,72
 XO 73,65,73
 PV 112,196,172
 s_cmp_lg_u64 s[84:85], 0
 XO 74,66,74
 XO 75,67,75
 PV 116,200,172
 s_cselect_b32 s92, s76, 0
 EX 130
 PV 120,204,172
 s_or_b32 s73, s73, s92
 EX 131
 PV 124,208,172
 s_lshl_b32 s76, s76, 1
 CV 192,128,129
 CV 193,130,131
 QZ 136,212,32
 buffer_store_dwordx4 v[68:71], v220, s[24:27], s39 offen offset:0 nt
 EX 132
 PM 80,228,0
 PM 82,228,0
 PM 84,228,0
 PM 86,228,0
 PM 88,228,0
 PM 90,228,0
 PM 92,228,0
 PM 94,228,0
 QK 136,216,36
 CV 80,80,81
 CV 81,82,83
 QK 136,220,40
 CV 82,84,85
 CV 83,86,87
 QK 136,224,44
 EX 133
 QZ 140,224,60
 CV 88,88,89
 CV 89,90,91
 QK 140,220,56
 CV 90,92,93
 CV 91,94,95
 QK 140,216,52
 XO 92,80,88
 XO 93,81,89
 QK 140,212,48
 buffer_store_dwordx4 v[72:75], v221, s[24:27], s39 offen offset:0 nt
 QZ 152,228,32
 XO 94,82,90
 XO 95,83,91
 QK 152,232,36
 s_not_b64 vcc, vcc
 XE 80,88,80
 XE 81,89,81
 XE 82,90,82
 XE 83,91,83
 CV 196,132,133
 PS 136
 PS 138
 PS 140
 PS 142
 QK 152,236,40
 EX 134
 QK 152,240,44
 EX 135
 QZ 156,240,60
 EX 144
 QK 156,236,56
 EX 145
 QK 156,232,52
 CV 197,134,135
 CV 194,144,145
 EX 146
 EX 147
 PS 152
 PS 154
 QK 156,228,48
 buffer_store_dwordx4 v[92:95], v221, s[24:27], s39 offen offset:128 nt
 CV 195,146,147
 PM 96,230,0
 PM 98,230,0
 PM 100,230,0
 PM 102,230,0
 PM 104,230,0
 PM 106,230,0
 PM 108,230,0
 PM 110,230,0
 CV 96,96,97
 CV 97,98,99
 CV 98,100,101
 CV 99,102,103
 CV 104,104,105
 CV 105,106,107
 CV 106,108,109
 CV 107,110,111
 XE 100,104,96
 XE 101,105,97
 XE 102,106,98
 XE 103,107,99
 s_not_b64 vcc, vcc
 XO 104,96,104
 XO 105,97,105
 XO 106,98,106
 XO 107,99,107
 EX 148
 EX 149
 EX 150
 CV 198,148,149
 EX 151
 buffer_store_dwordx4 v[80:83], v220, s[24:27], s39 offen offset:128 nt
 CV 199,150,151
 EX 136
 EX 137
 EX 138
 CV 200,136,137
 EX 139
 EX 140
 CV 201,138,139
 EX 141
 EX 142
 CV 204,140,141
 EX 143
 EX 152
 CV 205,142,143
 EX 153
 EX 154
 CV 202,152,153
 EX 155
 buffer_store_dwordx4 v[100:103], v220, s[24:27], s39 offen offset:256 nt
 PM 112,230,0
 PM 114,230,0
 PM 116,230,0
 PM 118,230,0
 CV 112,112,113
 CV 113,114,115
 CV 114,116,117
 CV 115,118,119
 PM 120,230,0
 PM 122,230,0
 PM 124,230,0
 PM 126,230,0
 CV 120,120,121
 CV 121,122,123
 CV 122,124,125
 CV 123,126,127
 XO 124,112,120
 XO 125,113,121
 XO 126,114,122
 XO 127,115,123
 s_not_b64 vcc, vcc
 XE 112,120,112
 XE 113,121,113
 XE 114,122,114
 XE 115,123,115
 CV 203,154,155
 buffer_store_dwordx4 v[104:107], v221, s[24:27], s39 offen offset:256 nt
 buffer_store_dwordx4 v[124:127], v221, s[24:27], s39 offen offset:384 nt
 buffer_store_dwordx4 v[112:115], v220, s[24:27], s39 offen offset:384 nt
 s_mov_b32 s39, s81
 s_and_b32 s26, s43, 0xfffff000
 s_cmp_eq_u32 s79, 0
 s_cbranch_scc1 L_Fe
 s_cmp_eq_u32 s79, 1
 s_cbranch_scc1 L_Fo
 s_cmp_eq_u32 s79, 2
 s_cbranch_scc0 L_init
 s_bitcmp1_b32 s43, 7
 s_cbranch_scc0 L_Z1
 s_branch L_z1
.p2align 12
L_t2:
 QZ 128,64,0
 s_add_u32 s31, s33, s37
 RV 96,213,8192
 SC 156
 QK 128,68,4
 s_mov_b32 s34, s45
 RV 98,213,12288
 SC 157
 QK 128,72,8
 s_and_b32 s62, s46, 0xfffff800
 RV 100,213,8200
 SC 158
 QK 128,76,12
 s_add_u32 s35, s34, 0x10000
 RV 102,213,12296
 SC 159
 QZ 132,76,28
 s_add_u32 s12, s86, s35
 RV 104,213,8704
 RV 106,213,12800
 QK 132,72,24
 s_addc_u32 s13, s87, 0
 RV 108,213,8712
 RV 110,213,12808
 QK 132,68,20
 s_sub_u32 s14, s62, s35
 RV 112,213,9216
 EX 156
 QK 132,64,16
 s_max_i32 s14, s14, 0
 RV 114,213,13312
 RV 116,213,9224
 QZ 136,64,32
 s_add_u32 m0, s31, 0
 RV 118,213,13320
 EX 157
 QK 136,68,36
 s_add_u32 s20, s60, s34
 RV 120,213,9728
 CV 190,156,157
 QK 136,72,40
 s_addc_u32 s21, s61, 0
 RV 122,213,13824
 RV 124,213,9736
 QK 136,76,44
 s_sub_u32 s22, s62, s34
 RV 126,213,13832
 EX 158
 QZ 140,76,60
 s_max_i32 s22, s22, 0
 EX 159
 QK 140,72,56
 s_add_u32 s34, s34, 0x20000
 CV 191,158,159
 QK 140,68,52
 s_add_u32 s16, s86, s34
 QK 140,64,48
 s_addc_u32 s17, s87, 0
 v_mfma_f32_16x16x32_bf16 v[144:147], a[80:83], a[0:3], v[208:211]
 s_sub_u32 s18, s62, s34
 s_waitcnt vmcnt(8)
 RK 0,219,0
 QK 144,84,4
 s_max_i32 s18, s18, 0
 RK 4,219,512
 QK 144,88,8
 s_cmp_eq_u32 s33, 0x8000
 RK 8,219,1024
 PS 128
 PS 130
 PS 132
 PS 134
 PS 136
 PS 138
 PS 140
 PS 142
 QK 144,92,12
 s_cselect_b32 s32, -2, 1
 EX 136
 v_mfma_f32_16x16x32_bf16 v[148:151], a[92:95], a[28:31], v[208:211]
 s_waitcnt lgkmcnt(3)
 RK 12,219,1536
 RK 28,219,5632
 QK 148,88,24
 s_barrier
 QK 148,84,20
 s_lshl_b32 s32, s32, 14
 buffer_load_dwordx4 v215, s[12:15], 0 offen offset:0 lds
 v_add_u32 v212, s32, v212
 QK 148,80,16
 s_add_u32 m0, s31, 896
 RK 148,212,0
 v_add_u32 v213, s32, v213
 QZ 152,80,32
 s_add_u32 s33, s33, s32
 RK 152,212,512
 RK 156,212,1024
 QK 152,84,36
 s_cmp_eq_u32 s33, 0x8000
 RK 160,212,1536
 RK 164,212,4096
 QK 152,88,40
 s_cselect_b32 s32, -2, 1
 RK 168,212,4608
 EX 137
 QK 152,92,44
 s_lshl_b32 s32, s32, 14
 buffer_load_dwordx4 v215, s[12:15], 0 offen offset:128 lds
 CV 168,136,137
 QZ 156,92,60
 s_add_u32 m0, s31, 49152
 RK 172,212,5120
 RK 176,212,5632
 QK 156,88,56
 s_cmp_eq_u32 s79, 2
 RV 180,213,0
 RV 182,213,4096
 QK 156,84,52
 s_cselect_b32 s95, 1, 0
 RV 184,213,8
 v_mul_u32_u24 v235, s95, v247
 QK 156,80,48
 s_add_u32 s35, s34, 0x10000
 RV 186,213,4104
 EX 138
 SM 128,176
 s_add_u32 s12, s86, s35
 RV 188,213,512
 buffer_load_dwordx4 v216, s[20:23], 0 offen offset:0 lds
 SM 132,184
 s_addc_u32 s13, s87, 0
 RV 190,213,4608
 RV 192,213,520
 EX 139
 EX 140
 PS 144
 PS 146
 PS 148
 PS 150
 PS 152
 PS 154
 PS 156
 PS 158
 PV 96,96,188
 s_add_u32 m0, s31, 50048
 RV 194,213,4616
 CV 169,138,139
 PV 64,96,184
 s_sub_u32 s14, s62, s35
 buffer_load_dwordx4 v216, s[20:23], 0 offen offset:128 lds
 RV 196,213,1024
 PV 32,96,180
 s_add_u32 m0, s31, 57344
 RV 198,213,5120
 RV 200,213,1032
 PV 0,96,176
 s_max_i32 s14, s14, 0
 RV 202,213,5128
 RV 204,213,1536
 PV 4,100,176
 s_mov_b64 s[40:41], s[44:45]
 RV 206,213,5632
 EX 141
 PV 36,100,180
 s_mov_b64 s[42:43], s[46:47]
 RV 208,213,1544
 CV 172,140,141
 PV 68,100,184
 s_mov_b64 s[44:45], s[48:49]
 buffer_load_dwordx4 v214, s[20:23], 0 offen offset:0 lds
 RV 210,213,5640
 PV 100,100,188
 s_add_u32 m0, s31, 58240
 RK 212,212,8192
 RK 216,212,8704
 PV 104,104,188
 s_mov_b64 s[46:47], s[50:51]
 RK 220,212,9216
 RK 224,212,9728
 PV 72,104,184
 s_mov_b64 s[48:49], s[52:53]
 RV 96,213,8192
 v_add_u32 v212, s32, v212
 PV 40,104,180
 s_mov_b64 s[50:51], s[54:55]
 RV 98,213,12288
 EX 142
 PV 8,104,176
 s_mov_b64 s[52:53], s[56:57]
 buffer_load_dwordx4 v214, s[20:23], 0 offen offset:128 lds
 RV 100,213,8200
 PV 12,108,176
 s_add_u32 m0, s31, 8192
 RV 102,213,12296
 RV 104,213,8704
 PV 44,108,180
 s_add_u32 s20, s60, s34
 RV 106,213,12800
 RK 24,219,5120
 PV 76,108,184
 s_addc_u32 s21, s61, 0
 RK 20,219,4608
 EX 143
 PV 108,108,188
 s_sub_u32 s22, s62, s34
 RV 108,213,8712
 CV 173,142,143
 PV 112,112,188
 s_max_i32 s22, s22, 0
 buffer_load_dwordx4 v215, s[16:19], 0 offen offset:0 lds
 RV 110,213,12808
 PV 80,112,184
 s_add_u32 m0, s31, 9088
 EX 152
 PV 48,112,180
 s_add_u32 s31, s33, s37
 EX 153
 PV 16,112,176
 s_add_u32 s34, s34, 0x20000
 RV 112,213,9216
 CV 170,152,153
 PV 20,116,176
 s_add_u32 s33, s33, s32
 RV 114,213,13312
 RK 16,219,4096
 PV 52,116,180
 s_mov_b64 s[54:55], s[58:59]
 buffer_load_dwordx4 v215, s[16:19], 0 offen offset:128 lds
 EX 154
 PV 84,116,184
 s_add_u32 m0, s31, 0
 EX 155
 PV 116,116,188
 s_add_u32 s16, s86, s34
 RV 116,213,9224
 CV 171,154,155
 PV 120,120,188
 s_addc_u32 s17, s87, 0
 RV 118,213,13320
 EX 156
 PV 88,120,184
 s_sub_u32 s18, s62, s34
 global_load_dword v255, v235, s[64:65]
 EX 157
 PV 56,120,180
 s_max_i32 s18, s18, 0
 EX 158
 PV 24,120,176
 s_and_b32 s30, s43, 0x3f
 RV 120,213,9728
 CV 174,156,157
 PV 28,124,176
 s_bfe_u32 s83, s42, 0x20006
 RV 122,213,13824
 EX 159
 PV 60,124,180
 s_and_b32 s89, s47, 0x100
 EX 128
 PV 92,124,184
 s_cselect_b32 s89, 0x10000, 0
 EX 129
 PV 124,124,188
 s_add_u32 s72, s45, s89
 RV 124,213,9736
 CV 175,158,159
 s_waitcnt lgkmcnt(15)
 QZ 136,148,32
 s_waitcnt lgkmcnt(15)
 RV 126,213,13832
 v_add_u32 v213, s32, v213
 QK 136,152,36
 s_cmp_eq_u32 s33, 0x8000
 EX 130
 s_waitcnt lgkmcnt(15)
 QK 136,156,40
 s_cselect_b32 s32, -2, 1
 EX 131
 s_waitcnt lgkmcnt(15)
 QK 136,160,44
 s_lshl_b32 s32, s32, 14
 CV 160,128,129
 CV 161,130,131
 QZ 140,160,60
 s_add_u32 s82, s82, s32
 EX 144
 QK 140,156,56
 EX 145
 QK 140,152,52
 EX 146
 QK 140,148,48
 s_waitcnt lgkmcnt(15)
 EX 147
 QZ 152,164,32
 s_waitcnt lgkmcnt(15)
 CV 162,144,145
 CV 163,146,147
 QK 152,168,36
 s_waitcnt lgkmcnt(15)
 EX 132
 QK 152,172,40
 EX 133
 EX 134
 CV 164,132,133
 PS 136
 PS 138
 PS 140
 PS 142
 s_waitcnt lgkmcnt(15)
 QK 152,176,44
 s_waitcnt vmcnt(9) lgkmcnt(0)
 EX 135
 QZ 156,176,60
 s_barrier
 QK 156,172,56
 RK 228,212,12288
 CV 165,134,135
 QK 156,168,52
 RK 232,212,12800
 RK 236,212,13312
 QK 156,164,48
 RK 240,212,13824
 buffer_load_dwordx4 v215, s[12:15], 0 offen offset:0 lds
 LS 128,144,160
 s_add_u32 m0, s31, 896
 EX 148
 PV 0,180,160
 EX 149
 PV 4,184,160
 EX 150
 CV 166,148,149
 EX 151
 PS 152
 PS 154
 PS 156
 PS 158
 v_accvgpr_read_b32 v225, a128
 v_accvgpr_read_b32 v224, a129
 v_add_f32 v225, v224, v225
 v_rcp_f32 v224, v225
 v_subrev_u32 v225, 0x21800000, v225
 PM 0,224,0
 PM 2,224,0
 PM 4,224,0
 PM 6,224,0
 PV 8,188,160
 buffer_load_dwordx4 v215, s[12:15], 0 offen offset:128 lds
 CV 0,0,1
 PV 12,192,160
 s_add_u32 m0, s31, 49152
 CV 1,2,3
 CV 2,4,5
 PV 16,196,160
 CV 3,6,7
 CV 167,150,151
 EX 136
 EX 137
 PM 8,224,0
 PM 10,224,0
 PM 12,224,0
 PM 14,224,0
 PV 20,200,160
 buffer_load_dwordx4 v216, s[20:23], 0 offen offset:0 lds
 CV 8,8,9
 PV 24,204,160
 s_add_u32 m0, s31, 50048
 CV 9,10,11
 CV 10,12,13
 PV 28,208,160
 CV 11,14,15
 XE 4,8,0
 LS 128,136,164
 XE 5,9,1
 XE 6,10,2
 PV 32,180,164
 XE 7,11,3
 CV 184,136,137
 PV 36,184,164
 s_not_b64 vcc, vcc
 buffer_load_dwordx4 v216, s[20:23], 0 offen offset:128 lds
 XO 8,0,8
 v_accvgpr_read_b32 v227, a130
 v_accvgpr_read_b32 v226, a131
 v_add_f32 v227, v226, v227
 v_rcp_f32 v226, v227
 v_subrev_u32 v227, 0x21800000, v227
 PV 40,188,164
 s_add_u32 m0, s31, 57344
 XO 9,1,9
 XO 10,2,10
 PV 44,192,164
 EX 138
 PV 48,196,164
 buffer_load_dwordx4 v214, s[20:23], 0 offen offset:0 lds
 XO 11,3,11
 PV 52,200,164
 s_add_u32 m0, s31, 58240
 EX 139
 PV 56,204,164
 EX 140
 PV 60,208,164
 EX 141
 SM 132,168
 CV 185,138,139
 PV 96,180,172
 buffer_load_dwordx4 v214, s[20:23], 0 offen offset:128 lds
 CV 188,140,141
 PV 64,180,168
 s_add_u32 m0, s31, 8192
 RV 180,213,0
 EX 142
 PV 68,184,168
 EX 143
 PV 100,184,172
 RV 184,213,8
 CV 189,142,143
 PV 104,188,172
 EX 152
 PV 72,188,168
 RV 188,213,512
 buffer_load_dwordx4 v215, s[16:19], 0 offen offset:0 lds
 PV 76,192,168
 s_add_u32 m0, s31, 9088
 EX 153
 PV 108,192,172
 s_add_u32 s31, s33, s37
 RV 192,213,520
 CV 186,152,153
 PV 112,196,172
 s_add_u32 s33, s33, s32
 EX 154
 PV 80,196,168
 RV 196,213,1024
 EX 155
 PV 84,200,168
 buffer_load_dwordx4 v215, s[16:19], 0 offen offset:128 lds
 CV 187,154,155
 PV 116,200,172
 RV 200,213,1032
 EX 156
 PV 120,204,172
 EX 157
 PV 88,204,168
 RV 204,213,1536
 CV 190,156,157
 PV 92,208,168
 EX 158
 PV 124,208,172
 RV 208,213,1544
 v_add_u32 v213, s32, v213
 v_mfma_f32_16x16x32_bf16 v[136:139], a[212:215], a[32:35], v[208:211]
 buffer_store_dwordx4 v[4:7], v220, s[24:27], s38 offen offset:0 nt
 EX 159
 PM 16,224,0
 PM 18,224,0
 PM 20,224,0
 PM 22,224,0
 PM 24,224,0
 PM 26,224,0
 PM 28,224,0
 PM 30,224,0
 QK 136,216,36
 RK 32,219,8192
 CV 16,16,17
 QK 136,220,40
 RK 36,219,8704
 CV 17,18,19
 QK 136,224,44
 RK 40,219,9216
 CV 18,20,21
 v_mfma_f32_16x16x32_bf16 v[140:143], a[212:215], a[48:51], v[208:211]
 RK 212,212,8192
 CV 19,22,23
 QK 140,216,52
 RK 216,212,8704
 CV 24,24,25
 CV 25,26,27
 CV 26,28,29
 CV 27,30,31
 PS 136
 PS 138
 QK 140,220,56
 RK 220,212,9216
 XO 28,16,24
 QK 140,224,60
 RK 224,212,9728
 XO 29,17,25
 LS 132,144,184
 buffer_store_dwordx4 v[8:11], v221, s[24:27], s38 offen offset:0 nt
 PV 64,96,184
 RK 44,219,9728
 XO 30,18,26
 PV 68,100,184
 RK 60,219,13824
 XO 31,19,27
 EX 136
 EX 137
 PS 140
 PS 142
 PV 72,104,184
 s_not_b64 vcc, vcc
 RK 56,219,13312
 XE 16,24,16
 PV 76,108,184
 RK 52,219,12800
 XE 17,25,17
 PV 80,112,184
 RK 48,219,12288
 XE 18,26,18
 PV 84,116,184
 XE 19,27,19
 CV 168,136,137
 PV 88,120,184
 EX 138
 PV 92,124,184
 buffer_store_dwordx4 v[28:31], v221, s[24:27], s38 offen offset:128 nt
 EX 139
 PM 32,226,0
 PM 34,226,0
 PM 36,226,0
 PM 38,226,0
 PM 40,226,0
 PM 42,226,0
 PM 44,226,0
 PM 46,226,0
 s_waitcnt lgkmcnt(8)
 QZ 128,212,0
 s_waitcnt lgkmcnt(7)
 CV 32,32,33
 CV 33,34,35
 QK 128,216,4
 s_waitcnt lgkmcnt(6)
 CV 34,36,37
 CV 35,38,39
 QK 128,220,8
 s_waitcnt vmcnt(12) lgkmcnt(5)
 CV 40,40,41
 CV 41,42,43
 QK 128,224,12
 s_barrier
 QZ 132,224,28
 CV 42,44,45
 CV 43,46,47
 QK 132,220,24
 buffer_store_dwordx4 v[16:19], v220, s[24:27], s38 offen offset:128 nt
 QK 132,216,20
 XE 36,40,32
 XE 37,41,33
 QK 132,212,16
 XE 38,42,34
 XE 39,43,35
 QZ 144,228,0
 s_not_b64 vcc, vcc
 XO 40,32,40
 XO 41,33,41
 QK 144,232,4
 XO 42,34,42
 XO 43,35,43
 CV 169,138,139
 CV 191,158,159
 EX 140
 PS 128
 PS 130
 PS 132
 PS 134
 QK 144,236,8
 EX 141
 QK 144,240,12
 CV 172,140,141
 v_add_u32 v212, s82, v212
 QZ 148,240,28
 buffer_store_dwordx4 v[36:39], v220, s[24:27], s38 offen offset:256 nt
 EX 142
 PM 48,226,0
 PM 50,226,0
 PM 52,226,0
 PM 54,226,0
 PM 56,226,0
 PM 58,226,0
 PM 60,226,0
 PM 62,226,0
 QK 148,236,24
 RK 64,212,0
 CV 48,48,49
 QK 148,232,20
 RK 68,212,512
 CV 49,50,51
 QK 148,228,16
 RK 72,212,1024
 CV 50,52,53
 v_mfma_f32_16x16x16_bf16 a[132:135], a[144:145], v[168:169], a[132:135]
 RK 76,212,1536
 CV 51,54,55
 CV 56,56,57
 PH 64,180,168
 RK 80,212,4096
 EX 143
 CV 57,58,59
 CV 58,60,61
 v_accvgpr_read_b32 v229, a132
 PS 144
 PS 146
 PS 148
 PS 150
 v_accvgpr_read_b32 v228, a133
 v_add_f32 v229, v228, v229
 v_rcp_f32 v228, v229
 v_subrev_u32 v229, 0x21800000, v229
 v_max3_u32 v225, v225, v227, v229
 PH 68,184,168
 buffer_store_dwordx4 v[40:43], v221, s[24:27], s38 offen offset:256 nt
 PH 72,188,168
 RK 84,212,4608
 CV 59,62,63
 XO 60,48,56
 PH 76,192,168
 RK 88,212,5120
 XO 61,49,57
 XO 62,50,58
 PH 80,196,168
 RK 92,212,5632
 XO 63,51,59
 CV 173,142,143
 PH 84,200,168
 s_not_b64 vcc, vcc
 XE 48,56,48
 XE 49,57,49
 PH 88,204,168
 XE 50,58,50
 EX 128
 PH 92,208,168
 EX 129
 XE 51,59,51
 LS 132,136,188
 EX 130
 PV 96,96,188
 EX 131
 PV 100,100,188
 buffer_store_dwordx4 v[60:63], v221, s[24:27], s38 offen offset:384 nt
 CV 192,128,129
 PM 64,228,0
 PM 66,228,0
 PM 68,228,0
 PM 70,228,0
 PM 72,228,0
 PM 74,228,0
 PM 76,228,0
 PM 78,228,0
 PV 104,104,188
 s_waitcnt lgkmcnt(0)
 CV 64,64,65
 CV 65,66,67
 PV 108,108,188
 CV 66,68,69
 CV 67,70,71
 PV 112,112,188
 CV 72,72,73
 CV 73,74,75
 PV 116,116,188
 CV 74,76,77
 CV 75,78,79
 PV 120,120,188
 XE 68,72,64
 XE 69,73,65
 PV 124,124,188
 XE 70,74,66
 XE 71,75,67
 v_mfma_f32_16x16x16_bf16 a[132:135], a[136:137], v[172:173], a[132:135]
 s_not_b64 vcc, vcc
 buffer_store_dwordx4 v[48:51], v220, s[24:27], s38 offen offset:384 nt
 PH 96,180,172
 XO 72,64,72
 XO 73,65,73
 XO 74,66,74
 PH 100,184,172
 XO 75,67,75
 v_accvgpr_read_b32 v231, a134
 v_accvgpr_read_b32 v230, a135
 v_add_f32 v231, v230, v231
 v_rcp_f32 v230, v231
 v_subrev_u32 v231, 0x21800000, v231
 v_max_u32 v225, v225, v231
 v_cmp_le_u32 s[84:85], s77, v225
 PH 104,188,172
 EX 132
 CV 193,130,131
 PH 108,192,172
 EX 133
 EX 134
 PH 112,196,172
 EX 135
 CV 196,132,133
 PH 116,200,172
 EX 144
 CV 197,134,135
 PH 120,204,172
 EX 145
 EX 146
 PH 124,208,172
 buffer_store_dwordx4 v[68:71], v220, s[24:27], s39 offen offset:0 nt
 CV 194,144,145
 EX 147
 PM 80,228,0
 PM 82,228,0
 PM 84,228,0
 PM 86,228,0
 PM 88,228,0
 PM 90,228,0
 PM 92,228,0
 PM 94,228,0
 QZ 136,212,32
 s_cmp_lg_u64 s[84:85], 0
 CV 80,80,81
 CV 81,82,83
 QK 136,216,36
 s_cselect_b32 s92, s76, 0
 CV 82,84,85
 CV 83,86,87
 QK 136,220,40
 s_or_b32 s73, s73, s92
 CV 88,88,89
 CV 89,90,91
 QK 136,224,44
 s_lshl_b32 s76, s76, 1
 CV 90,92,93
 CV 91,94,95
 QZ 140,224,60
 s_mov_b32 s38, s80
 XO 92,80,88
 XO 93,81,89
 QK 140,220,56
 XO 94,82,90
 XO 95,83,91
 QK 140,216,52
 s_not_b64 vcc, vcc
 buffer_store_dwordx4 v[72:75], v221, s[24:27], s39 offen offset:0 nt
 QK 140,212,48
 XE 80,88,80
 XE 81,89,81
 QZ 152,228,32
 XE 82,90,82
 XE 83,91,83
 QK 152,232,36
 EX 148
 QK 152,236,40
 EX 149
 CV 195,146,147
 CV 198,148,149
 EX 150
 PS 136
 PS 138
 PS 140
 PS 142
 QK 152,240,44
 EX 151
 QZ 156,240,60
 EX 136
 QK 156,236,56
 buffer_store_dwordx4 v[92:95], v221, s[24:27], s39 offen offset:128 nt
 CV 199,150,151
 PM 96,230,0
 PM 98,230,0
 PM 100,230,0
 PM 102,230,0
 PM 104,230,0
 PM 106,230,0
 PM 108,230,0
 PM 110,230,0
 PS 152
 PS 154
 QK 156,232,52
 CV 96,96,97
 CV 97,98,99
 QK 156,228,48
 CV 98,100,101
 CV 99,102,103
 CV 104,104,105
 CV 105,106,107
 CV 106,108,109
 CV 107,110,111
 XE 100,104,96
 XE 101,105,97
 XE 102,106,98
 XE 103,107,99
 s_not_b64 vcc, vcc
 XO 104,96,104
 XO 105,97,105
 XO 106,98,106
 XO 107,99,107
 EX 137
 buffer_store_dwordx4 v[80:83], v220, s[24:27], s39 offen offset:128 nt
 CV 200,136,137
 EX 138
 EX 139
 EX 140
 CV 201,138,139
 EX 141
 EX 142
 CV 204,140,141
 EX 143
 EX 152
 CV 205,142,143
 EX 153
 EX 154
 CV 202,152,153
 EX 155
 buffer_store_dwordx4 v[100:103], v220, s[24:27], s39 offen offset:256 nt
 PM 112,230,0
 PM 114,230,0
 PM 116,230,0
 PM 118,230,0
 CV 112,112,113
 CV 113,114,115
 CV 114,116,117
 CV 115,118,119
 PM 120,230,0
 PM 122,230,0
 PM 124,230,0
 PM 126,230,0
 CV 120,120,121
 CV 121,122,123
 CV 122,124,125
 CV 123,126,127
 XO 124,112,120
 XO 125,113,121
 XO 126,114,122
 XO 127,115,123
 s_not_b64 vcc, vcc
 XE 112,120,112
 XE 113,121,113
 XE 114,122,114
 XE 115,123,115
 CV 203,154,155
 buffer_store_dwordx4 v[104:107], v221, s[24:27], s39 offen offset:256 nt
 buffer_store_dwordx4 v[124:127], v221, s[24:27], s39 offen offset:384 nt
 buffer_store_dwordx4 v[112:115], v220, s[24:27], s39 offen offset:384 nt
 s_mov_b32 s39, s81
 s_and_b32 s26, s43, 0xfffff000
 s_cmp_eq_u32 s79, 0
 s_cbranch_scc1 L_Fe
 s_cmp_eq_u32 s79, 1
 s_cbranch_scc1 L_Fo
 s_cmp_eq_u32 s79, 2
 s_cbranch_scc0 L_init
 s_bitcmp1_b32 s43, 7
 s_cbranch_scc0 L_Z2
 s_branch L_z2
.p2align 12
L_t3:
 QZ 128,64,0
 s_add_u32 s31, s33, s37
 RV 96,213,8192
 SC 156
 QK 128,68,4
 s_mov_b32 s34, s45
 RV 98,213,12288
 SC 157
 QK 128,72,8
 s_and_b32 s62, s46, 0xfffff800
 RV 100,213,8200
 SC 158
 QK 128,76,12
 s_add_u32 s35, s34, 0x10000
 RV 102,213,12296
 SC 159
 QZ 132,76,28
 s_add_u32 s12, s86, s35
 RV 104,213,8704
 RV 106,213,12800
 QK 132,72,24
 s_addc_u32 s13, s87, 0
 RV 108,213,8712
 SC 128
 QK 132,68,20
 s_sub_u32 s14, s62, s35
 RV 110,213,12808
 SC 129
 QK 132,64,16
 s_max_i32 s14, s14, 0
 RV 112,213,9216
 SC 130
 QZ 136,64,32
 s_add_u32 m0, s31, 0
 RV 114,213,13312
 SC 131
 QK 136,68,36
 s_add_u32 s20, s60, s34
 RV 116,213,9224
 SC 132
 QK 136,72,40
 s_addc_u32 s21, s61, 0
 RV 118,213,13320
 SC 133
 QK 136,76,44
 s_sub_u32 s22, s62, s34
 RV 120,213,9728
 SC 134
 QZ 140,76,60
 s_max_i32 s22, s22, 0
 RV 122,213,13824
 SC 135
 QK 140,72,56
 s_add_u32 s34, s34, 0x20000
 RV 124,213,9736
 SC 136
 QK 140,68,52
 s_add_u32 s16, s86, s34
 RV 126,213,13832
 SC 137
 QK 140,64,48
 s_addc_u32 s17, s87, 0
 EX 156
 QZ 144,80,0
 s_sub_u32 s18, s62, s34
 EX 157
 QK 144,84,4
 s_max_i32 s18, s18, 0
 CV 190,156,157
 SC 138
 QK 144,88,8
 s_cmp_eq_u32 s33, 0x8000
 EX 158
 QK 144,92,12
 s_cselect_b32 s32, -2, 1
 EX 159
 QZ 148,92,28
 s_lshl_b32 s32, s32, 14
 v_add_u32 v212, s32, v212
 v_add_u32 v213, s32, v213
 QK 148,88,24
 s_add_u32 s33, s33, s32
 CV 191,158,159
 SC 139
 QK 148,84,20
 s_cmp_eq_u32 s33, 0x8000
 EX 128
 QK 148,80,16
 s_cselect_b32 s32, -2, 1
 EX 129
 QZ 152,80,32
 s_waitcnt vmcnt(8) lgkmcnt(0)
 CV 160,128,129
 SC 140
 QK 152,84,36
 s_barrier
 QK 152,88,40
 s_lshl_b32 s32, s32, 14
 buffer_load_dwordx4 v215, s[12:15], 0 offen offset:0 lds
 SC 141
 QK 152,92,44
 s_add_u32 m0, s31, 896
 RK 148,212,0
 SC 142
 QZ 156,92,60
 s_cmp_eq_u32 s79, 2
 RK 152,212,512
 SC 143
 QK 156,88,56
 s_cselect_b32 s95, 1, 0
 RK 156,212,1024
 v_mul_u32_u24 v235, s95, v247
 QK 156,84,52
 s_add_u32 s35, s34, 0x10000
 RK 160,212,1536
 RK 164,212,4096
 QK 156,80,48
 s_mov_b64 s[40:41], s[44:45]
 buffer_load_dwordx4 v215, s[12:15], 0 offen offset:128 lds
 RK 168,212,4608
 SM 128,176
 s_add_u32 m0, s31, 49152
 RK 172,212,5120
 RK 176,212,5632
 SM 132,184
 s_add_u32 s12, s86, s35
 RV 180,213,0
 v_add_u32 v212, s32, v212
 EX 130
 EX 131
 PS 144
 PS 146
 PS 148
 PS 150
 PS 152
 PS 154
 PS 156
 PS 158
 PV 96,96,188
 s_addc_u32 s13, s87, 0
 buffer_load_dwordx4 v216, s[20:23], 0 offen offset:0 lds
 CV 161,130,131
 PV 64,96,184
 s_add_u32 m0, s31, 50048
 RV 182,213,4096
 RV 184,213,8
 PV 32,96,180
 s_sub_u32 s14, s62, s35
 RV 186,213,4104
 RV 188,213,512
 PV 0,96,176
 s_max_i32 s14, s14, 0
 RV 190,213,4608
 EX 132
 PV 4,100,176
 s_mov_b64 s[42:43], s[46:47]
 RV 192,213,520
 buffer_load_dwordx4 v216, s[20:23], 0 offen offset:128 lds
 PV 36,100,180
 s_add_u32 m0, s31, 57344
 RV 194,213,4616
 RV 196,213,1024
 PV 68,100,184
 s_mov_b64 s[44:45], s[48:49]
 RV 198,213,5120
 EX 133
 PV 100,100,188
 s_mov_b64 s[46:47], s[50:51]
 RV 200,213,1032
 CV 164,132,133
 PV 104,104,188
 s_mov_b64 s[48:49], s[52:53]
 RV 202,213,5128
 RV 204,213,1536
 PV 72,104,184
 s_mov_b64 s[50:51], s[54:55]
 buffer_load_dwordx4 v214, s[20:23], 0 offen offset:0 lds
 RV 206,213,5632
 PV 40,104,180
 s_add_u32 m0, s31, 58240
 RV 208,213,1544
 RV 210,213,5640
 PV 8,104,176
 s_mov_b64 s[52:53], s[56:57]
 RV 96,213,8192
 EX 134
 PV 12,108,176
 s_mov_b64 s[54:55], s[58:59]
 RV 98,213,12288
 RV 100,213,8200
 PV 44,108,180
 s_and_b32 s30, s43, 0x3f
 RV 102,213,12296
 buffer_load_dwordx4 v214, s[20:23], 0 offen offset:128 lds
 PV 76,108,184
 s_add_u32 m0, s31, 8192
 RV 104,213,8704
 RV 106,213,12800
 PV 108,108,188
 s_add_u32 s20, s60, s34
 RV 108,213,8712
 EX 135
 PV 112,112,188
 s_addc_u32 s21, s61, 0
 RV 110,213,12808
 CV 165,134,135
 PV 80,112,184
 s_sub_u32 s22, s62, s34
 EX 136
 PV 48,112,180
 s_max_i32 s22, s22, 0
 buffer_load_dwordx4 v215, s[16:19], 0 offen offset:0 lds
 EX 137
 PV 16,112,176
 s_add_u32 m0, s31, 9088
 RV 112,213,9216
 CV 168,136,137
 PV 20,116,176
 s_add_u32 s31, s33, s37
 RV 114,213,13312
 EX 138
 PV 52,116,180
 s_add_u32 s34, s34, 0x20000
 EX 139
 PV 84,116,184
 s_add_u32 s33, s33, s32
 buffer_load_dwordx4 v215, s[16:19], 0 offen offset:128 lds
 CV 169,138,139
 PV 116,116,188
 s_add_u32 m0, s31, 0
 RV 116,213,9224
 RV 118,213,13320
 PV 120,120,188
 s_add_u32 s16, s86, s34
 EX 140
 PV 88,120,184
 s_addc_u32 s17, s87, 0
 EX 141
 PV 56,120,180
 s_sub_u32 s18, s62, s34
 EX 142
 PV 24,120,176
 s_max_i32 s18, s18, 0
 RV 120,213,9728
 CV 172,140,141
 PV 28,124,176
 s_bfe_u32 s83, s42, 0x20006
 RV 122,213,13824
 global_load_dword v255, v235, s[64:65]
 PV 60,124,180
 s_and_b32 s89, s47, 0x100
 EX 143
 PV 92,124,184
 s_cselect_b32 s89, 0x10000, 0
 EX 152
 PV 124,124,188
 s_add_u32 s72, s45, s89
 RV 124,213,9736
 CV 173,142,143
 s_waitcnt lgkmcnt(15)
 v_mfma_f32_16x16x32_bf16 v[128:131], a[148:151], a[0:3], v[208:211]
 s_waitcnt lgkmcnt(15)
 RV 126,213,13832
 v_add_u32 v213, s32, v213
 QK 128,152,4
 s_cmp_eq_u32 s33, 0x8000
 RK 0,219,0
 RK 4,219,512
 s_waitcnt lgkmcnt(15)
 QK 128,156,8
 s_cselect_b32 s32, -2, 1
 EX 153
 s_waitcnt lgkmcnt(15)
 QK 128,160,12
 s_lshl_b32 s32, s32, 14
 RK 8,219,1024
 CV 170,152,153
 v_mfma_f32_16x16x32_bf16 v[132:135], a[160:163], a[28:31], v[208:211]
 s_add_u32 s82, s82, s32
 RK 12,219,1536
 v_add_u32 v213, s32, v213
 QK 132,156,24
 RK 28,219,5632
 SC 128
 QK 132,152,20
 RK 24,219,5120
 SC 129
 QK 132,148,16
 RK 20,219,4608
 SC 130
 QZ 136,148,32
 RK 16,219,4096
 SC 131
 QK 136,152,36
 EX 154
 QK 136,156,40
 EX 155
 QK 136,160,44
 CV 171,154,155
 SC 132
 QZ 140,160,60
 EX 156
 QK 140,156,56
 EX 157
 QK 140,152,52
 CV 174,156,157
 SC 133
 QK 140,148,48
 s_waitcnt lgkmcnt(15)
 EX 158
 v_mfma_f32_16x16x32_bf16 v[152:155], a[164:167], a[32:35], v[208:211]
 s_waitcnt vmcnt(9) lgkmcnt(8)
 RK 32,219,8192
 SC 134
 QK 152,168,36
 s_barrier
 QK 152,172,40
 RK 212,212,8192
 SC 135
 QK 152,176,44
 RK 216,212,8704
 SC 136
 RK 220,212,9216
 RK 224,212,9728
 RK 228,212,12288
 buffer_load_dwordx4 v215, s[12:15], 0 offen offset:0 lds
 s_add_u32 m0, s31, 896
 RK 232,212,12800
 EX 159
 RK 236,212,13312
 RK 240,212,13824
 CV 175,158,159
 v_mfma_f32_16x16x32_bf16 v[156:159], a[176:179], a[60:63], v[208:211]
 RK 36,219,8704
 SC 137
 QK 156,172,56
 RK 40,219,9216
 SC 138
 QK 156,168,52
 buffer_load_dwordx4 v215, s[12:15], 0 offen offset:128 lds
 SC 139
 QK 156,164,48
 s_add_u32 m0, s31, 49152
 RK 44,219,9728
 SC 140
 EX 144
 EX 145
 EX 146
 CV 162,144,145
 EX 147
 EX 148
 CV 163,146,147
 buffer_load_dwordx4 v216, s[20:23], 0 offen offset:0 lds
 RK 60,219,13824
 RK 56,219,13312
 RK 52,219,12800
 s_add_u32 m0, s31, 50048
 EX 149
 EX 150
 CV 166,148,149
 EX 151
 EX 128
 CV 167,150,151
 EX 129
 EX 130
 SM 128,160
 RK 48,219,12288
 CV 176,128,129
 EX 131
 EX 132
 PS 152
 PS 154
 PS 156
 PS 158
 PV 32,180,164
 buffer_load_dwordx4 v216, s[20:23], 0 offen offset:128 lds
 CV 177,130,131
 PV 0,180,160
 s_add_u32 m0, s31, 57344
 EX 133
 PV 4,184,160
 CV 180,132,133
 SC 141
 PV 36,184,164
 EX 134
 PV 40,188,164
 EX 135
 PV 8,188,160
 buffer_load_dwordx4 v214, s[20:23], 0 offen offset:0 lds
 CV 181,134,135
 PV 12,192,160
 s_add_u32 m0, s31, 58240
 EX 136
 PV 44,192,164
 EX 137
 PV 48,196,164
 CV 184,136,137
 SC 142
 PV 16,196,160
 EX 138
 PV 20,200,160
 buffer_load_dwordx4 v214, s[20:23], 0 offen offset:128 lds
 SC 143
 PV 52,200,164
 s_add_u32 m0, s31, 8192
 EX 139
 PV 56,204,164
 CV 185,138,139
 v_add_u32 v212, s82, v212
 PV 24,204,160
 EX 152
 PV 28,208,160
 EX 153
 PV 60,208,164
 buffer_load_dwordx4 v215, s[16:19], 0 offen offset:0 lds
 CV 186,152,153
 v_mfma_f32_16x16x16_bf16 a[128:131], a[144:145], v[176:177], a[128:131]
 s_add_u32 m0, s31, 9088
 EX 154
 PH 0,96,176
 EX 155
 EX 140
 PH 4,100,176
 EX 141
 CV 187,154,155
 v_accvgpr_read_b32 v225, a128
 v_accvgpr_read_b32 v224, a129
 v_add_f32 v225, v224, v225
 v_rcp_f32 v224, v225
 v_subrev_u32 v225, 0x21800000, v225
 PM 0,224,0
 PM 2,224,0
 PM 4,224,0
 PM 6,224,0
 PH 8,104,176
 buffer_load_dwordx4 v215, s[16:19], 0 offen offset:128 lds
 CV 0,0,1
 CV 1,2,3
 PH 12,108,176
 CV 2,4,5
 CV 3,6,7
 CV 188,140,141
 PH 16,112,176
 EX 142
 EX 143
 EX 156
 PM 8,224,0
 PM 10,224,0
 PM 12,224,0
 PM 14,224,0
 PH 20,116,176
 CV 8,8,9
 CV 9,10,11
 CV 10,12,13
 PH 24,120,176
 CV 11,14,15
 XE 4,8,0
 XE 5,9,1
 PH 28,124,176
 XE 6,10,2
 XE 7,11,3
 CV 189,142,143
 v_mfma_f32_16x16x16_bf16 a[128:131], a[136:137], v[180:181], a[128:131]
 s_not_b64 vcc, vcc
 buffer_store_dwordx4 v[4:7], v220, s[24:27], s38 offen offset:0 nt
 XO 8,0,8
 PM 16,224,0
 PM 18,224,0
 PM 20,224,0
 PM 22,224,0
 PM 24,224,0
 PM 26,224,0
 PM 28,224,0
 PM 30,224,0
 v_accvgpr_read_b32 v227, a130
 v_accvgpr_read_b32 v226, a131
 v_add_f32 v227, v226, v227
 v_rcp_f32 v226, v227
 v_subrev_u32 v227, 0x21800000, v227
 PH 32,96,180
 XO 9,1,9
 XO 10,2,10
 XO 11,3,11
 PH 36,100,180
 CV 16,16,17
 CV 17,18,19
 CV 18,20,21
 PH 40,104,180
 CV 19,22,23
 EX 157
 PH 44,108,180
 CV 24,24,25
 CV 25,26,27
 CV 26,28,29
 PH 48,112,180
 CV 27,30,31
 XO 28,16,24
 XO 29,17,25
 PH 52,116,180
 buffer_store_dwordx4 v[8:11], v221, s[24:27], s38 offen offset:0 nt
 PH 56,120,180
 XO 30,18,26
 XO 31,19,27
 CV 190,156,157
 PH 60,124,180
 s_not_b64 vcc, vcc
 XE 16,24,16
 XE 17,25,17
 SM 132,168
 s_add_u32 s31, s33, s37
 XE 18,26,18
 PV 96,180,172
 s_add_u32 s33, s33, s32
 EX 158
 PV 64,180,168
 EX 159
 PV 68,184,168
 XE 19,27,19
 CV 191,158,159
 PV 100,184,172
 PV 104,188,172
 PV 72,188,168
 buffer_store_dwordx4 v[28:31], v221, s[24:27], s38 offen offset:128 nt
 PM 32,226,0
 PM 34,226,0
 PM 36,226,0
 PM 38,226,0
 PM 40,226,0
 PM 42,226,0
 PM 44,226,0
 PM 46,226,0
 PV 76,192,168
 s_waitcnt vmcnt(12) lgkmcnt(7)
 CV 32,32,33
 CV 33,34,35
 PV 108,192,172
 s_barrier
 PV 112,196,172
 RK 64,212,0
 CV 34,36,37
 PV 80,196,168
 RK 68,212,512
 CV 35,38,39
 PV 84,200,168
 RK 72,212,1024
 CV 40,40,41
 PV 116,200,172
 RK 76,212,1536
 CV 41,42,43
 PV 120,204,172
 buffer_store_dwordx4 v[16:19], v220, s[24:27], s38 offen offset:128 nt
 PV 88,204,168
 RK 80,212,4096
 CV 42,44,45
 PV 92,208,168
 RK 84,212,4608
 CV 43,46,47
 PV 124,208,172
 RK 88,212,5120
 XE 36,40,32
 QZ 128,212,0
 RK 92,212,5632
 XE 37,41,33
 QK 128,216,4
 XE 38,42,34
 XE 39,43,35
 QK 128,220,8
 s_not_b64 vcc, vcc
 XO 40,32,40
 XO 41,33,41
 QK 128,224,12
 XO 42,34,42
 XO 43,35,43
 QZ 132,224,28
 QK 132,220,24
 buffer_store_dwordx4 v[36:39], v220, s[24:27], s38 offen offset:256 nt
 PM 48,226,0
 PM 50,226,0
 PM 52,226,0
 PM 54,226,0
 PM 56,226,0
 PM 58,226,0
 PM 60,226,0
 PM 62,226,0
 QK 132,216,20
 s_waitcnt lgkmcnt(0)
 CV 48,48,49
 CV 49,50,51
 QK 132,212,16
 CV 50,52,53
 CV 51,54,55
 QZ 144,228,0
 CV 56,56,57
 CV 57,58,59
 QK 144,232,4
 CV 58,60,61
 CV 59,62,63
 QK 144,236,8
 XO 60,48,56
 XO 61,49,57
 QK 144,240,12
 XO 62,50,58
 XO 63,51,59
 QZ 148,240,28
 s_not_b64 vcc, vcc
 buffer_store_dwordx4 v[40:43], v221, s[24:27], s38 offen offset:256 nt
 QK 148,236,24
 XE 48,56,48
 XE 49,57,49
 QK 148,232,20
 XE 50,58,50
 XE 51,59,51
 QK 148,228,16
 SC 128
 SC 129
 LS 132,144,184
 EX 128
 PV 64,96,184
 EX 129
 PV 68,100,184
 CV 192,128,129
 SC 130
 SC 131
 EX 130
 PS 144
 PS 146
 PS 148
 PS 150
 v_accvgpr_read_b32 v229, a132
 v_accvgpr_read_b32 v228, a133
 v_add_f32 v229, v228, v229
 v_rcp_f32 v228, v229
 v_subrev_u32 v229, 0x21800000, v229
 v_max3_u32 v225, v225, v227, v229
 PV 72,104,184
 buffer_store_dwordx4 v[60:63], v221, s[24:27], s38 offen offset:384 nt
 EX 131
 PM 64,228,0
 PM 66,228,0
 PM 68,228,0
 PM 70,228,0
 PV 76,108,184
 CV 64,64,65
 CV 65,66,67
 CV 66,68,69
 CV 67,70,71
 CV 193,130,131
 PM 72,228,0
 PM 74,228,0
 PV 80,112,184
 CV 72,72,73
 CV 73,74,75
 SC 132
 XE 68,72,64
 XE 69,73,65
 PM 76,228,0
 PM 78,228,0
 PV 84,116,184
 CV 74,76,77
 CV 75,78,79
 PV 88,120,184
 XE 70,74,66
 XE 71,75,67
 PV 92,124,184
 s_not_b64 vcc, vcc
 buffer_store_dwordx4 v[48:51], v220, s[24:27], s38 offen offset:384 nt
 LS 132,136,188
 s_mov_b32 s38, s80
 XO 72,64,72
 XO 73,65,73
 PV 96,96,188
 XO 74,66,74
 XO 75,67,75
 PV 100,100,188
 SC 133
 v_accvgpr_read_b32 v231, a134
 v_accvgpr_read_b32 v230, a135
 v_add_f32 v231, v230, v231
 v_rcp_f32 v230, v231
 v_subrev_u32 v231, 0x21800000, v231
 v_max_u32 v225, v225, v231
 v_cmp_le_u32 s[84:85], s77, v225
 PV 104,104,188
 EX 132
 PV 108,108,188
 s_cmp_lg_u64 s[84:85], 0
 EX 133
 PV 112,112,188
 s_cselect_b32 s92, s76, 0
 CV 196,132,133
 SC 134
 PV 116,116,188
 s_or_b32 s73, s73, s92
 EX 134
 PV 120,120,188
 s_lshl_b32 s76, s76, 1
 buffer_store_dwordx4 v[68:71], v220, s[24:27], s39 offen offset:0 nt
 SC 135
 PM 80,228,0
 PM 82,228,0
 PM 84,228,0
 PM 86,228,0
 PM 88,228,0
 PM 90,228,0
 PM 92,228,0
 PM 94,228,0
 PV 124,124,188
 CV 80,80,81
 CV 81,82,83
 QZ 136,212,32
 CV 82,84,85
 CV 83,86,87
 QK 136,216,36
 EX 135
 QK 136,220,40
 CV 88,88,89
 CV 89,90,91
 QK 136,224,44
 CV 90,92,93
 CV 91,94,95
 QZ 140,224,60
 XO 92,80,88
 XO 93,81,89
 QK 140,220,56
 buffer_store_dwordx4 v[72:75], v221, s[24:27], s39 offen offset:0 nt
 QK 140,216,52
 XO 94,82,90
 XO 95,83,91
 QK 140,212,48
 s_not_b64 vcc, vcc
 XE 80,88,80
 XE 81,89,81
 QZ 152,228,32
 XE 82,90,82
 XE 83,91,83
 QK 152,232,36
 CV 197,134,135
 SC 136
 QK 152,236,40
 EX 144
 QK 152,240,44
 EX 145
 QZ 156,240,60
 CV 194,144,145
 SC 137
 QK 156,236,56
 EX 146
 QK 156,232,52
 buffer_store_dwordx4 v[92:95], v221, s[24:27], s39 offen offset:128 nt
 EX 147
 PM 96,230,0
 PM 98,230,0
 PM 100,230,0
 PM 102,230,0
 PM 104,230,0
 PM 106,230,0
 PM 108,230,0
 PM 110,230,0
 PS 152
 PS 154
 QK 156,228,48
 CV 96,96,97
 CV 97,98,99
 CV 98,100,101
 CV 99,102,103
 CV 104,104,105
 CV 105,106,107
 CV 106,108,109
 CV 107,110,111
 XE 100,104,96
 XE 101,105,97
 XE 102,106,98
 XE 103,107,99
 s_not_b64 vcc, vcc
 XO 104,96,104
 XO 105,97,105
 XO 106,98,106
 XO 107,99,107
 CV 195,146,147
 EX 148
 buffer_store_dwordx4 v[80:83], v220, s[24:27], s39 offen offset:128 nt
 EX 149
 EX 150
 CV 198,148,149
 EX 151
 EX 136
 CV 199,150,151
 EX 137
 SC 138
 CV 200,136,137
 SC 139
 EX 138
 EX 139
 SC 140
 CV 201,138,139
 SC 141
 EX 140
 EX 141
 SC 142
 CV 204,140,141
 SC 143
 EX 142
 EX 143
 EX 152
 buffer_store_dwordx4 v[100:103], v220, s[24:27], s39 offen offset:256 nt
 PM 112,230,0
 PM 114,230,0
 PM 116,230,0
 PM 118,230,0
 CV 112,112,113
 CV 113,114,115
 CV 114,116,117
 CV 115,118,119
 PM 120,230,0
 PM 122,230,0
 PM 124,230,0
 PM 126,230,0
 CV 120,120,121
 CV 121,122,123
 CV 122,124,125
 CV 123,126,127
 XO 124,112,120
 XO 125,113,121
 XO 126,114,122
 XO 127,115,123
 s_not_b64 vcc, vcc
 XE 112,120,112
 XE 113,121,113
 XE 114,122,114
 XE 115,123,115
 CV 205,142,143
 EX 153
 EX 154
 CV 202,152,153
 EX 155
 buffer_store_dwordx4 v[104:107], v221, s[24:27], s39 offen offset:256 nt
 CV 203,154,155
 buffer_store_dwordx4 v[124:127], v221, s[24:27], s39 offen offset:384 nt
 buffer_store_dwordx4 v[112:115], v220, s[24:27], s39 offen offset:384 nt
 s_mov_b32 s39, s81
 s_and_b32 s26, s43, 0xfffff000
 s_cmp_eq_u32 s79, 0
 s_cbranch_scc1 L_Fe
 s_cmp_eq_u32 s79, 1
 s_cbranch_scc1 L_Fo
 s_cmp_eq_u32 s79, 2
 s_cbranch_scc0 L_init
 s_bitcmp1_b32 s43, 7
 s_cbranch_scc0 L_Z3
 s_branch L_z3
.p2align 12
L_Fo:
 QZ 128,64,0
 s_mov_b32 s95, L_T0-L_pc
 RV 96,213,8192
 SC 156
 SC 157
 QK 128,68,4
 s_cmp_eq_u32 s46, 0
 RV 98,213,12288
 SC 158
 EX 156
 QK 128,72,8
 s_cselect_b32 s95, L_U0-L_pc, s95
 RV 100,213,8200
 SC 159
 EX 157
 QK 128,76,12
 s_bitcmp1_b32 s43, 7
 RV 102,213,12296
 CV 206,156,157
 EX 158
 QZ 132,76,28
 s_cselect_b32 s93, 0x8000, 0
 RV 104,213,8704
 v_subrev_u32 v212, 0x2000, v212
 SC 128
 QK 132,72,24
 s_add_u32 s95, s95, s93
 EX 159
 QK 132,68,20
 s_mov_b32 s94, s31
 RV 106,213,12800
 v_add_u32 v235, s95, v244
 QK 132,64,16
 s_add_u32 s35, s34, 0x10000
 RV 108,213,8712
 CV 207,158,159
 QZ 136,64,32
 s_add_u32 s12, s86, s35
 RV 110,213,12808
 SC 129
 QK 136,68,36
 s_addc_u32 s13, s87, 0
 global_load_dword v255, v235, s[64:65]
 QK 136,72,40
 s_sub_u32 s14, s62, s35
 RV 112,213,9216
 SC 130
 QK 136,76,44
 s_max_i32 s14, s14, 0
 RV 114,213,13312
 SC 131
 QZ 140,76,60
 s_add_u32 m0, s94, 0
 EX 128
 QK 140,72,56
 s_add_u32 s20, s60, s34
 RV 116,213,9224
 SC 132
 QK 140,68,52
 s_addc_u32 s21, s61, 0
 RV 118,213,13320
 SC 133
 QK 140,64,48
 s_sub_u32 s22, s62, s34
 RV 120,213,9728
 SC 134
 QZ 144,80,0
 s_max_i32 s22, s22, 0
 buffer_load_dwordx4 v215, s[12:15], 0 offen offset:0 lds
 SC 135
 QK 144,84,4
 s_add_u32 m0, s94, 896
 RV 122,213,13824
 SC 136
 QK 144,88,8
 s_add_u32 s34, s34, 0x20000
 RV 124,213,9736
 SC 137
 QK 144,92,12
 s_add_u32 s16, s86, s34
 buffer_load_dwordx4 v215, s[12:15], 0 offen offset:128 lds
 SC 138
 QZ 148,92,28
 s_addc_u32 s17, s87, 0
 RV 126,213,13832
 SC 139
 QK 148,88,24
 s_add_u32 m0, s94, 49152
 EX 129
 QK 148,84,20
 s_sub_u32 s18, s62, s34
 buffer_load_dwordx4 v216, s[20:23], 0 offen offset:0 lds
 CV 160,128,129
 QK 148,80,16
 s_max_i32 s18, s18, 0
 SC 140
 SC 141
 QZ 152,80,32
 s_cmp_eq_u32 s33, 0x8000
 EX 130
 QK 152,84,36
 s_cselect_b32 s32, -2, 1
 EX 131
 QK 152,88,40
 s_lshl_b32 s32, s32, 14
 v_add_u32 v212, s32, v212
 CV 161,130,131
 QK 152,92,44
 s_add_u32 m0, s94, 50048
 EX 132
 QZ 156,92,60
 s_lshl_b32 s91, s29, 16
 buffer_load_dwordx4 v216, s[20:23], 0 offen offset:128 lds
 SC 142
 QK 156,88,56
 s_waitcnt vmcnt(5) lgkmcnt(0)
 EX 133
 QK 156,84,52
 s_barrier
 EX 134
 PS 148
 PS 150
 PS 152
 PS 154
 QK 156,80,48
 s_add_u32 s80, s44, s91
 EX 135
 v_mfma_f32_16x16x32_bf16 a[128:131], a[144:147], v[192:195], 0
 s_sub_u32 s81, s44, s91
 RK 64,212,0
 CV 164,132,133
 LS 128,136,196
 s_add_u32 s81, s81, 0x70000
 EX 136
 v_mfma_f32_16x16x32_bf16 a[132:135], a[144:147], v[200:203], 0
 s_add_u32 m0, s94, 57344
 CV 165,134,135
 SC 143
 LS 132,136,204
 s_and_b32 s10, s47, 0xfffff000
 buffer_load_dwordx4 v214, s[20:23], 0 offen offset:0 lds
 SC 144
 PZ 96,96,204
 s_bfe_u32 s79, s47, 0x20008
 RK 68,212,512
 SC 145
 PZ 64,96,200
 s_bitcmp1_b32 s47, 8
 EX 137
 PZ 32,96,196
 s_cselect_b32 s82, 0x2000, 0
 RK 72,212,1024
 CV 168,136,137
 PZ 0,96,192
 s_mov_b32 s96, s80
 EX 138
 PZ 4,100,192
 s_add_u32 s97, s80, 0x100
 EX 139
 PZ 36,100,196
 s_add_u32 m0, s94, 58240
 RK 76,212,1536
 CV 169,138,139
 PZ 68,100,200
 s_mov_b32 s98, s81
 buffer_load_dwordx4 v214, s[20:23], 0 offen offset:128 lds
 SC 146
 PZ 100,100,204
 s_add_u32 s99, s81, 0x100
 EX 140
 PZ 104,104,204
 s_mov_b32 s100, s78
 RK 80,212,4096
 SC 147
 PZ 72,104,200
 s_bfe_u32 s101, s43, 0x2000a
 EX 141
 PZ 40,104,196
 s_and_b32 s71, s42, 0x3f
 CV 172,140,141
 v_add_u32 v213, s32, v213
 PZ 8,104,192
 s_add_u32 s71, s71, s30
 EX 142
 PZ 12,108,192
 s_add_u32 m0, s94, 8192
 EX 143
 PZ 44,108,196
 s_sub_u32 s71, s71, s101
 buffer_load_dwordx4 v215, s[16:19], 0 offen offset:0 lds
 CV 173,142,143
 PZ 76,108,200
 s_add_u32 s71, s71, 4
 RK 84,212,4608
 RK 88,212,5120
 PZ 108,108,204
 s_cmp_eq_u32 s46, 0
 EX 144
 PZ 112,112,204
 s_cselect_b32 s71, 0, s71
 EX 145
 PZ 80,112,200
 s_add_u32 s31, s33, s37
 RK 92,212,5632
 CV 162,144,145
 PZ 48,112,196
 s_add_u32 s33, s33, s32
 EX 146
 PZ 16,112,192
 s_add_u32 m0, s94, 9088
 EX 147
 PZ 20,116,192
 buffer_load_dwordx4 v215, s[16:19], 0 offen offset:128 lds
 CV 163,146,147
 PZ 52,116,196
 EX 148
 PZ 84,116,200
 EX 149
 PZ 116,116,204
 EX 150
 PZ 120,120,204
 EX 151
 PZ 88,120,200
 CV 166,148,149
 CV 167,150,151
 PZ 56,120,196
 EX 152
 PZ 24,120,192
 EX 153
 PZ 28,124,192
 EX 154
 PZ 60,124,196
 s_waitcnt lgkmcnt(0)
 EX 155
 PZ 92,124,200
 CV 170,152,153
 CV 171,154,155
 PZ 124,124,204
 s_branch L_A
L_init:
 v_subrev_u32 v212, 0x2000, v212
 s_add_u32 s35, s34, 0x10000
 s_add_u32 s12, s86, s35
 s_addc_u32 s13, s87, 0
 s_sub_u32 s14, s62, s35
 s_max_i32 s14, s14, 0
 s_add_u32 m0, s31, 0
 s_nop 0
 buffer_load_dwordx4 v215, s[12:15], 0 offen offset:0 lds
 s_add_u32 m0, s31, 896
 s_nop 0
 buffer_load_dwordx4 v215, s[12:15], 0 offen offset:128 lds
 s_add_u32 s20, s60, s34
 s_addc_u32 s21, s61, 0
 s_sub_u32 s22, s62, s34
 s_max_i32 s22, s22, 0
 s_add_u32 m0, s31, 49152
 s_nop 0
 buffer_load_dwordx4 v216, s[20:23], 0 offen offset:0 lds
 s_add_u32 m0, s31, 50048
 s_nop 0
 buffer_load_dwordx4 v216, s[20:23], 0 offen offset:128 lds
 s_add_u32 s34, s34, 0x20000
 s_add_u32 m0, s31, 57344
 s_nop 0
 buffer_load_dwordx4 v214, s[20:23], 0 offen offset:0 lds
 s_add_u32 m0, s31, 58240
 s_nop 0
 buffer_load_dwordx4 v214, s[20:23], 0 offen offset:128 lds
 s_add_u32 s16, s86, s34
 s_addc_u32 s17, s87, 0
 s_sub_u32 s18, s62, s34
 s_max_i32 s18, s18, 0
 s_add_u32 m0, s31, 8192
 s_nop 0
 buffer_load_dwordx4 v215, s[16:19], 0 offen offset:0 lds
 s_add_u32 m0, s31, 9088
 s_nop 0
 buffer_load_dwordx4 v215, s[16:19], 0 offen offset:128 lds
 v_mov_b64 v[176:177], v[192:193]
 v_mov_b64 v[178:179], v[194:195]
 v_mov_b64 v[180:181], v[196:197]
 v_mov_b64 v[182:183], v[198:199]
 v_mov_b64 v[184:185], v[200:201]
 v_mov_b64 v[186:187], v[202:203]
 v_mov_b64 v[188:189], v[204:205]
 v_mov_b64 v[190:191], v[206:207]
 v_mov_b64 v[0:1], 0
 v_mov_b64 v[2:3], 0
 v_mov_b64 v[4:5], 0
 v_mov_b64 v[6:7], 0
 v_mov_b64 v[8:9], 0
 v_mov_b64 v[10:11], 0
 v_mov_b64 v[12:13], 0
 v_mov_b64 v[14:15], 0
 v_mov_b64 v[16:17], 0
 v_mov_b64 v[18:19], 0
 v_mov_b64 v[20:21], 0
 v_mov_b64 v[22:23], 0
 v_mov_b64 v[24:25], 0
 v_mov_b64 v[26:27], 0
 v_mov_b64 v[28:29], 0
 v_mov_b64 v[30:31], 0
 v_mov_b64 v[32:33], 0
 v_mov_b64 v[34:35], 0
 v_mov_b64 v[36:37], 0
 v_mov_b64 v[38:39], 0
 v_mov_b64 v[40:41], 0
 v_mov_b64 v[42:43], 0
 v_mov_b64 v[44:45], 0
 v_mov_b64 v[46:47], 0
 v_mov_b64 v[48:49], 0
 v_mov_b64 v[50:51], 0
 v_mov_b64 v[52:53], 0
 v_mov_b64 v[54:55], 0
 v_mov_b64 v[56:57], 0
 v_mov_b64 v[58:59], 0
 v_mov_b64 v[60:61], 0
 v_mov_b64 v[62:63], 0
 v_mov_b64 v[64:65], 0
 v_mov_b64 v[66:67], 0
 v_mov_b64 v[68:69], 0
 v_mov_b64 v[70:71], 0
 v_mov_b64 v[72:73], 0
 v_mov_b64 v[74:75], 0
 v_mov_b64 v[76:77], 0
 v_mov_b64 v[78:79], 0
 v_mov_b64 v[80:81], 0
 v_mov_b64 v[82:83], 0
 v_mov_b64 v[84:85], 0
 v_mov_b64 v[86:87], 0
 v_mov_b64 v[88:89], 0
 v_mov_b64 v[90:91], 0
 v_mov_b64 v[92:93], 0
 v_mov_b64 v[94:95], 0
 v_mov_b64 v[96:97], 0
 v_mov_b64 v[98:99], 0
 v_mov_b64 v[100:101], 0
 v_mov_b64 v[102:103], 0
 v_mov_b64 v[104:105], 0
 v_mov_b64 v[106:107], 0
 v_mov_b64 v[108:109], 0
 v_mov_b64 v[110:111], 0
 v_mov_b64 v[112:113], 0
 v_mov_b64 v[114:115], 0
 v_mov_b64 v[116:117], 0
 v_mov_b64 v[118:119], 0
 v_mov_b64 v[120:121], 0
 v_mov_b64 v[122:123], 0
 v_mov_b64 v[124:125], 0
 v_mov_b64 v[126:127], 0
 v_accvgpr_write_b32 a128, 0
 v_accvgpr_write_b32 a129, 0
 v_accvgpr_write_b32 a130, 0
 v_accvgpr_write_b32 a131, 0
 v_accvgpr_write_b32 a132, 0
 v_accvgpr_write_b32 a133, 0
 v_accvgpr_write_b32 a134, 0
 v_accvgpr_write_b32 a135, 0
 s_branch L_tail
.fill 121, 4, 0xbf800000
L_Fe:
 QZ 128,64,0
 s_mov_b32 s95, L_T0-L_pc
 RV 96,213,0
 SC 156
 SC 157
 QK 128,68,4
 s_cmp_eq_u32 s46, 0
 RV 98,213,4096
 SC 158
 SC 159
 QK 128,72,8
 s_cselect_b32 s95, L_U0-L_pc, s95
 EX 156
 QK 128,76,12
 s_bitcmp1_b32 s43, 7
 RV 100,213,8
 RV 102,213,4104
 QZ 132,76,28
 s_cselect_b32 s93, 0x8000, 0
 EX 157
 QK 132,72,24
 s_add_u32 s95, s95, s93
 RV 104,213,512
 v_add_u32 v235, s95, v244
 QK 132,68,20
 s_add_u32 s35, s34, 0x10000
 global_load_dword v255, v235, s[64:65]
 QK 132,64,16
 s_add_u32 s12, s86, s35
 RV 106,213,4608
 CV 206,156,157
 QZ 136,64,32
 s_addc_u32 s13, s87, 0
 RV 108,213,520
 SC 128
 QK 136,68,36
 s_sub_u32 s14, s62, s35
 RV 110,213,4616
 SC 129
 QK 136,72,40
 s_max_i32 s14, s14, 0
 RV 112,213,1024
 SC 130
 QK 136,76,44
 s_add_u32 s20, s60, s34
 RV 114,213,5120
 SC 131
 QZ 140,76,60
 s_addc_u32 s21, s61, 0
 EX 158
 QK 140,72,56
 s_sub_u32 s22, s62, s34
 RV 116,213,1032
 SC 132
 QK 140,68,52
 s_max_i32 s22, s22, 0
 RV 118,213,5128
 SC 133
 QK 140,64,48
 s_add_u32 s34, s34, 0x20000
 RV 120,213,1536
 SC 134
 QZ 144,80,0
 s_add_u32 s16, s86, s34
 EX 159
 QK 144,84,4
 s_addc_u32 s17, s87, 0
 RV 122,213,5632
 CV 207,158,159
 QK 144,88,8
 s_add_u32 m0, s31, 0
 RV 124,213,1544
 SC 135
 QK 144,92,12
 s_sub_u32 s18, s62, s34
 buffer_load_dwordx4 v215, s[12:15], 0 offen offset:0 lds
 SC 136
 QZ 148,92,28
 s_max_i32 s18, s18, 0
 RV 126,213,5640
 SC 137
 QK 148,88,24
 s_lshl_b32 s91, s29, 16
 EX 128
 QK 148,84,20
 s_add_u32 m0, s31, 896
 EX 129
 QK 148,80,16
 s_add_u32 s80, s44, s91
 buffer_load_dwordx4 v215, s[12:15], 0 offen offset:128 lds
 CV 176,128,129
 QZ 152,80,32
 s_sub_u32 s81, s44, s91
 EX 130
 QK 152,84,36
 s_add_u32 s81, s81, 0x70000
 EX 131
 QK 152,88,40
 s_add_u32 m0, s31, 49152
 CV 177,130,131
 SC 138
 QK 152,92,44
 s_and_b32 s10, s47, 0xfffff000
 buffer_load_dwordx4 v216, s[20:23], 0 offen offset:0 lds
 SC 139
 QZ 156,92,60
 s_bfe_u32 s79, s47, 0x20008
 EX 132
 QK 156,88,56
 s_bitcmp1_b32 s47, 8
 EX 133
 QK 156,84,52
 s_cselect_b32 s82, 0x2000, 0
 CV 180,132,133
 SC 140
 EX 134
 SC 141
 PS 148
 PS 150
 PS 152
 PS 154
 QK 156,80,48
 s_add_u32 m0, s31, 50048
 SC 142
 SC 143
 v_mfma_f32_16x16x32_bf16 a[128:131], a[144:147], v[192:195], 0
 s_waitcnt lgkmcnt(0)
 buffer_load_dwordx4 v216, s[20:23], 0 offen offset:128 lds
 SC 144
 LS 128,136,196
 s_mov_b32 s96, s80
 EX 135
 v_mfma_f32_16x16x32_bf16 a[132:135], a[144:147], v[200:203], 0
 s_add_u32 m0, s31, 57344
 RK 64,212,8192
 CV 181,134,135
 LS 132,136,204
 s_add_u32 s97, s80, 0x100
 buffer_load_dwordx4 v214, s[20:23], 0 offen offset:0 lds
 SC 145
 PZ 96,96,204
 s_mov_b32 s98, s81
 EX 136
 PZ 64,96,200
 s_add_u32 s99, s81, 0x100
 RK 68,212,8704
 SC 146
 PZ 32,96,196
 s_add_u32 m0, s31, 58240
 EX 137
 PZ 0,96,192
 s_mov_b32 s100, s78
 buffer_load_dwordx4 v214, s[20:23], 0 offen offset:128 lds
 CV 184,136,137
 PZ 4,100,192
 s_bfe_u32 s101, s43, 0x2000a
 RK 72,212,9216
 SC 147
 PZ 36,100,196
 s_and_b32 s71, s42, 0x3f
 EX 138
 PZ 68,100,200
 s_add_u32 m0, s31, 8192
 EX 139
 PZ 100,100,204
 s_add_u32 s71, s71, s30
 buffer_load_dwordx4 v215, s[16:19], 0 offen offset:0 lds
 CV 185,138,139
 PZ 104,104,204
 s_sub_u32 s71, s71, s101
 EX 140
 PZ 72,104,200
 s_add_u32 s71, s71, 4
 EX 141
 PZ 40,104,196
 s_add_u32 m0, s31, 9088
 RK 76,212,9728
 CV 188,140,141
 PZ 8,104,192
 s_cmp_eq_u32 s46, 0
 buffer_load_dwordx4 v215, s[16:19], 0 offen offset:128 lds
 RK 80,212,12288
 PZ 12,108,192
 s_cselect_b32 s71, 0, s71
 EX 142
 PZ 44,108,196
 EX 143
 PZ 76,108,200
 RK 84,212,12800
 CV 189,142,143
 PZ 108,108,204
 EX 144
 PZ 112,112,204
 EX 145
 PZ 80,112,200
 RK 88,212,13312
 CV 178,144,145
 PZ 48,112,196
 EX 146
 PZ 16,112,192
 EX 147
 PZ 20,116,192
 RK 92,212,13824
 CV 179,146,147
 PZ 52,116,196
 EX 148
 PZ 84,116,200
 EX 149
 PZ 116,116,204
 EX 150
 PZ 120,120,204
 EX 151
 PZ 88,120,200
 CV 182,148,149
 CV 183,150,151
 PZ 56,120,196
 EX 152
 PZ 24,120,192
 EX 153
 PZ 28,124,192
 EX 154
 PZ 60,124,196
 s_waitcnt lgkmcnt(0)
 EX 155
 PZ 92,124,200
 s_cmp_lg_u32 s30, 0
 CV 186,152,153
 CV 187,154,155
 PZ 124,124,204
 s_cbranch_scc1 L_B
 s_cmp_eq_u32 s83, 3
 s_cbranch_scc0 L_tail
L_fetch:
 s_and_b32 s83, s43, 64
 s_sub_u32 s30, 4, s101
 s_cmp_lg_u32 s101, 0
 s_cbranch_scc1 L_pre
L_Bq:
 QZ 128,64,0
 s_cmp_eq_u32 s33, 0x8000
 RV 96,213,8192
 v_add_u32 v251, s96, v217
 QK 128,68,4
 s_cselect_b32 s32, -2, 1
 RV 98,213,12288
 v_add_u32 v252, s96, v218
 QK 128,72,8
 s_lshl_b32 s32, s32, 14
 RV 100,213,8200
 SC 156
 QK 128,76,12
 s_mov_b32 s96, s97
 RV 102,213,12296
 SC 157
 QZ 132,76,28
 s_mov_b32 s97, s98
 RV 104,213,8704
 SC 158
 QK 132,72,24
 s_mov_b32 s98, s99
 EX 156
 QK 132,68,20
 s_add_u32 s31, s33, s37
 RV 106,213,12800
 SC 159
 QK 132,64,16
 s_add_u32 s33, s33, s32
 RV 108,213,8712
 v_add_u32 v212, s32, v212
 QZ 136,64,32
 RV 110,213,12808
 SC 128
 QK 136,68,36
 EX 157
 QK 136,72,40
 RV 112,213,9216
 CV 190,156,157
 QK 136,76,44
 RV 114,213,13312
 SC 129
 QZ 140,76,60
 s_add_u32 m0, s100, 0
 EX 158
 QK 140,72,56
 RV 116,213,9224
 SC 130
 QK 140,68,52
 RV 118,213,13320
 SC 131
 QK 140,64,48
 RV 120,213,9728
 SC 132
 QZ 144,80,0
 buffer_load_dwordx4 v251, s[8:11], 0 offen offset:0 sc1 nt lds
 SC 133
 QK 144,84,4
 s_add_u32 m0, s100, 896
 RV 122,213,13824
 SC 134
 QK 144,88,8
 RV 124,213,9736
 SC 135
 QK 144,92,12
 buffer_load_dwordx4 v251, s[8:11], 0 offen offset:128 sc1 nt lds
 SC 136
 QZ 148,92,28
 s_add_u32 m0, s100, 2048
 RV 126,213,13832
 SC 137
 QK 148,88,24
 EX 159
 QK 148,84,20
 buffer_load_dwordx4 v252, s[8:11], 0 offen offset:0 sc1 nt lds
 CV 191,158,159
 QK 148,80,16
 s_add_u32 m0, s100, 2944
 EX 128
 QZ 152,80,32
 s_add_u32 s100, s100, 0x1000
 EX 129
 QK 152,84,36
 buffer_load_dwordx4 v252, s[8:11], 0 offen offset:128 sc1 nt lds
 CV 160,128,129
 QK 152,88,40
 EX 130
 QK 152,92,44
 EX 131
 QZ 156,92,60
 s_waitcnt vmcnt(12) lgkmcnt(0)
 EX 132
 QK 156,88,56
 s_barrier
 EX 133
 PS 144
 PS 146
 PS 148
 PS 150
 PS 152
 PS 154
 QK 156,84,52
 CV 161,130,131
 CV 164,132,133
 QK 156,80,48
 EX 134
 PV 96,96,188
 EX 135
 PV 64,96,184
 CV 165,134,135
 SC 138
 PV 32,96,180
 RK 64,212,0
 SC 139
 PV 0,96,176
 EX 136
 PV 4,100,176
 EX 137
 PV 36,100,180
 RK 68,212,512
 CV 168,136,137
 PV 68,100,184
 EX 138
 PV 100,100,188
 EX 139
 PV 104,104,188
 RK 72,212,1024
 CV 169,138,139
 PV 72,104,184
 SC 140
 SC 141
 PV 40,104,180
 EX 140
 PV 8,104,176
 RK 76,212,1536
 SC 142
 SM 128,176
 RK 80,212,4096
 SC 143
 PV 12,108,176
 EX 141
 PV 44,108,180
 CV 172,140,141
 v_add_u32 v213, s32, v213
 PV 76,108,184
 EX 142
 PV 108,108,188
 EX 143
 SM 132,184
 RK 84,212,4608
 CV 173,142,143
 PV 112,112,188
 EX 144
 PV 80,112,184
 EX 145
 PV 48,112,180
 RK 88,212,5120
 CV 162,144,145
 PV 16,112,176
 EX 146
 PV 20,116,176
 EX 147
 PV 52,116,180
 RK 92,212,5632
 CV 163,146,147
 PV 84,116,184
 EX 148
 PV 116,116,188
 EX 149
 PV 120,120,188
 EX 150
 PV 88,120,184
 EX 151
 PV 56,120,180
 CV 166,148,149
 CV 167,150,151
 PV 24,120,176
 EX 152
 PV 28,124,176
 EX 153
 PV 60,124,180
 s_waitcnt lgkmcnt(0)
 EX 154
 PV 92,124,184
 EX 155
 PV 124,124,188
 CV 170,152,153
 CV 171,154,155
L_Aq:
 QZ 128,64,0
 s_add_u32 s35, s34, 0x10000
 RV 96,213,0
 SC 156
 QK 128,68,4
 s_add_u32 s12, s86, s35
 RV 98,213,4096
 SC 157
 QK 128,72,8
 s_addc_u32 s13, s87, 0
 RV 100,213,8
 SC 158
 QK 128,76,12
 s_sub_u32 s14, s62, s35
 RV 102,213,4104
 SC 159
 QZ 132,76,28
 s_max_i32 s14, s14, 0
 EX 156
 QK 132,72,24
 s_add_u32 s20, s60, s34
 RV 104,213,512
 SC 128
 QK 132,68,20
 s_addc_u32 s21, s61, 0
 RV 106,213,4608
 SC 129
 QK 132,64,16
 s_sub_u32 s22, s62, s34
 RV 108,213,520
 SC 130
 QZ 136,64,32
 s_max_i32 s22, s22, 0
 RV 110,213,4616
 SC 131
 QK 136,68,36
 s_add_u32 s34, s34, 0x20000
 EX 157
 QK 136,72,40
 s_cmp_eq_u32 s71, 1
 RV 112,213,1024
 CV 174,156,157
 QK 136,76,44
 s_cselect_b32 s36, s72, s34
 RV 114,213,5120
 SC 132
 QZ 140,76,60
 s_cselect_b32 s35, s46, s62
 EX 158
 QK 140,72,56
 s_add_u32 s16, s86, s36
 RV 116,213,1032
 SC 133
 QK 140,68,52
 s_addc_u32 s17, s87, 0
 RV 118,213,5128
 SC 134
 QK 140,64,48
 s_sub_u32 s18, s35, s36
 RV 120,213,1536
 SC 135
 QZ 144,80,0
 s_max_i32 s18, s18, 0
 EX 159
 QK 144,84,4
 RV 122,213,5632
 CV 175,158,159
 QK 144,88,8
 s_add_u32 m0, s31, 0
 RV 124,213,1544
 SC 136
 QK 144,92,12
 buffer_load_dwordx4 v215, s[12:15], 0 offen offset:0 lds
 SC 137
 QZ 148,92,28
 RV 126,213,5640
 SC 138
 QK 148,88,24
 EX 128
 QK 148,84,20
 s_add_u32 m0, s31, 896
 EX 129
 QK 148,80,16
 buffer_load_dwordx4 v215, s[12:15], 0 offen offset:128 lds
 CV 176,128,129
 QZ 152,80,32
 EX 130
 QK 152,84,36
 EX 131
 QK 152,88,40
 s_add_u32 m0, s31, 49152
 CV 177,130,131
 SC 139
 QK 152,92,44
 buffer_load_dwordx4 v216, s[20:23], 0 offen offset:0 lds
 SC 140
 QZ 156,92,60
 EX 132
 QK 156,88,56
 EX 133
 QK 156,84,52
 s_add_u32 m0, s31, 50048
 EX 134
 EX 135
 CV 180,132,133
 PS 146
 PS 148
 PS 150
 PS 152
 PS 154
 QK 156,80,48
 s_waitcnt lgkmcnt(0)
 buffer_load_dwordx4 v216, s[20:23], 0 offen offset:128 lds
 CV 181,134,135
 PV 96,96,172
 EX 136
 PV 64,96,168
 EX 137
 PV 32,96,164
 s_add_u32 m0, s31, 57344
 RK 64,212,8192
 CV 184,136,137
 PV 0,96,160
 buffer_load_dwordx4 v214, s[20:23], 0 offen offset:0 lds
 SC 141
 PV 4,100,160
 EX 138
 PV 36,100,164
 RK 68,212,8704
 SC 142
 PV 68,100,168
 s_add_u32 m0, s31, 58240
 EX 139
 PV 100,100,172
 s_bitcmp1_b32 s29, 1
 buffer_load_dwordx4 v214, s[20:23], 0 offen offset:128 lds
 CV 185,138,139
 SM 128,160
 s_cselect_b32 s88, s60, s86
 RK 72,212,9216
 SC 143
 PV 104,104,172
 s_cselect_b32 s89, s61, s87
 EX 140
 PV 72,104,168
 s_add_u32 m0, s31, 8192
 EX 141
 PV 40,104,164
 s_mov_b32 s90, s63
 buffer_load_dwordx4 v215, s[16:19], 0 offen offset:0 lds
 CV 188,140,141
 PV 8,104,160
 s_mov_b32 s91, 0x20000
 RK 76,212,9728
 SC 144
 PV 12,108,160
 EX 142
 PV 44,108,164
 s_add_u32 m0, s31, 9088
 RK 80,212,12288
 SC 145
 PV 76,108,168
 buffer_load_dwordx4 v215, s[16:19], 0 offen offset:128 lds
 EX 143
 PV 108,108,172
 EX 144
 SM 132,168
 RK 84,212,12800
 CV 189,142,143
 PV 112,112,172
 EX 145
 PV 80,112,168
 EX 146
 PV 48,112,164
 RK 88,212,13312
 CV 178,144,145
 PV 16,112,160
 EX 147
 PV 20,116,160
 EX 148
 PV 52,116,164
 RK 92,212,13824
 CV 179,146,147
 PV 84,116,168
 EX 149
 PV 116,116,172
 s_sub_u32 s71, s71, 1
 EX 150
 PV 120,120,172
 EX 151
 PV 88,120,168
 s_sub_u32 s30, s30, 1
 CV 182,148,149
 CV 183,150,151
 PV 56,120,164
 EX 152
 PV 24,120,160
 EX 153
 PV 28,124,160
 EX 154
 PV 60,124,164
 s_waitcnt lgkmcnt(0)
 EX 155
 PV 92,124,168
 s_cmp_lg_u32 s30, 0
 CV 186,152,153
 CV 187,154,155
 PV 124,124,172
 s_cbranch_scc1 L_Bq
 s_cmp_eq_u32 s46, 0
 s_cbranch_scc1 L_own
 buffer_load_dword v255, v245, s[88:91], 0 offen
 s_mov_b32 s63, 0
L_rest:
 s_and_b32 s30, s42, 0x3f
 s_cbranch_scc1 L_B
 s_branch L_tail
L_own:
 s_bitcmp1_b32 s43, 7
 s_cbranch_scc1 L_Wsh
 s_cmp_lt_u32 s29, 2
 s_cbranch_scc1 L_Wlo
 s_cmp_eq_u32 s29, 2
 s_cbranch_scc1 L_W2
 s_branch L_W3
L_Wlo:
 s_cmp_eq_u32 s29, 0
 s_cbranch_scc1 L_W0
 s_branch L_W1
L_Wsh:
 s_cmp_lt_u32 s29, 2
 s_cbranch_scc1 L_wlo
 s_cmp_eq_u32 s29, 2
 s_cbranch_scc1 L_w2
 s_branch L_w3
L_wlo:
 s_cmp_eq_u32 s29, 0
 s_cbranch_scc1 L_w0
 s_branch L_w1
.p2align 12
L_B:
 QZ 128,64,0
 s_cmp_eq_u32 s33, 0x8000
 RV 96,213,8192
 SC 156
 QK 128,68,4
 s_cselect_b32 s32, -2, 1
 RV 98,213,12288
 SC 157
 QK 128,72,8
 s_lshl_b32 s32, s32, 14
 RV 100,213,8200
 SC 158
 QK 128,76,12
 s_add_u32 s31, s33, s37
 RV 102,213,12296
 SC 159
 QZ 132,76,28
 s_add_u32 s33, s33, s32
 RV 104,213,8704
 v_add_u32 v212, s32, v212
 QK 132,72,24
 EX 156
 QK 132,68,20
 RV 106,213,12800
 SC 128
 QK 132,64,16
 RV 108,213,8712
 SC 129
 QZ 136,64,32
 RV 110,213,12808
 SC 130
 QK 136,68,36
 EX 157
 QK 136,72,40
 RV 112,213,9216
 CV 190,156,157
 QK 136,76,44
 RV 114,213,13312
 SC 131
 QZ 140,76,60
 EX 158
 QK 140,72,56
 RV 116,213,9224
 SC 132
 QK 140,68,52
 RV 118,213,13320
 SC 133
 QK 140,64,48
 RV 120,213,9728
 SC 134
 QZ 144,80,0
 EX 159
 QK 144,84,4
 RV 122,213,13824
 CV 191,158,159
 QK 144,88,8
 RV 124,213,9736
 SC 135
 QK 144,92,12
 EX 128
 QZ 148,92,28
 RV 126,213,13832
 SC 136
 QK 148,88,24
 EX 129
 QK 148,84,20
 CV 160,128,129
 SC 137
 QK 148,80,16
 EX 130
 QZ 152,80,32
 EX 131
 QK 152,84,36
 CV 161,130,131
 SC 138
 QK 152,88,40
 EX 132
 QK 152,92,44
 EX 133
 QZ 156,92,60
 EX 134
 QK 156,88,56
 s_waitcnt vmcnt(8) lgkmcnt(0)
 CV 164,132,133
 SC 139
 QK 156,84,52
 s_barrier
 EX 135
 PS 150
 PS 152
 PS 154
 QK 156,80,48
 CV 165,134,135
 SC 140
 SM 128,176
 RK 64,212,0
 SC 141
 PV 96,96,188
 EX 136
 PV 64,96,184
 EX 137
 PV 32,96,180
 RK 68,212,512
 CV 168,136,137
 PV 0,96,176
 EX 138
 PV 4,100,176
 EX 139
 PV 36,100,180
 RK 72,212,1024
 CV 169,138,139
 PV 68,100,184
 EX 140
 PV 100,100,188
 EX 141
 SM 132,184
 RK 76,212,1536
 CV 172,140,141
 PV 104,104,188
 EX 150
 PV 72,104,184
 EX 151
 PV 40,104,180
 RK 80,212,4096
 SC 142
 PV 8,104,176
 EX 142
 PV 12,108,176
 SC 143
 SC 144
 PV 44,108,180
 RK 84,212,4608
 SC 145
 PV 76,108,184
 SC 146
 SC 147
 PV 108,108,188
 EX 143
 PV 112,112,188
 RK 88,212,5120
 CV 173,142,143
 PV 80,112,184
 SC 148
 SC 149
 PV 48,112,180
 EX 144
 PV 16,112,176
 RK 92,212,5632
 CV 167,150,151
 PV 20,116,176
 EX 145
 PV 52,116,180
 EX 146
 PV 84,116,184
 CV 162,144,145
 v_add_u32 v213, s32, v213
 PV 116,116,188
 EX 147
 PV 120,120,188
 EX 148
 PV 88,120,184
 EX 149
 PV 56,120,180
 CV 163,146,147
 CV 166,148,149
 PV 24,120,176
 EX 152
 PV 28,124,176
 EX 153
 PV 60,124,180
 s_waitcnt lgkmcnt(0)
 EX 154
 PV 92,124,184
 EX 155
 PV 124,124,188
 CV 170,152,153
 CV 171,154,155
L_A:
 QZ 128,64,0
 s_add_u32 s35, s34, 0x10000
 RV 96,213,0
 SC 156
 QK 128,68,4
 s_add_u32 s12, s86, s35
 RV 98,213,4096
 SC 157
 QK 128,72,8
 s_addc_u32 s13, s87, 0
 RV 100,213,8
 SC 158
 QK 128,76,12
 s_sub_u32 s14, s62, s35
 RV 102,213,4104
 SC 159
 QZ 132,76,28
 s_max_i32 s14, s14, 0
 EX 156
 QK 132,72,24
 s_add_u32 s20, s60, s34
 RV 104,213,512
 SC 128
 QK 132,68,20
 s_addc_u32 s21, s61, 0
 RV 106,213,4608
 SC 129
 QK 132,64,16
 s_sub_u32 s22, s62, s34
 RV 108,213,520
 SC 130
 QZ 136,64,32
 s_max_i32 s22, s22, 0
 RV 110,213,4616
 SC 131
 QK 136,68,36
 s_add_u32 s34, s34, 0x20000
 EX 157
 QK 136,72,40
 s_cmp_eq_u32 s71, 1
 RV 112,213,1024
 CV 174,156,157
 QK 136,76,44
 s_cselect_b32 s36, s72, s34
 RV 114,213,5120
 SC 132
 QZ 140,76,60
 s_cselect_b32 s35, s46, s62
 EX 158
 QK 140,72,56
 s_add_u32 s16, s86, s36
 RV 116,213,1032
 SC 133
 QK 140,68,52
 s_addc_u32 s17, s87, 0
 RV 118,213,5128
 SC 134
 QK 140,64,48
 s_sub_u32 s18, s35, s36
 RV 120,213,1536
 SC 135
 QZ 144,80,0
 s_max_i32 s18, s18, 0
 EX 159
 QK 144,84,4
 RV 122,213,5632
 CV 175,158,159
 QK 144,88,8
 s_add_u32 m0, s31, 0
 RV 124,213,1544
 SC 136
 QK 144,92,12
 buffer_load_dwordx4 v215, s[12:15], 0 offen offset:0 lds
 SC 137
 QZ 148,92,28
 RV 126,213,5640
 SC 138
 QK 148,88,24
 EX 128
 QK 148,84,20
 s_add_u32 m0, s31, 896
 EX 129
 QK 148,80,16
 buffer_load_dwordx4 v215, s[12:15], 0 offen offset:128 lds
 CV 176,128,129
 QZ 152,80,32
 EX 130
 QK 152,84,36
 EX 131
 QK 152,88,40
 s_add_u32 m0, s31, 49152
 CV 177,130,131
 SC 139
 QK 152,92,44
 buffer_load_dwordx4 v216, s[20:23], 0 offen offset:0 lds
 SC 140
 QZ 156,92,60
 EX 132
 QK 156,88,56
 EX 133
 QK 156,84,52
 s_add_u32 m0, s31, 50048
 EX 134
 EX 135
 CV 180,132,133
 PS 146
 PS 148
 PS 150
 PS 152
 PS 154
 QK 156,80,48
 s_waitcnt lgkmcnt(0)
 buffer_load_dwordx4 v216, s[20:23], 0 offen offset:128 lds
 CV 181,134,135
 PV 96,96,172
 EX 136
 PV 64,96,168
 EX 137
 PV 32,96,164
 s_add_u32 m0, s31, 57344
 RK 64,212,8192
 CV 184,136,137
 PV 0,96,160
 buffer_load_dwordx4 v214, s[20:23], 0 offen offset:0 lds
 SC 141
 PV 4,100,160
 EX 138
 PV 36,100,164
 RK 68,212,8704
 SC 142
 PV 68,100,168
 s_add_u32 m0, s31, 58240
 EX 139
 PV 100,100,172
 buffer_load_dwordx4 v214, s[20:23], 0 offen offset:128 lds
 CV 185,138,139
 SM 128,160
 RK 72,212,9216
 SC 143
 PV 104,104,172
 EX 140
 PV 72,104,168
 s_add_u32 m0, s31, 8192
 EX 141
 PV 40,104,164
 buffer_load_dwordx4 v215, s[16:19], 0 offen offset:0 lds
 CV 188,140,141
 PV 8,104,160
 RK 76,212,9728
 SC 144
 PV 12,108,160
 EX 142
 PV 44,108,164
 s_add_u32 m0, s31, 9088
 RK 80,212,12288
 SC 145
 PV 76,108,168
 buffer_load_dwordx4 v215, s[16:19], 0 offen offset:128 lds
 EX 143
 PV 108,108,172
 EX 144
 SM 132,168
 RK 84,212,12800
 CV 189,142,143
 PV 112,112,172
 EX 145
 PV 80,112,168
 EX 146
 PV 48,112,164
 RK 88,212,13312
 CV 178,144,145
 PV 16,112,160
 EX 147
 PV 20,116,160
 EX 148
 PV 52,116,164
 RK 92,212,13824
 CV 179,146,147
 PV 84,116,168
 EX 149
 PV 116,116,172
 s_sub_u32 s71, s71, 1
 EX 150
 PV 120,120,172
 EX 151
 PV 88,120,168
 s_sub_u32 s30, s30, 1
 CV 182,148,149
 CV 183,150,151
 PV 56,120,164
 EX 152
 PV 24,120,160
 EX 153
 PV 28,124,160
 EX 154
 PV 60,124,164
 s_waitcnt lgkmcnt(0)
 EX 155
 PV 92,124,168
 s_cmp_lg_u32 s30, 0
 CV 186,152,153
 CV 187,154,155
 PV 124,124,172
 s_cbranch_scc1 L_B
L_tail:
 s_cmp_lg_u32 s83, 0
 s_cbranch_scc1 L_glue
L_go:
 s_cmp_eq_u32 s46, 0
 s_cbranch_scc1 L_fin
 s_bitcmp1_b32 s43, 7
 s_cbranch_scc1 L_Tsh
 s_cmp_lt_u32 s29, 2
 s_cbranch_scc1 L_Tlo
 s_cmp_eq_u32 s29, 2
 s_cbranch_scc1 L_T2
 s_branch L_T3
L_Tlo:
 s_cmp_eq_u32 s29, 0
 s_cbranch_scc1 L_T0
 s_branch L_T1
L_Tsh:
 s_cmp_lt_u32 s29, 2
 s_cbranch_scc1 L_tlo
 s_cmp_eq_u32 s29, 2
 s_cbranch_scc1 L_t2
 s_branch L_t3
L_tlo:
 s_cmp_eq_u32 s29, 0
 s_cbranch_scc1 L_t0
 s_branch L_t1
L_fin:
 s_bitcmp1_b32 s43, 7
 s_cbranch_scc1 L_Ush
 s_cmp_lt_u32 s29, 2
 s_cbranch_scc1 L_Ulo
 s_cmp_eq_u32 s29, 2
 s_cbranch_scc1 L_U2
 s_branch L_U3
L_Ulo:
 s_cmp_eq_u32 s29, 0
 s_cbranch_scc1 L_U0
 s_branch L_U1
L_Ush:
 s_cmp_lt_u32 s29, 2
 s_cbranch_scc1 L_ulo
 s_cmp_eq_u32 s29, 2
 s_cbranch_scc1 L_u2
 s_branch L_u3
L_ulo:
 s_cmp_eq_u32 s29, 0
 s_cbranch_scc1 L_u0
 s_branch L_u1
L_glue:
 s_cmp_eq_u32 s83, 3
 s_cbranch_scc1 L_fetch
 s_cmp_eq_u32 s83, 64
 s_cbranch_scc1 L_H0
 s_bfe_u32 s88, s42, 0x30008
 s_lshl_b32 s88, s88, 2
 s_add_u32 s88, s88, s3
 v_mov_b32 v225, s88
 s_cmp_eq_u32 s83, 1
 s_cbranch_scc1 L_g1
 s_cmp_eq_u32 s83, 4
 s_cbranch_scc1 L_g3
 global_load_ubyte v235, v225, s[0:1] sc1
 s_mov_b32 s83, 4
 s_mov_b32 s30, 1
 s_branch L_B
L_g3:
 s_waitcnt vmcnt(8)
L_g4:
 v_readfirstlane_b32 s88, v235
 s_nop 1
 s_cmp_lg_u32 s88, 0
 s_cbranch_scc1 L_g5
 s_sleep 8
 global_load_ubyte v235, v225, s[0:1] sc1
 s_waitcnt vmcnt(0)
 s_branch L_g4
L_g5:
 s_mov_b32 s88, L_W0-L_pc
 s_bitcmp1_b32 s43, 7
 s_cselect_b32 s88, L_w0-L_pc, s88
 v_add_u32 v235, s88, v244
 global_load_dword v255, v235, s[64:65]
 buffer_load_dword v236, v234, s[4:7], s38 offen sc1
 buffer_load_dword v237, v234, s[4:7], s38 offen offset:64 sc1
 buffer_load_dword v238, v234, s[4:7], s39 offen sc1
 buffer_load_dword v239, v234, s[4:7], s39 offen offset:64 sc1
 s_mov_b64 s[8:9], s[4:5]
 s_mov_b32 s10, s6
 v_mov_b32 v217, v232
 v_mov_b32 v218, v233
 s_mov_b32 s30, 4
 s_mov_b32 s96, s38
 s_add_u32 s97, s38, 0x100
 s_mov_b32 s98, s39
 s_add_u32 s99, s39, 0x100
 s_mov_b32 s100, s78
 s_branch L_Bq
L_g1:
 v_mov_b32 v235, 1
 s_mov_b64 exec, 1
 global_store_byte v225, v235, s[0:1] sc1
 s_mov_b64 exec, -1
 s_mov_b32 s83, 0
 s_cmp_eq_u32 s46, 0
 s_cbranch_scc1 L_rest
 s_branch L_fetch
L_pre:
 v_add_u32 v251, s96, v217
 v_add_u32 v252, s96, v218
 s_add_u32 m0, s100, 0
 s_nop 0
 buffer_load_dwordx4 v251, s[8:11], 0 offen offset:0 sc1 nt lds
 s_add_u32 m0, s100, 896
 s_nop 0
 buffer_load_dwordx4 v251, s[8:11], 0 offen offset:128 sc1 nt lds
 s_add_u32 m0, s100, 2048
 s_nop 0
 buffer_load_dwordx4 v252, s[8:11], 0 offen offset:0 sc1 nt lds
 s_add_u32 m0, s100, 2944
 s_nop 0
 buffer_load_dwordx4 v252, s[8:11], 0 offen offset:128 sc1 nt lds
 s_add_u32 s100, s100, 0x1000
 s_mov_b32 s96, s97
 s_mov_b32 s97, s98
 s_mov_b32 s98, s99
 s_sub_u32 s101, s101, 1
 s_cmp_lg_u32 s101, 0
 s_cbranch_scc1 L_pre
 s_branch L_Bq
L_hop:
 s_branch L_done
.p2align 12
L_Z0:
 QZ 136,64,32
 s_cmp_eq_u32 s33, 0x8000
 RV 180,213,0
 SC 156
 QK 136,68,36
 s_cselect_b32 s32, -2, 1
 RV 182,213,4096
 SC 157
 QK 136,72,40
 s_lshl_b32 s32, s32, 14
 RV 184,213,8
 SC 158
 QK 136,76,44
 s_add_u32 s31, s33, s37
 RV 186,213,4104
 SC 159
 QZ 140,76,60
 s_add_u32 s33, s33, s32
 RV 188,213,512
 v_and_b32 v192, v253, v192
 QK 140,72,56
 RV 190,213,4608
 v_and_b32 v193, v254, v193
 QK 140,68,52
 RV 192,213,520
 v_and_b32 v196, v253, v196
 QK 140,64,48
 RV 194,213,4616
 v_and_b32 v197, v254, v197
 QZ 152,80,32
 RV 196,213,1024
 EX 156
 QK 152,84,36
 RV 198,213,5120
 EX 157
 EX 158
 PS 136
 PS 138
 PS 140
 PS 142
 QK 152,88,40
 RV 200,213,1032
 CV 206,156,157
 QK 152,92,44
 RV 202,213,5128
 EX 159
 RV 204,213,1536
 RV 206,213,5632
 CV 207,158,159
 QZ 156,92,60
 RV 208,213,1544
 EX 136
 QK 156,88,56
 RV 210,213,5640
 EX 137
 QK 156,84,52
 RK 148,212,8192
 CV 184,136,137
 QK 156,80,48
 RK 152,212,8704
 EX 138
 v_mfma_f32_16x16x16_bf16 a[128:131], a[144:145], v[192:193], 0
 s_waitcnt lgkmcnt(15)
 RK 156,212,9216
 EX 139
 v_mfma_f32_16x16x16_bf16 v[0:3], a[180:181], v[192:193], 0
 RK 160,212,9728
 EX 140
 CV 185,138,139
 EX 141
 PS 152
 PS 154
 PS 156
 PS 158
 v_accvgpr_read_b32 v225, a128
 v_accvgpr_read_b32 v224, a129
 v_add_f32 v225, v224, v225
 v_rcp_f32 v224, v225
 v_subrev_u32 v225, 0x21800000, v225
 PM 0,224,0
 PM 2,224,0
 s_waitcnt lgkmcnt(15)
 v_mfma_f32_16x16x16_bf16 v[4:7], a[184:185], v[192:193], 0
 s_waitcnt lgkmcnt(15)
 RK 164,212,12288
 CV 188,140,141
 CV 0,0,1
 v_mfma_f32_16x16x16_bf16 v[8:11], a[188:189], v[192:193], 0
 s_waitcnt lgkmcnt(14)
 RK 168,212,12800
 EX 142
 v_mfma_f32_16x16x16_bf16 v[12:15], a[192:193], v[192:193], 0
 RK 172,212,13312
 EX 143
 EX 152
 CV 189,142,143
 PM 4,224,0
 PM 6,224,0
 PM 8,224,0
 PM 10,224,0
 PM 12,224,0
 PM 14,224,0
 s_waitcnt lgkmcnt(14)
 v_mfma_f32_16x16x16_bf16 v[16:19], a[196:197], v[192:193], 0
 s_waitcnt lgkmcnt(12)
 RK 176,212,13824
 EX 153
 v_mfma_f32_16x16x16_bf16 v[20:23], a[200:201], v[192:193], 0
 s_waitcnt lgkmcnt(11)
 RV 96,213,8192
 CV 186,152,153
 CV 1,2,3
 v_mfma_f32_16x16x16_bf16 v[24:27], a[204:205], v[192:193], 0
 s_waitcnt lgkmcnt(10)
 RV 98,213,12288
 EX 154
 v_mfma_f32_16x16x16_bf16 v[28:31], a[208:209], v[192:193], 0
 RV 100,213,8200
 EX 155
 v_mfma_f32_16x16x16_bf16 a[128:131], a[136:137], v[196:197], a[128:131]
 RV 102,213,12296
 CV 187,154,155
 CV 2,4,5
 v_mfma_f32_16x16x16_bf16 v[32:35], a[180:181], v[196:197], 0
 RV 104,213,8704
 CV 3,6,7
 CV 8,8,9
 v_mfma_f32_16x16x16_bf16 v[36:39], a[184:185], v[196:197], 0
 RV 106,213,12800
 CV 9,10,11
 CV 10,12,13
 v_accvgpr_read_b32 v227, a130
 v_accvgpr_read_b32 v226, a131
 v_add_f32 v227, v226, v227
 v_rcp_f32 v226, v227
 v_subrev_u32 v227, 0x21800000, v227
 v_mfma_f32_16x16x16_bf16 v[40:43], a[188:189], v[196:197], 0
 RV 108,213,8712
 CV 11,14,15
 XE 4,8,0
 v_mfma_f32_16x16x16_bf16 v[44:47], a[192:193], v[196:197], 0
 RV 110,213,12808
 XE 5,9,1
 XE 6,10,2
 v_mfma_f32_16x16x16_bf16 v[48:51], a[196:197], v[196:197], 0
 RV 112,213,9216
 XE 7,11,3
 v_add_u32 v212, s32, v212
 v_mfma_f32_16x16x16_bf16 v[52:55], a[200:201], v[196:197], 0
 RV 114,213,13312
 EX 156
 v_mfma_f32_16x16x16_bf16 v[56:59], a[204:205], v[196:197], 0
 RV 116,213,9224
 EX 157
 v_mfma_f32_16x16x16_bf16 v[60:63], a[208:209], v[196:197], 0
 RV 118,213,13320
 EX 158
 v_mfma_f32_16x16x32_bf16 a[132:135], a[144:147], v[200:203], 0
 s_not_b64 vcc, vcc
 RV 120,213,9728
 CV 190,156,157
 LS 132,136,204
 RV 122,213,13824
 XO 8,0,8
 PZ 96,180,204
 RV 124,213,9736
 XO 9,1,9
 PZ 64,180,200
 RV 126,213,13832
 XO 10,2,10
 PZ 68,184,200
 buffer_store_dwordx4 v[4:7], v220, s[24:27], s38 offen offset:0 nt
 EX 159
 PM 16,224,0
 PM 18,224,0
 PM 20,224,0
 PM 22,224,0
 PM 24,224,0
 PM 26,224,0
 PM 28,224,0
 PM 30,224,0
 PZ 100,184,204
 CV 191,158,159
 XO 11,3,11
 PZ 104,188,204
 CV 16,16,17
 CV 17,18,19
 PZ 72,188,200
 CV 18,20,21
 CV 19,22,23
 PZ 76,192,200
 buffer_store_dwordx4 v[8:11], v221, s[24:27], s38 offen offset:0 nt
 PZ 108,192,204
 s_waitcnt vmcnt(10) lgkmcnt(0)
 CV 24,24,25
 CV 25,26,27
 PZ 112,196,204
 s_barrier
 PZ 80,196,200
 RK 212,212,0
 CV 26,28,29
 PZ 84,200,200
 RK 216,212,512
 CV 27,30,31
 PZ 116,200,204
 RK 220,212,1024
 XO 28,16,24
 PZ 120,204,204
 RK 224,212,1536
 XO 29,17,25
 PZ 88,204,200
 RK 240,212,5632
 XO 30,18,26
 PZ 92,208,200
 RK 236,212,5120
 XO 31,19,27
 PZ 124,208,204
 s_not_b64 vcc, vcc
 buffer_store_dwordx4 v[28:31], v221, s[24:27], s38 offen offset:128 nt
 XE 16,24,16
 PM 32,226,0
 PM 34,226,0
 PM 36,226,0
 PM 38,226,0
 PM 40,226,0
 PM 42,226,0
 PM 44,226,0
 PM 46,226,0
 QZ 136,148,32
 RK 232,212,4608
 XE 17,25,17
 QK 136,152,36
 RK 228,212,4096
 XE 18,26,18
 QK 136,156,40
 XE 19,27,19
 CV 32,32,33
 QK 136,160,44
 CV 33,34,35
 CV 34,36,37
 QZ 140,160,60
 buffer_store_dwordx4 v[16:19], v220, s[24:27], s38 offen offset:128 nt
 QK 140,156,56
 CV 35,38,39
 CV 40,40,41
 QK 140,152,52
 CV 41,42,43
 CV 42,44,45
 QK 140,148,48
 CV 43,46,47
 XE 36,40,32
 QZ 152,164,32
 XE 37,41,33
 XE 38,42,34
 QK 152,168,36
 XE 39,43,35
 v_add_u32 v213, s32, v213
 PS 136
 PS 138
 PS 140
 PS 142
 QK 152,172,40
 s_not_b64 vcc, vcc
 buffer_store_dwordx4 v[36:39], v220, s[24:27], s38 offen offset:256 nt
 EX 136
 PM 48,226,0
 PM 50,226,0
 PM 52,226,0
 PM 54,226,0
 PM 56,226,0
 PM 58,226,0
 PM 60,226,0
 PM 62,226,0
 QK 152,176,44
 RV 180,213,0
 XO 40,32,40
 QZ 156,176,60
 RV 182,213,4096
 XO 41,33,41
 QK 156,172,56
 RV 184,213,8
 XO 42,34,42
 QK 156,168,52
 RV 186,213,4104
 XO 43,35,43
 QK 156,164,48
 buffer_store_dwordx4 v[40:43], v221, s[24:27], s38 offen offset:256 nt
 SM 132,184
 RV 188,213,512
 CV 48,48,49
 PV 96,96,188
 RV 190,213,4608
 CV 49,50,51
 PV 64,96,184
 RV 192,213,520
 CV 50,52,53
 EX 137
 EX 138
 PS 152
 PS 154
 PS 156
 PS 158
 PV 68,100,184
 RV 194,213,4616
 CV 168,136,137
 PV 100,100,188
 RV 196,213,1024
 CV 51,54,55
 PV 104,104,188
 RV 198,213,5120
 CV 56,56,57
 PV 72,104,184
 RV 200,213,1032
 CV 57,58,59
 PV 76,108,184
 RV 202,213,5128
 CV 58,60,61
 PV 108,108,188
 RV 204,213,1536
 CV 59,62,63
 PV 112,112,188
 RV 206,213,5632
 XO 60,48,56
 PV 80,112,184
 RV 208,213,1544
 XO 61,49,57
 PV 84,116,184
 RV 210,213,5640
 XO 62,50,58
 PV 116,116,188
 RV 96,213,8192
 XO 63,51,59
 PV 120,120,188
 s_not_b64 vcc, vcc
 buffer_store_dwordx4 v[60:63], v221, s[24:27], s38 offen offset:384 nt
 PV 88,120,184
 RV 98,213,12288
 XE 48,56,48
 PV 92,124,184
 RV 100,213,8200
 XE 49,57,49
 PV 124,124,188
 s_waitcnt lgkmcnt(15)
 RV 102,213,12296
 XE 50,58,50
 EX 139
 EX 152
 CV 169,138,139
 QZ 136,212,32
 s_waitcnt lgkmcnt(15)
 RV 104,213,8704
 XE 51,59,51
 QK 136,216,36
 s_waitcnt lgkmcnt(15)
 RV 106,213,12800
 EX 153
 QK 136,220,40
 s_waitcnt lgkmcnt(15)
 buffer_store_dwordx4 v[48:51], v220, s[24:27], s38 offen offset:384 nt
 QK 136,224,44
 RV 108,213,8712
 CV 170,152,153
 EX 154
 EX 155
 EX 140
 CV 171,154,155
 s_waitcnt lgkmcnt(15)
 v_mfma_f32_16x16x32_bf16 v[152:155], a[240:243], a[44:47], v[208:211]
 s_waitcnt lgkmcnt(15)
 RV 110,213,12808
 EX 141
 EX 142
 PS 136
 PS 138
 QK 152,236,40
 s_waitcnt lgkmcnt(15)
 RV 112,213,9216
 CV 172,140,141
 QK 152,232,36
 s_waitcnt lgkmcnt(15)
 RV 114,213,13312
 EX 143
 QK 152,228,32
 RV 116,213,9224
 CV 173,142,143
 QZ 140,212,48
 RV 118,213,13320
 EX 156
 QK 140,216,52
 RV 120,213,9728
 EX 157
 EX 158
 PS 152
 PS 154
 QK 140,220,56
 RV 122,213,13824
 CV 174,156,157
 QK 140,224,60
 RV 124,213,9736
 EX 159
 EX 136
 CV 175,158,159
 v_mfma_f32_16x16x32_bf16 v[156:159], a[240:243], a[60:63], v[208:211]
 EX 137
 QK 156,236,56
 RV 126,213,13832
 CV 184,136,137
 EX 138
 EX 139
 PS 140
 PS 142
 QK 156,232,52
 EX 152
 QK 156,228,48
 EX 153
 LS 132,144,168
 s_waitcnt lgkmcnt(15)
 CV 185,138,139
 CV 186,152,153
 PV 64,180,168
 s_waitcnt lgkmcnt(15)
 EX 154
 PV 68,184,168
 s_waitcnt lgkmcnt(15)
 EX 155
 EX 140
 CV 187,154,155
 PS 156
 PS 158
 PV 72,188,168
 s_waitcnt lgkmcnt(15)
 EX 141
 PV 76,192,168
 s_waitcnt lgkmcnt(15)
 EX 142
 PV 80,196,168
 s_waitcnt lgkmcnt(15)
 EX 143
 PV 84,200,168
 s_waitcnt lgkmcnt(15)
 CV 188,140,141
 CV 189,142,143
 PV 88,204,168
 s_waitcnt lgkmcnt(15)
 EX 156
 PV 92,208,168
 EX 157
 LS 132,144,184
 s_waitcnt lgkmcnt(14)
 EX 158
 PV 64,96,184
 s_waitcnt lgkmcnt(12)
 EX 159
 PV 68,100,184
 s_waitcnt lgkmcnt(10)
 CV 190,156,157
 CV 191,158,159
 PV 72,104,184
 s_waitcnt lgkmcnt(8)
 PV 76,108,184
 v_accvgpr_read_b32 v229, a132
 v_accvgpr_read_b32 v228, a133
 v_add_f32 v229, v228, v229
 v_rcp_f32 v228, v229
 v_subrev_u32 v229, 0x21800000, v229
 PM 64,228,0
 PM 66,228,0
 PM 68,228,0
 PM 70,228,0
 PM 72,228,0
 PM 74,228,0
 PM 76,228,0
 PM 78,228,0
 v_max3_u32 v225, v225, v227, v229
 s_waitcnt lgkmcnt(6)
 PV 80,112,184
 s_waitcnt lgkmcnt(4)
 CV 64,64,65
 CV 65,66,67
 PV 84,116,184
 s_waitcnt lgkmcnt(2)
 CV 66,68,69
 CV 67,70,71
 PV 88,120,184
 s_waitcnt lgkmcnt(0)
 CV 72,72,73
 CV 73,74,75
 PV 92,124,184
 CV 74,76,77
 CV 75,78,79
 LS 132,136,172
 XE 68,72,64
 XE 69,73,65
 PV 96,180,172
 XE 70,74,66
 XE 71,75,67
 PV 100,184,172
 s_not_b64 vcc, vcc
 buffer_store_dwordx4 v[68:71], v220, s[24:27], s39 offen offset:0 nt
 XO 72,64,72
 PM 80,228,0
 PM 82,228,0
 PM 84,228,0
 PM 86,228,0
 PM 88,228,0
 PM 90,228,0
 PM 92,228,0
 PM 94,228,0
 PV 104,188,172
 XO 73,65,73
 XO 74,66,74
 PV 108,192,172
 XO 75,67,75
 CV 80,80,81
 PV 112,196,172
 CV 81,82,83
 CV 82,84,85
 PV 116,200,172
 CV 83,86,87
 CV 88,88,89
 PV 120,204,172
 buffer_store_dwordx4 v[72:75], v221, s[24:27], s39 offen offset:0 nt
 PV 124,208,172
 CV 89,90,91
 CV 90,92,93
 LS 132,136,188
 CV 91,94,95
 XO 92,80,88
 PV 96,96,188
 XO 93,81,89
 XO 94,82,90
 PV 100,100,188
 XO 95,83,91
 PV 104,104,188
 s_not_b64 vcc, vcc
 XE 80,88,80
 XE 81,89,81
 v_accvgpr_read_b32 v231, a134
 v_accvgpr_read_b32 v230, a135
 v_add_f32 v231, v230, v231
 v_rcp_f32 v230, v231
 v_subrev_u32 v231, 0x21800000, v231
 v_max_u32 v225, v225, v231
 v_cmp_le_u32 s[84:85], s77, v225
 PV 108,108,188
 buffer_store_dwordx4 v[92:95], v221, s[24:27], s39 offen offset:128 nt
 XE 82,90,82
 PM 96,230,0
 PM 98,230,0
 PM 100,230,0
 PM 102,230,0
 PM 104,230,0
 PM 106,230,0
 PM 108,230,0
 PM 110,230,0
 PV 112,112,188
 s_cmp_lg_u64 s[84:85], 0
 XE 83,91,83
 CV 96,96,97
 PV 116,116,188
 s_cselect_b32 s92, s76, 0
 CV 97,98,99
 CV 98,100,101
 PV 120,120,188
 s_or_b32 s73, s73, s92
 CV 99,102,103
 CV 104,104,105
 PV 124,124,188
 s_lshl_b32 s76, s76, 1
 CV 105,106,107
 CV 106,108,109
 buffer_store_dwordx4 v[80:83], v220, s[24:27], s39 offen offset:128 nt
 CV 107,110,111
 XE 100,104,96
 XE 101,105,97
 XE 102,106,98
 XE 103,107,99
 s_not_b64 vcc, vcc
 XO 104,96,104
 XO 105,97,105
 XO 106,98,106
 XO 107,99,107
 buffer_store_dwordx4 v[100:103], v220, s[24:27], s39 offen offset:256 nt
 PM 112,230,0
 PM 114,230,0
 PM 116,230,0
 PM 118,230,0
 CV 112,112,113
 CV 113,114,115
 CV 114,116,117
 CV 115,118,119
 PM 120,230,0
 PM 122,230,0
 PM 124,230,0
 PM 126,230,0
 CV 120,120,121
 CV 121,122,123
 CV 122,124,125
 CV 123,126,127
 XO 124,112,120
 XO 125,113,121
 XO 126,114,122
 XO 127,115,123
 s_not_b64 vcc, vcc
 XE 112,120,112
 XE 113,121,113
 XE 114,122,114
 XE 115,123,115
 buffer_store_dwordx4 v[104:107], v221, s[24:27], s39 offen offset:256 nt
 buffer_store_dwordx4 v[124:127], v221, s[24:27], s39 offen offset:384 nt
 buffer_store_dwordx4 v[112:115], v220, s[24:27], s39 offen offset:384 nt
 s_cmp_lg_u32 s73, 0
 s_cbranch_scc1 L_hop
 s_endpgm
.p2align 6
L_z0:
 RV 180,213,0
 RV 184,213,8
 v_and_b32 v192, v253, v192
 v_and_b32 v193, v254, v193
 RV 188,213,512
 v_and_b32 v196, v253, v196
 v_mfma_f32_16x16x16_bf16 a[128:131], a[144:145], v[192:193], 0
 s_waitcnt lgkmcnt(2)
 RV 192,213,520
 v_and_b32 v197, v254, v197
 v_mfma_f32_16x16x16_bf16 v[0:3], a[180:181], v[192:193], 0
 s_waitcnt lgkmcnt(2)
 RV 196,213,1024
 RV 200,213,1032
 v_mfma_f32_16x16x16_bf16 v[4:7], a[184:185], v[192:193], 0
 s_waitcnt lgkmcnt(3)
 RV 204,213,1536
 v_mfma_f32_16x16x16_bf16 v[8:11], a[188:189], v[192:193], 0
 RV 208,213,1544
 v_accvgpr_read_b32 v225, a128
 v_accvgpr_read_b32 v224, a129
 v_add_f32 v225, v224, v225
 v_rcp_f32 v224, v225
 v_subrev_u32 v225, 0x21800000, v225
 PM 0,224,0
 PM 2,224,0
 PM 4,224,0
 PM 6,224,0
 PM 8,224,0
 PM 10,224,0
 s_waitcnt lgkmcnt(4)
 v_mfma_f32_16x16x16_bf16 v[12:15], a[192:193], v[192:193], 0
 CV 0,0,1
 CV 1,2,3
 CV 2,4,5
 CV 3,6,7
 CV 8,8,9
 CV 9,10,11
 s_waitcnt lgkmcnt(3)
 v_mfma_f32_16x16x16_bf16 v[16:19], a[196:197], v[192:193], 0
 s_waitcnt lgkmcnt(2)
 XE 4,8,0
 XE 5,9,1
 PM 12,224,0
 PM 14,224,0
 v_mfma_f32_16x16x16_bf16 v[20:23], a[200:201], v[192:193], 0
 s_waitcnt lgkmcnt(1)
 CV 10,12,13
 CV 11,14,15
 v_mfma_f32_16x16x16_bf16 v[24:27], a[204:205], v[192:193], 0
 s_waitcnt lgkmcnt(0)
 XE 6,10,2
 XE 7,11,3
 v_mfma_f32_16x16x16_bf16 v[28:31], a[208:209], v[192:193], 0
 s_not_b64 vcc, vcc
 buffer_store_dwordx4 v[4:7], v220, s[24:27], s38 offen offset:0 nt
 XO 8,0,8
 PM 16,224,0
 PM 18,224,0
 PM 20,224,0
 PM 22,224,0
 PM 24,224,0
 PM 26,224,0
 PM 28,224,0
 PM 30,224,0
 v_mfma_f32_16x16x16_bf16 a[128:131], a[136:137], v[196:197], a[128:131]
 XO 9,1,9
 XO 10,2,10
 XO 11,3,11
 v_mfma_f32_16x16x16_bf16 v[32:35], a[180:181], v[196:197], 0
 CV 16,16,17
 CV 17,18,19
 CV 18,20,21
 v_mfma_f32_16x16x16_bf16 v[36:39], a[184:185], v[196:197], 0
 CV 19,22,23
 CV 24,24,25
 CV 25,26,27
 v_accvgpr_read_b32 v227, a130
 v_accvgpr_read_b32 v226, a131
 v_add_f32 v227, v226, v227
 v_rcp_f32 v226, v227
 v_subrev_u32 v227, 0x21800000, v227
 v_max3_u32 v225, v225, v227, v225
 v_max_u32 v225, v225, v227
 v_cmp_le_u32 s[84:85], s77, v225
 v_mfma_f32_16x16x16_bf16 v[40:43], a[188:189], v[196:197], 0
 buffer_store_dwordx4 v[8:11], v221, s[24:27], s38 offen offset:0 nt
 v_mfma_f32_16x16x16_bf16 v[44:47], a[192:193], v[196:197], 0
 CV 26,28,29
 CV 27,30,31
 XO 28,16,24
 v_mfma_f32_16x16x16_bf16 v[48:51], a[196:197], v[196:197], 0
 XO 29,17,25
 XO 30,18,26
 XO 31,19,27
 v_mfma_f32_16x16x16_bf16 v[52:55], a[200:201], v[196:197], 0
 s_not_b64 vcc, vcc
 XE 16,24,16
 XE 17,25,17
 v_mfma_f32_16x16x16_bf16 v[56:59], a[204:205], v[196:197], 0
 s_cmp_lg_u64 s[84:85], 0
 XE 18,26,18
 XE 19,27,19
 v_mfma_f32_16x16x16_bf16 v[60:63], a[208:209], v[196:197], 0
 s_cselect_b32 s92, s76, 0
 s_or_b32 s73, s73, s92
 s_lshl_b32 s76, s76, 1
 buffer_store_dwordx4 v[28:31], v221, s[24:27], s38 offen offset:128 nt
 PM 32,226,0
 PM 34,226,0
 PM 36,226,0
 PM 38,226,0
 CV 32,32,33
 CV 33,34,35
 CV 34,36,37
 CV 35,38,39
 PM 40,226,0
 PM 42,226,0
 PM 44,226,0
 PM 46,226,0
 CV 40,40,41
 CV 41,42,43
 CV 42,44,45
 CV 43,46,47
 XE 36,40,32
 XE 37,41,33
 XE 38,42,34
 XE 39,43,35
 s_not_b64 vcc, vcc
 XO 40,32,40
 XO 41,33,41
 XO 42,34,42
 XO 43,35,43
 buffer_store_dwordx4 v[16:19], v220, s[24:27], s38 offen offset:128 nt
 buffer_store_dwordx4 v[36:39], v220, s[24:27], s38 offen offset:256 nt
 PM 48,226,0
 PM 50,226,0
 PM 52,226,0
 PM 54,226,0
 CV 48,48,49
 CV 49,50,51
 CV 50,52,53
 CV 51,54,55
 PM 56,226,0
 PM 58,226,0
 PM 60,226,0
 PM 62,226,0
 CV 56,56,57
 CV 57,58,59
 CV 58,60,61
 CV 59,62,63
 XO 60,48,56
 XO 61,49,57
 XO 62,50,58
 XO 63,51,59
 s_not_b64 vcc, vcc
 XE 48,56,48
 XE 49,57,49
 XE 50,58,50
 XE 51,59,51
 buffer_store_dwordx4 v[40:43], v221, s[24:27], s38 offen offset:256 nt
 buffer_store_dwordx4 v[60:63], v221, s[24:27], s38 offen offset:384 nt
 buffer_store_dwordx4 v[48:51], v220, s[24:27], s38 offen offset:384 nt
 s_cmp_lg_u32 s73, 0
 s_cbranch_scc1 L_hop
 s_endpgm
.p2align 6
L_z2:
 v_mfma_f32_16x16x32_bf16 v[128:131], a[64:67], a[0:3], v[208:211]
 RV 180,213,0
 RV 182,213,4096
 QK 128,68,4
 RV 184,213,8
 QK 128,72,8
 RV 186,213,4104
 QK 128,76,12
 RV 188,213,512
 v_mfma_f32_16x16x32_bf16 v[132:135], a[76:79], a[28:31], v[208:211]
 RV 190,213,4608
 QK 132,72,24
 RV 192,213,520
 QK 132,68,20
 RV 194,213,4616
 QK 132,64,16
 RV 196,213,1024
 SC 128
 v_mfma_f32_16x16x32_bf16 a[128:131], a[144:147], v[192:195], 0
 RV 198,213,5120
 SC 129
 LS 128,136,196
 s_waitcnt lgkmcnt(8)
 RV 200,213,1032
 SC 130
 PZ 32,180,196
 RV 202,213,5128
 SC 131
 PZ 0,180,192
 s_waitcnt lgkmcnt(8)
 RV 204,213,1536
 SC 132
 PZ 4,184,192
 RV 206,213,5632
 SC 133
 PZ 36,184,196
 s_waitcnt lgkmcnt(8)
 RV 208,213,1544
 SC 134
 PZ 40,188,196
 RV 210,213,5640
 SC 135
 PZ 8,188,192
 s_waitcnt lgkmcnt(8)
 RV 96,213,8192
 EX 128
 PZ 12,192,192
 RV 100,213,8200
 EX 129
 PZ 44,192,196
 s_waitcnt lgkmcnt(8)
 RV 104,213,8704
 CV 176,128,129
 PZ 48,196,196
 RV 108,213,8712
 EX 130
 PZ 16,196,192
 s_waitcnt lgkmcnt(8)
 RV 112,213,9216
 RV 116,213,9224
 PZ 20,200,192
 EX 131
 PZ 52,200,196
 s_waitcnt lgkmcnt(8)
 RV 120,213,9728
 CV 177,130,131
 PZ 56,204,196
 EX 132
 PZ 24,204,192
 s_waitcnt lgkmcnt(7)
 EX 133
 PZ 28,208,192
 RV 124,213,9736
 CV 180,132,133
 PZ 60,208,196
 EX 134
 v_mfma_f32_16x16x16_bf16 a[128:131], a[144:145], v[176:177], a[128:131]
 s_waitcnt lgkmcnt(7)
 EX 135
 PH 0,96,176
 s_waitcnt lgkmcnt(6)
 CV 181,134,135
 PH 4,100,176
 s_waitcnt lgkmcnt(5)
 PH 8,104,176
 s_waitcnt lgkmcnt(4)
 PH 12,108,176
 s_waitcnt lgkmcnt(3)
 PH 16,112,176
 s_waitcnt lgkmcnt(2)
 PH 20,116,176
 v_accvgpr_read_b32 v225, a128
 v_accvgpr_read_b32 v224, a129
 v_add_f32 v225, v224, v225
 v_rcp_f32 v224, v225
 v_subrev_u32 v225, 0x21800000, v225
 PM 0,224,0
 PM 2,224,0
 PM 4,224,0
 PM 6,224,0
 PM 8,224,0
 PM 10,224,0
 PM 12,224,0
 PM 14,224,0
 s_waitcnt lgkmcnt(1)
 PH 24,120,176
 s_waitcnt lgkmcnt(0)
 CV 0,0,1
 CV 1,2,3
 CV 2,4,5
 PH 28,124,176
 CV 3,6,7
 CV 8,8,9
 CV 9,10,11
 v_mfma_f32_16x16x16_bf16 a[128:131], a[136:137], v[180:181], a[128:131]
 CV 10,12,13
 CV 11,14,15
 XE 4,8,0
 PH 32,96,180
 XE 5,9,1
 XE 6,10,2
 XE 7,11,3
 PH 36,100,180
 s_not_b64 vcc, vcc
 buffer_store_dwordx4 v[4:7], v220, s[24:27], s38 offen offset:0 nt
 v_accvgpr_read_b32 v227, a130
 PM 16,224,0
 PM 18,224,0
 PM 20,224,0
 PM 22,224,0
 PM 24,224,0
 PM 26,224,0
 PM 28,224,0
 PM 30,224,0
 v_accvgpr_read_b32 v226, a131
 v_add_f32 v227, v226, v227
 v_rcp_f32 v226, v227
 v_subrev_u32 v227, 0x21800000, v227
 v_max3_u32 v225, v225, v227, v225
 v_max_u32 v225, v225, v227
 v_cmp_le_u32 s[84:85], s77, v225
 PH 40,104,180
 XO 8,0,8
 XO 9,1,9
 XO 10,2,10
 PH 44,108,180
 XO 11,3,11
 CV 16,16,17
 CV 17,18,19
 PH 48,112,180
 CV 18,20,21
 CV 19,22,23
 CV 24,24,25
 PH 52,116,180
 buffer_store_dwordx4 v[8:11], v221, s[24:27], s38 offen offset:0 nt
 PH 56,120,180
 s_cmp_lg_u64 s[84:85], 0
 CV 25,26,27
 CV 26,28,29
 PH 60,124,180
 s_cselect_b32 s92, s76, 0
 CV 27,30,31
 XO 28,16,24
 XO 29,17,25
 XO 30,18,26
 XO 31,19,27
 s_not_b64 vcc, vcc
 XE 16,24,16
 XE 17,25,17
 XE 18,26,18
 XE 19,27,19
 s_or_b32 s73, s73, s92
 s_lshl_b32 s76, s76, 1
 buffer_store_dwordx4 v[28:31], v221, s[24:27], s38 offen offset:128 nt
 PM 32,226,0
 PM 34,226,0
 PM 36,226,0
 PM 38,226,0
 CV 32,32,33
 CV 33,34,35
 CV 34,36,37
 CV 35,38,39
 PM 40,226,0
 PM 42,226,0
 PM 44,226,0
 PM 46,226,0
 CV 40,40,41
 CV 41,42,43
 CV 42,44,45
 CV 43,46,47
 XE 36,40,32
 XE 37,41,33
 XE 38,42,34
 XE 39,43,35
 s_not_b64 vcc, vcc
 XO 40,32,40
 XO 41,33,41
 XO 42,34,42
 XO 43,35,43
 buffer_store_dwordx4 v[16:19], v220, s[24:27], s38 offen offset:128 nt
 buffer_store_dwordx4 v[36:39], v220, s[24:27], s38 offen offset:256 nt
 PM 48,226,0
 PM 50,226,0
 PM 52,226,0
 PM 54,226,0
 CV 48,48,49
 CV 49,50,51
 CV 50,52,53
 CV 51,54,55
 PM 56,226,0
 PM 58,226,0
 PM 60,226,0
 PM 62,226,0
 CV 56,56,57
 CV 57,58,59
 CV 58,60,61
 CV 59,62,63
 XO 60,48,56
 XO 61,49,57
 XO 62,50,58
 XO 63,51,59
 s_not_b64 vcc, vcc
 XE 48,56,48
 XE 49,57,49
 XE 50,58,50
 XE 51,59,51
 buffer_store_dwordx4 v[40:43], v221, s[24:27], s38 offen offset:256 nt
 buffer_store_dwordx4 v[60:63], v221, s[24:27], s38 offen offset:384 nt
 buffer_store_dwordx4 v[48:51], v220, s[24:27], s38 offen offset:384 nt
 s_cmp_lg_u32 s73, 0
 s_cbranch_scc1 L_hop
 s_endpgm
.p2align 12
L_Z1:
 QZ 136,64,32
 s_cmp_eq_u32 s33, 0x8000
 RV 180,213,0
 SC 156
 QK 136,68,36
 s_cselect_b32 s32, -2, 1
 RV 182,213,4096
 SC 157
 QK 136,72,40
 s_lshl_b32 s32, s32, 14
 RV 184,213,8
 SC 158
 QK 136,76,44
 s_add_u32 s31, s33, s37
 RV 186,213,4104
 SC 159
 QZ 140,76,60
 s_add_u32 s33, s33, s32
 RV 188,213,512
 v_and_b32 v194, v253, v194
 QK 140,72,56
 RV 190,213,4608
 v_and_b32 v195, v254, v195
 QK 140,68,52
 RV 192,213,520
 v_and_b32 v198, v253, v198
 QK 140,64,48
 RV 194,213,4616
 v_and_b32 v199, v254, v199
 QZ 152,80,32
 RV 196,213,1024
 EX 156
 QK 152,84,36
 RV 198,213,5120
 EX 157
 QK 152,88,40
 RV 200,213,1032
 CV 206,156,157
 QK 152,92,44
 RV 202,213,5128
 EX 158
 RV 204,213,1536
 RV 206,213,5632
 EX 159
 RV 208,213,1544
 CV 207,158,159
 QZ 156,92,60
 RV 210,213,5640
 QK 156,88,56
 RK 148,212,8192
 QK 156,84,52
 RK 152,212,8704
 QK 156,80,48
 RK 156,212,9216
 v_mfma_f32_16x16x32_bf16 a[128:131], a[144:147], v[192:195], 0
 s_waitcnt lgkmcnt(15)
 RK 160,212,9728
 PZ 0,180,192
 s_waitcnt lgkmcnt(15)
 RK 164,212,12288
 PZ 4,184,192
 s_waitcnt lgkmcnt(15)
 RK 168,212,12800
 PZ 8,188,192
 RK 172,212,13312
 PS 136
 PS 138
 PS 140
 PS 142
 PS 152
 PS 154
 PS 156
 PS 158
 v_accvgpr_read_b32 v225, a128
 v_accvgpr_read_b32 v224, a129
 v_add_f32 v225, v224, v225
 v_rcp_f32 v224, v225
 v_subrev_u32 v225, 0x21800000, v225
 PM 0,224,0
 PM 2,224,0
 PM 4,224,0
 PM 6,224,0
 PM 8,224,0
 PM 10,224,0
 s_waitcnt lgkmcnt(15)
 PZ 12,192,192
 s_waitcnt lgkmcnt(13)
 RK 176,212,13824
 CV 0,0,1
 PZ 16,196,192
 s_waitcnt lgkmcnt(12)
 RV 96,213,8192
 CV 1,2,3
 PZ 20,200,192
 RV 98,213,12288
 CV 2,4,5
 EX 136
 EX 137
 PM 12,224,0
 PM 14,224,0
 s_waitcnt lgkmcnt(12)
 PZ 24,204,192
 s_waitcnt lgkmcnt(10)
 RV 100,213,8200
 CV 184,136,137
 PZ 28,208,192
 RV 102,213,12296
 CV 3,6,7
 LS 128,136,196
 RV 104,213,8704
 CV 8,8,9
 PZ 32,180,196
 RV 106,213,12800
 CV 9,10,11
 PZ 36,184,196
 RV 108,213,8712
 CV 10,12,13
 v_accvgpr_read_b32 v227, a130
 v_accvgpr_read_b32 v226, a131
 v_add_f32 v227, v226, v227
 v_rcp_f32 v226, v227
 v_subrev_u32 v227, 0x21800000, v227
 PZ 40,188,196
 RV 110,213,12808
 CV 11,14,15
 PZ 44,192,196
 RV 112,213,9216
 XE 4,8,0
 PZ 48,196,196
 RV 114,213,13312
 XE 5,9,1
 PZ 52,200,196
 RV 116,213,9224
 XE 6,10,2
 PZ 56,204,196
 RV 118,213,13320
 XE 7,11,3
 PZ 60,208,196
 s_not_b64 vcc, vcc
 RV 120,213,9728
 XO 8,0,8
 v_mfma_f32_16x16x32_bf16 a[132:135], a[144:147], v[200:203], 0
 RV 122,213,13824
 XO 9,1,9
 LS 132,136,204
 RV 124,213,9736
 XO 10,2,10
 PZ 96,180,204
 RV 126,213,13832
 XO 11,3,11
 PZ 64,180,200
 buffer_store_dwordx4 v[4:7], v220, s[24:27], s38 offen offset:0 nt
 EX 138
 PM 16,224,0
 PM 18,224,0
 PM 20,224,0
 PM 22,224,0
 PM 24,224,0
 PM 26,224,0
 PM 28,224,0
 PM 30,224,0
 PZ 68,184,200
 EX 139
 PZ 100,184,204
 CV 185,138,139
 CV 16,16,17
 PZ 104,188,204
 EX 140
 PZ 72,188,200
 buffer_store_dwordx4 v[8:11], v221, s[24:27], s38 offen offset:0 nt
 PZ 76,192,200
 s_waitcnt vmcnt(10) lgkmcnt(0)
 EX 141
 PZ 108,192,204
 s_barrier
 PZ 112,196,204
 CV 188,140,141
 CV 17,18,19
 PZ 80,196,200
 EX 142
 PZ 84,200,200
 EX 143
 PZ 116,200,204
 CV 189,142,143
 CV 18,20,21
 PZ 120,204,204
 EX 152
 PZ 88,204,200
 EX 153
 PZ 92,208,200
 CV 186,152,153
 CV 19,22,23
 PZ 124,208,204
 EX 154
 QZ 136,148,32
 EX 155
 QK 136,152,36
 CV 187,154,155
 CV 24,24,25
 QK 136,156,40
 CV 25,26,27
 CV 26,28,29
 QK 136,160,44
 CV 27,30,31
 XO 28,16,24
 QZ 140,160,60
 XO 29,17,25
 XO 30,18,26
 QK 140,156,56
 XO 31,19,27
 v_add_u32 v212, s32, v212
 QK 140,152,52
 s_not_b64 vcc, vcc
 buffer_store_dwordx4 v[28:31], v221, s[24:27], s38 offen offset:128 nt
 EX 156
 PM 32,226,0
 PM 34,226,0
 PM 36,226,0
 PM 38,226,0
 PM 40,226,0
 PM 42,226,0
 PM 44,226,0
 PM 46,226,0
 QK 140,148,48
 RK 212,212,0
 XE 16,24,16
 QZ 152,164,32
 RK 216,212,512
 XE 17,25,17
 QK 152,168,36
 RK 220,212,1024
 XE 18,26,18
 QK 152,172,40
 RK 224,212,1536
 XE 19,27,19
 QK 152,176,44
 buffer_store_dwordx4 v[16:19], v220, s[24:27], s38 offen offset:128 nt
 EX 157
 EX 158
 CV 190,156,157
 EX 159
 CV 32,32,33
 CV 191,158,159
 QZ 156,176,60
 CV 33,34,35
 CV 34,36,37
 QK 156,172,56
 CV 35,38,39
 CV 40,40,41
 QK 156,168,52
 CV 41,42,43
 CV 42,44,45
 QK 156,164,48
 CV 43,46,47
 XE 36,40,32
 SM 132,184
 XE 37,41,33
 PV 96,96,188
 XE 38,42,34
 XE 39,43,35
 PV 64,96,184
 s_not_b64 vcc, vcc
 buffer_store_dwordx4 v[36:39], v220, s[24:27], s38 offen offset:256 nt
 XO 40,32,40
 PM 48,226,0
 PM 50,226,0
 PM 52,226,0
 PM 54,226,0
 PM 56,226,0
 PM 58,226,0
 PM 60,226,0
 PM 62,226,0
 PS 136
 PS 138
 PS 140
 PS 142
 PS 152
 PS 154
 PS 156
 PS 158
 PV 68,100,184
 XO 41,33,41
 XO 42,34,42
 PV 100,100,188
 XO 43,35,43
 CV 48,48,49
 PV 104,104,188
 buffer_store_dwordx4 v[40:43], v221, s[24:27], s38 offen offset:256 nt
 PV 72,104,184
 CV 49,50,51
 CV 50,52,53
 PV 76,108,184
 CV 51,54,55
 CV 56,56,57
 PV 108,108,188
 CV 57,58,59
 CV 58,60,61
 PV 112,112,188
 CV 59,62,63
 XO 60,48,56
 PV 80,112,184
 XO 61,49,57
 XO 62,50,58
 PV 84,116,184
 XO 63,51,59
 v_add_u32 v213, s32, v213
 PV 116,116,188
 s_not_b64 vcc, vcc
 buffer_store_dwordx4 v[60:63], v221, s[24:27], s38 offen offset:384 nt
 PV 120,120,188
 RV 180,213,0
 XE 48,56,48
 PV 88,120,184
 RV 182,213,4096
 XE 49,57,49
 PV 92,124,184
 RV 184,213,8
 XE 50,58,50
 PV 124,124,188
 RV 186,213,4104
 XE 51,59,51
 EX 136
 EX 137
 EX 138
 CV 168,136,137
 EX 139
 buffer_store_dwordx4 v[48:51], v220, s[24:27], s38 offen offset:384 nt
 RV 188,213,512
 RV 190,213,4608
 CV 169,138,139
 s_waitcnt lgkmcnt(9)
 v_mfma_f32_16x16x32_bf16 v[136:139], a[212:215], a[32:35], v[208:211]
 s_waitcnt lgkmcnt(8)
 RV 192,213,520
 EX 140
 QK 136,216,36
 s_waitcnt lgkmcnt(8)
 RV 194,213,4616
 EX 141
 QK 136,220,40
 s_waitcnt lgkmcnt(8)
 RV 196,213,1024
 CV 172,140,141
 QK 136,224,44
 RV 198,213,5120
 EX 142
 EX 143
 EX 152
 CV 173,142,143
 v_mfma_f32_16x16x32_bf16 v[140:143], a[212:215], a[48:51], v[208:211]
 RV 200,213,1032
 EX 153
 EX 154
 PS 136
 PS 138
 QK 140,216,52
 RV 202,213,5128
 CV 170,152,153
 QK 140,220,56
 RV 204,213,1536
 EX 155
 QK 140,224,60
 RV 206,213,5632
 CV 171,154,155
 RV 208,213,1544
 RV 210,213,5640
 LS 132,144,168
 s_waitcnt lgkmcnt(14)
 RV 96,213,8192
 EX 136
 PV 64,180,168
 s_waitcnt lgkmcnt(13)
 RV 100,213,8200
 EX 137
 EX 138
 PS 140
 PS 142
 PV 68,184,168
 s_waitcnt lgkmcnt(12)
 RV 104,213,8704
 CV 184,136,137
 PV 72,188,168
 s_waitcnt lgkmcnt(11)
 RV 108,213,8712
 EX 139
 PV 76,192,168
 s_waitcnt lgkmcnt(10)
 RV 112,213,9216
 CV 185,138,139
 PV 80,196,168
 s_waitcnt lgkmcnt(9)
 RV 116,213,9224
 EX 156
 PV 84,200,168
 s_waitcnt lgkmcnt(8)
 RV 120,213,9728
 EX 157
 PV 88,204,168
 s_waitcnt lgkmcnt(7)
 RV 124,213,9736
 CV 174,156,157
 PV 92,208,168
 EX 158
 v_mfma_f32_16x16x16_bf16 a[132:135], a[144:145], v[184:185], a[132:135]
 s_waitcnt lgkmcnt(7)
 EX 159
 EX 140
 PH 64,96,184
 s_waitcnt lgkmcnt(6)
 EX 141
 CV 175,158,159
 PH 68,100,184
 EX 142
 CV 188,140,141
 v_accvgpr_read_b32 v229, a132
 v_accvgpr_read_b32 v228, a133
 v_add_f32 v229, v228, v229
 v_rcp_f32 v228, v229
 v_subrev_u32 v229, 0x21800000, v229
 PM 64,228,0
 PM 66,228,0
 PM 68,228,0
 PM 70,228,0
 v_max3_u32 v225, v225, v227, v229
 s_waitcnt lgkmcnt(5)
 PH 72,104,184
 s_waitcnt lgkmcnt(4)
 EX 143
 CV 64,64,65
 PH 76,108,184
 s_waitcnt lgkmcnt(3)
 CV 65,66,67
 CV 66,68,69
 CV 67,70,71
 PH 80,112,184
 s_waitcnt lgkmcnt(2)
 CV 189,142,143
 PM 72,228,0
 PM 74,228,0
 PH 84,116,184
 s_waitcnt lgkmcnt(1)
 CV 72,72,73
 CV 73,74,75
 PM 76,228,0
 PM 78,228,0
 PH 88,120,184
 s_waitcnt lgkmcnt(0)
 CV 74,76,77
 CV 75,78,79
 XE 68,72,64
 PH 92,124,184
 XE 69,73,65
 XE 70,74,66
 XE 71,75,67
 LS 132,136,172
 s_not_b64 vcc, vcc
 buffer_store_dwordx4 v[68:71], v220, s[24:27], s39 offen offset:0 nt
 XO 72,64,72
 PM 80,228,0
 PM 82,228,0
 PM 84,228,0
 PM 86,228,0
 PM 88,228,0
 PM 90,228,0
 PM 92,228,0
 PM 94,228,0
 PV 96,180,172
 XO 73,65,73
 XO 74,66,74
 PV 100,184,172
 XO 75,67,75
 CV 80,80,81
 PV 104,188,172
 CV 81,82,83
 CV 82,84,85
 PV 108,192,172
 CV 83,86,87
 CV 88,88,89
 PV 112,196,172
 buffer_store_dwordx4 v[72:75], v221, s[24:27], s39 offen offset:0 nt
 PV 116,200,172
 CV 89,90,91
 CV 90,92,93
 PV 120,204,172
 CV 91,94,95
 XO 92,80,88
 PV 124,208,172
 XO 93,81,89
 XO 94,82,90
 v_mfma_f32_16x16x16_bf16 a[132:135], a[136:137], v[188:189], a[132:135]
 XO 95,83,91
 PH 96,96,188
 s_not_b64 vcc, vcc
 XE 80,88,80
 XE 81,89,81
 PH 100,100,188
 XE 82,90,82
 XE 83,91,83
 v_accvgpr_read_b32 v231, a134
 v_accvgpr_read_b32 v230, a135
 v_add_f32 v231, v230, v231
 v_rcp_f32 v230, v231
 v_subrev_u32 v231, 0x21800000, v231
 v_max_u32 v225, v225, v231
 v_cmp_le_u32 s[84:85], s77, v225
 PH 104,104,188
 buffer_store_dwordx4 v[92:95], v221, s[24:27], s39 offen offset:128 nt
 PM 96,230,0
 PM 98,230,0
 PM 100,230,0
 PM 102,230,0
 PH 108,108,188
 CV 96,96,97
 CV 97,98,99
 CV 98,100,101
 CV 99,102,103
 PM 104,230,0
 PM 106,230,0
 PH 112,112,188
 CV 104,104,105
 CV 105,106,107
 PM 108,230,0
 PM 110,230,0
 PH 116,116,188
 buffer_store_dwordx4 v[80:83], v220, s[24:27], s39 offen offset:128 nt
 PH 120,120,188
 s_cmp_lg_u64 s[84:85], 0
 CV 106,108,109
 CV 107,110,111
 PH 124,124,188
 s_cselect_b32 s92, s76, 0
 XE 100,104,96
 XE 101,105,97
 XE 102,106,98
 XE 103,107,99
 s_not_b64 vcc, vcc
 XO 104,96,104
 XO 105,97,105
 XO 106,98,106
 XO 107,99,107
 s_or_b32 s73, s73, s92
 s_lshl_b32 s76, s76, 1
 buffer_store_dwordx4 v[100:103], v220, s[24:27], s39 offen offset:256 nt
 PM 112,230,0
 PM 114,230,0
 PM 116,230,0
 PM 118,230,0
 CV 112,112,113
 CV 113,114,115
 CV 114,116,117
 CV 115,118,119
 PM 120,230,0
 PM 122,230,0
 PM 124,230,0
 PM 126,230,0
 CV 120,120,121
 CV 121,122,123
 CV 122,124,125
 CV 123,126,127
 XO 124,112,120
 XO 125,113,121
 XO 126,114,122
 XO 127,115,123
 s_not_b64 vcc, vcc
 XE 112,120,112
 XE 113,121,113
 XE 114,122,114
 XE 115,123,115
 buffer_store_dwordx4 v[104:107], v221, s[24:27], s39 offen offset:256 nt
 buffer_store_dwordx4 v[124:127], v221, s[24:27], s39 offen offset:384 nt
 buffer_store_dwordx4 v[112:115], v220, s[24:27], s39 offen offset:384 nt
 s_cmp_lg_u32 s73, 0
 s_cbranch_scc1 L_hop
 s_endpgm
.p2align 6
L_z1:
 RV 180,213,0
 RV 182,213,4096
 v_and_b32 v194, v253, v194
 v_and_b32 v195, v254, v195
 v_and_b32 v198, v253, v198
 v_and_b32 v199, v254, v199
 v_mfma_f32_16x16x32_bf16 a[128:131], a[144:147], v[192:195], 0
 RV 184,213,8
 RV 186,213,4104
 LS 128,136,196
 s_waitcnt lgkmcnt(2)
 RV 188,213,512
 PZ 32,180,196
 RV 190,213,4608
 RV 192,213,520
 PZ 0,180,192
 s_waitcnt lgkmcnt(3)
 RV 194,213,4616
 PZ 4,184,192
 RV 196,213,1024
 v_accvgpr_read_b32 v225, a128
 v_accvgpr_read_b32 v224, a129
 v_add_f32 v225, v224, v225
 v_rcp_f32 v224, v225
 v_subrev_u32 v225, 0x21800000, v225
 PM 0,224,0
 PM 2,224,0
 PM 4,224,0
 PM 6,224,0
 v_accvgpr_read_b32 v227, a130
 v_accvgpr_read_b32 v226, a131
 v_add_f32 v227, v226, v227
 v_rcp_f32 v226, v227
 v_subrev_u32 v227, 0x21800000, v227
 v_max3_u32 v225, v225, v227, v225
 v_max_u32 v225, v225, v227
 v_cmp_le_u32 s[84:85], s77, v225
 PZ 36,184,196
 s_waitcnt lgkmcnt(3)
 RV 198,213,5120
 CV 0,0,1
 PZ 40,188,196
 s_cmp_lg_u64 s[84:85], 0
 RV 200,213,1032
 CV 1,2,3
 PZ 8,188,192
 s_cselect_b32 s92, s76, 0
 RV 202,213,5128
 CV 2,4,5
 s_waitcnt lgkmcnt(4)
 PZ 12,192,192
 s_or_b32 s73, s73, s92
 RV 204,213,1536
 CV 3,6,7
 PZ 44,192,196
 s_lshl_b32 s76, s76, 1
 RV 206,213,5632
 RV 208,213,1544
 PM 8,224,0
 PM 10,224,0
 PM 12,224,0
 PM 14,224,0
 CV 8,8,9
 CV 9,10,11
 CV 10,12,13
 CV 11,14,15
 XE 4,8,0
 XE 5,9,1
 XE 6,10,2
 s_waitcnt lgkmcnt(5)
 PZ 48,196,196
 RV 210,213,5640
 XE 7,11,3
 PZ 16,196,192
 s_not_b64 vcc, vcc
 buffer_store_dwordx4 v[4:7], v220, s[24:27], s38 offen offset:0 nt
 s_waitcnt lgkmcnt(4)
 PZ 20,200,192
 XO 8,0,8
 XO 9,1,9
 PZ 52,200,196
 s_waitcnt lgkmcnt(2)
 XO 10,2,10
 XO 11,3,11
 PM 16,224,0
 PM 18,224,0
 PZ 56,204,196
 CV 16,16,17
 CV 17,18,19
 PM 20,224,0
 PM 22,224,0
 PZ 24,204,192
 s_waitcnt lgkmcnt(0)
 CV 18,20,21
 CV 19,22,23
 PZ 28,208,192
 PZ 60,208,196
 buffer_store_dwordx4 v[8:11], v221, s[24:27], s38 offen offset:0 nt
 s_nop 1
 PM 24,224,0
 CV 24,24,25
 PM 26,224,0
 CV 25,26,27
 PM 28,224,0
 CV 26,28,29
 PM 30,224,0
 CV 27,30,31
 XO 28,16,24
 XO 29,17,25
 XO 30,18,26
 XO 31,19,27
 s_not_b64 vcc, vcc
 XE 16,24,16
 XE 17,25,17
 XE 18,26,18
 XE 19,27,19
 buffer_store_dwordx4 v[28:31], v221, s[24:27], s38 offen offset:128 nt
 PM 32,226,0
 PM 34,226,0
 PM 36,226,0
 PM 38,226,0
 CV 32,32,33
 CV 33,34,35
 CV 34,36,37
 CV 35,38,39
 PM 40,226,0
 PM 42,226,0
 PM 44,226,0
 PM 46,226,0
 CV 40,40,41
 CV 41,42,43
 CV 42,44,45
 CV 43,46,47
 XE 36,40,32
 XE 37,41,33
 XE 38,42,34
 XE 39,43,35
 s_not_b64 vcc, vcc
 XO 40,32,40
 XO 41,33,41
 XO 42,34,42
 XO 43,35,43
 buffer_store_dwordx4 v[16:19], v220, s[24:27], s38 offen offset:128 nt
 buffer_store_dwordx4 v[36:39], v220, s[24:27], s38 offen offset:256 nt
 PM 48,226,0
 PM 50,226,0
 PM 52,226,0
 PM 54,226,0
 CV 48,48,49
 CV 49,50,51
 CV 50,52,53
 CV 51,54,55
 PM 56,226,0
 PM 58,226,0
 PM 60,226,0
 PM 62,226,0
 CV 56,56,57
 CV 57,58,59
 CV 58,60,61
 CV 59,62,63
 XO 60,48,56
 XO 61,49,57
 XO 62,50,58
 XO 63,51,59
 s_not_b64 vcc, vcc
 XE 48,56,48
 XE 49,57,49
 XE 50,58,50
 XE 51,59,51
 buffer_store_dwordx4 v[40:43], v221, s[24:27], s38 offen offset:256 nt
 buffer_store_dwordx4 v[60:63], v221, s[24:27], s38 offen offset:384 nt
 buffer_store_dwordx4 v[48:51], v220, s[24:27], s38 offen offset:384 nt
 s_cmp_lg_u32 s73, 0
 s_cbranch_scc1 L_hop
 s_endpgm
.p2align 6
L_z3:
 QZ 128,64,0
 RV 180,213,0
 RV 182,213,4096
 QK 128,68,4
 RV 184,213,8
 QK 128,72,8
 RV 186,213,4104
 QK 128,76,12
 RV 188,213,512
 QZ 132,76,28
 RV 190,213,4608
 QK 132,72,24
 RV 192,213,520
 QK 132,68,20
 RV 194,213,4616
 QK 132,64,16
 RV 196,213,1024
 SC 128
 v_mfma_f32_16x16x32_bf16 v[144:147], a[80:83], a[0:3], v[208:211]
 RV 198,213,5120
 SC 129
 QK 144,84,4
 RV 200,213,1032
 SC 130
 QK 144,88,8
 RV 202,213,5128
 SC 131
 QK 144,92,12
 RV 204,213,1536
 SC 132
 v_mfma_f32_16x16x32_bf16 v[148:151], a[92:95], a[28:31], v[208:211]
 RV 206,213,5632
 SC 133
 QK 148,88,24
 RV 208,213,1544
 SC 134
 QK 148,84,20
 RV 210,213,5640
 SC 135
 QK 148,80,16
 RV 96,213,8192
 EX 128
 v_mfma_f32_16x16x32_bf16 a[128:131], a[144:147], v[192:195], 0
 RV 98,213,12288
 EX 129
 LS 128,136,196
 RV 100,213,8200
 CV 176,128,129
 EX 130
 EX 131
 PS 144
 PS 146
 PS 148
 PS 150
 s_waitcnt lgkmcnt(15)
 PZ 32,180,196
 RV 102,213,12296
 CV 177,130,131
 PZ 0,180,192
 s_waitcnt lgkmcnt(15)
 RV 104,213,8704
 RV 106,213,12800
 PZ 4,184,192
 RV 108,213,8712
 EX 144
 PZ 36,184,196
 s_waitcnt lgkmcnt(15)
 RV 110,213,12808
 EX 145
 PZ 40,188,196
 RV 112,213,9216
 CV 178,144,145
 PZ 8,188,192
 s_waitcnt lgkmcnt(15)
 RV 114,213,13312
 EX 146
 PZ 12,192,192
 RV 116,213,9224
 RV 118,213,13320
 PZ 44,192,196
 s_waitcnt lgkmcnt(15)
 EX 147
 PZ 48,196,196
 RV 120,213,9728
 CV 179,146,147
 PZ 16,196,192
 s_waitcnt lgkmcnt(15)
 RV 122,213,13824
 RV 124,213,9736
 PZ 20,200,192
 EX 132
 PZ 52,200,196
 s_waitcnt lgkmcnt(15)
 EX 133
 PZ 56,204,196
 RV 126,213,13832
 CV 180,132,133
 PZ 24,204,192
 s_waitcnt lgkmcnt(15)
 EX 134
 PZ 28,208,192
 EX 135
 PZ 60,208,196
 EX 148
 LS 128,144,176
 s_waitcnt lgkmcnt(14)
 EX 149
 PV 0,96,176
 s_waitcnt lgkmcnt(12)
 CV 181,134,135
 CV 182,148,149
 PV 4,100,176
 s_waitcnt lgkmcnt(10)
 EX 150
 PV 8,104,176
 EX 151
 v_accvgpr_read_b32 v225, a128
 v_accvgpr_read_b32 v224, a129
 v_add_f32 v225, v224, v225
 v_rcp_f32 v224, v225
 v_subrev_u32 v225, 0x21800000, v225
 PM 0,224,0
 PM 2,224,0
 PM 4,224,0
 PM 6,224,0
 PM 8,224,0
 PM 10,224,0
 s_waitcnt lgkmcnt(8)
 PV 12,108,176
 s_waitcnt lgkmcnt(6)
 CV 0,0,1
 CV 1,2,3
 PV 16,112,176
 s_waitcnt lgkmcnt(4)
 CV 2,4,5
 CV 3,6,7
 PV 20,116,176
 CV 8,8,9
 CV 9,10,11
 CV 183,150,151
 XE 4,8,0
 XE 5,9,1
 PM 12,224,0
 PM 14,224,0
 s_waitcnt lgkmcnt(2)
 PV 24,120,176
 s_waitcnt lgkmcnt(0)
 CV 10,12,13
 CV 11,14,15
 PV 28,124,176
 XE 6,10,2
 XE 7,11,3
 LS 128,136,180
 s_not_b64 vcc, vcc
 buffer_store_dwordx4 v[4:7], v220, s[24:27], s38 offen offset:0 nt
 XO 8,0,8
 PM 16,224,0
 PM 18,224,0
 PM 20,224,0
 PM 22,224,0
 PM 24,224,0
 PM 26,224,0
 PM 28,224,0
 PM 30,224,0
 v_accvgpr_read_b32 v227, a130
 v_accvgpr_read_b32 v226, a131
 v_add_f32 v227, v226, v227
 v_rcp_f32 v226, v227
 v_subrev_u32 v227, 0x21800000, v227
 v_max3_u32 v225, v225, v227, v225
 v_max_u32 v225, v225, v227
 v_cmp_le_u32 s[84:85], s77, v225
 PV 32,96,180
 XO 9,1,9
 XO 10,2,10
 PV 36,100,180
 s_cmp_lg_u64 s[84:85], 0
 XO 11,3,11
 CV 16,16,17
 PV 40,104,180
 s_cselect_b32 s92, s76, 0
 CV 17,18,19
 CV 18,20,21
 PV 44,108,180
 s_or_b32 s73, s73, s92
 buffer_store_dwordx4 v[8:11], v221, s[24:27], s38 offen offset:0 nt
 PV 48,112,180
 s_lshl_b32 s76, s76, 1
 CV 19,22,23
 CV 24,24,25
 PV 52,116,180
 CV 25,26,27
 CV 26,28,29
 PV 56,120,180
 CV 27,30,31
 XO 28,16,24
 PV 60,124,180
 XO 29,17,25
 XO 30,18,26
 XO 31,19,27
 s_not_b64 vcc, vcc
 XE 16,24,16
 XE 17,25,17
 XE 18,26,18
 XE 19,27,19
 v_mul_f32 v48, v226, v48
 v_mul_f32 v49, v226, v49
 v_mul_f32 v50, v226, v50
 v_mul_f32 v51, v226, v51
 v_mul_f32 v52, v226, v52
 v_mul_f32 v53, v226, v53
 v_mul_f32 v54, v226, v54
 v_mul_f32 v55, v226, v55
 buffer_store_dwordx4 v[28:31], v221, s[24:27], s38 offen offset:128 nt
 PM 32,226,0
 PM 34,226,0
 PM 36,226,0
 PM 38,226,0
 CV 32,32,33
 CV 33,34,35
 CV 34,36,37
 CV 35,38,39
 PM 40,226,0
 PM 42,226,0
 PM 44,226,0
 PM 46,226,0
 CV 40,40,41
 CV 41,42,43
 CV 42,44,45
 CV 43,46,47
 XE 36,40,32
 XE 37,41,33
 XE 38,42,34
 XE 39,43,35
 s_not_b64 vcc, vcc
 XO 40,32,40
 XO 41,33,41
 XO 42,34,42
 XO 43,35,43
 CV 48,48,49
 CV 49,50,51
 CV 50,52,53
 CV 51,54,55
 v_mul_f32 v56, v226, v56
 buffer_store_dwordx4 v[16:19], v220, s[24:27], s38 offen offset:128 nt
 v_mul_f32 v57, v226, v57
 v_mul_f32 v58, v226, v58
 v_mul_f32 v59, v226, v59
 v_mul_f32 v60, v226, v60
 v_mul_f32 v61, v226, v61
 v_mul_f32 v62, v226, v62
 v_mul_f32 v63, v226, v63
 CV 56,56,57
 CV 57,58,59
 CV 58,60,61
 CV 59,62,63
 XO 60,48,56
 XO 61,49,57
 XO 62,50,58
 XO 63,51,59
 s_not_b64 vcc, vcc
 XE 48,56,48
 XE 49,57,49
 XE 50,58,50
 XE 51,59,51
 buffer_store_dwordx4 v[36:39], v220, s[24:27], s38 offen offset:256 nt
 buffer_store_dwordx4 v[40:43], v221, s[24:27], s38 offen offset:256 nt
 buffer_store_dwordx4 v[60:63], v221, s[24:27], s38 offen offset:384 nt
 buffer_store_dwordx4 v[48:51], v220, s[24:27], s38 offen offset:384 nt
 s_cmp_lg_u32 s73, 0
 s_cbranch_scc1 L_hop
 s_endpgm
.p2align 12
L_Z2:
 v_mfma_f32_16x16x32_bf16 v[128:131], a[64:67], a[0:3], v[208:211]
 s_cmp_eq_u32 s33, 0x8000
 RV 180,213,0
 SC 156
 QK 128,68,4
 s_cselect_b32 s32, -2, 1
 RV 182,213,4096
 SC 157
 QK 128,72,8
 s_lshl_b32 s32, s32, 14
 RV 184,213,8
 SC 158
 QK 128,76,12
 s_add_u32 s31, s33, s37
 RV 186,213,4104
 SC 159
 v_mfma_f32_16x16x32_bf16 v[132:135], a[76:79], a[28:31], v[208:211]
 s_add_u32 s33, s33, s32
 RV 188,213,512
 EX 156
 QK 132,72,24
 RV 190,213,4608
 SC 128
 QK 132,68,20
 RV 192,213,520
 SC 129
 QK 132,64,16
 RV 194,213,4616
 SC 130
 QZ 136,64,32
 RV 196,213,1024
 SC 131
 QK 136,68,36
 RV 198,213,5120
 EX 157
 QK 136,72,40
 RV 200,213,1032
 CV 206,156,157
 QK 136,76,44
 RV 202,213,5128
 SC 132
 QZ 140,76,60
 RV 204,213,1536
 SC 133
 QK 140,72,56
 RV 206,213,5632
 SC 134
 QK 140,68,52
 RV 208,213,1544
 SC 135
 QK 140,64,48
 RV 210,213,5640
 SC 136
 QZ 152,80,32
 RK 148,212,8192
 SC 137
 QK 152,84,36
 RK 152,212,8704
 SC 138
 QK 152,88,40
 RK 156,212,9216
 SC 139
 QK 152,92,44
 RK 160,212,9728
 SC 140
 RK 164,212,12288
 RK 168,212,12800
 EX 158
 RK 172,212,13312
 EX 159
 RK 176,212,13824
 RV 96,213,8192
 CV 207,158,159
 QZ 156,92,60
 RV 98,213,12288
 SC 141
 QK 156,88,56
 RV 100,213,8200
 SC 142
 QK 156,84,52
 RV 102,213,12296
 SC 143
 QK 156,80,48
 RV 104,213,8704
 v_add_u32 v212, s32, v212
 v_mfma_f32_16x16x32_bf16 a[128:131], a[144:147], v[192:195], 0
 RV 106,213,12800
 EX 128
 LS 128,136,196
 RV 108,213,8712
 EX 129
 EX 130
 PS 152
 PS 154
 PS 156
 PS 158
 s_waitcnt lgkmcnt(15)
 PZ 32,180,196
 RV 110,213,12808
 CV 176,128,129
 PZ 0,180,192
 s_waitcnt lgkmcnt(15)
 RV 112,213,9216
 EX 131
 PZ 4,184,192
 RV 114,213,13312
 CV 177,130,131
 PZ 36,184,196
 s_waitcnt lgkmcnt(15)
 RV 116,213,9224
 EX 132
 PZ 40,188,196
 RV 118,213,13320
 EX 133
 PZ 8,188,192
 s_waitcnt lgkmcnt(15)
 RV 120,213,9728
 CV 180,132,133
 PZ 12,192,192
 RV 122,213,13824
 EX 134
 PZ 44,192,196
 s_waitcnt lgkmcnt(15)
 RV 124,213,9736
 EX 135
 PZ 48,196,196
 RV 126,213,13832
 CV 181,134,135
 PZ 16,196,192
 s_waitcnt lgkmcnt(15)
 EX 136
 PZ 20,200,192
 EX 137
 PZ 52,200,196
 s_waitcnt lgkmcnt(15)
 CV 184,136,137
 v_add_u32 v213, s32, v213
 PZ 56,204,196
 EX 138
 PZ 24,204,192
 s_waitcnt lgkmcnt(15)
 EX 139
 PZ 28,208,192
 EX 140
 PZ 60,208,196
 EX 141
 v_mfma_f32_16x16x16_bf16 a[128:131], a[144:145], v[176:177], a[128:131]
 s_waitcnt lgkmcnt(15)
 CV 185,138,139
 EX 142
 PH 0,96,176
 s_waitcnt lgkmcnt(13)
 EX 143
 CV 188,140,141
 PH 4,100,176
 EX 152
 CV 189,142,143
 v_accvgpr_read_b32 v225, a128
 v_accvgpr_read_b32 v224, a129
 v_add_f32 v225, v224, v225
 v_rcp_f32 v224, v225
 v_subrev_u32 v225, 0x21800000, v225
 PM 0,224,0
 PM 2,224,0
 PM 4,224,0
 PM 6,224,0
 s_waitcnt lgkmcnt(11)
 PH 8,104,176
 s_waitcnt lgkmcnt(9)
 EX 153
 CV 0,0,1
 PH 12,108,176
 s_waitcnt lgkmcnt(7)
 CV 1,2,3
 CV 2,4,5
 CV 3,6,7
 PH 16,112,176
 EX 154
 CV 186,152,153
 EX 155
 EX 156
 PM 8,224,0
 PM 10,224,0
 PM 12,224,0
 PM 14,224,0
 s_waitcnt lgkmcnt(5)
 PH 20,116,176
 s_waitcnt vmcnt(8) lgkmcnt(0)
 CV 8,8,9
 CV 9,10,11
 PH 24,120,176
 s_barrier
 PH 28,124,176
 CV 10,12,13
 CV 11,14,15
 XE 4,8,0
 v_mfma_f32_16x16x16_bf16 a[128:131], a[136:137], v[180:181], a[128:131]
 XE 5,9,1
 XE 6,10,2
 XE 7,11,3
 PH 32,96,180
 buffer_store_dwordx4 v[4:7], v220, s[24:27], s38 offen offset:0 nt
 CV 187,154,155
 EX 157
 PM 16,224,0
 PM 18,224,0
 PM 20,224,0
 PM 22,224,0
 PM 24,224,0
 PM 26,224,0
 PM 28,224,0
 PM 30,224,0
 v_accvgpr_read_b32 v227, a130
 v_accvgpr_read_b32 v226, a131
 v_add_f32 v227, v226, v227
 v_rcp_f32 v226, v227
 v_subrev_u32 v227, 0x21800000, v227
 PH 36,100,180
 CV 16,16,17
 CV 17,18,19
 CV 18,20,21
 PH 40,104,180
 CV 19,22,23
 CV 24,24,25
 CV 25,26,27
 PH 44,108,180
 s_not_b64 vcc, vcc
 XO 8,0,8
 XO 9,1,9
 PH 48,112,180
 XO 10,2,10
 XO 11,3,11
 CV 26,28,29
 PH 52,116,180
 buffer_store_dwordx4 v[8:11], v221, s[24:27], s38 offen offset:0 nt
 PH 56,120,180
 CV 27,30,31
 XO 28,16,24
 XO 29,17,25
 PH 60,124,180
 XO 30,18,26
 XO 31,19,27
 CV 190,156,157
 v_mfma_f32_16x16x32_bf16 a[132:135], a[144:147], v[200:203], 0
 s_not_b64 vcc, vcc
 XE 16,24,16
 XE 17,25,17
 LS 132,136,204
 XE 18,26,18
 XE 19,27,19
 PZ 96,180,204
 EX 158
 PZ 64,180,200
 RV 180,213,0
 EX 159
 PZ 68,184,200
 buffer_store_dwordx4 v[28:31], v221, s[24:27], s38 offen offset:128 nt
 CV 191,158,159
 PM 32,226,0
 PM 34,226,0
 PM 36,226,0
 PM 38,226,0
 PM 40,226,0
 PM 42,226,0
 PM 44,226,0
 PM 46,226,0
 PZ 100,184,204
 RV 182,213,4096
 CV 32,32,33
 PZ 104,188,204
 RV 184,213,8
 CV 33,34,35
 PZ 72,188,200
 RV 186,213,4104
 CV 34,36,37
 PZ 76,192,200
 RV 188,213,512
 CV 35,38,39
 PZ 108,192,204
 buffer_store_dwordx4 v[16:19], v220, s[24:27], s38 offen offset:128 nt
 PZ 112,196,204
 RV 190,213,4608
 CV 40,40,41
 PZ 80,196,200
 RV 192,213,520
 CV 41,42,43
 PZ 84,200,200
 RV 194,213,4616
 CV 42,44,45
 PZ 116,200,204
 RV 196,213,1024
 CV 43,46,47
 PZ 120,204,204
 RV 198,213,5120
 XE 36,40,32
 PZ 88,204,200
 RV 200,213,1032
 XE 37,41,33
 PZ 92,208,200
 RV 202,213,5128
 XE 38,42,34
 PZ 124,208,204
 RV 204,213,1536
 XE 39,43,35
 QZ 136,148,32
 s_not_b64 vcc, vcc
 buffer_store_dwordx4 v[36:39], v220, s[24:27], s38 offen offset:256 nt
 XO 40,32,40
 PM 48,226,0
 PM 50,226,0
 PM 52,226,0
 PM 54,226,0
 PM 56,226,0
 PM 58,226,0
 PM 60,226,0
 PM 62,226,0
 QK 136,152,36
 RV 206,213,5632
 XO 41,33,41
 QK 136,156,40
 RV 208,213,1544
 XO 42,34,42
 QK 136,160,44
 RV 210,213,5640
 XO 43,35,43
 QZ 140,160,60
 CV 48,48,49
 CV 49,50,51
 QK 140,156,56
 buffer_store_dwordx4 v[40:43], v221, s[24:27], s38 offen offset:256 nt
 QK 140,152,52
 CV 50,52,53
 CV 51,54,55
 QK 140,148,48
 CV 56,56,57
 CV 57,58,59
 v_mfma_f32_16x16x32_bf16 v[152:155], a[164:167], a[32:35], v[208:211]
 CV 58,60,61
 CV 59,62,63
 QK 152,168,36
 XO 60,48,56
 XO 61,49,57
 QK 152,172,40
 XO 62,50,58
 XO 63,51,59
 QK 152,176,44
 s_not_b64 vcc, vcc
 XE 48,56,48
 XE 49,57,49
 v_mfma_f32_16x16x32_bf16 v[156:159], a[176:179], a[60:63], v[208:211]
 buffer_store_dwordx4 v[60:63], v221, s[24:27], s38 offen offset:384 nt
 QK 156,172,56
 XE 50,58,50
 XE 51,59,51
 QK 156,168,52
 SC 136
 SC 137
 QK 156,164,48
 EX 136
 SM 132,184
 SC 138
 PV 96,96,188
 EX 137
 PV 64,96,184
 CV 168,136,137
 SC 139
 EX 138
 EX 139
 PS 152
 PS 154
 PS 156
 PS 158
 PV 68,100,184
 buffer_store_dwordx4 v[48:51], v220, s[24:27], s38 offen offset:384 nt
 PV 100,100,188
 CV 169,138,139
 SC 140
 PV 104,104,188
 EX 152
 PV 72,104,184
 EX 153
 PV 76,108,184
 CV 170,152,153
 SC 141
 PV 108,108,188
 EX 154
 PV 112,112,188
 EX 155
 PV 80,112,184
 CV 171,154,155
 SC 142
 PV 84,116,184
 EX 140
 PV 116,116,188
 EX 141
 PV 120,120,188
 CV 172,140,141
 SC 143
 PV 88,120,184
 EX 142
 PV 92,124,184
 EX 143
 PV 124,124,188
 EX 156
 LS 132,144,168
 s_waitcnt lgkmcnt(14)
 EX 157
 PV 64,180,168
 s_waitcnt lgkmcnt(12)
 CV 173,142,143
 CV 174,156,157
 PV 68,184,168
 s_waitcnt lgkmcnt(10)
 EX 158
 PV 72,188,168
 EX 159
 v_accvgpr_read_b32 v229, a132
 v_accvgpr_read_b32 v228, a133
 v_add_f32 v229, v228, v229
 v_rcp_f32 v228, v229
 v_subrev_u32 v229, 0x21800000, v229
 PM 64,228,0
 PM 66,228,0
 PM 68,228,0
 PM 70,228,0
 PM 72,228,0
 PM 74,228,0
 v_max3_u32 v225, v225, v227, v229
 s_waitcnt lgkmcnt(8)
 PV 76,192,168
 s_waitcnt lgkmcnt(6)
 CV 64,64,65
 CV 65,66,67
 PV 80,196,168
 s_waitcnt lgkmcnt(4)
 CV 66,68,69
 CV 67,70,71
 PV 84,200,168
 CV 72,72,73
 CV 73,74,75
 CV 175,158,159
 XE 68,72,64
 XE 69,73,65
 PM 76,228,0
 PM 78,228,0
 s_waitcnt lgkmcnt(2)
 PV 88,204,168
 s_waitcnt lgkmcnt(0)
 CV 74,76,77
 CV 75,78,79
 PV 92,208,168
 XE 70,74,66
 XE 71,75,67
 LS 132,136,172
 s_not_b64 vcc, vcc
 buffer_store_dwordx4 v[68:71], v220, s[24:27], s39 offen offset:0 nt
 XO 72,64,72
 PM 80,228,0
 PM 82,228,0
 PM 84,228,0
 PM 86,228,0
 PM 88,228,0
 PM 90,228,0
 PM 92,228,0
 PM 94,228,0
 v_accvgpr_read_b32 v231, a134
 v_accvgpr_read_b32 v230, a135
 v_add_f32 v231, v230, v231
 v_rcp_f32 v230, v231
 v_subrev_u32 v231, 0x21800000, v231
 v_max_u32 v225, v225, v231
 v_cmp_le_u32 s[84:85], s77, v225
 PV 96,180,172
 XO 73,65,73
 XO 74,66,74
 PV 100,184,172
 s_cmp_lg_u64 s[84:85], 0
 XO 75,67,75
 CV 80,80,81
 PV 104,188,172
 s_cselect_b32 s92, s76, 0
 buffer_store_dwordx4 v[72:75], v221, s[24:27], s39 offen offset:0 nt
 PV 108,192,172
 s_or_b32 s73, s73, s92
 CV 81,82,83
 CV 82,84,85
 PV 112,196,172
 s_lshl_b32 s76, s76, 1
 CV 83,86,87
 CV 88,88,89
 PV 116,200,172
 CV 89,90,91
 CV 90,92,93
 PV 120,204,172
 CV 91,94,95
 XO 92,80,88
 PV 124,208,172
 XO 93,81,89
 XO 94,82,90
 XO 95,83,91
 s_not_b64 vcc, vcc
 XE 80,88,80
 XE 81,89,81
 buffer_store_dwordx4 v[92:95], v221, s[24:27], s39 offen offset:128 nt
 XE 82,90,82
 XE 83,91,83
 PM 96,230,0
 PM 98,230,0
 PM 100,230,0
 PM 102,230,0
 CV 96,96,97
 CV 97,98,99
 CV 98,100,101
 CV 99,102,103
 PM 104,230,0
 PM 106,230,0
 PM 108,230,0
 PM 110,230,0
 CV 104,104,105
 CV 105,106,107
 CV 106,108,109
 CV 107,110,111
 XE 100,104,96
 XE 101,105,97
 XE 102,106,98
 XE 103,107,99
 s_not_b64 vcc, vcc
 XO 104,96,104
 buffer_store_dwordx4 v[80:83], v220, s[24:27], s39 offen offset:128 nt
 XO 105,97,105
 XO 106,98,106
 XO 107,99,107
 v_mul_f32 v112, v230, v112
 v_mul_f32 v113, v230, v113
 v_mul_f32 v114, v230, v114
 v_mul_f32 v115, v230, v115
 v_mul_f32 v116, v230, v116
 v_mul_f32 v117, v230, v117
 v_mul_f32 v118, v230, v118
 v_mul_f32 v119, v230, v119
 CV 112,112,113
 CV 113,114,115
 CV 114,116,117
 CV 115,118,119
 v_mul_f32 v120, v230, v120
 v_mul_f32 v121, v230, v121
 v_mul_f32 v122, v230, v122
 v_mul_f32 v123, v230, v123
 v_mul_f32 v124, v230, v124
 v_mul_f32 v125, v230, v125
 v_mul_f32 v126, v230, v126
 v_mul_f32 v127, v230, v127
 CV 120,120,121
 buffer_store_dwordx4 v[100:103], v220, s[24:27], s39 offen offset:256 nt
 CV 121,122,123
 CV 122,124,125
 CV 123,126,127
 XO 124,112,120
 XO 125,113,121
 XO 126,114,122
 XO 127,115,123
 s_not_b64 vcc, vcc
 XE 112,120,112
 XE 113,121,113
 XE 114,122,114
 XE 115,123,115
 buffer_store_dwordx4 v[104:107], v221, s[24:27], s39 offen offset:256 nt
 buffer_store_dwordx4 v[124:127], v221, s[24:27], s39 offen offset:384 nt
 buffer_store_dwordx4 v[112:115], v220, s[24:27], s39 offen offset:384 nt
 s_cmp_lg_u32 s73, 0
 s_cbranch_scc1 L_hop
 s_endpgm
.p2align 12
L_Z3:
 QZ 128,64,0
 s_cmp_eq_u32 s33, 0x8000
 RV 180,213,0
 SC 156
 QK 128,68,4
 s_cselect_b32 s32, -2, 1
 RV 182,213,4096
 SC 157
 QK 128,72,8
 s_lshl_b32 s32, s32, 14
 RV 184,213,8
 SC 158
 QK 128,76,12
 s_add_u32 s31, s33, s37
 RV 186,213,4104
 SC 159
 QZ 132,76,28
 s_add_u32 s33, s33, s32
 RV 188,213,512
 EX 156
 QK 132,72,24
 RV 190,213,4608
 EX 157
 QK 132,68,20
 RV 192,213,520
 CV 206,156,157
 QK 132,64,16
 RV 194,213,4616
 EX 158
 v_mfma_f32_16x16x32_bf16 v[144:147], a[80:83], a[0:3], v[208:211]
 RV 196,213,1024
 EX 159
 QK 144,84,4
 RV 198,213,5120
 CV 207,158,159
 PS 128
 PS 130
 PS 132
 PS 134
 QK 144,88,8
 RV 200,213,1032
 EX 128
 QK 144,92,12
 RV 202,213,5128
 EX 129
 v_mfma_f32_16x16x32_bf16 v[148:151], a[92:95], a[28:31], v[208:211]
 RV 204,213,1536
 CV 176,128,129
 QK 148,88,24
 RV 206,213,5632
 EX 130
 QK 148,84,20
 RV 208,213,1544
 EX 131
 QK 148,80,16
 RV 210,213,5640
 CV 177,130,131
 QZ 136,64,32
 RK 148,212,8192
 EX 132
 QK 136,68,36
 RK 152,212,8704
 EX 133
 EX 134
 PS 144
 PS 146
 PS 148
 PS 150
 QK 136,72,40
 RK 156,212,9216
 CV 180,132,133
 QK 136,76,44
 RK 160,212,9728
 v_add_u32 v212, s32, v212
 QZ 140,76,60
 RV 96,213,8192
 EX 144
 QK 140,72,56
 RV 98,213,12288
 EX 145
 QK 140,68,52
 RV 100,213,8200
 CV 178,144,145
 QK 140,64,48
 RV 102,213,12296
 EX 146
 QZ 152,80,32
 RV 104,213,8704
 EX 147
 QK 152,84,36
 RV 106,213,12800
 CV 179,146,147
 EX 135
 EX 148
 PS 136
 PS 138
 PS 140
 PS 142
 QK 152,88,40
 RV 108,213,8712
 CV 181,134,135
 QK 152,92,44
 RV 110,213,12808
 EX 149
 QZ 156,92,60
 RV 112,213,9216
 CV 182,148,149
 QK 156,88,56
 RV 114,213,13312
 EX 150
 QK 156,84,52
 RV 116,213,9224
 EX 151
 QK 156,80,48
 RV 118,213,13320
 CV 183,150,151
 v_mfma_f32_16x16x32_bf16 a[128:131], a[144:147], v[192:195], 0
 RV 120,213,9728
 EX 136
 LS 128,136,196
 RV 122,213,13824
 EX 137
 EX 138
 PS 152
 PS 154
 PS 156
 PS 158
 s_waitcnt lgkmcnt(15)
 PZ 32,180,196
 RV 124,213,9736
 CV 184,136,137
 PZ 0,180,192
 s_waitcnt lgkmcnt(15)
 RV 126,213,13832
 v_add_u32 v213, s32, v213
 PZ 4,184,192
 EX 139
 PZ 36,184,196
 s_waitcnt lgkmcnt(15)
 EX 140
 PZ 40,188,196
 EX 141
 PZ 8,188,192
 s_waitcnt lgkmcnt(15)
 CV 185,138,139
 CV 188,140,141
 PZ 12,192,192
 EX 142
 PZ 44,192,196
 s_waitcnt lgkmcnt(15)
 EX 143
 PZ 48,196,196
 EX 152
 PZ 16,196,192
 s_waitcnt lgkmcnt(15)
 EX 153
 PZ 20,200,192
 CV 189,142,143
 CV 186,152,153
 PZ 52,200,196
 s_waitcnt lgkmcnt(15)
 EX 154
 PZ 56,204,196
 s_waitcnt vmcnt(8) lgkmcnt(0)
 EX 155
 PZ 24,204,192
 s_barrier
 PZ 28,208,192
 EX 156
 PZ 60,208,196
 EX 157
 LS 128,144,176
 CV 187,154,155
 CV 190,156,157
 PV 0,96,176
 EX 158
 PV 4,100,176
 EX 159
 PV 8,104,176
 CV 191,158,159
 v_accvgpr_read_b32 v225, a128
 v_accvgpr_read_b32 v224, a129
 v_add_f32 v225, v224, v225
 v_rcp_f32 v224, v225
 v_subrev_u32 v225, 0x21800000, v225
 PM 0,224,0
 PM 2,224,0
 PM 4,224,0
 PM 6,224,0
 PM 8,224,0
 PM 10,224,0
 PV 12,108,176
 CV 0,0,1
 CV 1,2,3
 PV 16,112,176
 CV 2,4,5
 CV 3,6,7
 PV 20,116,176
 CV 8,8,9
 CV 9,10,11
 PM 12,224,0
 PM 14,224,0
 PV 24,120,176
 CV 10,12,13
 CV 11,14,15
 PV 28,124,176
 XE 4,8,0
 XE 5,9,1
 LS 128,136,180
 XE 6,10,2
 XE 7,11,3
 PV 32,96,180
 s_not_b64 vcc, vcc
 buffer_store_dwordx4 v[4:7], v220, s[24:27], s38 offen offset:0 nt
 XO 8,0,8
 PM 16,224,0
 PM 18,224,0
 PM 20,224,0
 PM 22,224,0
 PM 24,224,0
 PM 26,224,0
 PM 28,224,0
 PM 30,224,0
 v_accvgpr_read_b32 v227, a130
 v_accvgpr_read_b32 v226, a131
 v_add_f32 v227, v226, v227
 v_rcp_f32 v226, v227
 v_subrev_u32 v227, 0x21800000, v227
 PV 36,100,180
 XO 9,1,9
 XO 10,2,10
 PV 40,104,180
 XO 11,3,11
 CV 16,16,17
 PV 44,108,180
 buffer_store_dwordx4 v[8:11], v221, s[24:27], s38 offen offset:0 nt
 PV 48,112,180
 CV 17,18,19
 CV 18,20,21
 PV 52,116,180
 CV 19,22,23
 CV 24,24,25
 PV 56,120,180
 CV 25,26,27
 CV 26,28,29
 PV 60,124,180
 CV 27,30,31
 XO 28,16,24
 v_mfma_f32_16x16x32_bf16 a[132:135], a[144:147], v[200:203], 0
 XO 29,17,25
 XO 30,18,26
 LS 132,136,204
 XO 31,19,27
 v_mul_f32 v48, v226, v48
 PZ 96,180,204
 s_not_b64 vcc, vcc
 buffer_store_dwordx4 v[28:31], v221, s[24:27], s38 offen offset:128 nt
 XE 16,24,16
 PM 32,226,0
 PM 34,226,0
 PM 36,226,0
 PM 38,226,0
 PM 40,226,0
 PM 42,226,0
 PM 44,226,0
 PM 46,226,0
 PZ 64,180,200
 RV 180,213,0
 XE 17,25,17
 PZ 68,184,200
 XE 18,26,18
 XE 19,27,19
 PZ 100,184,204
 RV 184,213,8
 CV 32,32,33
 PZ 104,188,204
 CV 33,34,35
 CV 34,36,37
 PZ 72,188,200
 buffer_store_dwordx4 v[16:19], v220, s[24:27], s38 offen offset:128 nt
 PZ 76,192,200
 RV 188,213,512
 CV 35,38,39
 PZ 108,192,204
 RV 192,213,520
 CV 40,40,41
 PZ 112,196,204
 CV 41,42,43
 CV 42,44,45
 PZ 80,196,200
 RV 196,213,1024
 CV 43,46,47
 PZ 84,200,200
 XE 36,40,32
 XE 37,41,33
 PZ 116,200,204
 RV 200,213,1032
 XE 38,42,34
 PZ 120,204,204
 XE 39,43,35
 v_mul_f32 v49, v226, v49
 PZ 88,204,200
 s_not_b64 vcc, vcc
 buffer_store_dwordx4 v[36:39], v220, s[24:27], s38 offen offset:256 nt
 PZ 92,208,200
 RV 204,213,1536
 XO 40,32,40
 PZ 124,208,204
 RV 208,213,1544
 XO 41,33,41
 v_mfma_f32_16x16x32_bf16 v[136:139], a[148:151], a[32:35], v[208:211]
 XO 42,34,42
 XO 43,35,43
 QK 136,152,36
 v_mul_f32 v50, v226, v50
 v_mul_f32 v51, v226, v51
 QK 136,156,40
 v_mul_f32 v52, v226, v52
 v_mul_f32 v53, v226, v53
 QK 136,160,44
 v_mul_f32 v54, v226, v54
 v_mul_f32 v55, v226, v55
 v_mfma_f32_16x16x32_bf16 v[140:143], a[148:151], a[48:51], v[208:211]
 buffer_store_dwordx4 v[40:43], v221, s[24:27], s38 offen offset:256 nt
 QK 140,152,52
 CV 48,48,49
 CV 49,50,51
 QK 140,156,56
 CV 50,52,53
 CV 51,54,55
 v_mul_f32 v56, v226, v56
 v_mul_f32 v57, v226, v57
 v_mul_f32 v58, v226, v58
 PS 136
 PS 138
 QK 140,160,60
 v_mul_f32 v59, v226, v59
 v_mul_f32 v60, v226, v60
 LS 132,144,184
 v_mul_f32 v61, v226, v61
 v_mul_f32 v62, v226, v62
 PV 64,96,184
 v_mul_f32 v63, v226, v63
 CV 56,56,57
 CV 57,58,59
 CV 58,60,61
 CV 59,62,63
 PS 140
 PS 142
 PV 68,100,184
 XO 60,48,56
 XO 61,49,57
 PV 72,104,184
 XO 62,50,58
 XO 63,51,59
 PV 76,108,184
 s_not_b64 vcc, vcc
 buffer_store_dwordx4 v[60:63], v221, s[24:27], s38 offen offset:384 nt
 PV 80,112,184
 XE 48,56,48
 XE 49,57,49
 PV 84,116,184
 XE 50,58,50
 XE 51,59,51
 PV 88,120,184
 EX 136
 PV 92,124,184
 EX 137
 EX 138
 CV 168,136,137
 EX 139
 EX 140
 CV 169,138,139
 buffer_store_dwordx4 v[48:51], v220, s[24:27], s38 offen offset:384 nt
 EX 141
 v_mfma_f32_16x16x16_bf16 a[132:135], a[144:145], v[168:169], a[132:135]
 s_waitcnt lgkmcnt(7)
 EX 142
 CV 172,140,141
 PH 64,180,168
 s_waitcnt lgkmcnt(6)
 EX 143
 PH 68,184,168
 s_waitcnt lgkmcnt(5)
 CV 173,142,143
 PH 72,188,168
 s_waitcnt lgkmcnt(4)
 PH 76,192,168
 v_accvgpr_read_b32 v229, a132
 v_accvgpr_read_b32 v228, a133
 v_add_f32 v229, v228, v229
 v_rcp_f32 v228, v229
 v_subrev_u32 v229, 0x21800000, v229
 PM 64,228,0
 PM 66,228,0
 PM 68,228,0
 PM 70,228,0
 PM 72,228,0
 PM 74,228,0
 PM 76,228,0
 PM 78,228,0
 v_max3_u32 v225, v225, v227, v229
 s_waitcnt lgkmcnt(3)
 PH 80,196,168
 s_waitcnt lgkmcnt(2)
 CV 64,64,65
 CV 65,66,67
 CV 66,68,69
 PH 84,200,168
 s_waitcnt lgkmcnt(1)
 CV 67,70,71
 CV 72,72,73
 CV 73,74,75
 PH 88,204,168
 s_waitcnt lgkmcnt(0)
 CV 74,76,77
 CV 75,78,79
 XE 68,72,64
 PH 92,208,168
 XE 69,73,65
 XE 70,74,66
 XE 71,75,67
 LS 132,136,188
 s_not_b64 vcc, vcc
 buffer_store_dwordx4 v[68:71], v220, s[24:27], s39 offen offset:0 nt
 XO 72,64,72
 PM 80,228,0
 PM 82,228,0
 PM 84,228,0
 PM 86,228,0
 PM 88,228,0
 PM 90,228,0
 PM 92,228,0
 PM 94,228,0
 PV 96,96,188
 XO 73,65,73
 XO 74,66,74
 PV 100,100,188
 XO 75,67,75
 CV 80,80,81
 PV 104,104,188
 CV 81,82,83
 CV 82,84,85
 PV 108,108,188
 CV 83,86,87
 CV 88,88,89
 PV 112,112,188
 buffer_store_dwordx4 v[72:75], v221, s[24:27], s39 offen offset:0 nt
 PV 116,116,188
 CV 89,90,91
 CV 90,92,93
 PV 120,120,188
 CV 91,94,95
 XO 92,80,88
 PV 124,124,188
 XO 93,81,89
 XO 94,82,90
 v_mfma_f32_16x16x16_bf16 a[132:135], a[136:137], v[172:173], a[132:135]
 XO 95,83,91
 PH 96,180,172
 s_not_b64 vcc, vcc
 XE 80,88,80
 XE 81,89,81
 PH 100,184,172
 XE 82,90,82
 XE 83,91,83
 v_accvgpr_read_b32 v231, a134
 v_accvgpr_read_b32 v230, a135
 v_add_f32 v231, v230, v231
 v_rcp_f32 v230, v231
 v_subrev_u32 v231, 0x21800000, v231
 v_max_u32 v225, v225, v231
 v_cmp_le_u32 s[84:85], s77, v225
 PH 104,188,172
 buffer_store_dwordx4 v[92:95], v221, s[24:27], s39 offen offset:128 nt
 PM 96,230,0
 PM 98,230,0
 PM 100,230,0
 PM 102,230,0
 PH 108,192,172
 CV 96,96,97
 CV 97,98,99
 CV 98,100,101
 CV 99,102,103
 PM 104,230,0
 PM 106,230,0
 PH 112,196,172
 CV 104,104,105
 CV 105,106,107
 PM 108,230,0
 PM 110,230,0
 PH 116,200,172
 buffer_store_dwordx4 v[80:83], v220, s[24:27], s39 offen offset:128 nt
 PH 120,204,172
 s_cmp_lg_u64 s[84:85], 0
 CV 106,108,109
 CV 107,110,111
 PH 124,208,172
 s_cselect_b32 s92, s76, 0
 XE 100,104,96
 XE 101,105,97
 XE 102,106,98
 XE 103,107,99
 s_not_b64 vcc, vcc
 XO 104,96,104
 XO 105,97,105
 XO 106,98,106
 XO 107,99,107
 s_or_b32 s73, s73, s92
 s_lshl_b32 s76, s76, 1
 buffer_store_dwordx4 v[100:103], v220, s[24:27], s39 offen offset:256 nt
 PM 112,230,0
 PM 114,230,0
 PM 116,230,0
 PM 118,230,0
 CV 112,112,113
 CV 113,114,115
 CV 114,116,117
 CV 115,118,119
 PM 120,230,0
 PM 122,230,0
 PM 124,230,0
 PM 126,230,0
 CV 120,120,121
 CV 121,122,123
 CV 122,124,125
 CV 123,126,127
 XO 124,112,120
 XO 125,113,121
 XO 126,114,122
 XO 127,115,123
 s_not_b64 vcc, vcc
 XE 112,120,112
 XE 113,121,113
 XE 114,122,114
 XE 115,123,115
 buffer_store_dwordx4 v[104:107], v221, s[24:27], s39 offen offset:256 nt
 buffer_store_dwordx4 v[124:127], v221, s[24:27], s39 offen offset:384 nt
 buffer_store_dwordx4 v[112:115], v220, s[24:27], s39 offen offset:384 nt
 s_cmp_lg_u32 s73, 0
 s_cbranch_scc1 L_hop
 s_endpgm
.p2align 12
L_U0:
 v_mfma_f32_16x16x32_bf16 v[128:131], a[64:67], a[0:3], v[208:211]
 s_cmp_eq_u32 s33, 0x8000
 RV 96,213,8192
 v_add_u32 v251, L_U0-L_pc-0, v244
 QK 128,68,4
 s_cselect_b32 s32, -2, 1
 RV 98,213,12288
 SC 156
 QK 128,72,8
 s_lshl_b32 s32, s32, 14
 RV 100,213,8200
 v_add_u32 v212, s32, v212
 QK 128,76,12
 s_add_u32 s31, s33, s37
 RV 102,213,12296
 SC 157
 v_mfma_f32_16x16x32_bf16 v[132:135], a[76:79], a[28:31], v[208:211]
 s_add_u32 s33, s33, s32
 RV 104,213,8704
 SC 158
 QK 132,72,24
 s_add_u32 s31, s33, s37
 RV 106,213,12800
 SC 159
 QK 132,68,20
 RV 108,213,8712
 RV 110,213,12808
 QK 132,64,16
 RV 112,213,9216
 global_load_dword v255, v251, s[64:65]
 QZ 136,64,32
 RV 114,213,13312
 EX 156
 QK 136,68,36
 RV 116,213,9224
 EX 157
 QK 136,72,40
 RV 118,213,13320
 CV 190,156,157
 QK 136,76,44
 RV 120,213,9728
 EX 158
 QZ 140,76,60
 RV 122,213,13824
 RV 124,213,9736
 QK 140,72,56
 EX 159
 QK 140,68,52
 RV 126,213,13832
 v_add_u32 v213, s32, v213
 QK 140,64,48
 s_cmp_eq_u32 s33, 0x8000
 CV 191,158,159
 QZ 152,80,32
 s_cselect_b32 s32, -2, 1
 QK 152,84,36
 s_lshl_b32 s32, s32, 14
 QK 152,88,40
 s_add_u32 s33, s33, s32
 PS 128
 PS 130
 PS 132
 PS 134
 PS 136
 PS 138
 PS 140
 PS 142
 QK 152,92,44
 EX 136
 QZ 156,92,60
 s_waitcnt vmcnt(9) lgkmcnt(0)
 EX 137
 QK 156,88,56
 s_barrier
 QK 156,84,52
 RK 148,212,0
 CV 168,136,137
 QK 156,80,48
 RK 152,212,512
 RK 156,212,1024
 SM 128,176
 RK 160,212,1536
 EX 138
 SM 132,184
 RK 164,212,4096
 EX 139
 EX 140
 PS 152
 PS 154
 PS 156
 PS 158
 PV 96,96,188
 RK 168,212,4608
 CV 169,138,139
 PV 64,96,184
 RK 172,212,5120
 RK 176,212,5632
 PV 32,96,180
 RV 180,213,0
 EX 141
 PV 0,96,176
 RV 182,213,4096
 CV 172,140,141
 PV 4,100,176
 RV 184,213,8
 EX 142
 PV 36,100,180
 RV 186,213,4104
 EX 143
 PV 68,100,184
 RV 188,213,512
 CV 173,142,143
 PV 100,100,188
 RV 190,213,4608
 RV 192,213,520
 PV 104,104,188
 EX 152
 PV 72,104,184
 RV 194,213,4616
 RV 196,213,1024
 PV 40,104,180
 EX 153
 PV 8,104,176
 RV 198,213,5120
 CV 170,152,153
 PV 12,108,176
 RV 200,213,1032
 RV 202,213,5128
 PV 44,108,180
 EX 154
 PV 76,108,184
 RV 204,213,1536
 RV 206,213,5632
 PV 108,108,188
 EX 155
 PV 112,112,188
 RV 208,213,1544
 CV 171,154,155
 PV 80,112,184
 RV 210,213,5640
 RK 212,212,8192
 PV 48,112,180
 EX 156
 PV 16,112,176
 RK 216,212,8704
 RK 220,212,9216
 PV 20,116,176
 EX 157
 PV 52,116,180
 RK 224,212,9728
 CV 174,156,157
 PV 84,116,184
 RK 228,212,12288
 RK 232,212,12800
 PV 116,116,188
 EX 158
 PV 120,120,188
 RK 236,212,13312
 RK 240,212,13824
 PV 88,120,184
 EX 159
 PV 56,120,180
 RV 96,213,8192
 CV 175,158,159
 PV 24,120,176
 RV 98,213,12288
 v_add_u32 v212, s32, v212
 PV 28,124,176
 RV 100,213,8200
 RV 102,213,12296
 PV 60,124,180
 EX 128
 PV 92,124,184
 RV 104,213,8704
 RV 106,213,12800
 PV 124,124,188
 s_waitcnt lgkmcnt(15)
 EX 129
 QZ 136,148,32
 s_waitcnt lgkmcnt(15)
 RV 108,213,8712
 CV 160,128,129
 QK 136,152,36
 s_waitcnt lgkmcnt(15)
 RV 110,213,12808
 RV 112,213,9216
 QK 136,156,40
 s_waitcnt lgkmcnt(15)
 EX 130
 QK 136,160,44
 RV 114,213,13312
 RV 116,213,9224
 QZ 140,160,60
 EX 131
 QK 140,156,56
 RV 118,213,13320
 CV 161,130,131
 QK 140,152,52
 RV 120,213,9728
 RV 122,213,13824
 QK 140,148,48
 s_waitcnt lgkmcnt(15)
 EX 132
 QZ 152,164,32
 s_waitcnt lgkmcnt(15)
 RV 124,213,9736
 RV 126,213,13832
 QK 152,168,36
 s_waitcnt lgkmcnt(15)
 EX 133
 QK 152,172,40
 CV 164,132,133
 v_add_u32 v213, s32, v213
 EX 134
 EX 135
 PS 136
 PS 138
 PS 140
 PS 142
 s_waitcnt lgkmcnt(15)
 QK 152,176,44
 EX 136
 QZ 156,176,60
 EX 137
 QK 156,172,56
 CV 165,134,135
 CV 184,136,137
 QK 156,168,52
 EX 138
 QK 156,164,48
 EX 139
 v_mfma_f32_16x16x16_bf16 a[128:131], a[144:145], v[160:161], a[128:131]
 s_waitcnt lgkmcnt(15)
 EX 140
 CV 185,138,139
 PH 0,180,160
 s_waitcnt vmcnt(1) lgkmcnt(0)
 EX 141
 PH 4,184,160
 s_barrier
 CV 188,140,141
 v_accvgpr_read_b32 v225, a128
 PS 152
 PS 154
 PS 156
 PS 158
 v_accvgpr_read_b32 v224, a129
 v_add_f32 v225, v224, v225
 v_rcp_f32 v224, v225
 v_subrev_u32 v225, 0x21800000, v225
 PM 0,224,0
 PM 2,224,0
 PM 4,224,0
 PM 6,224,0
 PH 8,188,160
 RK 148,212,0
 EX 142
 PH 12,192,160
 RK 152,212,512
 EX 143
 PH 16,196,160
 RK 156,212,1024
 CV 0,0,1
 CV 1,2,3
 CV 2,4,5
 CV 3,6,7
 CV 189,142,143
 PM 8,224,0
 PM 10,224,0
 PM 12,224,0
 PM 14,224,0
 PH 20,200,160
 RK 160,212,1536
 EX 152
 PH 24,204,160
 RK 176,212,5632
 EX 153
 PH 28,208,160
 RK 172,212,5120
 CV 8,8,9
 CV 9,10,11
 v_mfma_f32_16x16x16_bf16 a[128:131], a[136:137], v[164:165], a[128:131]
 RK 168,212,4608
 CV 10,12,13
 CV 11,14,15
 PH 32,180,164
 RK 164,212,4096
 XE 4,8,0
 XE 5,9,1
 PH 36,184,164
 XE 6,10,2
 XE 7,11,3
 CV 186,152,153
 v_accvgpr_read_b32 v227, a130
 v_accvgpr_read_b32 v226, a131
 v_add_f32 v227, v226, v227
 v_rcp_f32 v226, v227
 v_subrev_u32 v227, 0x21800000, v227
 PH 40,188,164
 buffer_store_dwordx4 v[4:7], v220, s[24:27], s38 offen offset:0 nt
 EX 154
 PM 16,224,0
 PM 18,224,0
 PM 20,224,0
 PM 22,224,0
 PM 24,224,0
 PM 26,224,0
 PM 28,224,0
 PM 30,224,0
 PH 44,192,164
 EX 155
 CV 16,16,17
 PH 48,196,164
 CV 187,154,155
 CV 17,18,19
 CV 18,20,21
 PH 52,200,164
 CV 19,22,23
 EX 156
 PH 56,204,164
 EX 157
 CV 24,24,25
 PH 60,208,164
 CV 25,26,27
 CV 26,28,29
 CV 27,30,31
 SM 132,168
 s_not_b64 vcc, vcc
 XO 8,0,8
 PV 96,180,172
 XO 9,1,9
 XO 10,2,10
 PV 64,180,168
 RV 180,213,0
 XO 11,3,11
 PV 68,184,168
 buffer_store_dwordx4 v[8:11], v221, s[24:27], s38 offen offset:0 nt
 PV 100,184,172
 RV 182,213,4096
 XO 28,16,24
 PV 104,188,172
 RV 184,213,8
 XO 29,17,25
 PV 72,188,168
 RV 186,213,4104
 XO 30,18,26
 PV 76,192,168
 RV 188,213,512
 XO 31,19,27
 PV 108,192,172
 s_not_b64 vcc, vcc
 RV 190,213,4608
 CV 190,156,157
 PV 112,196,172
 RV 192,213,520
 XE 16,24,16
 PV 80,196,168
 buffer_store_dwordx4 v[28:31], v221, s[24:27], s38 offen offset:128 nt
 EX 158
 PM 32,226,0
 PM 34,226,0
 PM 36,226,0
 PM 38,226,0
 PM 40,226,0
 PM 42,226,0
 PM 44,226,0
 PM 46,226,0
 PV 84,200,168
 RV 194,213,4616
 XE 17,25,17
 PV 116,200,172
 RV 196,213,1024
 XE 18,26,18
 PV 120,204,172
 RV 198,213,5120
 XE 19,27,19
 PV 88,204,168
 buffer_store_dwordx4 v[16:19], v220, s[24:27], s38 offen offset:128 nt
 PV 92,208,168
 RV 200,213,1032
 CV 32,32,33
 PV 124,208,172
 RV 202,213,5128
 CV 33,34,35
 QZ 136,212,32
 RV 204,213,1536
 CV 34,36,37
 QK 136,216,36
 RV 206,213,5632
 CV 35,38,39
 QK 136,220,40
 RV 208,213,1544
 CV 40,40,41
 QK 136,224,44
 RV 210,213,5640
 CV 41,42,43
 QZ 140,224,60
 EX 159
 QK 140,220,56
 CV 191,158,159
 CV 42,44,45
 QK 140,216,52
 CV 43,46,47
 XE 36,40,32
 QK 140,212,48
 XE 37,41,33
 XE 38,42,34
 QZ 152,228,32
 XE 39,43,35
 QK 152,232,36
 s_not_b64 vcc, vcc
 buffer_store_dwordx4 v[36:39], v220, s[24:27], s38 offen offset:256 nt
 XO 40,32,40
 PM 48,226,0
 PM 50,226,0
 PM 52,226,0
 PM 54,226,0
 PM 56,226,0
 PM 58,226,0
 PM 60,226,0
 PM 62,226,0
 PS 136
 PS 138
 PS 140
 PS 142
 QK 152,236,40
 XO 41,33,41
 XO 42,34,42
 QK 152,240,44
 XO 43,35,43
 CV 48,48,49
 QZ 156,240,60
 CV 49,50,51
 CV 50,52,53
 QK 156,236,56
 buffer_store_dwordx4 v[40:43], v221, s[24:27], s38 offen offset:256 nt
 QK 156,232,52
 CV 51,54,55
 CV 56,56,57
 QK 156,228,48
 EX 136
 SM 132,184
 CV 57,58,59
 PV 96,96,188
 CV 58,60,61
 CV 59,62,63
 PV 64,96,184
 RV 96,213,8192
 XO 60,48,56
 XO 61,49,57
 XO 62,50,58
 XO 63,51,59
 PS 152
 PS 154
 PS 156
 PS 158
 PV 68,100,184
 s_not_b64 vcc, vcc
 buffer_store_dwordx4 v[60:63], v221, s[24:27], s38 offen offset:384 nt
 PV 100,100,188
 RV 98,213,12288
 XE 48,56,48
 PV 104,104,188
 RV 100,213,8200
 XE 49,57,49
 PV 72,104,184
 RV 102,213,12296
 XE 50,58,50
 PV 76,108,184
 RV 104,213,8704
 XE 51,59,51
 PV 108,108,188
 RV 106,213,12800
 RV 108,213,8712
 PV 112,112,188
 EX 137
 PV 80,112,184
 buffer_store_dwordx4 v[48:51], v220, s[24:27], s38 offen offset:384 nt
 PV 84,116,184
 RV 110,213,12808
 CV 168,136,137
 PV 116,116,188
 RV 112,213,9216
 RV 114,213,13312
 PV 120,120,188
 RV 116,213,9224
 EX 138
 PV 88,120,184
 RV 118,213,13320
 EX 139
 PV 92,124,184
 RV 120,213,9728
 CV 169,138,139
 PV 124,124,188
 s_waitcnt lgkmcnt(15)
 RV 122,213,13824
 EX 152
 QZ 136,148,32
 s_waitcnt lgkmcnt(15)
 RV 124,213,9736
 RV 126,213,13832
 QK 136,152,36
 s_waitcnt lgkmcnt(15)
 EX 153
 QK 136,156,40
 s_waitcnt lgkmcnt(15)
 EX 154
 QK 136,160,44
 s_waitcnt lgkmcnt(15)
 EX 155
 CV 170,152,153
 CV 171,154,155
 v_mfma_f32_16x16x32_bf16 v[152:155], a[176:179], a[44:47], v[208:211]
 s_waitcnt lgkmcnt(15)
 EX 140
 QK 152,172,40
 s_waitcnt lgkmcnt(15)
 EX 141
 QK 152,168,36
 s_waitcnt lgkmcnt(15)
 EX 142
 CV 172,140,141
 EX 143
 PS 136
 PS 138
 QK 152,164,32
 EX 156
 CV 173,142,143
 QZ 140,148,48
 EX 157
 QK 140,152,52
 EX 158
 QK 140,156,56
 EX 159
 CV 174,156,157
 CV 175,158,159
 EX 136
 PS 152
 PS 154
 QK 140,160,60
 EX 137
 v_mfma_f32_16x16x32_bf16 v[156:159], a[176:179], a[60:63], v[208:211]
 EX 138
 QK 156,172,56
 EX 139
 QK 156,168,52
 CV 184,136,137
 CV 185,138,139
 EX 152
 EX 153
 PS 140
 PS 142
 QK 156,164,48
 EX 154
 LS 132,144,168
 s_waitcnt lgkmcnt(15)
 EX 155
 PV 64,180,168
 s_waitcnt lgkmcnt(15)
 CV 186,152,153
 CV 187,154,155
 PV 68,184,168
 s_waitcnt lgkmcnt(15)
 EX 140
 EX 141
 EX 142
 PS 156
 PS 158
 PV 72,188,168
 s_waitcnt lgkmcnt(15)
 EX 143
 PV 76,192,168
 s_waitcnt lgkmcnt(15)
 CV 188,140,141
 CV 189,142,143
 PV 80,196,168
 s_waitcnt lgkmcnt(15)
 EX 156
 PV 84,200,168
 s_waitcnt lgkmcnt(15)
 EX 157
 PV 88,204,168
 s_waitcnt lgkmcnt(15)
 EX 158
 PV 92,208,168
 EX 159
 LS 132,144,184
 s_waitcnt lgkmcnt(14)
 CV 190,156,157
 CV 191,158,159
 PV 64,96,184
 s_waitcnt lgkmcnt(12)
 PV 68,100,184
 s_waitcnt lgkmcnt(10)
 PV 72,104,184
 s_waitcnt lgkmcnt(8)
 PV 76,108,184
 s_waitcnt lgkmcnt(6)
 PV 80,112,184
 s_waitcnt lgkmcnt(4)
 PV 84,116,184
 v_accvgpr_read_b32 v229, a132
 v_accvgpr_read_b32 v228, a133
 v_add_f32 v229, v228, v229
 v_rcp_f32 v228, v229
 v_subrev_u32 v229, 0x21800000, v229
 PM 64,228,0
 PM 66,228,0
 PM 68,228,0
 PM 70,228,0
 PM 72,228,0
 PM 74,228,0
 PM 76,228,0
 PM 78,228,0
 v_max3_u32 v225, v225, v227, v229
 s_waitcnt lgkmcnt(2)
 PV 88,120,184
 s_waitcnt lgkmcnt(0)
 CV 64,64,65
 CV 65,66,67
 PV 92,124,184
 CV 66,68,69
 CV 67,70,71
 LS 132,136,172
 CV 72,72,73
 CV 73,74,75
 PV 96,180,172
 CV 74,76,77
 CV 75,78,79
 PV 100,184,172
 XE 68,72,64
 XE 69,73,65
 PV 104,188,172
 XE 70,74,66
 XE 71,75,67
 PV 108,192,172
 s_not_b64 vcc, vcc
 buffer_store_dwordx4 v[68:71], v220, s[24:27], s39 offen offset:0 nt
 XO 72,64,72
 PM 80,228,0
 PM 82,228,0
 PM 84,228,0
 PM 86,228,0
 PM 88,228,0
 PM 90,228,0
 PM 92,228,0
 PM 94,228,0
 PV 112,196,172
 XO 73,65,73
 XO 74,66,74
 PV 116,200,172
 XO 75,67,75
 CV 80,80,81
 PV 120,204,172
 CV 81,82,83
 CV 82,84,85
 PV 124,208,172
 CV 83,86,87
 CV 88,88,89
 LS 132,136,188
 buffer_store_dwordx4 v[72:75], v221, s[24:27], s39 offen offset:0 nt
 PV 96,96,188
 CV 89,90,91
 CV 90,92,93
 PV 100,100,188
 CV 91,94,95
 XO 92,80,88
 PV 104,104,188
 XO 93,81,89
 XO 94,82,90
 v_accvgpr_read_b32 v231, a134
 v_accvgpr_read_b32 v230, a135
 v_add_f32 v231, v230, v231
 v_rcp_f32 v230, v231
 v_subrev_u32 v231, 0x21800000, v231
 v_max_u32 v225, v225, v231
 v_cmp_le_u32 s[84:85], s77, v225
 PV 108,108,188
 XO 95,83,91
 PV 112,112,188
 s_not_b64 vcc, vcc
 buffer_store_dwordx4 v[92:95], v221, s[24:27], s39 offen offset:128 nt
 XE 80,88,80
 PM 96,230,0
 PM 98,230,0
 PM 100,230,0
 PM 102,230,0
 PM 104,230,0
 PM 106,230,0
 PM 108,230,0
 PM 110,230,0
 PV 116,116,188
 s_cmp_lg_u64 s[84:85], 0
 XE 81,89,81
 XE 82,90,82
 PV 120,120,188
 s_cselect_b32 s92, s76, 0
 XE 83,91,83
 CV 96,96,97
 PV 124,124,188
 s_or_b32 s73, s73, s92
 CV 97,98,99
 CV 98,100,101
 CV 99,102,103
 CV 104,104,105
 CV 105,106,107
 buffer_store_dwordx4 v[80:83], v220, s[24:27], s39 offen offset:128 nt
 CV 106,108,109
 CV 107,110,111
 XE 100,104,96
 XE 101,105,97
 XE 102,106,98
 XE 103,107,99
 s_not_b64 vcc, vcc
 XO 104,96,104
 XO 105,97,105
 XO 106,98,106
 XO 107,99,107
 v_mul_f32 v112, v230, v112
 v_mul_f32 v113, v230, v113
 v_mul_f32 v114, v230, v114
 v_mul_f32 v115, v230, v115
 v_mul_f32 v116, v230, v116
 v_mul_f32 v117, v230, v117
 v_mul_f32 v118, v230, v118
 v_mul_f32 v119, v230, v119
 CV 112,112,113
 CV 113,114,115
 CV 114,116,117
 CV 115,118,119
 v_mul_f32 v120, v230, v120
 buffer_store_dwordx4 v[100:103], v220, s[24:27], s39 offen offset:256 nt
 v_mul_f32 v121, v230, v121
 v_mul_f32 v122, v230, v122
 v_mul_f32 v123, v230, v123
 v_mul_f32 v124, v230, v124
 v_mul_f32 v125, v230, v125
 v_mul_f32 v126, v230, v126
 v_mul_f32 v127, v230, v127
 CV 120,120,121
 CV 121,122,123
 CV 122,124,125
 CV 123,126,127
 XO 124,112,120
 XO 125,113,121
 XO 126,114,122
 XO 127,115,123
 s_not_b64 vcc, vcc
 XE 112,120,112
 XE 113,121,113
 XE 114,122,114
 XE 115,123,115
 s_lshl_b32 s76, s76, 1
 buffer_store_dwordx4 v[104:107], v221, s[24:27], s39 offen offset:256 nt
 buffer_store_dwordx4 v[124:127], v221, s[24:27], s39 offen offset:384 nt
 buffer_store_dwordx4 v[112:115], v220, s[24:27], s39 offen offset:384 nt
 s_cmp_lg_u32 s73, 0
 s_cbranch_scc1 L_hop
 s_endpgm
.p2align 12
L_U1:
 QZ 128,64,0
 s_cmp_eq_u32 s33, 0x8000
 RV 96,213,8192
 v_add_u32 v251, L_U1-L_pc-8192, v244
 QK 128,68,4
 s_cselect_b32 s32, -2, 1
 RV 98,213,12288
 SC 156
 QK 128,72,8
 s_lshl_b32 s32, s32, 14
 RV 100,213,8200
 v_add_u32 v212, s32, v212
 QK 128,76,12
 s_add_u32 s31, s33, s37
 RV 102,213,12296
 SC 157
 QZ 132,76,28
 s_add_u32 s33, s33, s32
 RV 104,213,8704
 SC 158
 QK 132,72,24
 s_add_u32 s31, s33, s37
 RV 106,213,12800
 SC 159
 QK 132,68,20
 RV 108,213,8712
 SC 128
 QK 132,64,16
 RV 110,213,12808
 SC 129
 QZ 136,64,32
 RV 112,213,9216
 SC 130
 QK 136,68,36
 RV 114,213,13312
 SC 131
 QK 136,72,40
 RV 116,213,9224
 SC 132
 QK 136,76,44
 RV 118,213,13320
 SC 133
 QZ 140,76,60
 RV 120,213,9728
 SC 134
 QK 140,72,56
 RV 122,213,13824
 SC 135
 QK 140,68,52
 RV 124,213,9736
 SC 136
 QK 140,64,48
 RV 126,213,13832
 v_add_u32 v213, s32, v213
 v_mfma_f32_16x16x32_bf16 v[144:147], a[80:83], a[0:3], v[208:211]
 s_cmp_eq_u32 s33, 0x8000
 global_load_dword v255, v251, s[64:65]
 SC 137
 QK 144,84,4
 s_cselect_b32 s32, -2, 1
 EX 156
 QK 144,88,8
 s_lshl_b32 s32, s32, 14
 EX 157
 QK 144,92,12
 s_add_u32 s33, s33, s32
 CV 190,156,157
 SC 138
 v_mfma_f32_16x16x32_bf16 v[148:151], a[92:95], a[28:31], v[208:211]
 EX 158
 QK 148,88,24
 EX 159
 QK 148,84,20
 CV 191,158,159
 SC 144
 QK 148,80,16
 EX 128
 QZ 152,80,32
 s_waitcnt vmcnt(9) lgkmcnt(0)
 EX 129
 QK 152,84,36
 s_barrier
 QK 152,88,40
 RK 148,212,0
 CV 160,128,129
 QK 152,92,44
 RK 152,212,512
 SC 145
 QZ 156,92,60
 RK 156,212,1024
 SC 146
 QK 156,88,56
 RK 160,212,1536
 SC 147
 QK 156,84,52
 RK 164,212,4096
 SC 148
 QK 156,80,48
 RK 168,212,4608
 SC 149
 SM 128,176
 RK 172,212,5120
 SC 150
 SM 132,184
 RK 176,212,5632
 SC 151
 EX 130
 EX 131
 PS 152
 PS 154
 PS 156
 PS 158
 PV 96,96,188
 RV 180,213,0
 CV 161,130,131
 PV 64,96,184
 RV 182,213,4096
 SC 139
 PV 32,96,180
 RV 184,213,8
 SC 140
 PV 0,96,176
 RV 186,213,4104
 SC 141
 PV 4,100,176
 RV 188,213,512
 SC 142
 PV 36,100,180
 RV 190,213,4608
 SC 143
 PV 68,100,184
 RV 192,213,520
 RV 194,213,4616
 PV 100,100,188
 RV 196,213,1024
 EX 132
 PV 104,104,188
 RV 198,213,5120
 EX 133
 PV 72,104,184
 RV 200,213,1032
 CV 164,132,133
 PV 40,104,180
 RV 202,213,5128
 EX 134
 PV 8,104,176
 RV 204,213,1536
 RV 206,213,5632
 PV 12,108,176
 EX 135
 PV 44,108,180
 RV 208,213,1544
 CV 165,134,135
 PV 76,108,184
 RV 210,213,5640
 RK 212,212,8192
 PV 108,108,188
 EX 144
 PV 112,112,188
 RK 216,212,8704
 RK 220,212,9216
 PV 80,112,184
 EX 145
 PV 48,112,180
 RK 224,212,9728
 CV 162,144,145
 PV 16,112,176
 RK 228,212,12288
 RK 232,212,12800
 PV 20,116,176
 EX 146
 PV 52,116,180
 RK 236,212,13312
 RK 240,212,13824
 PV 84,116,184
 EX 147
 PV 116,116,188
 RV 96,213,8192
 CV 163,146,147
 PV 120,120,188
 RV 98,213,12288
 v_add_u32 v212, s32, v212
 PV 88,120,184
 RV 100,213,8200
 RV 102,213,12296
 PV 56,120,180
 EX 148
 PV 24,120,176
 RV 104,213,8704
 RV 106,213,12800
 PV 28,124,176
 EX 149
 PV 60,124,180
 RV 108,213,8712
 CV 166,148,149
 PV 92,124,184
 RV 110,213,12808
 RV 112,213,9216
 PV 124,124,188
 EX 150
 RV 114,213,13312
 RV 116,213,9224
 EX 151
 EX 136
 RV 118,213,13320
 RV 120,213,9728
 CV 167,150,151
 EX 137
 RV 122,213,13824
 SM 128,160
 s_waitcnt lgkmcnt(15)
 RV 124,213,9736
 CV 168,136,137
 PV 32,180,164
 RV 126,213,13832
 v_add_u32 v213, s32, v213
 PV 0,180,160
 s_waitcnt lgkmcnt(15)
 EX 138
 PV 4,184,160
 EX 139
 PV 36,184,164
 s_waitcnt lgkmcnt(15)
 EX 140
 PV 40,188,164
 CV 169,138,139
 v_accvgpr_read_b32 v225, a128
 v_accvgpr_read_b32 v224, a129
 v_add_f32 v225, v224, v225
 v_rcp_f32 v224, v225
 v_subrev_u32 v225, 0x21800000, v225
 PM 0,224,0
 PM 2,224,0
 PM 4,224,0
 PM 6,224,0
 v_accvgpr_read_b32 v227, a130
 v_accvgpr_read_b32 v226, a131
 v_add_f32 v227, v226, v227
 v_rcp_f32 v226, v227
 v_subrev_u32 v227, 0x21800000, v227
 PV 8,188,160
 s_waitcnt vmcnt(1) lgkmcnt(0)
 EX 141
 PV 12,192,160
 s_barrier
 PV 44,192,164
 CV 172,140,141
 CV 0,0,1
 PV 48,196,164
 EX 142
 EX 143
 EX 152
 PM 8,224,0
 PM 10,224,0
 PM 12,224,0
 PM 14,224,0
 PV 16,196,160
 CV 173,142,143
 CV 1,2,3
 PV 20,200,160
 EX 153
 PV 52,200,164
 CV 170,152,153
 CV 2,4,5
 PV 56,204,164
 EX 154
 PV 24,204,160
 EX 155
 PV 28,208,160
 CV 171,154,155
 CV 3,6,7
 PV 60,208,164
 EX 156
 QZ 136,148,32
 EX 157
 QK 136,152,36
 CV 174,156,157
 CV 8,8,9
 QK 136,156,40
 EX 158
 QK 136,160,44
 EX 159
 QZ 140,160,60
 RK 160,212,1536
 CV 175,158,159
 QK 140,156,56
 RK 156,212,1024
 CV 9,10,11
 QK 140,152,52
 RK 152,212,512
 CV 10,12,13
 QK 140,148,48
 RK 148,212,0
 CV 11,14,15
 QZ 152,164,32
 XE 4,8,0
 XE 5,9,1
 QK 152,168,36
 XE 6,10,2
 XE 7,11,3
 QK 152,172,40
 s_not_b64 vcc, vcc
 buffer_store_dwordx4 v[4:7], v220, s[24:27], s38 offen offset:0 nt
 XO 8,0,8
 PM 16,224,0
 PM 18,224,0
 PM 20,224,0
 PM 22,224,0
 PM 24,224,0
 PM 26,224,0
 PM 28,224,0
 PM 30,224,0
 QK 152,176,44
 XO 9,1,9
 XO 10,2,10
 QZ 156,176,60
 XO 11,3,11
 SC 136
 QK 156,172,56
 SC 137
 SC 138
 QK 156,168,52
 EX 136
 QK 156,164,48
 buffer_store_dwordx4 v[8:11], v221, s[24:27], s38 offen offset:0 nt
 SM 132,168
 SC 139
 PV 96,180,172
 EX 137
 PV 64,180,168
 RV 180,213,0
 CV 184,136,137
 EX 138
 EX 139
 PS 156
 PS 158
 PV 68,184,168
 RV 182,213,4096
 CV 185,138,139
 PV 100,184,172
 RV 184,213,8
 SC 140
 PV 104,188,172
 RV 186,213,4104
 SC 141
 PV 72,188,168
 RV 188,213,512
 SC 142
 PV 76,192,168
 RV 190,213,4608
 SC 143
 PV 108,192,172
 RV 192,213,520
 CV 16,16,17
 PV 112,196,172
 RV 194,213,4616
 CV 17,18,19
 PV 80,196,168
 RV 196,213,1024
 CV 18,20,21
 PV 84,200,168
 RV 198,213,5120
 CV 19,22,23
 PV 116,200,172
 RV 200,213,1032
 CV 24,24,25
 PV 120,204,172
 RV 202,213,5128
 CV 25,26,27
 PV 88,204,168
 RV 204,213,1536
 CV 26,28,29
 PV 92,208,168
 RV 206,213,5632
 CV 27,30,31
 PV 124,208,172
 RV 208,213,1544
 XO 28,16,24
 QZ 136,212,32
 RV 210,213,5640
 XO 29,17,25
 QK 136,216,36
 EX 140
 QK 136,220,40
 EX 141
 QK 136,224,44
 CV 188,140,141
 XO 30,18,26
 EX 142
 EX 143
 XO 31,19,27
 CV 189,142,143
 QZ 140,224,60
 s_not_b64 vcc, vcc
 buffer_store_dwordx4 v[28:31], v221, s[24:27], s38 offen offset:128 nt
 SC 152
 PM 32,226,0
 PM 34,226,0
 PM 36,226,0
 PM 38,226,0
 PM 40,226,0
 PM 42,226,0
 PM 44,226,0
 PM 46,226,0
 QK 140,220,56
 SC 153
 SC 154
 QK 140,216,52
 EX 152
 QK 140,212,48
 EX 153
 SC 155
 CV 186,152,153
 EX 154
 EX 155
 XE 16,24,16
 CV 187,154,155
 QZ 152,228,32
 XE 17,25,17
 XE 18,26,18
 QK 152,232,36
 XE 19,27,19
 CV 32,32,33
 QK 152,236,40
 buffer_store_dwordx4 v[16:19], v220, s[24:27], s38 offen offset:128 nt
 QK 152,240,44
 EX 156
 EX 157
 EX 158
 CV 190,156,157
 EX 159
 CV 33,34,35
 CV 191,158,159
 QZ 156,240,60
 CV 34,36,37
 CV 35,38,39
 QK 156,236,56
 CV 40,40,41
 CV 41,42,43
 QK 156,232,52
 CV 42,44,45
 CV 43,46,47
 QK 156,228,48
 XE 36,40,32
 XE 37,41,33
 SM 132,184
 XE 38,42,34
 PV 96,96,188
 XE 39,43,35
 SC 136
 PV 64,96,184
 s_not_b64 vcc, vcc
 buffer_store_dwordx4 v[36:39], v220, s[24:27], s38 offen offset:256 nt
 XO 40,32,40
 PM 48,226,0
 PM 50,226,0
 PM 52,226,0
 PM 54,226,0
 PM 56,226,0
 PM 58,226,0
 PM 60,226,0
 PM 62,226,0
 PS 156
 PS 158
 PV 68,100,184
 RV 96,213,8192
 XO 41,33,41
 PV 100,100,188
 RV 100,213,8200
 XO 42,34,42
 PV 104,104,188
 XO 43,35,43
 CV 48,48,49
 PV 72,104,184
 buffer_store_dwordx4 v[40:43], v221, s[24:27], s38 offen offset:256 nt
 PV 76,108,184
 RV 104,213,8704
 CV 49,50,51
 PV 108,108,188
 RV 108,213,8712
 CV 50,52,53
 PV 112,112,188
 CV 51,54,55
 CV 56,56,57
 PV 80,112,184
 RV 112,213,9216
 CV 57,58,59
 PV 84,116,184
 CV 58,60,61
 CV 59,62,63
 PV 116,116,188
 RV 116,213,9224
 XO 60,48,56
 PV 120,120,188
 XO 61,49,57
 XO 62,50,58
 PV 88,120,184
 RV 120,213,9728
 XO 63,51,59
 PV 92,124,184
 s_not_b64 vcc, vcc
 buffer_store_dwordx4 v[60:63], v221, s[24:27], s38 offen offset:384 nt
 PV 124,124,188
 RV 124,213,9736
 XE 48,56,48
 XE 49,57,49
 XE 50,58,50
 XE 51,59,51
 SC 137
 EX 136
 EX 137
 SC 138
 CV 168,136,137
 SC 139
 EX 138
 EX 139
 SC 152
 CV 169,138,139
 s_waitcnt lgkmcnt(15)
 v_mfma_f32_16x16x32_bf16 v[136:139], a[148:151], a[32:35], v[208:211]
 SC 153
 SC 154
 QK 136,152,36
 buffer_store_dwordx4 v[48:51], v220, s[24:27], s38 offen offset:384 nt
 QK 136,156,40
 EX 152
 QK 136,160,44
 EX 153
 SC 155
 CV 170,152,153
 EX 154
 EX 155
 SC 140
 CV 171,154,155
 SC 141
 EX 140
 LS 132,144,168
 s_waitcnt lgkmcnt(15)
 EX 141
 PV 64,180,168
 s_waitcnt lgkmcnt(15)
 CV 172,140,141
 SC 142
 PV 68,184,168
 s_waitcnt lgkmcnt(15)
 SC 143
 SC 136
 PV 72,188,168
 s_waitcnt lgkmcnt(15)
 EX 142
 PV 76,192,168
 s_waitcnt lgkmcnt(14)
 EX 143
 PV 80,196,168
 s_waitcnt lgkmcnt(12)
 CV 173,142,143
 SC 137
 PV 84,200,168
 s_waitcnt lgkmcnt(10)
 EX 136
 PV 88,204,168
 s_waitcnt lgkmcnt(8)
 EX 137
 PV 92,208,168
 CV 184,136,137
 SC 138
 v_mfma_f32_16x16x32_bf16 v[140:143], a[148:151], a[48:51], v[208:211]
 EX 138
 QK 140,152,52
 EX 156
 QK 140,156,56
 EX 157
 QK 140,160,60
 SC 139
 CV 174,156,157
 EX 139
 EX 158
 CV 185,138,139
 EX 159
 s_nop 0
 v_mfma_f32_16x16x16_bf16 a[132:135], a[144:145], v[184:185], a[132:135]
 s_waitcnt lgkmcnt(7)
 CV 175,158,159
 SC 140
 SC 141
 PH 64,96,184
 s_waitcnt lgkmcnt(6)
 EX 140
 SC 142
 PH 68,100,184
 EX 141
 v_accvgpr_read_b32 v229, a132
 v_accvgpr_read_b32 v228, a133
 v_add_f32 v229, v228, v229
 v_rcp_f32 v228, v229
 v_subrev_u32 v229, 0x21800000, v229
 PM 64,228,0
 PM 66,228,0
 PM 68,228,0
 PM 70,228,0
 v_max3_u32 v225, v225, v227, v229
 s_waitcnt lgkmcnt(5)
 PH 72,104,184
 s_waitcnt lgkmcnt(4)
 CV 64,64,65
 CV 65,66,67
 CV 66,68,69
 PH 76,108,184
 s_waitcnt lgkmcnt(3)
 CV 67,70,71
 CV 188,140,141
 SC 143
 PH 80,112,184
 EX 142
 EX 143
 PM 72,228,0
 PM 74,228,0
 PM 76,228,0
 PM 78,228,0
 s_waitcnt lgkmcnt(2)
 PH 84,116,184
 s_waitcnt lgkmcnt(1)
 CV 72,72,73
 CV 73,74,75
 CV 74,76,77
 PH 88,120,184
 s_waitcnt lgkmcnt(0)
 CV 75,78,79
 XE 68,72,64
 XE 69,73,65
 PH 92,124,184
 XE 70,74,66
 XE 71,75,67
 CV 189,142,143
 LS 132,136,172
 s_not_b64 vcc, vcc
 buffer_store_dwordx4 v[68:71], v220, s[24:27], s39 offen offset:0 nt
 XO 72,64,72
 PM 80,228,0
 PM 82,228,0
 PM 84,228,0
 PM 86,228,0
 PM 88,228,0
 PM 90,228,0
 PM 92,228,0
 PM 94,228,0
 PV 96,180,172
 XO 73,65,73
 XO 74,66,74
 PV 100,184,172
 XO 75,67,75
 CV 80,80,81
 PV 104,188,172
 CV 81,82,83
 CV 82,84,85
 PV 108,192,172
 CV 83,86,87
 CV 88,88,89
 PV 112,196,172
 buffer_store_dwordx4 v[72:75], v221, s[24:27], s39 offen offset:0 nt
 PV 116,200,172
 CV 89,90,91
 CV 90,92,93
 PV 120,204,172
 CV 91,94,95
 XO 92,80,88
 PV 124,208,172
 XO 93,81,89
 XO 94,82,90
 v_mfma_f32_16x16x16_bf16 a[132:135], a[136:137], v[188:189], a[132:135]
 XO 95,83,91
 PH 96,96,188
 s_not_b64 vcc, vcc
 XE 80,88,80
 XE 81,89,81
 PH 100,100,188
 XE 82,90,82
 XE 83,91,83
 v_accvgpr_read_b32 v231, a134
 v_accvgpr_read_b32 v230, a135
 v_add_f32 v231, v230, v231
 v_rcp_f32 v230, v231
 v_subrev_u32 v231, 0x21800000, v231
 v_max_u32 v225, v225, v231
 v_cmp_le_u32 s[84:85], s77, v225
 PH 104,104,188
 buffer_store_dwordx4 v[92:95], v221, s[24:27], s39 offen offset:128 nt
 PM 96,230,0
 PM 98,230,0
 PM 100,230,0
 PM 102,230,0
 PH 108,108,188
 CV 96,96,97
 CV 97,98,99
 CV 98,100,101
 CV 99,102,103
 PM 104,230,0
 PM 106,230,0
 PH 112,112,188
 CV 104,104,105
 CV 105,106,107
 PM 108,230,0
 PM 110,230,0
 PH 116,116,188
 buffer_store_dwordx4 v[80:83], v220, s[24:27], s39 offen offset:128 nt
 PH 120,120,188
 s_cmp_lg_u64 s[84:85], 0
 CV 106,108,109
 CV 107,110,111
 PH 124,124,188
 s_cselect_b32 s92, s76, 0
 XE 100,104,96
 XE 101,105,97
 XE 102,106,98
 XE 103,107,99
 s_not_b64 vcc, vcc
 XO 104,96,104
 XO 105,97,105
 XO 106,98,106
 XO 107,99,107
 s_or_b32 s73, s73, s92
 s_lshl_b32 s76, s76, 1
 buffer_store_dwordx4 v[100:103], v220, s[24:27], s39 offen offset:256 nt
 PM 112,230,0
 PM 114,230,0
 PM 116,230,0
 PM 118,230,0
 CV 112,112,113
 CV 113,114,115
 CV 114,116,117
 CV 115,118,119
 PM 120,230,0
 PM 122,230,0
 PM 124,230,0
 PM 126,230,0
 CV 120,120,121
 CV 121,122,123
 CV 122,124,125
 CV 123,126,127
 XO 124,112,120
 XO 125,113,121
 XO 126,114,122
 XO 127,115,123
 s_not_b64 vcc, vcc
 XE 112,120,112
 XE 113,121,113
 XE 114,122,114
 XE 115,123,115
 buffer_store_dwordx4 v[104:107], v221, s[24:27], s39 offen offset:256 nt
 buffer_store_dwordx4 v[124:127], v221, s[24:27], s39 offen offset:384 nt
 buffer_store_dwordx4 v[112:115], v220, s[24:27], s39 offen offset:384 nt
 s_cmp_lg_u32 s73, 0
 s_cbranch_scc1 L_hop
 s_endpgm
.p2align 12
L_U2:
 QZ 128,64,0
 s_cmp_eq_u32 s33, 0x8000
 RV 96,213,8192
 v_add_u32 v251, L_U2-L_pc-16384, v244
 QK 128,68,4
 s_cselect_b32 s32, -2, 1
 RV 98,213,12288
 SC 156
 QK 128,72,8
 s_lshl_b32 s32, s32, 14
 RV 100,213,8200
 v_add_u32 v212, s32, v212
 QK 128,76,12
 s_add_u32 s31, s33, s37
 RV 102,213,12296
 SC 157
 QZ 132,76,28
 s_add_u32 s33, s33, s32
 RV 104,213,8704
 SC 158
 QK 132,72,24
 s_add_u32 s31, s33, s37
 RV 106,213,12800
 SC 159
 QK 132,68,20
 RV 108,213,8712
 SC 128
 QK 132,64,16
 RV 110,213,12808
 SC 129
 QZ 136,64,32
 RV 112,213,9216
 SC 130
 QK 136,68,36
 RV 114,213,13312
 SC 131
 QK 136,72,40
 RV 116,213,9224
 SC 132
 QK 136,76,44
 RV 118,213,13320
 SC 133
 QZ 140,76,60
 RV 120,213,9728
 SC 134
 QK 140,72,56
 RV 122,213,13824
 SC 135
 QK 140,68,52
 RV 124,213,9736
 SC 136
 QK 140,64,48
 RV 126,213,13832
 v_add_u32 v213, s32, v213
 QZ 144,80,0
 s_cmp_eq_u32 s33, 0x8000
 global_load_dword v255, v251, s[64:65]
 SC 137
 QK 144,84,4
 s_cselect_b32 s32, -2, 1
 EX 156
 QK 144,88,8
 s_lshl_b32 s32, s32, 14
 EX 157
 QK 144,92,12
 s_add_u32 s33, s33, s32
 CV 190,156,157
 SC 138
 QZ 148,92,28
 EX 158
 QK 148,88,24
 EX 159
 QK 148,84,20
 CV 191,158,159
 SC 139
 QK 148,80,16
 EX 128
 QZ 152,80,32
 s_waitcnt vmcnt(9) lgkmcnt(0)
 EX 129
 QK 152,84,36
 s_barrier
 QK 152,88,40
 RK 148,212,0
 CV 160,128,129
 QK 152,92,44
 RK 152,212,512
 SC 140
 QZ 156,92,60
 RK 156,212,1024
 SC 141
 QK 156,88,56
 RK 160,212,1536
 SC 142
 QK 156,84,52
 RK 164,212,4096
 SC 143
 QK 156,80,48
 RK 168,212,4608
 SC 152
 SM 128,176
 RK 172,212,5120
 SC 153
 SM 132,184
 RK 176,212,5632
 SC 154
 PV 96,96,188
 RV 180,213,0
 SC 155
 PV 64,96,184
 RV 182,213,4096
 SC 156
 PV 32,96,180
 RV 184,213,8
 SC 157
 PV 0,96,176
 RV 186,213,4104
 SC 158
 PV 4,100,176
 RV 188,213,512
 SC 159
 PV 36,100,180
 RV 190,213,4608
 SC 144
 PV 68,100,184
 RV 192,213,520
 SC 145
 PV 100,100,188
 RV 194,213,4616
 SC 146
 PV 104,104,188
 RV 196,213,1024
 SC 147
 PV 72,104,184
 RV 198,213,5120
 SC 148
 PV 40,104,180
 RV 200,213,1032
 SC 149
 PV 8,104,176
 RV 202,213,5128
 SC 150
 PV 12,108,176
 RV 204,213,1536
 SC 151
 PV 44,108,180
 RV 206,213,5632
 RV 208,213,1544
 PV 76,108,184
 RV 210,213,5640
 EX 130
 PV 108,108,188
 RK 212,212,8192
 EX 131
 PV 112,112,188
 RK 216,212,8704
 CV 161,130,131
 PV 80,112,184
 RK 220,212,9216
 EX 132
 PV 48,112,180
 RK 224,212,9728
 RK 228,212,12288
 PV 16,112,176
 EX 133
 PV 20,116,176
 RK 232,212,12800
 CV 164,132,133
 PV 52,116,180
 RK 236,212,13312
 RK 240,212,13824
 PV 84,116,184
 EX 134
 PV 116,116,188
 RV 96,213,8192
 v_add_u32 v212, s32, v212
 PV 120,120,188
 RV 98,213,12288
 RV 100,213,8200
 PV 88,120,184
 EX 135
 PV 56,120,180
 RV 102,213,12296
 CV 165,134,135
 PV 24,120,176
 RV 104,213,8704
 RV 106,213,12800
 PV 28,124,176
 EX 136
 PV 60,124,180
 RV 108,213,8712
 RV 110,213,12808
 PV 92,124,184
 EX 137
 PV 124,124,188
 s_waitcnt lgkmcnt(15)
 RV 112,213,9216
 CV 168,136,137
 v_mfma_f32_16x16x32_bf16 v[128:131], a[148:151], a[0:3], v[208:211]
 s_waitcnt lgkmcnt(15)
 RV 114,213,13312
 RV 116,213,9224
 QK 128,152,4
 s_waitcnt lgkmcnt(15)
 EX 138
 QK 128,156,8
 s_waitcnt lgkmcnt(15)
 RV 118,213,13320
 RV 120,213,9728
 QK 128,160,12
 EX 139
 v_mfma_f32_16x16x32_bf16 v[132:135], a[160:163], a[28:31], v[208:211]
 RV 122,213,13824
 CV 169,138,139
 QK 132,156,24
 RV 124,213,9736
 RV 126,213,13832
 QK 132,152,20
 EX 140
 QK 132,148,16
 EX 141
 QZ 136,148,32
 CV 172,140,141
 v_add_u32 v213, s32, v213
 QK 136,152,36
 EX 142
 QK 136,156,40
 EX 143
 EX 152
 CV 173,142,143
 PS 128
 PS 130
 PS 132
 PS 134
 QK 136,160,44
 EX 153
 QZ 140,160,60
 EX 154
 QK 140,156,56
 EX 155
 QK 140,152,52
 CV 170,152,153
 CV 171,154,155
 QK 140,148,48
 s_waitcnt vmcnt(1) lgkmcnt(0)
 EX 156
 QZ 152,164,32
 s_barrier
 QK 152,168,36
 EX 157
 QK 152,172,40
 EX 158
 QK 152,176,44
 EX 159
 CV 174,156,157
 CV 175,158,159
 QZ 156,176,60
 EX 144
 QK 156,172,56
 EX 145
 QK 156,168,52
 EX 146
 QK 156,164,48
 EX 147
 CV 162,144,145
 CV 163,146,147
 EX 148
 EX 149
 EX 150
 CV 166,148,149
 EX 151
 EX 128
 CV 167,150,151
 EX 129
 EX 130
 SM 128,160
 CV 176,128,129
 EX 131
 EX 132
 PS 136
 PS 138
 PS 140
 PS 142
 PS 152
 PS 154
 PS 156
 PS 158
 PV 32,180,164
 EX 133
 PV 0,180,160
 CV 177,130,131
 CV 180,132,133
 PV 4,184,160
 EX 134
 PV 36,184,164
 EX 135
 PV 40,188,164
 EX 136
 PV 8,188,160
 EX 137
 PV 12,192,160
 CV 181,134,135
 CV 184,136,137
 PV 44,192,164
 EX 138
 PV 48,196,164
 EX 139
 PV 16,196,160
 EX 152
 PV 20,200,160
 EX 153
 PV 52,200,164
 CV 185,138,139
 CV 186,152,153
 PV 56,204,164
 EX 154
 PV 24,204,160
 EX 155
 PV 28,208,160
 EX 140
 PV 60,208,164
 EX 141
 v_mfma_f32_16x16x16_bf16 a[128:131], a[144:145], v[176:177], a[128:131]
 CV 187,154,155
 EX 142
 PH 0,96,176
 EX 143
 CV 188,140,141
 PH 4,100,176
 EX 156
 CV 189,142,143
 v_accvgpr_read_b32 v225, a128
 v_accvgpr_read_b32 v224, a129
 v_add_f32 v225, v224, v225
 v_rcp_f32 v224, v225
 v_subrev_u32 v225, 0x21800000, v225
 PM 0,224,0
 PM 2,224,0
 PM 4,224,0
 PM 6,224,0
 PH 8,104,176
 EX 157
 CV 0,0,1
 PH 12,108,176
 CV 1,2,3
 CV 2,4,5
 CV 3,6,7
 PH 16,112,176
 EX 158
 CV 190,156,157
 EX 159
 PM 8,224,0
 PM 10,224,0
 PM 12,224,0
 PM 14,224,0
 PH 20,116,176
 CV 8,8,9
 CV 9,10,11
 CV 10,12,13
 PH 24,120,176
 CV 11,14,15
 XE 4,8,0
 XE 5,9,1
 PH 28,124,176
 XE 6,10,2
 XE 7,11,3
 CV 191,158,159
 v_mfma_f32_16x16x16_bf16 a[128:131], a[136:137], v[180:181], a[128:131]
 s_not_b64 vcc, vcc
 buffer_store_dwordx4 v[4:7], v220, s[24:27], s38 offen offset:0 nt
 XO 8,0,8
 PM 16,224,0
 PM 18,224,0
 PM 20,224,0
 PM 22,224,0
 PM 24,224,0
 PM 26,224,0
 PM 28,224,0
 PM 30,224,0
 v_accvgpr_read_b32 v227, a130
 v_accvgpr_read_b32 v226, a131
 v_add_f32 v227, v226, v227
 v_rcp_f32 v226, v227
 v_subrev_u32 v227, 0x21800000, v227
 PH 32,96,180
 XO 9,1,9
 XO 10,2,10
 XO 11,3,11
 PH 36,100,180
 CV 16,16,17
 CV 17,18,19
 CV 18,20,21
 PH 40,104,180
 buffer_store_dwordx4 v[8:11], v221, s[24:27], s38 offen offset:0 nt
 PH 44,108,180
 CV 19,22,23
 CV 24,24,25
 CV 25,26,27
 PH 48,112,180
 CV 26,28,29
 CV 27,30,31
 XO 28,16,24
 PH 52,116,180
 XO 29,17,25
 XO 30,18,26
 XO 31,19,27
 PH 56,120,180
 s_not_b64 vcc, vcc
 XE 16,24,16
 XE 17,25,17
 PH 60,124,180
 XE 18,26,18
 XE 19,27,19
 SM 132,168
 PV 96,180,172
 buffer_store_dwordx4 v[28:31], v221, s[24:27], s38 offen offset:128 nt
 PM 32,226,0
 PM 34,226,0
 PM 36,226,0
 PM 38,226,0
 PM 40,226,0
 PM 42,226,0
 PM 44,226,0
 PM 46,226,0
 PV 64,180,168
 RV 180,213,0
 CV 32,32,33
 PV 68,184,168
 RV 182,213,4096
 CV 33,34,35
 PV 100,184,172
 RV 184,213,8
 CV 34,36,37
 PV 104,188,172
 RV 186,213,4104
 CV 35,38,39
 PV 72,188,168
 buffer_store_dwordx4 v[16:19], v220, s[24:27], s38 offen offset:128 nt
 PV 76,192,168
 RV 188,213,512
 CV 40,40,41
 PV 108,192,172
 RV 190,213,4608
 CV 41,42,43
 PV 112,196,172
 RV 192,213,520
 CV 42,44,45
 PV 80,196,168
 RV 194,213,4616
 CV 43,46,47
 PV 84,200,168
 RV 196,213,1024
 XE 36,40,32
 PV 116,200,172
 RV 198,213,5120
 XE 37,41,33
 PV 120,204,172
 RV 200,213,1032
 XE 38,42,34
 PV 88,204,168
 RV 202,213,5128
 XE 39,43,35
 PV 92,208,168
 s_not_b64 vcc, vcc
 buffer_store_dwordx4 v[36:39], v220, s[24:27], s38 offen offset:256 nt
 XO 40,32,40
 PM 48,226,0
 PM 50,226,0
 PM 52,226,0
 PM 54,226,0
 PM 56,226,0
 PM 58,226,0
 PM 60,226,0
 PM 62,226,0
 PV 124,208,172
 RV 204,213,1536
 XO 41,33,41
 QZ 136,212,32
 RV 206,213,5632
 XO 42,34,42
 QK 136,216,36
 RV 208,213,1544
 XO 43,35,43
 QK 136,220,40
 RV 210,213,5640
 CV 48,48,49
 QK 136,224,44
 buffer_store_dwordx4 v[40:43], v221, s[24:27], s38 offen offset:256 nt
 v_mfma_f32_16x16x32_bf16 v[152:155], a[240:243], a[44:47], v[208:211]
 CV 49,50,51
 CV 50,52,53
 QK 152,236,40
 CV 51,54,55
 CV 56,56,57
 QK 152,232,36
 CV 57,58,59
 CV 58,60,61
 QK 152,228,32
 CV 59,62,63
 XO 60,48,56
 QZ 140,212,48
 XO 61,49,57
 XO 62,50,58
 QK 140,216,52
 XO 63,51,59
 QK 140,220,56
 s_not_b64 vcc, vcc
 buffer_store_dwordx4 v[60:63], v221, s[24:27], s38 offen offset:384 nt
 XE 48,56,48
 PS 136
 PS 138
 PS 152
 PS 154
 QK 140,224,60
 XE 49,57,49
 XE 50,58,50
 v_mfma_f32_16x16x32_bf16 v[156:159], a[240:243], a[60:63], v[208:211]
 EX 136
 QK 156,236,56
 EX 137
 QK 156,232,52
 XE 51,59,51
 CV 168,136,137
 QK 156,228,48
 EX 138
 LS 132,144,184
 buffer_store_dwordx4 v[48:51], v220, s[24:27], s38 offen offset:384 nt
 PV 64,96,184
 EX 139
 PV 68,100,184
 EX 152
 PV 72,104,184
 EX 153
 CV 169,138,139
 CV 170,152,153
 EX 154
 PS 140
 PS 142
 PS 156
 PS 158
 PV 76,108,184
 EX 155
 PV 80,112,184
 EX 140
 PV 84,116,184
 EX 141
 PV 88,120,184
 CV 171,154,155
 CV 172,140,141
 PV 92,124,184
 EX 142
 LS 132,144,168
 s_waitcnt lgkmcnt(14)
 EX 143
 PV 64,180,168
 s_waitcnt lgkmcnt(12)
 EX 156
 PV 68,184,168
 s_waitcnt lgkmcnt(10)
 EX 157
 PV 72,188,168
 CV 173,142,143
 CV 174,156,157
 v_accvgpr_read_b32 v229, a132
 v_accvgpr_read_b32 v228, a133
 v_add_f32 v229, v228, v229
 v_rcp_f32 v228, v229
 v_subrev_u32 v229, 0x21800000, v229
 PM 64,228,0
 PM 66,228,0
 PM 68,228,0
 PM 70,228,0
 PM 72,228,0
 PM 74,228,0
 v_max3_u32 v225, v225, v227, v229
 s_waitcnt lgkmcnt(8)
 PV 76,192,168
 s_waitcnt lgkmcnt(6)
 CV 64,64,65
 CV 65,66,67
 PV 80,196,168
 s_waitcnt lgkmcnt(4)
 CV 66,68,69
 CV 67,70,71
 PV 84,200,168
 s_waitcnt lgkmcnt(2)
 EX 158
 PV 88,204,168
 EX 159
 CV 72,72,73
 CV 73,74,75
 CV 175,158,159
 PM 76,228,0
 PM 78,228,0
 s_waitcnt lgkmcnt(0)
 PV 92,208,168
 CV 74,76,77
 CV 75,78,79
 LS 132,136,188
 XE 68,72,64
 XE 69,73,65
 PV 96,96,188
 XE 70,74,66
 XE 71,75,67
 PV 100,100,188
 s_not_b64 vcc, vcc
 buffer_store_dwordx4 v[68:71], v220, s[24:27], s39 offen offset:0 nt
 XO 72,64,72
 PM 80,228,0
 PM 82,228,0
 PM 84,228,0
 PM 86,228,0
 PM 88,228,0
 PM 90,228,0
 PM 92,228,0
 PM 94,228,0
 PV 104,104,188
 XO 73,65,73
 XO 74,66,74
 PV 108,108,188
 XO 75,67,75
 CV 80,80,81
 PV 112,112,188
 CV 81,82,83
 CV 82,84,85
 PV 116,116,188
 CV 83,86,87
 CV 88,88,89
 PV 120,120,188
 buffer_store_dwordx4 v[72:75], v221, s[24:27], s39 offen offset:0 nt
 PV 124,124,188
 CV 89,90,91
 CV 90,92,93
 LS 132,136,172
 CV 91,94,95
 XO 92,80,88
 PV 96,180,172
 XO 93,81,89
 XO 94,82,90
 PV 100,184,172
 XO 95,83,91
 PV 104,188,172
 s_not_b64 vcc, vcc
 XE 80,88,80
 XE 81,89,81
 v_accvgpr_read_b32 v231, a134
 v_accvgpr_read_b32 v230, a135
 v_add_f32 v231, v230, v231
 v_rcp_f32 v230, v231
 v_subrev_u32 v231, 0x21800000, v231
 v_max_u32 v225, v225, v231
 v_cmp_le_u32 s[84:85], s77, v225
 PV 108,192,172
 buffer_store_dwordx4 v[92:95], v221, s[24:27], s39 offen offset:128 nt
 XE 82,90,82
 PM 96,230,0
 PM 98,230,0
 PM 100,230,0
 PM 102,230,0
 PM 104,230,0
 PM 106,230,0
 PM 108,230,0
 PM 110,230,0
 PV 112,196,172
 s_cmp_lg_u64 s[84:85], 0
 XE 83,91,83
 CV 96,96,97
 PV 116,200,172
 s_cselect_b32 s92, s76, 0
 CV 97,98,99
 CV 98,100,101
 PV 120,204,172
 s_or_b32 s73, s73, s92
 CV 99,102,103
 CV 104,104,105
 PV 124,208,172
 s_lshl_b32 s76, s76, 1
 CV 105,106,107
 CV 106,108,109
 buffer_store_dwordx4 v[80:83], v220, s[24:27], s39 offen offset:128 nt
 CV 107,110,111
 XE 100,104,96
 XE 101,105,97
 XE 102,106,98
 XE 103,107,99
 s_not_b64 vcc, vcc
 XO 104,96,104
 XO 105,97,105
 XO 106,98,106
 XO 107,99,107
 buffer_store_dwordx4 v[100:103], v220, s[24:27], s39 offen offset:256 nt
 PM 112,230,0
 PM 114,230,0
 PM 116,230,0
 PM 118,230,0
 CV 112,112,113
 CV 113,114,115
 CV 114,116,117
 CV 115,118,119
 PM 120,230,0
 PM 122,230,0
 PM 124,230,0
 PM 126,230,0
 CV 120,120,121
 CV 121,122,123
 CV 122,124,125
 CV 123,126,127
 XO 124,112,120
 XO 125,113,121
 XO 126,114,122
 XO 127,115,123
 s_not_b64 vcc, vcc
 XE 112,120,112
 XE 113,121,113
 XE 114,122,114
 XE 115,123,115
 buffer_store_dwordx4 v[104:107], v221, s[24:27], s39 offen offset:256 nt
 buffer_store_dwordx4 v[124:127], v221, s[24:27], s39 offen offset:384 nt
 buffer_store_dwordx4 v[112:115], v220, s[24:27], s39 offen offset:384 nt
 s_cmp_lg_u32 s73, 0
 s_cbranch_scc1 L_hop
 s_endpgm
.p2align 12
L_U3:
 QZ 128,64,0
 s_cmp_eq_u32 s33, 0x8000
 RV 96,213,8192
 v_add_u32 v251, L_U3-L_pc-24576, v244
 QK 128,68,4
 s_cselect_b32 s32, -2, 1
 RV 98,213,12288
 SC 156
 QK 128,72,8
 s_lshl_b32 s32, s32, 14
 RV 100,213,8200
 v_add_u32 v212, s32, v212
 QK 128,76,12
 s_add_u32 s31, s33, s37
 RV 102,213,12296
 SC 157
 QZ 132,76,28
 s_add_u32 s33, s33, s32
 RV 104,213,8704
 SC 158
 QK 132,72,24
 s_add_u32 s31, s33, s37
 RV 106,213,12800
 SC 159
 QK 132,68,20
 RV 108,213,8712
 SC 128
 QK 132,64,16
 RV 110,213,12808
 SC 129
 QZ 136,64,32
 RV 112,213,9216
 SC 130
 QK 136,68,36
 RV 114,213,13312
 SC 131
 QK 136,72,40
 RV 116,213,9224
 SC 132
 QK 136,76,44
 RV 118,213,13320
 SC 133
 QZ 140,76,60
 RV 120,213,9728
 SC 134
 QK 140,72,56
 RV 122,213,13824
 SC 135
 QK 140,68,52
 RV 124,213,9736
 SC 136
 QK 140,64,48
 RV 126,213,13832
 v_add_u32 v213, s32, v213
 QZ 144,80,0
 s_cmp_eq_u32 s33, 0x8000
 global_load_dword v255, v251, s[64:65]
 SC 137
 QK 144,84,4
 s_cselect_b32 s32, -2, 1
 EX 156
 QK 144,88,8
 s_lshl_b32 s32, s32, 14
 EX 157
 QK 144,92,12
 s_add_u32 s33, s33, s32
 CV 190,156,157
 SC 138
 QZ 148,92,28
 EX 158
 QK 148,88,24
 EX 159
 QK 148,84,20
 CV 191,158,159
 SC 144
 QK 148,80,16
 EX 128
 QZ 152,80,32
 s_waitcnt vmcnt(9) lgkmcnt(0)
 EX 129
 QK 152,84,36
 s_barrier
 QK 152,88,40
 RK 148,212,0
 CV 160,128,129
 QK 152,92,44
 RK 152,212,512
 SC 145
 QZ 156,92,60
 RK 156,212,1024
 SC 146
 QK 156,88,56
 RK 160,212,1536
 SC 147
 QK 156,84,52
 RK 164,212,4096
 SC 148
 QK 156,80,48
 RK 168,212,4608
 SC 149
 SM 128,176
 RK 172,212,5120
 SC 150
 SM 132,184
 RK 176,212,5632
 SC 151
 PV 96,96,188
 RV 180,213,0
 SC 139
 PV 64,96,184
 RV 182,213,4096
 SC 140
 PV 32,96,180
 RV 184,213,8
 SC 141
 PV 0,96,176
 RV 186,213,4104
 SC 142
 PV 4,100,176
 RV 188,213,512
 SC 143
 PV 36,100,180
 RV 190,213,4608
 SC 152
 PV 68,100,184
 RV 192,213,520
 SC 153
 PV 100,100,188
 RV 194,213,4616
 SC 154
 PV 104,104,188
 RV 196,213,1024
 SC 155
 PV 72,104,184
 RV 198,213,5120
 SC 156
 PV 40,104,180
 RV 200,213,1032
 SC 157
 PV 8,104,176
 RV 202,213,5128
 SC 158
 PV 12,108,176
 RV 204,213,1536
 SC 159
 PV 44,108,180
 RV 206,213,5632
 RV 208,213,1544
 PV 76,108,184
 RV 210,213,5640
 EX 130
 PV 108,108,188
 RK 212,212,8192
 EX 131
 PV 112,112,188
 RK 216,212,8704
 CV 161,130,131
 PV 80,112,184
 RK 220,212,9216
 EX 132
 PV 48,112,180
 RK 224,212,9728
 v_add_u32 v212, s32, v212
 PV 16,112,176
 RV 96,213,8192
 RV 98,213,12288
 PV 20,116,176
 EX 133
 PV 52,116,180
 RV 100,213,8200
 CV 164,132,133
 PV 84,116,184
 RV 102,213,12296
 RV 104,213,8704
 PV 116,116,188
 EX 134
 PV 120,120,188
 RV 106,213,12800
 RV 108,213,8712
 PV 88,120,184
 EX 135
 PV 56,120,180
 RV 110,213,12808
 CV 165,134,135
 PV 24,120,176
 RV 112,213,9216
 RV 114,213,13312
 PV 28,124,176
 EX 144
 PV 60,124,180
 RV 116,213,9224
 RV 118,213,13320
 PV 92,124,184
 EX 145
 PV 124,124,188
 s_waitcnt lgkmcnt(15)
 RV 120,213,9728
 CV 162,144,145
 QZ 128,148,0
 s_waitcnt lgkmcnt(15)
 RV 122,213,13824
 RV 124,213,9736
 QK 128,152,4
 s_waitcnt lgkmcnt(15)
 EX 146
 QK 128,156,8
 s_waitcnt lgkmcnt(15)
 RV 126,213,13832
 v_add_u32 v213, s32, v213
 QK 128,160,12
 EX 147
 QZ 132,160,28
 EX 148
 QK 132,156,24
 EX 149
 QK 132,152,20
 CV 163,146,147
 CV 166,148,149
 QK 132,148,16
 s_waitcnt lgkmcnt(15)
 EX 150
 v_mfma_f32_16x16x32_bf16 v[144:147], a[164:167], a[0:3], v[208:211]
 s_waitcnt lgkmcnt(15)
 EX 151
 QK 144,168,4
 s_waitcnt lgkmcnt(15)
 EX 136
 QK 144,172,8
 s_waitcnt lgkmcnt(15)
 EX 137
 QK 144,176,12
 CV 167,150,151
 CV 168,136,137
 v_mfma_f32_16x16x32_bf16 v[148:151], a[176:179], a[28:31], v[208:211]
 EX 138
 QK 148,172,24
 EX 139
 QK 148,168,20
 EX 140
 QK 148,164,16
 EX 141
 CV 169,138,139
 QZ 136,148,32
 s_waitcnt vmcnt(1) lgkmcnt(0)
 EX 142
 QK 136,152,36
 s_barrier
 QK 136,156,40
 EX 143
 CV 172,140,141
 CV 173,142,143
 EX 152
 PS 128
 PS 130
 PS 132
 PS 134
 PS 144
 PS 146
 PS 148
 PS 150
 QK 136,160,44
 EX 153
 QZ 140,160,60
 EX 154
 QK 140,156,56
 EX 155
 QK 140,152,52
 CV 170,152,153
 CV 171,154,155
 QK 140,148,48
 EX 156
 QZ 152,164,32
 EX 157
 QK 152,168,36
 EX 158
 QK 152,172,40
 EX 159
 QK 152,176,44
 CV 174,156,157
 CV 175,158,159
 QZ 156,176,60
 EX 128
 QK 156,172,56
 EX 129
 QK 156,168,52
 EX 130
 QK 156,164,48
 EX 131
 SM 128,160
 CV 176,128,129
 PV 32,180,164
 EX 144
 PV 0,180,160
 EX 145
 PV 4,184,160
 CV 177,130,131
 CV 178,144,145
 EX 146
 EX 147
 PS 136
 PS 138
 PS 140
 PS 142
 PS 152
 PS 154
 PS 156
 PS 158
 PV 36,184,164
 EX 132
 PV 40,188,164
 EX 133
 PV 8,188,160
 CV 179,146,147
 CV 180,132,133
 PV 12,192,160
 EX 134
 PV 44,192,164
 EX 135
 PV 48,196,164
 EX 148
 PV 16,196,160
 EX 149
 PV 20,200,160
 CV 181,134,135
 CV 182,148,149
 PV 52,200,164
 EX 150
 PV 56,204,164
 EX 151
 PV 24,204,160
 EX 136
 PV 28,208,160
 EX 137
 PV 60,208,164
 CV 183,150,151
 CV 184,136,137
 LS 128,144,176
 EX 138
 PV 0,96,176
 EX 139
 PV 4,100,176
 EX 140
 PV 8,104,176
 EX 141
 PV 12,108,176
 v_accvgpr_read_b32 v225, a128
 v_accvgpr_read_b32 v224, a129
 v_add_f32 v225, v224, v225
 v_rcp_f32 v224, v225
 v_subrev_u32 v225, 0x21800000, v225
 PM 0,224,0
 PM 2,224,0
 PM 4,224,0
 PM 6,224,0
 PM 8,224,0
 PM 10,224,0
 PM 12,224,0
 PM 14,224,0
 PV 16,112,176
 CV 0,0,1
 CV 1,2,3
 PV 20,116,176
 CV 2,4,5
 CV 3,6,7
 PV 24,120,176
 CV 8,8,9
 CV 9,10,11
 PV 28,124,176
 CV 10,12,13
 CV 11,14,15
 LS 128,136,180
 XE 4,8,0
 XE 5,9,1
 PV 32,96,180
 XE 6,10,2
 XE 7,11,3
 PV 36,100,180
 s_not_b64 vcc, vcc
 buffer_store_dwordx4 v[4:7], v220, s[24:27], s38 offen offset:0 nt
 v_accvgpr_read_b32 v227, a130
 PM 16,224,0
 PM 18,224,0
 PM 20,224,0
 PM 22,224,0
 PM 24,224,0
 PM 26,224,0
 PM 28,224,0
 PM 30,224,0
 v_accvgpr_read_b32 v226, a131
 v_add_f32 v227, v226, v227
 v_rcp_f32 v226, v227
 v_subrev_u32 v227, 0x21800000, v227
 PV 40,104,180
 XO 8,0,8
 XO 9,1,9
 PV 44,108,180
 XO 10,2,10
 XO 11,3,11
 PV 48,112,180
 buffer_store_dwordx4 v[8:11], v221, s[24:27], s38 offen offset:0 nt
 PV 52,116,180
 CV 16,16,17
 CV 17,18,19
 PV 56,120,180
 CV 18,20,21
 CV 19,22,23
 PV 60,124,180
 CV 24,24,25
 CV 25,26,27
 SM 132,168
 CV 26,28,29
 PV 96,180,172
 CV 27,30,31
 XO 28,16,24
 PV 64,180,168
 RV 180,213,0
 XO 29,17,25
 PV 68,184,168
 XO 30,18,26
 XO 31,19,27
 PV 100,184,172
 s_not_b64 vcc, vcc
 buffer_store_dwordx4 v[28:31], v221, s[24:27], s38 offen offset:128 nt
 XE 16,24,16
 PM 32,226,0
 PM 34,226,0
 PM 36,226,0
 PM 38,226,0
 PM 40,226,0
 PM 42,226,0
 PM 44,226,0
 PM 46,226,0
 PV 104,188,172
 RV 184,213,8
 XE 17,25,17
 PV 72,188,168
 RV 188,213,512
 XE 18,26,18
 PV 76,192,168
 XE 19,27,19
 CV 32,32,33
 PV 108,192,172
 RV 192,213,520
 CV 33,34,35
 PV 112,196,172
 buffer_store_dwordx4 v[16:19], v220, s[24:27], s38 offen offset:128 nt
 PV 80,196,168
 RV 196,213,1024
 CV 34,36,37
 PV 84,200,168
 CV 35,38,39
 CV 40,40,41
 PV 116,200,172
 RV 200,213,1032
 CV 41,42,43
 PV 120,204,172
 CV 42,44,45
 CV 43,46,47
 PV 88,204,168
 RV 204,213,1536
 XE 36,40,32
 PV 92,208,168
 XE 37,41,33
 XE 38,42,34
 PV 124,208,172
 RV 208,213,1544
 XE 39,43,35
 buffer_store_dwordx4 v[36:39], v220, s[24:27], s38 offen offset:256 nt
 s_not_b64 vcc, vcc
 XO 40,32,40
 XO 41,33,41
 XO 42,34,42
 XO 43,35,43
 PM 48,226,0
 PM 50,226,0
 PM 52,226,0
 PM 54,226,0
 CV 48,48,49
 CV 49,50,51
 CV 50,52,53
 CV 51,54,55
 PM 56,226,0
 PM 58,226,0
 PM 60,226,0
 PM 62,226,0
 CV 56,56,57
 CV 57,58,59
 CV 58,60,61
 CV 59,62,63
 XO 60,48,56
 XO 61,49,57
 XO 62,50,58
 buffer_store_dwordx4 v[40:43], v221, s[24:27], s38 offen offset:256 nt
 XO 63,51,59
 s_not_b64 vcc, vcc
 XE 48,56,48
 XE 49,57,49
 XE 50,58,50
 XE 51,59,51
 CV 185,138,139
 v_mfma_f32_16x16x32_bf16 v[136:139], a[212:215], a[32:35], v[208:211]
 EX 142
 QK 136,216,36
 EX 143
 QK 136,220,40
 CV 188,140,141
 CV 189,142,143
 QK 136,224,44
 EX 152
 v_mfma_f32_16x16x32_bf16 v[140:143], a[212:215], a[48:51], v[208:211]
 buffer_store_dwordx4 v[60:63], v221, s[24:27], s38 offen offset:384 nt
 QK 140,216,52
 EX 153
 QK 140,220,56
 EX 154
 QK 140,224,60
 EX 155
 CV 186,152,153
 CV 187,154,155
 EX 156
 PS 136
 PS 138
 LS 132,144,184
 EX 136
 EX 137
 EX 138
 PS 140
 PS 142
 PV 64,96,184
 buffer_store_dwordx4 v[48:51], v220, s[24:27], s38 offen offset:384 nt
 PV 68,100,184
 EX 139
 PV 72,104,184
 CV 168,136,137
 CV 169,138,139
 PV 76,108,184
 EX 157
 PV 80,112,184
 EX 158
 PV 84,116,184
 EX 159
 PV 88,120,184
 CV 190,156,157
 CV 191,158,159
 PV 92,124,184
 EX 140
 v_mfma_f32_16x16x16_bf16 a[132:135], a[144:145], v[168:169], a[132:135]
 s_waitcnt lgkmcnt(7)
 EX 141
 EX 142
 PH 64,180,168
 s_waitcnt lgkmcnt(6)
 EX 143
 CV 172,140,141
 PH 68,184,168
 s_waitcnt lgkmcnt(5)
 CV 173,142,143
 PH 72,188,168
 v_accvgpr_read_b32 v229, a132
 v_accvgpr_read_b32 v228, a133
 v_add_f32 v229, v228, v229
 v_rcp_f32 v228, v229
 v_subrev_u32 v229, 0x21800000, v229
 PM 64,228,0
 PM 66,228,0
 PM 68,228,0
 PM 70,228,0
 PM 72,228,0
 PM 74,228,0
 v_max3_u32 v225, v225, v227, v229
 s_waitcnt lgkmcnt(4)
 PH 76,192,168
 s_waitcnt lgkmcnt(3)
 CV 64,64,65
 CV 65,66,67
 CV 66,68,69
 PH 80,196,168
 s_waitcnt lgkmcnt(2)
 CV 67,70,71
 CV 72,72,73
 CV 73,74,75
 PH 84,200,168
 s_waitcnt lgkmcnt(1)
 XE 68,72,64
 XE 69,73,65
 PM 76,228,0
 PM 78,228,0
 PH 88,204,168
 s_waitcnt lgkmcnt(0)
 CV 74,76,77
 CV 75,78,79
 PH 92,208,168
 XE 70,74,66
 XE 71,75,67
 LS 132,136,188
 s_not_b64 vcc, vcc
 buffer_store_dwordx4 v[68:71], v220, s[24:27], s39 offen offset:0 nt
 XO 72,64,72
 PM 80,228,0
 PM 82,228,0
 PM 84,228,0
 PM 86,228,0
 PM 88,228,0
 PM 90,228,0
 PM 92,228,0
 PM 94,228,0
 PV 96,96,188
 XO 73,65,73
 XO 74,66,74
 PV 100,100,188
 XO 75,67,75
 CV 80,80,81
 PV 104,104,188
 CV 81,82,83
 CV 82,84,85
 PV 108,108,188
 CV 83,86,87
 CV 88,88,89
 PV 112,112,188
 buffer_store_dwordx4 v[72:75], v221, s[24:27], s39 offen offset:0 nt
 PV 116,116,188
 CV 89,90,91
 CV 90,92,93
 PV 120,120,188
 CV 91,94,95
 XO 92,80,88
 PV 124,124,188
 XO 93,81,89
 XO 94,82,90
 v_mfma_f32_16x16x16_bf16 a[132:135], a[136:137], v[172:173], a[132:135]
 XO 95,83,91
 PH 96,180,172
 s_not_b64 vcc, vcc
 XE 80,88,80
 XE 81,89,81
 PH 100,184,172
 XE 82,90,82
 XE 83,91,83
 v_accvgpr_read_b32 v231, a134
 v_accvgpr_read_b32 v230, a135
 v_add_f32 v231, v230, v231
 v_rcp_f32 v230, v231
 v_subrev_u32 v231, 0x21800000, v231
 v_max_u32 v225, v225, v231
 v_cmp_le_u32 s[84:85], s77, v225
 PH 104,188,172
 buffer_store_dwordx4 v[92:95], v221, s[24:27], s39 offen offset:128 nt
 PM 96,230,0
 PM 98,230,0
 PM 100,230,0
 PM 102,230,0
 PH 108,192,172
 CV 96,96,97
 CV 97,98,99
 CV 98,100,101
 CV 99,102,103
 PM 104,230,0
 PM 106,230,0
 PH 112,196,172
 CV 104,104,105
 CV 105,106,107
 PM 108,230,0
 PM 110,230,0
 PH 116,200,172
 buffer_store_dwordx4 v[80:83], v220, s[24:27], s39 offen offset:128 nt
 PH 120,204,172
 s_cmp_lg_u64 s[84:85], 0
 CV 106,108,109
 CV 107,110,111
 PH 124,208,172
 s_cselect_b32 s92, s76, 0
 XE 100,104,96
 XE 101,105,97
 XE 102,106,98
 XE 103,107,99
 s_not_b64 vcc, vcc
 XO 104,96,104
 XO 105,97,105
 XO 106,98,106
 XO 107,99,107
 v_mul_f32 v112, v230, v112
 v_mul_f32 v113, v230, v113
 v_mul_f32 v114, v230, v114
 v_mul_f32 v115, v230, v115
 v_mul_f32 v116, v230, v116
 v_mul_f32 v117, v230, v117
 v_mul_f32 v118, v230, v118
 v_mul_f32 v119, v230, v119
 CV 112,112,113
 buffer_store_dwordx4 v[100:103], v220, s[24:27], s39 offen offset:256 nt
 CV 113,114,115
 CV 114,116,117
 CV 115,118,119
 v_mul_f32 v120, v230, v120
 v_mul_f32 v121, v230, v121
 v_mul_f32 v122, v230, v122
 v_mul_f32 v123, v230, v123
 v_mul_f32 v124, v230, v124
 v_mul_f32 v125, v230, v125
 v_mul_f32 v126, v230, v126
 v_mul_f32 v127, v230, v127
 CV 120,120,121
 CV 121,122,123
 CV 122,124,125
 CV 123,126,127
 XO 124,112,120
 XO 125,113,121
 XO 126,114,122
 XO 127,115,123
 s_not_b64 vcc, vcc
 XE 112,120,112
 XE 113,121,113
 XE 114,122,114
 XE 115,123,115
 buffer_store_dwordx4 v[104:107], v221, s[24:27], s39 offen offset:256 nt
 s_or_b32 s73, s73, s92
 s_lshl_b32 s76, s76, 1
 buffer_store_dwordx4 v[124:127], v221, s[24:27], s39 offen offset:384 nt
 buffer_store_dwordx4 v[112:115], v220, s[24:27], s39 offen offset:384 nt
 s_cmp_lg_u32 s73, 0
 s_cbranch_scc1 L_hop
 s_endpgm
.p2align 12
L_u0:
 QZ 136,64,32
 s_cmp_eq_u32 s33, 0x8000
 RV 96,213,8192
 SC 156
 QK 136,68,36
 s_cselect_b32 s32, -2, 1
 RV 98,213,12288
 SC 157
 QK 136,72,40
 s_lshl_b32 s32, s32, 14
 RV 100,213,8200
 v_add_u32 v212, s32, v212
 QK 136,76,44
 s_add_u32 s31, s33, s37
 RV 102,213,12296
 SC 158
 QZ 140,76,60
 s_add_u32 s33, s33, s32
 RV 104,213,8704
 SC 159
 QK 140,72,56
 s_add_u32 s31, s33, s37
 RV 106,213,12800
 v_and_b32 v178, v253, v178
 QK 140,68,52
 RV 108,213,8712
 v_and_b32 v179, v254, v179
 QK 140,64,48
 RV 110,213,12808
 v_and_b32 v182, v253, v182
 QZ 152,80,32
 RV 112,213,9216
 v_and_b32 v183, v254, v183
 QK 152,84,36
 RV 114,213,13312
 RV 116,213,9224
 EX 156
 EX 157
 PS 136
 PS 138
 PS 140
 PS 142
 QK 152,88,40
 RV 118,213,13320
 CV 190,156,157
 QK 152,92,44
 RV 120,213,9728
 RV 122,213,13824
 EX 158
 RV 124,213,9736
 EX 159
 RV 126,213,13832
 v_add_u32 v213, s32, v213
 CV 191,158,159
 QZ 156,92,60
 s_cmp_eq_u32 s33, 0x8000
 EX 136
 QK 156,88,56
 s_cselect_b32 s32, -2, 1
 EX 137
 QK 156,84,52
 s_lshl_b32 s32, s32, 14
 EX 138
 QK 156,80,48
 s_add_u32 s33, s33, s32
 EX 139
 SM 128,176
 s_waitcnt lgkmcnt(14)
 CV 168,136,137
 PV 32,96,180
 EX 140
 PV 0,96,176
 EX 141
 CV 169,138,139
 CV 172,140,141
 EX 142
 PS 152
 PS 154
 PS 156
 PS 158
 v_accvgpr_read_b32 v225, a128
 v_accvgpr_read_b32 v224, a129
 v_add_f32 v225, v224, v225
 v_rcp_f32 v224, v225
 v_subrev_u32 v225, 0x21800000, v225
 PM 0,224,0
 PM 2,224,0
 v_accvgpr_read_b32 v227, a130
 v_accvgpr_read_b32 v226, a131
 v_add_f32 v227, v226, v227
 v_rcp_f32 v226, v227
 v_subrev_u32 v227, 0x21800000, v227
 s_waitcnt lgkmcnt(12)
 PV 4,100,176
 s_waitcnt vmcnt(8) lgkmcnt(0)
 EX 143
 PV 36,100,180
 s_barrier
 PV 40,104,180
 RK 148,212,0
 CV 173,142,143
 PV 8,104,176
 RK 152,212,512
 CV 0,0,1
 EX 152
 EX 153
 PM 4,224,0
 PM 6,224,0
 PV 12,108,176
 RK 156,212,1024
 CV 170,152,153
 EX 154
 EX 155
 PM 8,224,0
 PM 10,224,0
 PV 44,108,180
 RK 160,212,1536
 CV 171,154,155
 EX 156
 EX 157
 PM 12,224,0
 PM 14,224,0
 PV 48,112,180
 RK 164,212,4096
 CV 174,156,157
 PV 16,112,176
 RK 168,212,4608
 CV 1,2,3
 PV 20,116,176
 RK 172,212,5120
 CV 2,4,5
 PV 52,116,180
 RK 176,212,5632
 CV 3,6,7
 PV 56,120,180
 RV 180,213,0
 CV 8,8,9
 PV 24,120,176
 RV 182,213,4096
 CV 9,10,11
 PV 28,124,176
 RV 184,213,8
 CV 10,12,13
 PV 60,124,180
 RV 186,213,4104
 CV 11,14,15
 SM 132,184
 RV 188,213,512
 XE 4,8,0
 PV 96,96,188
 RV 190,213,4608
 XE 5,9,1
 PV 64,96,184
 RV 192,213,520
 XE 6,10,2
 PV 68,100,184
 RV 194,213,4616
 XE 7,11,3
 PV 100,100,188
 s_not_b64 vcc, vcc
 RV 196,213,1024
 XO 8,0,8
 PV 104,104,188
 RV 198,213,5120
 XO 9,1,9
 PV 72,104,184
 RV 200,213,1032
 XO 10,2,10
 PV 76,108,184
 RV 202,213,5128
 XO 11,3,11
 PV 108,108,188
 RV 204,213,1536
 RV 206,213,5632
 PV 112,112,188
 RV 208,213,1544
 EX 158
 PV 80,112,184
 RV 210,213,5640
 EX 159
 PV 84,116,184
 RK 212,212,8192
 CV 175,158,159
 PV 116,116,188
 RK 216,212,8704
 PV 120,120,188
 RK 220,212,9216
 PV 88,120,184
 RK 224,212,9728
 PV 92,124,184
 RK 228,212,12288
 PV 124,124,188
 s_waitcnt lgkmcnt(15)
 RK 232,212,12800
 QZ 136,148,32
 s_waitcnt lgkmcnt(15)
 RK 236,212,13312
 QK 136,152,36
 s_waitcnt lgkmcnt(15)
 RK 240,212,13824
 v_add_u32 v212, s32, v212
 QK 136,156,40
 s_waitcnt lgkmcnt(15)
 RV 96,213,8192
 QK 136,160,44
 RV 98,213,12288
 QZ 140,160,60
 RV 100,213,8200
 QK 140,156,56
 RV 102,213,12296
 QK 140,152,52
 RV 104,213,8704
 QK 140,148,48
 s_waitcnt lgkmcnt(15)
 RV 106,213,12800
 QZ 152,164,32
 s_waitcnt lgkmcnt(15)
 RV 108,213,8712
 QK 152,168,36
 s_waitcnt lgkmcnt(15)
 RV 110,213,12808
 QK 152,172,40
 s_waitcnt lgkmcnt(15)
 RV 112,213,9216
 QK 152,176,44
 RV 114,213,13312
 PS 136
 PS 138
 PS 140
 PS 142
 QZ 156,176,60
 RV 116,213,9224
 RV 118,213,13320
 QK 156,172,56
 RV 120,213,9728
 EX 136
 QK 156,168,52
 RV 122,213,13824
 EX 137
 QK 156,164,48
 RV 124,213,9736
 CV 184,136,137
 SM 132,168
 s_waitcnt lgkmcnt(15)
 RV 126,213,13832
 v_add_u32 v213, s32, v213
 PV 96,180,172
 buffer_store_dwordx4 v[4:7], v220, s[24:27], s38 offen offset:0 nt
 EX 138
 PM 16,224,0
 PM 18,224,0
 PM 20,224,0
 PM 22,224,0
 PM 24,224,0
 PM 26,224,0
 PM 28,224,0
 PM 30,224,0
 PS 152
 PS 154
 PS 156
 PS 158
 PV 64,180,168
 s_waitcnt lgkmcnt(15)
 EX 139
 PV 68,184,168
 CV 185,138,139
 CV 16,16,17
 PV 100,184,172
 s_waitcnt lgkmcnt(15)
 buffer_store_dwordx4 v[8:11], v221, s[24:27], s38 offen offset:0 nt
 PV 104,188,172
 s_waitcnt vmcnt(2) lgkmcnt(0)
 EX 140
 PV 72,188,168
 s_barrier
 PV 76,192,168
 RK 148,212,0
 CV 17,18,19
 PV 108,192,172
 RK 152,212,512
 CV 18,20,21
 PV 112,196,172
 RK 156,212,1024
 CV 19,22,23
 PV 80,196,168
 RK 160,212,1536
 CV 24,24,25
 PV 84,200,168
 RV 180,213,0
 CV 25,26,27
 PV 116,200,172
 RV 182,213,4096
 CV 26,28,29
 PV 120,204,172
 RV 184,213,8
 CV 27,30,31
 PV 88,204,168
 RV 186,213,4104
 XO 28,16,24
 PV 92,208,168
 RV 188,213,512
 XO 29,17,25
 PV 124,208,172
 RV 190,213,4608
 XO 30,18,26
 QZ 136,212,32
 RV 192,213,520
 XO 31,19,27
 QK 136,216,36
 s_not_b64 vcc, vcc
 buffer_store_dwordx4 v[28:31], v221, s[24:27], s38 offen offset:128 nt
 EX 141
 PM 32,226,0
 PM 34,226,0
 PM 36,226,0
 PM 38,226,0
 PM 40,226,0
 PM 42,226,0
 PM 44,226,0
 PM 46,226,0
 QK 136,220,40
 RV 194,213,4616
 CV 188,140,141
 QK 136,224,44
 RV 196,213,1024
 XE 16,24,16
 EX 142
 EX 143
 EX 152
 CV 189,142,143
 QZ 140,224,60
 RV 198,213,5120
 XE 17,25,17
 QK 140,220,56
 RV 200,213,1032
 XE 18,26,18
 QK 140,216,52
 RV 202,213,5128
 XE 19,27,19
 QK 140,212,48
 buffer_store_dwordx4 v[16:19], v220, s[24:27], s38 offen offset:128 nt
 RV 204,213,1536
 RV 206,213,5632
 EX 153
 EX 154
 CV 186,152,153
 EX 155
 EX 156
 CV 187,154,155
 QZ 152,228,32
 RV 208,213,1544
 CV 32,32,33
 EX 157
 EX 158
 PS 136
 PS 138
 PS 140
 PS 142
 QK 152,232,36
 RV 210,213,5640
 CV 190,156,157
 QK 152,236,40
 EX 159
 QK 152,240,44
 CV 191,158,159
 CV 33,34,35
 QZ 156,240,60
 CV 34,36,37
 CV 35,38,39
 QK 156,236,56
 EX 136
 QK 156,232,52
 EX 137
 QK 156,228,48
 CV 40,40,41
 CV 41,42,43
 SM 132,184
 CV 42,44,45
 PV 96,96,188
 CV 43,46,47
 XE 36,40,32
 PV 64,96,184
 RV 96,213,8192
 XE 37,41,33
 XE 38,42,34
 XE 39,43,35
 CV 168,136,137
 PS 152
 PS 154
 PS 156
 PS 158
 PV 68,100,184
 s_not_b64 vcc, vcc
 buffer_store_dwordx4 v[36:39], v220, s[24:27], s38 offen offset:256 nt
 XO 40,32,40
 PM 48,226,0
 PM 50,226,0
 PM 52,226,0
 PM 54,226,0
 PM 56,226,0
 PM 58,226,0
 PM 60,226,0
 PM 62,226,0
 PV 100,100,188
 RV 100,213,8200
 XO 41,33,41
 PV 104,104,188
 XO 42,34,42
 XO 43,35,43
 PV 72,104,184
 RV 104,213,8704
 CV 48,48,49
 PV 76,108,184
 CV 49,50,51
 CV 50,52,53
 PV 108,108,188
 buffer_store_dwordx4 v[40:43], v221, s[24:27], s38 offen offset:256 nt
 PV 112,112,188
 RV 108,213,8712
 CV 51,54,55
 PV 80,112,184
 RV 112,213,9216
 CV 56,56,57
 PV 84,116,184
 EX 138
 PV 116,116,188
 RV 116,213,9224
 CV 57,58,59
 PV 120,120,188
 CV 58,60,61
 CV 59,62,63
 PV 88,120,184
 RV 120,213,9728
 XO 60,48,56
 PV 92,124,184
 XO 61,49,57
 XO 62,50,58
 PV 124,124,188
 RV 124,213,9736
 XO 63,51,59
 buffer_store_dwordx4 v[60:63], v221, s[24:27], s38 offen offset:384 nt
 s_not_b64 vcc, vcc
 XE 48,56,48
 XE 49,57,49
 XE 50,58,50
 XE 51,59,51
 EX 139
 EX 140
 CV 169,138,139
 s_waitcnt lgkmcnt(15)
 v_mfma_f32_16x16x32_bf16 v[136:139], a[148:151], a[32:35], v[208:211]
 s_waitcnt lgkmcnt(15)
 EX 141
 QK 136,152,36
 s_waitcnt lgkmcnt(15)
 EX 142
 QK 136,156,40
 s_waitcnt lgkmcnt(15)
 EX 143
 QK 136,160,44
 buffer_store_dwordx4 v[48:51], v220, s[24:27], s38 offen offset:384 nt
 CV 172,140,141
 CV 173,142,143
 v_mfma_f32_16x16x32_bf16 v[140:143], a[148:151], a[48:51], v[208:211]
 EX 152
 QK 140,152,52
 EX 153
 QK 140,156,56
 EX 154
 CV 170,152,153
 EX 155
 PS 136
 PS 138
 QK 140,160,60
 EX 136
 CV 171,154,155
 EX 137
 EX 138
 LS 132,144,168
 s_waitcnt lgkmcnt(15)
 EX 139
 PV 64,180,168
 CV 184,136,137
 CV 185,138,139
 EX 156
 EX 157
 PS 140
 PS 142
 s_waitcnt lgkmcnt(15)
 PV 68,184,168
 s_waitcnt lgkmcnt(15)
 EX 158
 PV 72,188,168
 s_waitcnt lgkmcnt(15)
 EX 159
 PV 76,192,168
 s_waitcnt lgkmcnt(14)
 CV 174,156,157
 CV 175,158,159
 PV 80,196,168
 s_waitcnt lgkmcnt(12)
 EX 140
 PV 84,200,168
 s_waitcnt lgkmcnt(10)
 EX 141
 PV 88,204,168
 s_waitcnt lgkmcnt(8)
 EX 142
 PV 92,208,168
 EX 143
 v_mfma_f32_16x16x16_bf16 a[132:135], a[144:145], v[184:185], a[132:135]
 s_waitcnt lgkmcnt(7)
 CV 188,140,141
 CV 189,142,143
 PH 64,96,184
 s_waitcnt lgkmcnt(6)
 PH 68,100,184
 s_waitcnt lgkmcnt(5)
 PH 72,104,184
 s_waitcnt lgkmcnt(4)
 PH 76,108,184
 s_waitcnt lgkmcnt(3)
 PH 80,112,184
 s_waitcnt lgkmcnt(2)
 PH 84,116,184
 v_accvgpr_read_b32 v229, a132
 v_accvgpr_read_b32 v228, a133
 v_add_f32 v229, v228, v229
 v_rcp_f32 v228, v229
 v_subrev_u32 v229, 0x21800000, v229
 PM 64,228,0
 PM 66,228,0
 PM 68,228,0
 PM 70,228,0
 PM 72,228,0
 PM 74,228,0
 PM 76,228,0
 PM 78,228,0
 v_max3_u32 v225, v225, v227, v229
 s_waitcnt lgkmcnt(1)
 PH 88,120,184
 s_waitcnt lgkmcnt(0)
 CV 64,64,65
 CV 65,66,67
 CV 66,68,69
 PH 92,124,184
 CV 67,70,71
 CV 72,72,73
 CV 73,74,75
 LS 132,136,172
 CV 74,76,77
 CV 75,78,79
 PV 96,180,172
 XE 68,72,64
 XE 69,73,65
 PV 100,184,172
 XE 70,74,66
 XE 71,75,67
 PV 104,188,172
 s_not_b64 vcc, vcc
 buffer_store_dwordx4 v[68:71], v220, s[24:27], s39 offen offset:0 nt
 XO 72,64,72
 PM 80,228,0
 PM 82,228,0
 PM 84,228,0
 PM 86,228,0
 PM 88,228,0
 PM 90,228,0
 PM 92,228,0
 PM 94,228,0
 PV 108,192,172
 XO 73,65,73
 XO 74,66,74
 PV 112,196,172
 XO 75,67,75
 CV 80,80,81
 PV 116,200,172
 CV 81,82,83
 CV 82,84,85
 PV 120,204,172
 CV 83,86,87
 CV 88,88,89
 PV 124,208,172
 buffer_store_dwordx4 v[72:75], v221, s[24:27], s39 offen offset:0 nt
 v_mfma_f32_16x16x16_bf16 a[132:135], a[136:137], v[188:189], a[132:135]
 CV 89,90,91
 CV 90,92,93
 CV 91,94,95
 PH 96,96,188
 XO 92,80,88
 XO 93,81,89
 XO 94,82,90
 PH 100,100,188
 XO 95,83,91
 v_accvgpr_read_b32 v231, a134
 v_accvgpr_read_b32 v230, a135
 v_add_f32 v231, v230, v231
 v_rcp_f32 v230, v231
 v_subrev_u32 v231, 0x21800000, v231
 v_max_u32 v225, v225, v231
 v_cmp_le_u32 s[84:85], s77, v225
 PH 104,104,188
 s_not_b64 vcc, vcc
 XE 80,88,80
 XE 81,89,81
 PH 108,108,188
 XE 82,90,82
 XE 83,91,83
 PH 112,112,188
 buffer_store_dwordx4 v[92:95], v221, s[24:27], s39 offen offset:128 nt
 PM 96,230,0
 PM 98,230,0
 PM 100,230,0
 PM 102,230,0
 PM 104,230,0
 PM 106,230,0
 PM 108,230,0
 PM 110,230,0
 PH 116,116,188
 CV 96,96,97
 CV 97,98,99
 CV 98,100,101
 PH 120,120,188
 s_cmp_lg_u64 s[84:85], 0
 CV 99,102,103
 CV 104,104,105
 PH 124,124,188
 s_cselect_b32 s92, s76, 0
 CV 105,106,107
 CV 106,108,109
 CV 107,110,111
 XE 100,104,96
 buffer_store_dwordx4 v[80:83], v220, s[24:27], s39 offen offset:128 nt
 XE 101,105,97
 XE 102,106,98
 XE 103,107,99
 s_not_b64 vcc, vcc
 XO 104,96,104
 XO 105,97,105
 XO 106,98,106
 XO 107,99,107
 s_or_b32 s73, s73, s92
 s_lshl_b32 s76, s76, 1
 buffer_store_dwordx4 v[100:103], v220, s[24:27], s39 offen offset:256 nt
 PM 112,230,0
 PM 114,230,0
 PM 116,230,0
 PM 118,230,0
 CV 112,112,113
 CV 113,114,115
 CV 114,116,117
 CV 115,118,119
 PM 120,230,0
 PM 122,230,0
 PM 124,230,0
 PM 126,230,0
 CV 120,120,121
 CV 121,122,123
 CV 122,124,125
 CV 123,126,127
 XO 124,112,120
 XO 125,113,121
 XO 126,114,122
 XO 127,115,123
 s_not_b64 vcc, vcc
 XE 112,120,112
 XE 113,121,113
 XE 114,122,114
 XE 115,123,115
 buffer_store_dwordx4 v[104:107], v221, s[24:27], s39 offen offset:256 nt
 buffer_store_dwordx4 v[124:127], v221, s[24:27], s39 offen offset:384 nt
 buffer_store_dwordx4 v[112:115], v220, s[24:27], s39 offen offset:384 nt
 s_cmp_lg_u32 s73, 0
 s_cbranch_scc1 L_hop
 s_endpgm
.p2align 12
L_u1:
 v_mfma_f32_16x16x32_bf16 v[128:131], a[64:67], a[0:3], v[208:211]
 s_cmp_eq_u32 s33, 0x8000
 RV 96,213,8192
 SC 156
 QK 128,68,4
 s_cselect_b32 s32, -2, 1
 RV 98,213,12288
 SC 157
 QK 128,72,8
 s_lshl_b32 s32, s32, 14
 RV 100,213,8200
 v_add_u32 v212, s32, v212
 QK 128,76,12
 s_add_u32 s31, s33, s37
 RV 102,213,12296
 SC 158
 v_mfma_f32_16x16x32_bf16 v[132:135], a[76:79], a[28:31], v[208:211]
 s_add_u32 s33, s33, s32
 RV 104,213,8704
 SC 159
 QK 132,72,24
 s_add_u32 s31, s33, s37
 RV 106,213,12800
 SC 128
 QK 132,68,20
 RV 108,213,8712
 SC 129
 QK 132,64,16
 RV 110,213,12808
 SC 130
 QZ 136,64,32
 RV 112,213,9216
 SC 131
 QK 136,68,36
 RV 114,213,13312
 RV 116,213,9224
 QK 136,72,40
 RV 118,213,13320
 SC 132
 QK 136,76,44
 RV 120,213,9728
 SC 133
 QZ 140,76,60
 RV 122,213,13824
 SC 134
 QK 140,72,56
 RV 124,213,9736
 SC 135
 QK 140,68,52
 RV 126,213,13832
 v_add_u32 v213, s32, v213
 QK 140,64,48
 s_cmp_eq_u32 s33, 0x8000
 EX 156
 QZ 152,80,32
 s_cselect_b32 s32, -2, 1
 EX 157
 QK 152,84,36
 s_lshl_b32 s32, s32, 14
 CV 190,156,157
 SC 136
 QK 152,88,40
 s_add_u32 s33, s33, s32
 EX 158
 QK 152,92,44
 EX 159
 SC 137
 CV 191,158,159
 QZ 156,92,60
 EX 136
 QK 156,88,56
 EX 137
 QK 156,84,52
 CV 168,136,137
 SC 138
 QK 156,80,48
 SC 139
 SC 140
 SM 128,176
 SC 141
 SM 132,184
 s_waitcnt lgkmcnt(14)
 SC 142
 PV 96,96,188
 EX 138
 PV 64,96,184
 EX 139
 PV 32,96,180
 CV 169,138,139
 SC 143
 PV 0,96,176
 s_waitcnt vmcnt(8) lgkmcnt(0)
 EX 140
 PV 4,100,176
 s_barrier
 PV 36,100,180
 RK 148,212,0
 SC 152
 PV 68,100,184
 RK 152,212,512
 SC 153
 PV 100,100,188
 RK 156,212,1024
 SC 154
 PV 104,104,188
 RK 160,212,1536
 SC 155
 PV 72,104,184
 RK 164,212,4096
 SC 156
 PV 40,104,180
 RK 168,212,4608
 SC 157
 PV 8,104,176
 RK 172,212,5120
 SC 158
 PV 12,108,176
 RK 176,212,5632
 SC 159
 PV 44,108,180
 RV 180,213,0
 RV 182,213,4096
 PV 76,108,184
 RV 184,213,8
 EX 141
 PV 108,108,188
 RV 186,213,4104
 CV 172,140,141
 PV 112,112,188
 RV 188,213,512
 EX 142
 PV 80,112,184
 RV 190,213,4608
 EX 143
 PV 48,112,180
 RV 192,213,520
 CV 173,142,143
 PV 16,112,176
 RV 194,213,4616
 RV 196,213,1024
 PV 20,116,176
 EX 152
 PV 52,116,180
 RV 198,213,5120
 RV 200,213,1032
 PV 84,116,184
 EX 153
 PV 116,116,188
 RV 202,213,5128
 CV 170,152,153
 PV 120,120,188
 RV 204,213,1536
 RV 206,213,5632
 PV 88,120,184
 EX 154
 PV 56,120,180
 RV 208,213,1544
 RV 210,213,5640
 PV 24,120,176
 EX 155
 PV 28,124,176
 RK 212,212,8192
 CV 171,154,155
 PV 60,124,180
 RK 216,212,8704
 RK 220,212,9216
 PV 92,124,184
 EX 156
 PV 124,124,188
 s_waitcnt lgkmcnt(15)
 RK 224,212,9728
 RK 228,212,12288
 QZ 136,148,32
 s_waitcnt lgkmcnt(15)
 EX 157
 QK 136,152,36
 s_waitcnt lgkmcnt(15)
 RK 232,212,12800
 CV 174,156,157
 QK 136,156,40
 s_waitcnt lgkmcnt(15)
 RK 236,212,13312
 RK 240,212,13824
 QK 136,160,44
 EX 158
 QZ 140,160,60
 RV 96,213,8192
 v_add_u32 v212, s32, v212
 QK 140,156,56
 RV 98,213,12288
 RV 100,213,8200
 QK 140,152,52
 EX 159
 QK 140,148,48
 s_waitcnt lgkmcnt(15)
 RV 102,213,12296
 CV 175,158,159
 QZ 152,164,32
 s_waitcnt lgkmcnt(15)
 RV 104,213,8704
 RV 106,213,12800
 QK 152,168,36
 s_waitcnt lgkmcnt(15)
 EX 128
 QK 152,172,40
 s_waitcnt lgkmcnt(15)
 RV 108,213,8712
 RV 110,213,12808
 QK 152,176,44
 EX 129
 QZ 156,176,60
 RV 112,213,9216
 CV 160,128,129
 QK 156,172,56
 RV 114,213,13312
 RV 116,213,9224
 QK 156,168,52
 EX 130
 QK 156,164,48
 RV 118,213,13320
 RV 120,213,9728
 EX 131
 EX 132
 RV 122,213,13824
 RV 124,213,9736
 CV 161,130,131
 EX 133
 RV 126,213,13832
 v_mfma_f32_16x16x16_bf16 a[128:131], a[144:145], v[160:161], a[128:131]
 CV 164,132,133
 EX 134
 EX 135
 v_add_u32 v213, s32, v213
 PS 136
 PS 138
 PS 140
 PS 142
 PS 152
 PS 154
 PS 156
 PS 158
 v_accvgpr_read_b32 v225, a128
 v_accvgpr_read_b32 v224, a129
 v_add_f32 v225, v224, v225
 v_rcp_f32 v224, v225
 v_subrev_u32 v225, 0x21800000, v225
 s_waitcnt lgkmcnt(15)
 PH 0,180,160
 s_waitcnt lgkmcnt(15)
 EX 136
 CV 165,134,135
 PH 4,184,160
 s_waitcnt lgkmcnt(15)
 EX 137
 EX 138
 PH 8,188,160
 EX 139
 CV 184,136,137
 CV 185,138,139
 EX 152
 PM 0,224,0
 PM 2,224,0
 PM 4,224,0
 PM 6,224,0
 PM 8,224,0
 PM 10,224,0
 s_waitcnt lgkmcnt(15)
 PH 12,192,160
 s_waitcnt lgkmcnt(15)
 CV 0,0,1
 CV 1,2,3
 CV 2,4,5
 PH 16,196,160
 s_waitcnt lgkmcnt(15)
 CV 3,6,7
 EX 153
 PH 20,200,160
 CV 8,8,9
 CV 9,10,11
 CV 186,152,153
 XE 4,8,0
 XE 5,9,1
 EX 154
 PM 12,224,0
 PM 14,224,0
 s_waitcnt lgkmcnt(15)
 PH 24,204,160
 s_waitcnt vmcnt(0) lgkmcnt(0)
 CV 10,12,13
 CV 11,14,15
 PH 28,208,160
 s_barrier
 v_mfma_f32_16x16x16_bf16 a[128:131], a[136:137], v[164:165], a[128:131]
 XE 6,10,2
 EX 155
 PH 32,180,164
 XE 7,11,3
 EX 140
 PH 36,184,164
 s_not_b64 vcc, vcc
 buffer_store_dwordx4 v[4:7], v220, s[24:27], s38 offen offset:0 nt
 v_accvgpr_read_b32 v227, a130
 PM 16,224,0
 PM 18,224,0
 PM 20,224,0
 PM 22,224,0
 PM 24,224,0
 PM 26,224,0
 PM 28,224,0
 PM 30,224,0
 v_accvgpr_read_b32 v226, a131
 v_add_f32 v227, v226, v227
 v_rcp_f32 v226, v227
 v_subrev_u32 v227, 0x21800000, v227
 PH 40,188,164
 XO 8,0,8
 XO 9,1,9
 XO 10,2,10
 PH 44,192,164
 XO 11,3,11
 CV 16,16,17
 CV 17,18,19
 PH 48,196,164
 CV 18,20,21
 CV 19,22,23
 CV 24,24,25
 PH 52,200,164
 buffer_store_dwordx4 v[8:11], v221, s[24:27], s38 offen offset:0 nt
 PH 56,204,164
 CV 25,26,27
 CV 26,28,29
 CV 27,30,31
 PH 60,208,164
 XO 28,16,24
 XO 29,17,25
 XO 30,18,26
 SM 132,168
 XO 31,19,27
 PV 96,180,172
 s_not_b64 vcc, vcc
 XE 16,24,16
 XE 17,25,17
 PV 64,180,168
 RV 180,213,0
 XE 18,26,18
 PV 68,184,168
 RV 182,213,4096
 XE 19,27,19
 PV 100,184,172
 buffer_store_dwordx4 v[28:31], v221, s[24:27], s38 offen offset:128 nt
 v_mul_f32 v48, v226, v48
 PM 32,226,0
 PM 34,226,0
 PM 36,226,0
 PM 38,226,0
 PM 40,226,0
 PM 42,226,0
 PM 44,226,0
 PM 46,226,0
 PV 104,188,172
 RV 184,213,8
 CV 32,32,33
 PV 72,188,168
 RV 186,213,4104
 CV 33,34,35
 PV 76,192,168
 RV 188,213,512
 CV 34,36,37
 PV 108,192,172
 RV 190,213,4608
 CV 35,38,39
 PV 112,196,172
 buffer_store_dwordx4 v[16:19], v220, s[24:27], s38 offen offset:128 nt
 PV 80,196,168
 RV 192,213,520
 CV 40,40,41
 PV 84,200,168
 RV 194,213,4616
 CV 41,42,43
 PV 116,200,172
 RV 196,213,1024
 CV 42,44,45
 PV 120,204,172
 RV 198,213,5120
 CV 43,46,47
 PV 88,204,168
 RV 200,213,1032
 XE 36,40,32
 PV 92,208,168
 RV 202,213,5128
 XE 37,41,33
 PV 124,208,172
 RV 204,213,1536
 XE 38,42,34
 QZ 136,212,32
 RV 206,213,5632
 XE 39,43,35
 QK 136,216,36
 s_not_b64 vcc, vcc
 buffer_store_dwordx4 v[36:39], v220, s[24:27], s38 offen offset:256 nt
 QK 136,220,40
 RV 208,213,1544
 XO 40,32,40
 QK 136,224,44
 RV 210,213,5640
 XO 41,33,41
 XO 42,34,42
 XO 43,35,43
 v_mul_f32 v49, v226, v49
 v_mul_f32 v50, v226, v50
 v_mul_f32 v51, v226, v51
 v_mul_f32 v52, v226, v52
 v_mul_f32 v53, v226, v53
 v_mul_f32 v54, v226, v54
 v_mul_f32 v55, v226, v55
 CV 48,48,49
 CV 49,50,51
 CV 50,52,53
 CV 51,54,55
 v_mul_f32 v56, v226, v56
 v_mul_f32 v57, v226, v57
 v_mul_f32 v58, v226, v58
 buffer_store_dwordx4 v[40:43], v221, s[24:27], s38 offen offset:256 nt
 v_mul_f32 v59, v226, v59
 v_mul_f32 v60, v226, v60
 v_mul_f32 v61, v226, v61
 v_mul_f32 v62, v226, v62
 v_mul_f32 v63, v226, v63
 CV 56,56,57
 CV 57,58,59
 CV 58,60,61
 CV 59,62,63
 XO 60,48,56
 XO 61,49,57
 XO 62,50,58
 XO 63,51,59
 CV 187,154,155
 v_mfma_f32_16x16x32_bf16 v[152:155], a[240:243], a[44:47], v[208:211]
 s_not_b64 vcc, vcc
 XE 48,56,48
 XE 49,57,49
 QK 152,236,40
 XE 50,58,50
 XE 51,59,51
 QK 152,232,36
 buffer_store_dwordx4 v[60:63], v221, s[24:27], s38 offen offset:384 nt
 QK 152,228,32
 EX 141
 EX 142
 CV 188,140,141
 EX 143
 EX 156
 CV 189,142,143
 QZ 140,212,48
 EX 157
 EX 158
 CV 190,156,157
 PS 136
 PS 138
 PS 152
 PS 154
 QK 140,216,52
 buffer_store_dwordx4 v[48:51], v220, s[24:27], s38 offen offset:384 nt
 QK 140,220,56
 EX 159
 QK 140,224,60
 EX 136
 CV 191,158,159
 v_mfma_f32_16x16x32_bf16 v[156:159], a[240:243], a[60:63], v[208:211]
 EX 137
 QK 156,236,56
 EX 138
 QK 156,232,52
 EX 139
 QK 156,228,48
 CV 168,136,137
 CV 169,138,139
 LS 132,144,184
 EX 152
 PV 64,96,184
 EX 153
 PV 68,100,184
 EX 154
 CV 170,152,153
 EX 155
 PS 140
 PS 142
 PS 156
 PS 158
 PV 72,104,184
 EX 140
 PV 76,108,184
 EX 141
 PV 80,112,184
 CV 171,154,155
 CV 172,140,141
 PV 84,116,184
 EX 142
 PV 88,120,184
 EX 143
 PV 92,124,184
 EX 156
 LS 132,144,168
 s_waitcnt lgkmcnt(14)
 EX 157
 PV 64,180,168
 s_waitcnt lgkmcnt(12)
 CV 173,142,143
 CV 174,156,157
 PV 68,184,168
 s_waitcnt lgkmcnt(10)
 EX 158
 PV 72,188,168
 EX 159
 v_accvgpr_read_b32 v229, a132
 v_accvgpr_read_b32 v228, a133
 v_add_f32 v229, v228, v229
 v_rcp_f32 v228, v229
 v_subrev_u32 v229, 0x21800000, v229
 PM 64,228,0
 PM 66,228,0
 PM 68,228,0
 PM 70,228,0
 PM 72,228,0
 PM 74,228,0
 v_max3_u32 v225, v225, v227, v229
 s_waitcnt lgkmcnt(8)
 PV 76,192,168
 s_waitcnt lgkmcnt(6)
 CV 64,64,65
 CV 65,66,67
 PV 80,196,168
 s_waitcnt lgkmcnt(4)
 CV 66,68,69
 CV 67,70,71
 PV 84,200,168
 CV 72,72,73
 CV 73,74,75
 CV 175,158,159
 XE 68,72,64
 XE 69,73,65
 PM 76,228,0
 PM 78,228,0
 s_waitcnt lgkmcnt(2)
 PV 88,204,168
 s_waitcnt lgkmcnt(0)
 CV 74,76,77
 CV 75,78,79
 PV 92,208,168
 XE 70,74,66
 XE 71,75,67
 LS 132,136,188
 s_not_b64 vcc, vcc
 buffer_store_dwordx4 v[68:71], v220, s[24:27], s39 offen offset:0 nt
 XO 72,64,72
 PM 80,228,0
 PM 82,228,0
 PM 84,228,0
 PM 86,228,0
 PM 88,228,0
 PM 90,228,0
 PM 92,228,0
 PM 94,228,0
 PV 96,96,188
 XO 73,65,73
 XO 74,66,74
 PV 100,100,188
 XO 75,67,75
 CV 80,80,81
 PV 104,104,188
 CV 81,82,83
 CV 82,84,85
 PV 108,108,188
 CV 83,86,87
 CV 88,88,89
 PV 112,112,188
 buffer_store_dwordx4 v[72:75], v221, s[24:27], s39 offen offset:0 nt
 PV 116,116,188
 CV 89,90,91
 CV 90,92,93
 PV 120,120,188
 CV 91,94,95
 XO 92,80,88
 PV 124,124,188
 XO 93,81,89
 XO 94,82,90
 LS 132,136,172
 XO 95,83,91
 PV 96,180,172
 s_not_b64 vcc, vcc
 XE 80,88,80
 XE 81,89,81
 PV 100,184,172
 XE 82,90,82
 XE 83,91,83
 v_accvgpr_read_b32 v231, a134
 v_accvgpr_read_b32 v230, a135
 v_add_f32 v231, v230, v231
 v_rcp_f32 v230, v231
 v_subrev_u32 v231, 0x21800000, v231
 v_max_u32 v225, v225, v231
 v_cmp_le_u32 s[84:85], s77, v225
 PV 104,188,172
 buffer_store_dwordx4 v[92:95], v221, s[24:27], s39 offen offset:128 nt
 PM 96,230,0
 PM 98,230,0
 PM 100,230,0
 PM 102,230,0
 PV 108,192,172
 s_cmp_lg_u64 s[84:85], 0
 CV 96,96,97
 CV 97,98,99
 CV 98,100,101
 CV 99,102,103
 PM 104,230,0
 PM 106,230,0
 PV 112,196,172
 s_cselect_b32 s92, s76, 0
 CV 104,104,105
 CV 105,106,107
 PM 108,230,0
 PM 110,230,0
 PV 116,200,172
 s_or_b32 s73, s73, s92
 buffer_store_dwordx4 v[80:83], v220, s[24:27], s39 offen offset:128 nt
 PV 120,204,172
 s_lshl_b32 s76, s76, 1
 CV 106,108,109
 CV 107,110,111
 PV 124,208,172
 XE 100,104,96
 XE 101,105,97
 XE 102,106,98
 XE 103,107,99
 s_not_b64 vcc, vcc
 XO 104,96,104
 XO 105,97,105
 XO 106,98,106
 XO 107,99,107
 buffer_store_dwordx4 v[100:103], v220, s[24:27], s39 offen offset:256 nt
 PM 112,230,0
 PM 114,230,0
 PM 116,230,0
 PM 118,230,0
 CV 112,112,113
 CV 113,114,115
 CV 114,116,117
 CV 115,118,119
 PM 120,230,0
 PM 122,230,0
 PM 124,230,0
 PM 126,230,0
 CV 120,120,121
 CV 121,122,123
 CV 122,124,125
 CV 123,126,127
 XO 124,112,120
 XO 125,113,121
 XO 126,114,122
 XO 127,115,123
 s_not_b64 vcc, vcc
 XE 112,120,112
 XE 113,121,113
 XE 114,122,114
 XE 115,123,115
 buffer_store_dwordx4 v[104:107], v221, s[24:27], s39 offen offset:256 nt
 buffer_store_dwordx4 v[124:127], v221, s[24:27], s39 offen offset:384 nt
 buffer_store_dwordx4 v[112:115], v220, s[24:27], s39 offen offset:384 nt
 s_cmp_lg_u32 s73, 0
 s_cbranch_scc1 L_hop
 s_endpgm
.p2align 12
L_u2:
 QZ 128,64,0
 s_cmp_eq_u32 s33, 0x8000
 RV 96,213,8192
 SC 156
 QK 128,68,4
 s_cselect_b32 s32, -2, 1
 RV 98,213,12288
 SC 157
 QK 128,72,8
 s_lshl_b32 s32, s32, 14
 RV 100,213,8200
 v_add_u32 v212, s32, v212
 QK 128,76,12
 s_add_u32 s31, s33, s37
 RV 102,213,12296
 SC 158
 QZ 132,76,28
 s_add_u32 s33, s33, s32
 RV 104,213,8704
 SC 159
 QK 132,72,24
 s_add_u32 s31, s33, s37
 RV 106,213,12800
 SC 128
 QK 132,68,20
 RV 108,213,8712
 SC 129
 QK 132,64,16
 RV 110,213,12808
 SC 130
 QZ 136,64,32
 RV 112,213,9216
 SC 131
 QK 136,68,36
 RV 114,213,13312
 RV 116,213,9224
 QK 136,72,40
 RV 118,213,13320
 SC 132
 QK 136,76,44
 RV 120,213,9728
 SC 133
 QZ 140,76,60
 RV 122,213,13824
 SC 134
 QK 140,72,56
 RV 124,213,9736
 SC 135
 QK 140,68,52
 RV 126,213,13832
 v_add_u32 v213, s32, v213
 QK 140,64,48
 s_cmp_eq_u32 s33, 0x8000
 EX 156
 v_mfma_f32_16x16x32_bf16 v[144:147], a[80:83], a[0:3], v[208:211]
 s_cselect_b32 s32, -2, 1
 EX 157
 QK 144,84,4
 s_lshl_b32 s32, s32, 14
 CV 190,156,157
 SC 136
 QK 144,88,8
 s_add_u32 s33, s33, s32
 EX 158
 QK 144,92,12
 EX 159
 v_mfma_f32_16x16x32_bf16 v[148:151], a[92:95], a[28:31], v[208:211]
 CV 191,158,159
 SC 137
 QK 148,88,24
 EX 136
 QK 148,84,20
 EX 137
 QK 148,80,16
 CV 168,136,137
 SC 138
 QZ 152,80,32
 SC 139
 SC 140
 QK 152,84,36
 EX 138
 QK 152,88,40
 EX 139
 QK 152,92,44
 CV 169,138,139
 SC 141
 QZ 156,92,60
 EX 140
 QK 156,88,56
 EX 141
 QK 156,84,52
 s_waitcnt vmcnt(8) lgkmcnt(0)
 CV 172,140,141
 SC 142
 QK 156,80,48
 s_barrier
 SM 128,176
 RK 148,212,0
 SC 143
 SM 132,184
 RK 152,212,512
 SC 152
 PV 96,96,188
 RK 156,212,1024
 SC 153
 PV 64,96,184
 RK 160,212,1536
 SC 154
 PV 32,96,180
 RK 164,212,4096
 SC 155
 PV 0,96,176
 RK 168,212,4608
 SC 156
 PV 4,100,176
 RK 172,212,5120
 SC 157
 PV 36,100,180
 RK 176,212,5632
 SC 158
 PV 68,100,184
 RV 180,213,0
 SC 159
 PV 100,100,188
 RV 182,213,4096
 SC 144
 PV 104,104,188
 RV 184,213,8
 SC 145
 PV 72,104,184
 RV 186,213,4104
 SC 146
 PV 40,104,180
 RV 188,213,512
 SC 147
 PV 8,104,176
 RV 190,213,4608
 SC 148
 PV 12,108,176
 RV 192,213,520
 SC 149
 PV 44,108,180
 RV 194,213,4616
 SC 150
 PV 76,108,184
 RV 196,213,1024
 SC 151
 PV 108,108,188
 RV 198,213,5120
 RV 200,213,1032
 PV 112,112,188
 RV 202,213,5128
 EX 142
 PV 80,112,184
 RV 204,213,1536
 EX 143
 PV 48,112,180
 RV 206,213,5632
 CV 173,142,143
 PV 16,112,176
 RV 208,213,1544
 EX 152
 PV 20,116,176
 RV 210,213,5640
 RK 212,212,8192
 PV 52,116,180
 EX 153
 PV 84,116,184
 RK 216,212,8704
 CV 170,152,153
 PV 116,116,188
 RK 220,212,9216
 RK 224,212,9728
 PV 120,120,188
 EX 154
 PV 88,120,184
 RV 96,213,8192
 v_add_u32 v212, s32, v212
 PV 56,120,180
 RV 98,213,12288
 RV 100,213,8200
 PV 24,120,176
 EX 155
 PV 28,124,176
 RV 102,213,12296
 CV 171,154,155
 PV 60,124,180
 RV 104,213,8704
 RV 106,213,12800
 PV 92,124,184
 EX 156
 PV 124,124,188
 s_waitcnt lgkmcnt(15)
 RV 108,213,8712
 RV 110,213,12808
 QZ 136,148,32
 s_waitcnt lgkmcnt(15)
 EX 157
 QK 136,152,36
 s_waitcnt lgkmcnt(15)
 RV 112,213,9216
 CV 174,156,157
 QK 136,156,40
 s_waitcnt lgkmcnt(15)
 RV 114,213,13312
 RV 116,213,9224
 QK 136,160,44
 EX 158
 QZ 140,160,60
 RV 118,213,13320
 RV 120,213,9728
 QK 140,156,56
 EX 159
 QK 140,152,52
 RV 122,213,13824
 CV 175,158,159
 QK 140,148,48
 s_waitcnt lgkmcnt(15)
 RV 124,213,9736
 RV 126,213,13832
 QZ 152,164,32
 s_waitcnt lgkmcnt(15)
 EX 128
 QK 152,168,36
 s_waitcnt lgkmcnt(15)
 EX 129
 QK 152,172,40
 s_waitcnt lgkmcnt(15)
 CV 160,128,129
 v_add_u32 v213, s32, v213
 QK 152,176,44
 EX 130
 QZ 156,176,60
 EX 131
 QK 156,172,56
 EX 144
 QK 156,168,52
 EX 145
 QK 156,164,48
 CV 161,130,131
 CV 162,144,145
 EX 146
 EX 147
 EX 132
 CV 163,146,147
 EX 133
 EX 134
 LS 128,144,160
 EX 135
 CV 164,132,133
 CV 165,134,135
 EX 148
 PS 136
 PS 138
 PS 140
 PS 142
 PS 152
 PS 154
 PS 156
 PS 158
 v_accvgpr_read_b32 v225, a128
 v_accvgpr_read_b32 v224, a129
 v_add_f32 v225, v224, v225
 v_rcp_f32 v224, v225
 v_subrev_u32 v225, 0x21800000, v225
 s_waitcnt lgkmcnt(15)
 PV 0,180,160
 s_waitcnt lgkmcnt(15)
 EX 149
 PV 4,184,160
 s_waitcnt lgkmcnt(15)
 EX 150
 PV 8,188,160
 s_waitcnt vmcnt(0) lgkmcnt(0)
 EX 151
 PV 12,192,160
 s_barrier
 CV 166,148,149
 CV 167,150,151
 PM 0,224,0
 PM 2,224,0
 PM 4,224,0
 PM 6,224,0
 PM 8,224,0
 PM 10,224,0
 PM 12,224,0
 PM 14,224,0
 PV 16,196,160
 CV 0,0,1
 CV 1,2,3
 PV 20,200,160
 CV 2,4,5
 CV 3,6,7
 PV 24,204,160
 EX 136
 PV 28,208,160
 EX 137
 LS 128,136,164
 CV 8,8,9
 CV 9,10,11
 PV 32,180,164
 CV 10,12,13
 CV 11,14,15
 PV 36,184,164
 XE 4,8,0
 XE 5,9,1
 v_accvgpr_read_b32 v227, a130
 v_accvgpr_read_b32 v226, a131
 v_add_f32 v227, v226, v227
 v_rcp_f32 v226, v227
 v_subrev_u32 v227, 0x21800000, v227
 PV 40,188,164
 XE 6,10,2
 XE 7,11,3
 PV 44,192,164
 s_not_b64 vcc, vcc
 buffer_store_dwordx4 v[4:7], v220, s[24:27], s38 offen offset:0 nt
 XO 8,0,8
 PM 16,224,0
 PM 18,224,0
 PM 20,224,0
 PM 22,224,0
 PM 24,224,0
 PM 26,224,0
 PM 28,224,0
 PM 30,224,0
 PV 48,196,164
 XO 9,1,9
 XO 10,2,10
 PV 52,200,164
 XO 11,3,11
 CV 16,16,17
 PV 56,204,164
 CV 17,18,19
 CV 18,20,21
 PV 60,208,164
 CV 19,22,23
 CV 24,24,25
 SM 132,168
 buffer_store_dwordx4 v[8:11], v221, s[24:27], s38 offen offset:0 nt
 PV 96,180,172
 CV 25,26,27
 CV 26,28,29
 PV 64,180,168
 RV 180,213,0
 CV 27,30,31
 PV 68,184,168
 XO 28,16,24
 XO 29,17,25
 PV 100,184,172
 RV 184,213,8
 XO 30,18,26
 PV 104,188,172
 XO 31,19,27
 CV 184,136,137
 PV 72,188,168
 s_not_b64 vcc, vcc
 RV 188,213,512
 XE 16,24,16
 PV 76,192,168
 buffer_store_dwordx4 v[28:31], v221, s[24:27], s38 offen offset:128 nt
 XE 17,25,17
 PM 32,226,0
 PM 34,226,0
 PM 36,226,0
 PM 38,226,0
 PM 40,226,0
 PM 42,226,0
 PM 44,226,0
 PM 46,226,0
 PV 108,192,172
 RV 192,213,520
 XE 18,26,18
 PV 112,196,172
 XE 19,27,19
 CV 32,32,33
 PV 80,196,168
 RV 196,213,1024
 CV 33,34,35
 PV 84,200,168
 CV 34,36,37
 CV 35,38,39
 PV 116,200,172
 buffer_store_dwordx4 v[16:19], v220, s[24:27], s38 offen offset:128 nt
 PV 120,204,172
 RV 200,213,1032
 CV 40,40,41
 PV 88,204,168
 RV 204,213,1536
 CV 41,42,43
 PV 92,208,168
 CV 42,44,45
 CV 43,46,47
 PV 124,208,172
 RV 208,213,1544
 XE 36,40,32
 XE 37,41,33
 XE 38,42,34
 XE 39,43,35
 s_not_b64 vcc, vcc
 XO 40,32,40
 XO 41,33,41
 XO 42,34,42
 XO 43,35,43
 buffer_store_dwordx4 v[36:39], v220, s[24:27], s38 offen offset:256 nt
 PM 48,226,0
 PM 50,226,0
 PM 52,226,0
 PM 54,226,0
 CV 48,48,49
 CV 49,50,51
 CV 50,52,53
 CV 51,54,55
 PM 56,226,0
 PM 58,226,0
 PM 60,226,0
 PM 62,226,0
 CV 56,56,57
 CV 57,58,59
 CV 58,60,61
 CV 59,62,63
 XO 60,48,56
 XO 61,49,57
 XO 62,50,58
 XO 63,51,59
 s_not_b64 vcc, vcc
 XE 48,56,48
 XE 49,57,49
 XE 50,58,50
 buffer_store_dwordx4 v[40:43], v221, s[24:27], s38 offen offset:256 nt
 XE 51,59,51
 EX 138
 EX 139
 EX 140
 CV 185,138,139
 v_mfma_f32_16x16x32_bf16 v[136:139], a[212:215], a[32:35], v[208:211]
 EX 141
 QK 136,216,36
 EX 142
 QK 136,220,40
 EX 143
 QK 136,224,44
 CV 188,140,141
 CV 189,142,143
 v_mfma_f32_16x16x32_bf16 v[140:143], a[212:215], a[48:51], v[208:211]
 buffer_store_dwordx4 v[60:63], v221, s[24:27], s38 offen offset:384 nt
 QK 140,216,52
 EX 152
 QK 140,220,56
 EX 153
 EX 154
 CV 186,152,153
 PS 136
 PS 138
 QK 140,224,60
 EX 155
 EX 136
 CV 187,154,155
 EX 137
 EX 138
 LS 132,144,184
 buffer_store_dwordx4 v[48:51], v220, s[24:27], s38 offen offset:384 nt
 PV 64,96,184
 EX 139
 CV 168,136,137
 CV 169,138,139
 EX 156
 PS 140
 PS 142
 PV 68,100,184
 EX 157
 PV 72,104,184
 EX 158
 PV 76,108,184
 EX 159
 PV 80,112,184
 CV 190,156,157
 CV 191,158,159
 PV 84,116,184
 EX 140
 PV 88,120,184
 EX 141
 PV 92,124,184
 EX 142
 v_mfma_f32_16x16x16_bf16 a[132:135], a[144:145], v[168:169], a[132:135]
 s_waitcnt lgkmcnt(7)
 EX 143
 CV 172,140,141
 PH 64,180,168
 s_waitcnt lgkmcnt(6)
 CV 173,142,143
 PH 68,184,168
 s_waitcnt lgkmcnt(5)
 PH 72,188,168
 s_waitcnt lgkmcnt(4)
 PH 76,192,168
 s_waitcnt lgkmcnt(3)
 PH 80,196,168
 v_accvgpr_read_b32 v229, a132
 v_accvgpr_read_b32 v228, a133
 v_add_f32 v229, v228, v229
 v_rcp_f32 v228, v229
 v_subrev_u32 v229, 0x21800000, v229
 PM 64,228,0
 PM 66,228,0
 PM 68,228,0
 PM 70,228,0
 PM 72,228,0
 PM 74,228,0
 PM 76,228,0
 PM 78,228,0
 v_max3_u32 v225, v225, v227, v229
 s_waitcnt lgkmcnt(2)
 PH 84,200,168
 s_waitcnt lgkmcnt(1)
 CV 64,64,65
 CV 65,66,67
 CV 66,68,69
 PH 88,204,168
 s_waitcnt lgkmcnt(0)
 CV 67,70,71
 CV 72,72,73
 CV 73,74,75
 PH 92,208,168
 CV 74,76,77
 CV 75,78,79
 XE 68,72,64
 LS 132,136,188
 XE 69,73,65
 XE 70,74,66
 PV 96,96,188
 XE 71,75,67
 PV 100,100,188
 s_not_b64 vcc, vcc
 buffer_store_dwordx4 v[68:71], v220, s[24:27], s39 offen offset:0 nt
 XO 72,64,72
 PM 80,228,0
 PM 82,228,0
 PM 84,228,0
 PM 86,228,0
 PM 88,228,0
 PM 90,228,0
 PM 92,228,0
 PM 94,228,0
 PV 104,104,188
 XO 73,65,73
 XO 74,66,74
 PV 108,108,188
 XO 75,67,75
 CV 80,80,81
 PV 112,112,188
 CV 81,82,83
 CV 82,84,85
 PV 116,116,188
 CV 83,86,87
 CV 88,88,89
 PV 120,120,188
 buffer_store_dwordx4 v[72:75], v221, s[24:27], s39 offen offset:0 nt
 PV 124,124,188
 CV 89,90,91
 CV 90,92,93
 v_mfma_f32_16x16x16_bf16 a[132:135], a[136:137], v[172:173], a[132:135]
 CV 91,94,95
 XO 92,80,88
 XO 93,81,89
 PH 96,180,172
 XO 94,82,90
 XO 95,83,91
 PH 100,184,172
 s_not_b64 vcc, vcc
 XE 80,88,80
 XE 81,89,81
 v_accvgpr_read_b32 v231, a134
 v_accvgpr_read_b32 v230, a135
 v_add_f32 v231, v230, v231
 v_rcp_f32 v230, v231
 v_subrev_u32 v231, 0x21800000, v231
 v_max_u32 v225, v225, v231
 v_cmp_le_u32 s[84:85], s77, v225
 PH 104,188,172
 buffer_store_dwordx4 v[92:95], v221, s[24:27], s39 offen offset:128 nt
 XE 82,90,82
 XE 83,91,83
 PM 96,230,0
 PM 98,230,0
 PM 100,230,0
 PM 102,230,0
 PH 108,192,172
 CV 96,96,97
 CV 97,98,99
 CV 98,100,101
 CV 99,102,103
 PM 104,230,0
 PM 106,230,0
 PH 112,196,172
 CV 104,104,105
 CV 105,106,107
 PM 108,230,0
 PM 110,230,0
 PH 116,200,172
 buffer_store_dwordx4 v[80:83], v220, s[24:27], s39 offen offset:128 nt
 PH 120,204,172
 s_cmp_lg_u64 s[84:85], 0
 CV 106,108,109
 CV 107,110,111
 PH 124,208,172
 s_cselect_b32 s92, s76, 0
 XE 100,104,96
 XE 101,105,97
 XE 102,106,98
 XE 103,107,99
 s_not_b64 vcc, vcc
 XO 104,96,104
 XO 105,97,105
 XO 106,98,106
 XO 107,99,107
 s_or_b32 s73, s73, s92
 s_lshl_b32 s76, s76, 1
 buffer_store_dwordx4 v[100:103], v220, s[24:27], s39 offen offset:256 nt
 PM 112,230,0
 PM 114,230,0
 PM 116,230,0
 PM 118,230,0
 CV 112,112,113
 CV 113,114,115
 CV 114,116,117
 CV 115,118,119
 PM 120,230,0
 PM 122,230,0
 PM 124,230,0
 PM 126,230,0
 CV 120,120,121
 CV 121,122,123
 CV 122,124,125
 CV 123,126,127
 XO 124,112,120
 XO 125,113,121
 XO 126,114,122
 XO 127,115,123
 s_not_b64 vcc, vcc
 XE 112,120,112
 XE 113,121,113
 XE 114,122,114
 XE 115,123,115
 buffer_store_dwordx4 v[104:107], v221, s[24:27], s39 offen offset:256 nt
 buffer_store_dwordx4 v[124:127], v221, s[24:27], s39 offen offset:384 nt
 buffer_store_dwordx4 v[112:115], v220, s[24:27], s39 offen offset:384 nt
 s_cmp_lg_u32 s73, 0
 s_cbranch_scc1 L_hop
 s_endpgm
.p2align 12
L_u3:
 QZ 128,64,0
 s_cmp_eq_u32 s33, 0x8000
 RV 96,213,8192
 SC 156
 QK 128,68,4
 s_cselect_b32 s32, -2, 1
 RV 98,213,12288
 SC 157
 QK 128,72,8
 s_lshl_b32 s32, s32, 14
 RV 100,213,8200
 v_add_u32 v212, s32, v212
 QK 128,76,12
 s_add_u32 s31, s33, s37
 RV 102,213,12296
 SC 158
 QZ 132,76,28
 s_add_u32 s33, s33, s32
 RV 104,213,8704
 SC 159
 QK 132,72,24
 s_add_u32 s31, s33, s37
 RV 106,213,12800
 SC 128
 QK 132,68,20
 RV 108,213,8712
 SC 129
 QK 132,64,16
 RV 110,213,12808
 SC 130
 QZ 136,64,32
 RV 112,213,9216
 SC 131
 QK 136,68,36
 RV 114,213,13312
 RV 116,213,9224
 QK 136,72,40
 RV 118,213,13320
 SC 132
 QK 136,76,44
 RV 120,213,9728
 SC 133
 QZ 140,76,60
 RV 122,213,13824
 SC 134
 QK 140,72,56
 RV 124,213,9736
 SC 135
 QK 140,68,52
 RV 126,213,13832
 v_add_u32 v213, s32, v213
 QK 140,64,48
 s_cmp_eq_u32 s33, 0x8000
 EX 156
 QZ 144,80,0
 s_cselect_b32 s32, -2, 1
 EX 157
 QK 144,84,4
 s_lshl_b32 s32, s32, 14
 CV 190,156,157
 SC 136
 QK 144,88,8
 s_add_u32 s33, s33, s32
 EX 158
 QK 144,92,12
 EX 159
 QZ 148,92,28
 CV 191,158,159
 SC 137
 QK 148,88,24
 EX 128
 QK 148,84,20
 EX 129
 QK 148,80,16
 CV 160,128,129
 SC 138
 QZ 152,80,32
 EX 130
 QK 152,84,36
 EX 131
 QK 152,88,40
 CV 161,130,131
 SC 139
 QK 152,92,44
 EX 132
 QZ 156,92,60
 EX 133
 QK 156,88,56
 CV 164,132,133
 SC 140
 QK 156,84,52
 s_waitcnt vmcnt(8) lgkmcnt(0)
 EX 134
 QK 156,80,48
 s_barrier
 SM 128,176
 RK 148,212,0
 SC 141
 SM 132,184
 RK 152,212,512
 SC 142
 PV 96,96,188
 RK 156,212,1024
 SC 143
 EX 135
 EX 136
 PS 144
 PS 146
 PS 148
 PS 150
 PS 152
 PS 154
 PS 156
 PS 158
 PV 64,96,184
 RK 160,212,1536
 CV 165,134,135
 PV 32,96,180
 RK 164,212,4096
 RK 168,212,4608
 PV 0,96,176
 RK 172,212,5120
 EX 137
 PV 4,100,176
 RK 176,212,5632
 CV 168,136,137
 PV 36,100,180
 RV 180,213,0
 v_add_u32 v212, s32, v212
 PV 68,100,184
 RV 182,213,4096
 EX 138
 PV 100,100,188
 RV 184,213,8
 EX 139
 PV 104,104,188
 RV 186,213,4104
 CV 169,138,139
 PV 72,104,184
 RV 188,213,512
 RV 190,213,4608
 PV 40,104,180
 EX 140
 PV 8,104,176
 RV 192,213,520
 RV 194,213,4616
 PV 12,108,176
 EX 141
 PV 44,108,180
 RV 196,213,1024
 CV 172,140,141
 PV 76,108,184
 RV 198,213,5120
 RV 200,213,1032
 PV 108,108,188
 EX 142
 PV 112,112,188
 RV 202,213,5128
 RV 204,213,1536
 PV 80,112,184
 EX 143
 PV 48,112,180
 RV 206,213,5632
 CV 173,142,143
 PV 16,112,176
 RV 208,213,1544
 RV 210,213,5640
 PV 20,116,176
 EX 152
 PV 52,116,180
 RV 96,213,8192
 RV 98,213,12288
 PV 84,116,184
 EX 153
 PV 116,116,188
 RV 100,213,8200
 CV 170,152,153
 PV 120,120,188
 RV 102,213,12296
 RV 104,213,8704
 PV 88,120,184
 EX 154
 PV 56,120,180
 RV 106,213,12800
 RV 108,213,8712
 PV 24,120,176
 EX 155
 PV 28,124,176
 RV 110,213,12808
 CV 171,154,155
 PV 60,124,180
 RV 112,213,9216
 RV 114,213,13312
 PV 92,124,184
 EX 156
 PV 124,124,188
 s_waitcnt lgkmcnt(15)
 RV 116,213,9224
 RV 118,213,13320
 v_mfma_f32_16x16x32_bf16 v[128:131], a[148:151], a[0:3], v[208:211]
 s_waitcnt lgkmcnt(15)
 EX 157
 QK 128,152,4
 s_waitcnt lgkmcnt(15)
 RV 120,213,9728
 CV 174,156,157
 QK 128,156,8
 s_waitcnt lgkmcnt(15)
 RV 122,213,13824
 RV 124,213,9736
 QK 128,160,12
 EX 158
 v_mfma_f32_16x16x32_bf16 v[132:135], a[160:163], a[28:31], v[208:211]
 RV 126,213,13832
 v_add_u32 v213, s32, v213
 QK 132,156,24
 EX 159
 QK 132,152,20
 EX 144
 QK 132,148,16
 CV 175,158,159
 SC 128
 QZ 136,148,32
 EX 145
 QK 136,152,36
 CV 162,144,145
 SC 129
 QK 136,156,40
 EX 146
 QK 136,160,44
 EX 147
 QZ 140,160,60
 CV 163,146,147
 SC 130
 QK 140,156,56
 EX 148
 QK 140,152,52
 EX 149
 QK 140,148,48
 s_waitcnt lgkmcnt(15)
 CV 166,148,149
 SC 131
 v_mfma_f32_16x16x32_bf16 v[152:155], a[164:167], a[32:35], v[208:211]
 s_waitcnt lgkmcnt(15)
 EX 150
 QK 152,168,36
 s_waitcnt lgkmcnt(15)
 EX 151
 QK 152,172,40
 s_waitcnt lgkmcnt(15)
 CV 167,150,151
 SC 132
 QK 152,176,44
 EX 128
 v_mfma_f32_16x16x32_bf16 v[156:159], a[176:179], a[60:63], v[208:211]
 EX 129
 QK 156,172,56
 CV 176,128,129
 SC 133
 QK 156,168,52
 EX 130
 QK 156,164,48
 s_waitcnt vmcnt(0) lgkmcnt(0)
 EX 131
 SM 128,160
 s_barrier
 CV 177,130,131
 PV 32,180,164
 EX 132
 PV 0,180,160
 EX 133
 SC 134
 CV 180,132,133
 SC 135
 PS 152
 PS 154
 PS 156
 PS 158
 PV 4,184,160
 EX 134
 PV 36,184,164
 EX 135
 PV 40,188,164
 CV 181,134,135
 SC 136
 PV 8,188,160
 SC 137
 SC 138
 PV 12,192,160
 EX 136
 PV 44,192,164
 EX 137
 PV 48,196,164
 CV 184,136,137
 SC 139
 PV 16,196,160
 EX 138
 PV 20,200,160
 EX 139
 PV 52,200,164
 CV 185,138,139
 SC 140
 PV 56,204,164
 EX 152
 PV 24,204,160
 EX 153
 PV 28,208,160
 CV 186,152,153
 SC 141
 PV 60,208,164
 EX 154
 v_mfma_f32_16x16x16_bf16 a[128:131], a[144:145], v[176:177], a[128:131]
 EX 155
 SC 142
 PH 0,96,176
 CV 187,154,155
 EX 140
 PH 4,100,176
 EX 141
 SC 143
 v_accvgpr_read_b32 v225, a128
 v_accvgpr_read_b32 v224, a129
 v_add_f32 v225, v224, v225
 v_rcp_f32 v224, v225
 v_subrev_u32 v225, 0x21800000, v225
 PM 0,224,0
 PM 2,224,0
 PM 4,224,0
 PM 6,224,0
 PH 8,104,176
 CV 0,0,1
 CV 1,2,3
 CV 2,4,5
 PH 12,108,176
 CV 3,6,7
 EX 142
 PH 16,112,176
 EX 143
 CV 188,140,141
 CV 189,142,143
 EX 156
 PM 8,224,0
 PM 10,224,0
 PM 12,224,0
 PM 14,224,0
 PH 20,116,176
 EX 157
 CV 8,8,9
 PH 24,120,176
 CV 9,10,11
 CV 10,12,13
 CV 11,14,15
 PH 28,124,176
 XE 4,8,0
 XE 5,9,1
 XE 6,10,2
 v_mfma_f32_16x16x16_bf16 a[128:131], a[136:137], v[180:181], a[128:131]
 XE 7,11,3
 EX 158
 PH 32,96,180
 s_not_b64 vcc, vcc
 buffer_store_dwordx4 v[4:7], v220, s[24:27], s38 offen offset:0 nt
 XO 8,0,8
 PM 16,224,0
 PM 18,224,0
 PM 20,224,0
 PM 22,224,0
 PM 24,224,0
 PM 26,224,0
 PM 28,224,0
 PM 30,224,0
 v_accvgpr_read_b32 v227, a130
 v_accvgpr_read_b32 v226, a131
 v_add_f32 v227, v226, v227
 v_rcp_f32 v226, v227
 v_subrev_u32 v227, 0x21800000, v227
 PH 36,100,180
 XO 9,1,9
 XO 10,2,10
 XO 11,3,11
 PH 40,104,180
 CV 16,16,17
 CV 17,18,19
 CV 18,20,21
 PH 44,108,180
 buffer_store_dwordx4 v[8:11], v221, s[24:27], s38 offen offset:0 nt
 PH 48,112,180
 CV 19,22,23
 CV 24,24,25
 CV 25,26,27
 PH 52,116,180
 CV 26,28,29
 CV 27,30,31
 XO 28,16,24
 PH 56,120,180
 XO 29,17,25
 XO 30,18,26
 XO 31,19,27
 PH 60,124,180
 s_not_b64 vcc, vcc
 XE 16,24,16
 XE 17,25,17
 SM 132,168
 XE 18,26,18
 PV 96,180,172
 XE 19,27,19
 CV 190,156,157
 PV 64,180,168
 buffer_store_dwordx4 v[28:31], v221, s[24:27], s38 offen offset:128 nt
 EX 159
 PM 32,226,0
 PM 34,226,0
 PM 36,226,0
 PM 38,226,0
 PM 40,226,0
 PM 42,226,0
 PM 44,226,0
 PM 46,226,0
 PV 68,184,168
 CV 32,32,33
 CV 33,34,35
 PV 100,184,172
 CV 34,36,37
 CV 35,38,39
 PV 104,188,172
 CV 40,40,41
 CV 41,42,43
 PV 72,188,168
 buffer_store_dwordx4 v[16:19], v220, s[24:27], s38 offen offset:128 nt
 PV 76,192,168
 CV 42,44,45
 CV 43,46,47
 PV 108,192,172
 XE 36,40,32
 XE 37,41,33
 PV 112,196,172
 XE 38,42,34
 XE 39,43,35
 PV 80,196,168
 s_not_b64 vcc, vcc
 XO 40,32,40
 XO 41,33,41
 PV 84,200,168
 XO 42,34,42
 XO 43,35,43
 PV 116,200,172
 CV 191,158,159
 PV 120,204,172
 buffer_store_dwordx4 v[36:39], v220, s[24:27], s38 offen offset:256 nt
 PM 48,226,0
 PM 50,226,0
 PM 52,226,0
 PM 54,226,0
 PM 56,226,0
 PM 58,226,0
 PM 60,226,0
 PM 62,226,0
 PV 88,204,168
 CV 48,48,49
 CV 49,50,51
 PV 92,208,168
 CV 50,52,53
 CV 51,54,55
 PV 124,208,172
 CV 56,56,57
 CV 57,58,59
 LS 132,144,184
 CV 58,60,61
 CV 59,62,63
 PV 64,96,184
 buffer_store_dwordx4 v[40:43], v221, s[24:27], s38 offen offset:256 nt
 PV 68,100,184
 XO 60,48,56
 XO 61,49,57
 PV 72,104,184
 XO 62,50,58
 XO 63,51,59
 v_accvgpr_read_b32 v229, a132
 v_accvgpr_read_b32 v228, a133
 v_add_f32 v229, v228, v229
 v_rcp_f32 v228, v229
 v_subrev_u32 v229, 0x21800000, v229
 v_max3_u32 v225, v225, v227, v229
 PV 76,108,184
 s_not_b64 vcc, vcc
 XE 48,56,48
 XE 49,57,49
 PV 80,112,184
 XE 50,58,50
 XE 51,59,51
 PV 84,116,184
 buffer_store_dwordx4 v[60:63], v221, s[24:27], s38 offen offset:384 nt
 PM 64,228,0
 PM 66,228,0
 PM 68,228,0
 PM 70,228,0
 PM 72,228,0
 PM 74,228,0
 PM 76,228,0
 PM 78,228,0
 PV 88,120,184
 CV 64,64,65
 CV 65,66,67
 PV 92,124,184
 CV 66,68,69
 CV 67,70,71
 LS 132,136,188
 CV 72,72,73
 CV 73,74,75
 PV 96,96,188
 CV 74,76,77
 CV 75,78,79
 PV 100,100,188
 buffer_store_dwordx4 v[48:51], v220, s[24:27], s38 offen offset:384 nt
 PV 104,104,188
 XE 68,72,64
 XE 69,73,65
 v_accvgpr_read_b32 v231, a134
 v_accvgpr_read_b32 v230, a135
 v_add_f32 v231, v230, v231
 v_rcp_f32 v230, v231
 v_subrev_u32 v231, 0x21800000, v231
 v_max_u32 v225, v225, v231
 v_cmp_le_u32 s[84:85], s77, v225
 PV 108,108,188
 XE 70,74,66
 XE 71,75,67
 PV 112,112,188
 s_not_b64 vcc, vcc
 XO 72,64,72
 XO 73,65,73
 PV 116,116,188
 s_cmp_lg_u64 s[84:85], 0
 XO 74,66,74
 XO 75,67,75
 PV 120,120,188
 s_cselect_b32 s92, s76, 0
 buffer_store_dwordx4 v[68:71], v220, s[24:27], s39 offen offset:0 nt
 PM 80,228,0
 PM 82,228,0
 PM 84,228,0
 PM 86,228,0
 PM 88,228,0
 PM 90,228,0
 PM 92,228,0
 PM 94,228,0
 PV 124,124,188
 s_or_b32 s73, s73, s92
 CV 80,80,81
 CV 81,82,83
 CV 82,84,85
 CV 83,86,87
 CV 88,88,89
 CV 89,90,91
 CV 90,92,93
 CV 91,94,95
 XO 92,80,88
 XO 93,81,89
 XO 94,82,90
 XO 95,83,91
 s_not_b64 vcc, vcc
 buffer_store_dwordx4 v[72:75], v221, s[24:27], s39 offen offset:0 nt
 XE 80,88,80
 XE 81,89,81
 XE 82,90,82
 XE 83,91,83
 s_lshl_b32 s76, s76, 1
 buffer_store_dwordx4 v[92:95], v221, s[24:27], s39 offen offset:128 nt
 PM 96,230,0
 PM 98,230,0
 PM 100,230,0
 PM 102,230,0
 CV 96,96,97
 CV 97,98,99
 CV 98,100,101
 CV 99,102,103
 PM 104,230,0
 PM 106,230,0
 PM 108,230,0
 PM 110,230,0
 CV 104,104,105
 CV 105,106,107
 CV 106,108,109
 CV 107,110,111
 XE 100,104,96
 XE 101,105,97
 XE 102,106,98
 XE 103,107,99
 s_not_b64 vcc, vcc
 XO 104,96,104
 XO 105,97,105
 XO 106,98,106
 XO 107,99,107
 buffer_store_dwordx4 v[80:83], v220, s[24:27], s39 offen offset:128 nt
 buffer_store_dwordx4 v[100:103], v220, s[24:27], s39 offen offset:256 nt
 PM 112,230,0
 PM 114,230,0
 PM 116,230,0
 PM 118,230,0
 CV 112,112,113
 CV 113,114,115
 CV 114,116,117
 CV 115,118,119
 PM 120,230,0
 PM 122,230,0
 PM 124,230,0
 PM 126,230,0
 CV 120,120,121
 CV 121,122,123
 CV 122,124,125
 CV 123,126,127
 XO 124,112,120
 XO 125,113,121
 XO 126,114,122
 XO 127,115,123
 s_not_b64 vcc, vcc
 XE 112,120,112
 XE 113,121,113
 XE 114,122,114
 XE 115,123,115
 buffer_store_dwordx4 v[104:107], v221, s[24:27], s39 offen offset:256 nt
 buffer_store_dwordx4 v[124:127], v221, s[24:27], s39 offen offset:384 nt
 buffer_store_dwordx4 v[112:115], v220, s[24:27], s39 offen offset:384 nt
 s_cmp_lg_u32 s73, 0
 s_cbranch_scc1 L_hop
 s_endpgm
.p2align 12
.fill 592, 4, 0xbf800000
L_W0:
 v_mfma_f32_16x16x32_bf16 v[128:131], a[64:67], a[0:3], v[208:211]
 s_cmp_eq_u32 s33, 0x8000
 RV 96,213,8192
 v_add_u32 v251, L_W0-L_pc-0, v244
 QK 128,68,4
 s_cselect_b32 s32, -2, 1
 RV 98,213,12288
 SC 156
 QK 128,72,8
 s_lshl_b32 s32, s32, 14
 RV 100,213,8200
 v_add_u32 v212, s32, v212
 QK 128,76,12
 s_add_u32 s31, s33, s37
 RV 102,213,12296
 SC 157
 v_mfma_f32_16x16x32_bf16 v[132:135], a[76:79], a[28:31], v[208:211]
 s_add_u32 s33, s33, s32
 RV 104,213,8704
 SC 158
 QK 132,72,24
 s_add_u32 s31, s33, s37
 RV 106,213,12800
 SC 159
 QK 132,68,20
 RV 108,213,8712
 SC 128
 QK 132,64,16
 RV 110,213,12808
 SC 129
 QZ 136,64,32
 RV 112,213,9216
 SC 130
 QK 136,68,36
 RV 114,213,13312
 SC 131
 QK 136,72,40
 RV 116,213,9224
 SC 132
 QK 136,76,44
 RV 118,213,13320
 SC 133
 QZ 140,76,60
 RV 120,213,9728
 SC 134
 QK 140,72,56
 RV 122,213,13824
 SC 135
 QK 140,68,52
 RV 124,213,9736
 SC 136
 QK 140,64,48
 RV 126,213,13832
 v_add_u32 v213, s32, v213
 QZ 152,80,32
 s_cmp_eq_u32 s33, 0x8000
 global_load_dword v255, v251, s[64:65]
 SC 137
 QK 152,84,36
 s_cselect_b32 s32, -2, 1
 s_waitcnt vmcnt(9)
 RK 64,223,0
 SC 138
 QK 152,88,40
 s_lshl_b32 s32, s32, 14
 RK 68,223,1024
 SC 139
 QK 152,92,44
 s_add_u32 s33, s33, s32
 RK 72,223,2048
 SC 140
 EX 156
 EX 157
 EX 158
 CV 190,156,157
 EX 159
 EX 136
 CV 191,158,159
 QZ 156,92,60
 s_waitcnt lgkmcnt(3)
 RK 76,223,3072
 SC 141
 QK 156,88,56
 s_barrier
 QK 156,84,52
 RK 148,212,0
 SC 142
 QK 156,80,48
 RK 152,212,512
 SC 143
 SM 128,176
 RK 156,212,1024
 RK 160,212,1536
 SM 132,184
 RK 164,212,4096
 EX 137
 EX 138
 PS 152
 PS 154
 PS 156
 PS 158
 PV 96,96,188
 RK 168,212,4608
 CV 168,136,137
 PV 64,96,184
 RK 172,212,5120
 RK 176,212,5632
 PV 32,96,180
 RV 180,213,0
 EX 139
 PV 0,96,176
 RV 182,213,4096
 CV 169,138,139
 PV 4,100,176
 RV 184,213,8
 EX 140
 PV 36,100,180
 RV 186,213,4104
 EX 141
 PV 68,100,184
 RV 188,213,512
 CV 172,140,141
 PV 100,100,188
 RV 190,213,4608
 RV 192,213,520
 PV 104,104,188
 EX 142
 PV 72,104,184
 RV 194,213,4616
 RV 196,213,1024
 PV 40,104,180
 EX 143
 PV 8,104,176
 RV 198,213,5120
 CV 173,142,143
 PV 12,108,176
 RV 200,213,1032
 RV 202,213,5128
 PV 44,108,180
 EX 152
 PV 76,108,184
 RV 204,213,1536
 RV 206,213,5632
 PV 108,108,188
 EX 153
 PV 112,112,188
 RV 208,213,1544
 CV 170,152,153
 PV 80,112,184
 RV 210,213,5640
 RK 212,212,8192
 PV 48,112,180
 EX 154
 PV 16,112,176
 RK 216,212,8704
 RK 220,212,9216
 PV 20,116,176
 EX 155
 PV 52,116,180
 RK 224,212,9728
 CV 171,154,155
 PV 84,116,184
 RK 228,212,12288
 RK 232,212,12800
 PV 116,116,188
 EX 156
 PV 120,120,188
 RK 236,212,13312
 RK 240,212,13824
 PV 88,120,184
 EX 157
 PV 56,120,180
 RV 96,213,8192
 CV 174,156,157
 PV 24,120,176
 RV 98,213,12288
 v_add_u32 v212, s32, v212
 PV 28,124,176
 RV 100,213,8200
 RV 102,213,12296
 PV 60,124,180
 EX 158
 PV 92,124,184
 RV 104,213,8704
 RV 106,213,12800
 PV 124,124,188
 s_waitcnt lgkmcnt(15)
 EX 159
 QZ 136,148,32
 s_waitcnt lgkmcnt(15)
 RV 108,213,8712
 CV 175,158,159
 QK 136,152,36
 s_waitcnt lgkmcnt(15)
 RV 110,213,12808
 RV 112,213,9216
 QK 136,156,40
 s_waitcnt lgkmcnt(15)
 EX 128
 QK 136,160,44
 RV 114,213,13312
 RV 116,213,9224
 QZ 140,160,60
 EX 129
 QK 140,156,56
 RV 118,213,13320
 CV 160,128,129
 QK 140,152,52
 RV 120,213,9728
 SC 136
 QK 140,148,48
 s_waitcnt lgkmcnt(15)
 RV 122,213,13824
 SC 137
 QZ 152,164,32
 s_waitcnt lgkmcnt(15)
 RV 124,213,9736
 SC 138
 QK 152,168,36
 s_waitcnt lgkmcnt(15)
 RV 126,213,13832
 SC 139
 QK 152,172,40
 s_waitcnt lgkmcnt(15)
 RK 80,223,4096
 SC 140
 QK 152,176,44
 RK 84,223,5120
 SC 141
 QZ 156,176,60
 RK 88,223,6144
 SC 142
 QK 156,172,56
 RK 92,223,7168
 SC 143
 QK 156,168,52
 EX 130
 QK 156,164,48
 EX 131
 QK 0,246,64
 CV 161,130,131
 v_add_u32 v213, s32, v213
 QK 4,244,64
 s_waitcnt vmcnt(1) lgkmcnt(4)
 EX 132
 QK 12,244,68
 s_barrier
 EX 133
 PS 152
 PS 154
 PS 156
 PS 158
 QK 8,246,68
 RK 64,223,8192
 CV 164,132,133
 QK 16,246,72
 RK 68,223,9216
 RK 148,212,0
 QK 20,244,72
 RK 72,223,10240
 EX 134
 QK 28,244,76
 RK 152,212,512
 EX 135
 QK 24,246,76
 s_waitcnt lgkmcnt(8)
 RK 76,223,11264
 CV 165,134,135
 QK 32,246,80
 RK 156,212,1024
 EX 136
 QK 36,244,80
 s_waitcnt lgkmcnt(9)
 RK 80,223,12288
 RK 160,212,1536
 QK 44,244,84
 EX 137
 QK 40,246,84
 s_waitcnt lgkmcnt(10)
 RK 84,223,13312
 CV 184,136,137
 QK 48,246,88
 RK 176,212,5632
 RK 172,212,5120
 QK 52,244,88
 s_waitcnt lgkmcnt(12)
 EX 138
 QK 60,244,92
 RK 88,223,14336
 RK 168,212,4608
 QK 56,246,92
 EX 139
 v_mfma_f32_16x16x16_bf16 a[128:131], a[144:145], v[160:161], a[128:131]
 RK 92,223,15360
 EX 140
 PH 0,180,160
 RK 164,212,4096
 EX 141
 PH 4,184,160
 CV 185,138,139
 EX 142
 v_accvgpr_read_b32 v225, a128
 v_accvgpr_read_b32 v224, a129
 v_add_f32 v225, v224, v225
 v_add_f32 v225, v236, v225
 v_rcp_f32 v224, v225
 v_subrev_u32 v225, 0x21800000, v225
 PM 0,224,0
 PM 2,224,0
 PM 4,224,0
 PM 6,224,0
 PH 8,188,160
 CV 0,0,1
 CV 1,2,3
 CV 2,4,5
 PH 12,192,160
 CV 3,6,7
 EX 143
 PH 16,196,160
 CV 188,140,141
 EX 152
 CV 189,142,143
 EX 153
 PM 8,224,0
 PM 10,224,0
 PM 12,224,0
 PM 14,224,0
 PH 20,200,160
 CV 8,8,9
 CV 9,10,11
 CV 10,12,13
 PH 24,204,160
 CV 11,14,15
 XE 4,8,0
 XE 5,9,1
 PH 28,208,160
 XE 6,10,2
 XE 7,11,3
 CV 186,152,153
 v_mfma_f32_16x16x16_bf16 a[128:131], a[136:137], v[164:165], a[128:131]
 buffer_store_dwordx4 v[4:7], v220, s[24:27], s38 offen offset:0 nt
 EX 154
 PM 16,224,0
 PM 18,224,0
 PM 20,224,0
 PM 22,224,0
 PM 24,224,0
 PM 26,224,0
 PM 28,224,0
 PM 30,224,0
 v_accvgpr_read_b32 v227, a130
 v_accvgpr_read_b32 v226, a131
 v_add_f32 v227, v226, v227
 v_add_f32 v227, v237, v227
 v_rcp_f32 v226, v227
 v_subrev_u32 v227, 0x21800000, v227
 PH 32,180,164
 CV 16,16,17
 CV 17,18,19
 CV 18,20,21
 PH 36,184,164
 CV 19,22,23
 EX 155
 PH 40,188,164
 CV 24,24,25
 CV 25,26,27
 CV 26,28,29
 PH 44,192,164
 CV 27,30,31
 EX 156
 PH 48,196,164
 EX 157
 CV 187,154,155
 PH 52,200,164
 EX 158
 CV 190,156,157
 PH 56,204,164
 EX 159
 PH 60,208,164
 CV 191,158,159
 SM 132,168
 s_not_b64 vcc, vcc
 XO 8,0,8
 PV 96,180,172
 XO 9,1,9
 XO 10,2,10
 PV 64,180,168
 RV 180,213,0
 XO 11,3,11
 PV 68,184,168
 buffer_store_dwordx4 v[8:11], v221, s[24:27], s38 offen offset:0 nt
 PV 100,184,172
 RV 182,213,4096
 XO 28,16,24
 PV 104,188,172
 RV 184,213,8
 XO 29,17,25
 PV 72,188,168
 RV 186,213,4104
 XO 30,18,26
 PV 76,192,168
 RV 188,213,512
 XO 31,19,27
 PV 108,192,172
 s_not_b64 vcc, vcc
 RV 190,213,4608
 XE 16,24,16
 PV 112,196,172
 RV 192,213,520
 XE 17,25,17
 PV 80,196,168
 RV 194,213,4616
 XE 18,26,18
 PV 84,200,168
 buffer_store_dwordx4 v[28:31], v221, s[24:27], s38 offen offset:128 nt
 XE 19,27,19
 PM 32,226,0
 PM 34,226,0
 PM 36,226,0
 PM 38,226,0
 PM 40,226,0
 PM 42,226,0
 PM 44,226,0
 PM 46,226,0
 PV 116,200,172
 RV 196,213,1024
 CV 32,32,33
 PV 120,204,172
 RV 198,213,5120
 CV 33,34,35
 PV 88,204,168
 RV 200,213,1032
 CV 34,36,37
 PV 92,208,168
 RV 202,213,5128
 CV 35,38,39
 PV 124,208,172
 s_waitcnt lgkmcnt(15)
 RV 204,213,1536
 CV 40,40,41
 QK 64,246,64
 buffer_store_dwordx4 v[16:19], v220, s[24:27], s38 offen offset:128 nt
 QK 68,244,64
 s_waitcnt lgkmcnt(15)
 RV 206,213,5632
 CV 41,42,43
 QK 76,244,68
 RV 208,213,1544
 CV 42,44,45
 QK 72,246,68
 s_waitcnt lgkmcnt(15)
 RV 210,213,5640
 CV 43,46,47
 QK 80,246,72
 XE 36,40,32
 XE 37,41,33
 QK 84,244,72
 s_waitcnt lgkmcnt(15)
 XE 38,42,34
 XE 39,43,35
 QK 92,244,76
 s_not_b64 vcc, vcc
 XO 40,32,40
 XO 41,33,41
 QK 88,246,76
 s_waitcnt lgkmcnt(15)
 XO 42,34,42
 XO 43,35,43
 QK 96,246,80
 buffer_store_dwordx4 v[36:39], v220, s[24:27], s38 offen offset:256 nt
 PM 48,226,0
 PM 50,226,0
 PM 52,226,0
 PM 54,226,0
 PM 56,226,0
 PM 58,226,0
 PM 60,226,0
 PM 62,226,0
 QK 100,244,80
 s_waitcnt lgkmcnt(15)
 CV 48,48,49
 CV 49,50,51
 QK 108,244,84
 CV 50,52,53
 CV 51,54,55
 QK 104,246,84
 s_waitcnt lgkmcnt(15)
 CV 56,56,57
 CV 57,58,59
 QK 112,246,88
 CV 58,60,61
 CV 59,62,63
 QK 116,244,88
 s_waitcnt lgkmcnt(15)
 XO 60,48,56
 XO 61,49,57
 QK 124,244,92
 buffer_store_dwordx4 v[40:43], v221, s[24:27], s38 offen offset:256 nt
 QK 120,246,92
 XO 62,50,58
 XO 63,51,59
 QZ 136,212,32
 s_not_b64 vcc, vcc
 XE 48,56,48
 XE 49,57,49
 QK 136,216,36
 XE 50,58,50
 XE 51,59,51
 QK 136,220,40
 QK 136,224,44
 QZ 140,224,60
 QK 140,220,56
 QK 140,216,52
 buffer_store_dwordx4 v[60:63], v221, s[24:27], s38 offen offset:384 nt
 QK 140,212,48
 QZ 152,228,32
 QK 152,232,36
 QK 152,236,40
 SC 136
 SC 137
 QK 152,240,44
 EX 136
 QZ 156,240,60
 EX 137
 QK 156,236,56
 CV 168,136,137
 SC 138
 QK 156,232,52
 buffer_store_dwordx4 v[48:51], v220, s[24:27], s38 offen offset:384 nt
 QK 156,228,48
 SC 139
 SC 140
 SM 132,184
 SC 141
 PV 96,96,188
 EX 138
 PV 64,96,184
 RV 96,213,8192
 SC 142
 EX 139
 EX 140
 PS 152
 PS 154
 PS 156
 PS 158
 PV 68,100,184
 RV 98,213,12288
 CV 169,138,139
 PV 100,100,188
 RV 100,213,8200
 SC 143
 PV 104,104,188
 EX 152
 PV 72,104,184
 RV 102,213,12296
 RV 104,213,8704
 PV 76,108,184
 EX 153
 PV 108,108,188
 RV 106,213,12800
 CV 170,152,153
 PV 112,112,188
 RV 108,213,8712
 RV 110,213,12808
 PV 80,112,184
 RV 112,213,9216
 EX 154
 PV 84,116,184
 EX 155
 PV 116,116,188
 RV 114,213,13312
 CV 171,154,155
 PV 120,120,188
 RV 116,213,9224
 RV 118,213,13320
 PV 88,120,184
 RV 120,213,9728
 EX 141
 PV 92,124,184
 RV 122,213,13824
 CV 172,140,141
 PV 124,124,188
 RV 124,213,9736
 EX 142
 QZ 136,148,32
 EX 143
 QK 136,152,36
 RV 126,213,13832
 CV 173,142,143
 QK 136,156,40
 EX 156
 QK 136,160,44
 EX 157
 v_mfma_f32_16x16x32_bf16 v[152:155], a[176:179], a[44:47], v[208:211]
 EX 158
 QK 152,172,40
 EX 159
 QK 152,168,36
 s_waitcnt lgkmcnt(15)
 CV 174,156,157
 CV 175,158,159
 QK 152,164,32
 SC 136
 SC 137
 QZ 140,148,48
 EX 136
 QK 140,152,52
 EX 137
 QK 140,156,56
 CV 184,136,137
 SC 138
 SC 139
 EX 138
 PS 152
 PS 154
 QK 140,160,60
 EX 139
 v_mfma_f32_16x16x32_bf16 v[156:159], a[176:179], a[60:63], v[208:211]
 EX 152
 QK 156,172,56
 EX 153
 QK 156,168,52
 CV 185,138,139
 CV 186,152,153
 QK 156,164,48
 EX 154
 LS 132,144,168
 s_waitcnt lgkmcnt(15)
 EX 155
 PV 64,180,168
 s_waitcnt lgkmcnt(15)
 CV 187,154,155
 SC 140
 PV 68,184,168
 SC 141
 SC 142
 EX 140
 EX 141
 PS 156
 PS 158
 s_waitcnt lgkmcnt(15)
 PV 72,188,168
 s_waitcnt lgkmcnt(15)
 CV 188,140,141
 SC 143
 PV 76,192,168
 s_waitcnt lgkmcnt(15)
 EX 142
 PV 80,196,168
 s_waitcnt lgkmcnt(15)
 EX 143
 PV 84,200,168
 s_waitcnt lgkmcnt(15)
 EX 156
 PV 88,204,168
 s_waitcnt lgkmcnt(15)
 EX 157
 PV 92,208,168
 CV 189,142,143
 CV 190,156,157
 LS 132,144,184
 s_waitcnt lgkmcnt(14)
 EX 158
 PV 64,96,184
 s_waitcnt lgkmcnt(12)
 EX 159
 PV 68,100,184
 s_waitcnt lgkmcnt(10)
 CV 191,158,159
 PV 72,104,184
 s_waitcnt lgkmcnt(8)
 PV 76,108,184
 s_waitcnt lgkmcnt(6)
 PV 80,112,184
 v_accvgpr_read_b32 v229, a132
 v_accvgpr_read_b32 v228, a133
 v_add_f32 v229, v228, v229
 v_add_f32 v229, v238, v229
 v_rcp_f32 v228, v229
 v_subrev_u32 v229, 0x21800000, v229
 PM 64,228,0
 PM 66,228,0
 PM 68,228,0
 PM 70,228,0
 PM 72,228,0
 PM 74,228,0
 PM 76,228,0
 PM 78,228,0
 v_max3_u32 v225, v225, v227, v229
 s_waitcnt lgkmcnt(4)
 PV 84,116,184
 s_waitcnt lgkmcnt(2)
 CV 64,64,65
 CV 65,66,67
 PV 88,120,184
 s_waitcnt lgkmcnt(0)
 CV 66,68,69
 CV 67,70,71
 PV 92,124,184
 CV 72,72,73
 CV 73,74,75
 LS 132,136,172
 CV 74,76,77
 CV 75,78,79
 PV 96,180,172
 XE 68,72,64
 XE 69,73,65
 PV 100,184,172
 XE 70,74,66
 XE 71,75,67
 PV 104,188,172
 s_not_b64 vcc, vcc
 buffer_store_dwordx4 v[68:71], v220, s[24:27], s39 offen offset:0 nt
 XO 72,64,72
 PM 80,228,0
 PM 82,228,0
 PM 84,228,0
 PM 86,228,0
 PM 88,228,0
 PM 90,228,0
 PM 92,228,0
 PM 94,228,0
 PV 108,192,172
 XO 73,65,73
 XO 74,66,74
 PV 112,196,172
 XO 75,67,75
 CV 80,80,81
 PV 116,200,172
 CV 81,82,83
 CV 82,84,85
 PV 120,204,172
 CV 83,86,87
 CV 88,88,89
 PV 124,208,172
 CV 89,90,91
 CV 90,92,93
 LS 132,136,188
 buffer_store_dwordx4 v[72:75], v221, s[24:27], s39 offen offset:0 nt
 PV 96,96,188
 CV 91,94,95
 XO 92,80,88
 PV 100,100,188
 XO 93,81,89
 XO 94,82,90
 PV 104,104,188
 XO 95,83,91
 v_accvgpr_read_b32 v231, a134
 v_accvgpr_read_b32 v230, a135
 v_add_f32 v231, v230, v231
 v_add_f32 v231, v239, v231
 v_rcp_f32 v230, v231
 v_subrev_u32 v231, 0x21800000, v231
 v_max_u32 v225, v225, v231
 v_cmp_le_u32 s[84:85], s77, v225
 PV 108,108,188
 s_not_b64 vcc, vcc
 XE 80,88,80
 XE 81,89,81
 PV 112,112,188
 s_cmp_lg_u64 s[84:85], 0
 XE 82,90,82
 XE 83,91,83
 PV 116,116,188
 s_cselect_b32 s92, s76, 0
 buffer_store_dwordx4 v[92:95], v221, s[24:27], s39 offen offset:128 nt
 PM 96,230,0
 PM 98,230,0
 PM 100,230,0
 PM 102,230,0
 PM 104,230,0
 PM 106,230,0
 PM 108,230,0
 PM 110,230,0
 PV 120,120,188
 s_or_b32 s73, s73, s92
 CV 96,96,97
 CV 97,98,99
 PV 124,124,188
 s_lshl_b32 s76, s76, 1
 CV 98,100,101
 CV 99,102,103
 CV 104,104,105
 CV 105,106,107
 CV 106,108,109
 CV 107,110,111
 XE 100,104,96
 XE 101,105,97
 XE 102,106,98
 XE 103,107,99
 s_not_b64 vcc, vcc
 XO 104,96,104
 XO 105,97,105
 XO 106,98,106
 XO 107,99,107
 buffer_store_dwordx4 v[80:83], v220, s[24:27], s39 offen offset:128 nt
 buffer_store_dwordx4 v[100:103], v220, s[24:27], s39 offen offset:256 nt
 PM 112,230,0
 PM 114,230,0
 PM 116,230,0
 PM 118,230,0
 CV 112,112,113
 CV 113,114,115
 CV 114,116,117
 CV 115,118,119
 PM 120,230,0
 PM 122,230,0
 PM 124,230,0
 PM 126,230,0
 CV 120,120,121
 CV 121,122,123
 CV 122,124,125
 CV 123,126,127
 XO 124,112,120
 XO 125,113,121
 XO 126,114,122
 XO 127,115,123
 s_not_b64 vcc, vcc
 XE 112,120,112
 XE 113,121,113
 XE 114,122,114
 XE 115,123,115
 buffer_store_dwordx4 v[104:107], v221, s[24:27], s39 offen offset:256 nt
 buffer_store_dwordx4 v[124:127], v221, s[24:27], s39 offen offset:384 nt
 buffer_store_dwordx4 v[112:115], v220, s[24:27], s39 offen offset:384 nt
 s_cmp_lg_u32 s73, 0
 s_cbranch_scc1 L_hop
 s_endpgm
.p2align 12
.fill 592, 4, 0xbf800000
L_W1:
 QZ 128,64,0
 s_cmp_eq_u32 s33, 0x8000
 RV 96,213,8192
 v_add_u32 v251, L_W1-L_pc-8192, v244
 QK 128,68,4
 s_cselect_b32 s32, -2, 1
 RV 98,213,12288
 SC 156
 QK 128,72,8
 s_lshl_b32 s32, s32, 14
 RV 100,213,8200
 v_add_u32 v212, s32, v212
 QK 128,76,12
 s_add_u32 s31, s33, s37
 RV 102,213,12296
 SC 157
 QZ 132,76,28
 s_add_u32 s33, s33, s32
 RV 104,213,8704
 SC 158
 QK 132,72,24
 s_add_u32 s31, s33, s37
 RV 106,213,12800
 SC 159
 QK 132,68,20
 RV 108,213,8712
 SC 128
 QK 132,64,16
 RV 110,213,12808
 SC 129
 QZ 136,64,32
 RV 112,213,9216
 SC 130
 QK 136,68,36
 RV 114,213,13312
 SC 131
 QK 136,72,40
 RV 116,213,9224
 SC 132
 QK 136,76,44
 RV 118,213,13320
 SC 133
 QZ 140,76,60
 RV 120,213,9728
 SC 134
 QK 140,72,56
 RV 122,213,13824
 SC 135
 QK 140,68,52
 RV 124,213,9736
 SC 136
 QK 140,64,48
 RV 126,213,13832
 v_add_u32 v213, s32, v213
 v_mfma_f32_16x16x32_bf16 v[144:147], a[80:83], a[0:3], v[208:211]
 s_cmp_eq_u32 s33, 0x8000
 global_load_dword v255, v251, s[64:65]
 SC 137
 QK 144,84,4
 s_cselect_b32 s32, -2, 1
 s_waitcnt vmcnt(9)
 RK 64,223,0
 SC 138
 QK 144,88,8
 s_lshl_b32 s32, s32, 14
 RK 68,223,1024
 SC 139
 QK 144,92,12
 s_add_u32 s33, s33, s32
 RK 72,223,2048
 SC 140
 v_mfma_f32_16x16x32_bf16 v[148:151], a[92:95], a[28:31], v[208:211]
 RK 76,223,3072
 SC 141
 QK 148,88,24
 EX 156
 QK 148,84,20
 EX 157
 QK 148,80,16
 s_waitcnt lgkmcnt(4)
 CV 190,156,157
 SC 144
 QZ 152,80,32
 s_barrier
 QK 152,84,36
 RK 148,212,0
 SC 145
 QK 152,88,40
 RK 152,212,512
 SC 146
 QK 152,92,44
 RK 156,212,1024
 SC 147
 RK 160,212,1536
 RK 164,212,4096
 EX 158
 RK 168,212,4608
 EX 159
 RK 172,212,5120
 RK 176,212,5632
 CV 191,158,159
 QZ 156,92,60
 RV 180,213,0
 SC 148
 QK 156,88,56
 RV 182,213,4096
 SC 149
 QK 156,84,52
 RV 184,213,8
 SC 150
 QK 156,80,48
 RV 186,213,4104
 SC 151
 SM 128,176
 RV 188,213,512
 SC 142
 SM 132,184
 RV 190,213,4608
 SC 143
 PV 96,96,188
 RV 192,213,520
 SC 152
 PV 64,96,184
 RV 194,213,4616
 SC 153
 PV 32,96,180
 RV 196,213,1024
 SC 154
 PV 0,96,176
 RV 198,213,5120
 SC 155
 PV 4,100,176
 RV 200,213,1032
 SC 156
 PV 36,100,180
 RV 202,213,5128
 SC 157
 PV 68,100,184
 RV 204,213,1536
 SC 158
 PV 100,100,188
 RV 206,213,5632
 SC 159
 PV 104,104,188
 RV 208,213,1544
 EX 128
 PV 72,104,184
 RV 210,213,5640
 EX 129
 PV 40,104,180
 RK 212,212,8192
 CV 160,128,129
 PV 8,104,176
 RK 216,212,8704
 EX 130
 PV 12,108,176
 RK 220,212,9216
 RK 224,212,9728
 PV 44,108,180
 EX 131
 PV 76,108,184
 RK 228,212,12288
 CV 161,130,131
 PV 108,108,188
 RK 232,212,12800
 RK 236,212,13312
 PV 112,112,188
 EX 132
 PV 80,112,184
 RK 240,212,13824
 v_add_u32 v212, s32, v212
 PV 48,112,180
 RV 96,213,8192
 RV 98,213,12288
 PV 16,112,176
 EX 133
 PV 20,116,176
 RV 100,213,8200
 CV 164,132,133
 PV 52,116,180
 RV 102,213,12296
 RV 104,213,8704
 PV 84,116,184
 EX 134
 PV 116,116,188
 RV 106,213,12800
 RV 108,213,8712
 PV 120,120,188
 EX 135
 PV 88,120,184
 RV 110,213,12808
 CV 165,134,135
 PV 56,120,180
 RV 112,213,9216
 RV 114,213,13312
 PV 24,120,176
 EX 144
 PV 28,124,176
 RV 116,213,9224
 RV 118,213,13320
 PV 60,124,180
 EX 145
 PV 92,124,184
 RV 120,213,9728
 CV 162,144,145
 PV 124,124,188
 s_waitcnt lgkmcnt(15)
 RV 122,213,13824
 RV 124,213,9736
 QK 0,246,64
 EX 146
 QK 4,244,64
 s_waitcnt lgkmcnt(15)
 RV 126,213,13832
 v_add_u32 v213, s32, v213
 QK 12,244,68
 RK 80,223,4096
 RK 84,223,5120
 QK 8,246,68
 s_waitcnt lgkmcnt(15)
 EX 147
 QK 16,246,72
 RK 88,223,6144
 CV 163,146,147
 QK 20,244,72
 s_waitcnt lgkmcnt(15)
 RK 92,223,7168
 RK 64,223,8192
 QK 28,244,76
 EX 148
 QK 24,246,76
 RK 68,223,9216
 RK 72,223,10240
 EX 149
 EX 150
 CV 166,148,149
 EX 151
 EX 136
 s_waitcnt vmcnt(1) lgkmcnt(7)
 s_waitcnt lgkmcnt(6)
 QK 32,246,80
 RK 76,223,11264
 CV 167,150,151
 QK 36,244,80
 s_barrier
 s_waitcnt lgkmcnt(6)
 QK 44,244,84
 EX 137
 QK 40,246,84
 s_waitcnt lgkmcnt(5)
 RK 80,223,12288
 CV 168,136,137
 QK 48,246,88
 EX 138
 QK 52,244,88
 s_waitcnt lgkmcnt(5)
 RK 84,223,13312
 RK 88,223,14336
 QK 60,244,92
 EX 139
 QK 56,246,92
 RK 92,223,15360
 CV 169,138,139
 SM 128,160
 EX 140
 PV 32,180,164
 EX 141
 PV 0,180,160
 EX 142
 PV 4,184,160
 EX 143
 PV 36,184,164
 CV 172,140,141
 CV 173,142,143
 PV 40,188,164
 EX 152
 v_accvgpr_read_b32 v225, a128
 v_accvgpr_read_b32 v224, a129
 v_add_f32 v225, v224, v225
 v_add_f32 v225, v236, v225
 v_rcp_f32 v224, v225
 v_subrev_u32 v225, 0x21800000, v225
 PM 0,224,0
 PM 2,224,0
 PM 4,224,0
 PM 6,224,0
 v_accvgpr_read_b32 v227, a130
 v_accvgpr_read_b32 v226, a131
 v_add_f32 v227, v226, v227
 v_add_f32 v227, v237, v227
 v_rcp_f32 v226, v227
 v_subrev_u32 v227, 0x21800000, v227
 PV 8,188,160
 EX 153
 PV 12,192,160
 CV 170,152,153
 CV 0,0,1
 PV 44,192,164
 EX 154
 PV 48,196,164
 EX 155
 EX 156
 CV 171,154,155
 PM 8,224,0
 PM 10,224,0
 PM 12,224,0
 PM 14,224,0
 PV 16,196,160
 EX 157
 PV 20,200,160
 CV 174,156,157
 CV 1,2,3
 PV 52,200,164
 EX 158
 PV 56,204,164
 EX 159
 PV 24,204,160
 CV 175,158,159
 CV 2,4,5
 PV 28,208,160
 CV 3,6,7
 CV 8,8,9
 PV 60,208,164
 CV 9,10,11
 CV 10,12,13
 QZ 136,148,32
 CV 11,14,15
 XE 4,8,0
 QK 136,152,36
 XE 5,9,1
 XE 6,10,2
 QK 136,156,40
 XE 7,11,3
 QK 136,160,44
 s_not_b64 vcc, vcc
 buffer_store_dwordx4 v[4:7], v220, s[24:27], s38 offen offset:0 nt
 XO 8,0,8
 PM 16,224,0
 PM 18,224,0
 PM 20,224,0
 PM 22,224,0
 PM 24,224,0
 PM 26,224,0
 PM 28,224,0
 PM 30,224,0
 QZ 140,160,60
 RK 160,212,1536
 XO 9,1,9
 QK 140,156,56
 RK 156,212,1024
 XO 10,2,10
 QK 140,152,52
 RK 152,212,512
 XO 11,3,11
 QK 140,148,48
 RK 148,212,0
 CV 16,16,17
 QZ 152,164,32
 CV 17,18,19
 CV 18,20,21
 QK 152,168,36
 buffer_store_dwordx4 v[8:11], v221, s[24:27], s38 offen offset:0 nt
 QK 152,172,40
 CV 19,22,23
 CV 24,24,25
 QK 152,176,44
 CV 25,26,27
 CV 26,28,29
 QZ 156,176,60
 CV 27,30,31
 XO 28,16,24
 QK 156,172,56
 XO 29,17,25
 XO 30,18,26
 QK 156,168,52
 XO 31,19,27
 SC 136
 QK 156,164,48
 s_not_b64 vcc, vcc
 XE 16,24,16
 XE 17,25,17
 SM 132,168
 XE 18,26,18
 PV 96,180,172
 buffer_store_dwordx4 v[28:31], v221, s[24:27], s38 offen offset:128 nt
 XE 19,27,19
 PM 32,226,0
 PM 34,226,0
 PM 36,226,0
 PM 38,226,0
 PM 40,226,0
 PM 42,226,0
 PM 44,226,0
 PM 46,226,0
 PV 64,180,168
 RV 180,213,0
 CV 32,32,33
 PV 68,184,168
 RV 182,213,4096
 CV 33,34,35
 PV 100,184,172
 RV 184,213,8
 CV 34,36,37
 PV 104,188,172
 RV 186,213,4104
 CV 35,38,39
 PV 72,188,168
 RV 188,213,512
 CV 40,40,41
 PV 76,192,168
 buffer_store_dwordx4 v[16:19], v220, s[24:27], s38 offen offset:128 nt
 PV 108,192,172
 RV 190,213,4608
 CV 41,42,43
 PV 112,196,172
 RV 192,213,520
 CV 42,44,45
 PV 80,196,168
 RV 194,213,4616
 CV 43,46,47
 PV 84,200,168
 RV 196,213,1024
 XE 36,40,32
 PV 116,200,172
 RV 198,213,5120
 XE 37,41,33
 PV 120,204,172
 RV 200,213,1032
 XE 38,42,34
 PV 88,204,168
 RV 202,213,5128
 XE 39,43,35
 PV 92,208,168
 s_not_b64 vcc, vcc
 buffer_store_dwordx4 v[36:39], v220, s[24:27], s38 offen offset:256 nt
 SC 137
 PM 48,226,0
 PM 50,226,0
 PM 52,226,0
 PM 54,226,0
 PM 56,226,0
 PM 58,226,0
 PM 60,226,0
 PM 62,226,0
 PV 124,208,172
 s_waitcnt lgkmcnt(15)
 RV 204,213,1536
 SC 138
 QK 64,246,64
 RV 206,213,5632
 SC 139
 QK 68,244,64
 s_waitcnt lgkmcnt(15)
 RV 208,213,1544
 XO 40,32,40
 QK 76,244,68
 RV 210,213,5640
 XO 41,33,41
 QK 72,246,68
 s_waitcnt lgkmcnt(15)
 EX 136
 QK 80,246,72
 EX 137
 QK 84,244,72
 s_waitcnt lgkmcnt(15)
 CV 184,136,137
 XO 42,34,42
 QK 92,244,76
 EX 138
 QK 88,246,76
 s_waitcnt lgkmcnt(15)
 EX 139
 QK 96,246,80
 CV 185,138,139
 XO 43,35,43
 QK 100,244,80
 s_waitcnt lgkmcnt(15)
 buffer_store_dwordx4 v[40:43], v221, s[24:27], s38 offen offset:256 nt
 QK 108,244,84
 SC 140
 SC 141
 QK 104,246,84
 s_waitcnt lgkmcnt(15)
 EX 140
 QK 112,246,88
 EX 141
 QK 116,244,88
 s_waitcnt lgkmcnt(15)
 CV 188,140,141
 SC 142
 QK 124,244,92
 SC 143
 SC 152
 QK 120,246,92
 EX 142
 QZ 136,212,32
 EX 143
 QK 136,216,36
 CV 189,142,143
 SC 153
 QK 136,220,40
 EX 152
 QK 136,224,44
 EX 153
 QZ 140,224,60
 CV 186,152,153
 SC 154
 QK 140,220,56
 SC 155
 CV 48,48,49
 QK 140,216,52
 EX 154
 QK 140,212,48
 EX 155
 CV 49,50,51
 CV 187,154,155
 QZ 152,228,32
 CV 50,52,53
 CV 51,54,55
 QK 152,232,36
 CV 56,56,57
 CV 57,58,59
 QK 152,236,40
 CV 58,60,61
 CV 59,62,63
 QK 152,240,44
 XO 60,48,56
 XO 61,49,57
 XO 62,50,58
 XO 63,51,59
 buffer_store_dwordx4 v[60:63], v221, s[24:27], s38 offen offset:384 nt
 SC 156
 SC 157
 EX 156
 EX 157
 SC 158
 CV 190,156,157
 SC 159
 EX 158
 EX 159
 s_not_b64 vcc, vcc
 CV 191,158,159
 QZ 156,240,60
 XE 48,56,48
 XE 49,57,49
 QK 156,236,56
 XE 50,58,50
 XE 51,59,51
 QK 156,232,52
 SC 136
 SC 137
 QK 156,228,48
 EX 136
 SM 132,184
 buffer_store_dwordx4 v[48:51], v220, s[24:27], s38 offen offset:384 nt
 PV 96,96,188
 EX 137
 PV 64,96,184
 RV 96,213,8192
 CV 168,136,137
 PV 68,100,184
 SC 138
 SC 139
 PV 100,100,188
 RV 100,213,8200
 SC 152
 PV 104,104,188
 EX 138
 PV 72,104,184
 RV 104,213,8704
 SC 153
 PV 76,108,184
 EX 139
 PV 108,108,188
 RV 108,213,8712
 CV 169,138,139
 PV 112,112,188
 EX 152
 PV 80,112,184
 RV 112,213,9216
 SC 154
 PV 84,116,184
 EX 153
 PV 116,116,188
 RV 116,213,9224
 CV 170,152,153
 PV 120,120,188
 SC 155
 SC 140
 PV 88,120,184
 RV 120,213,9728
 SC 141
 PV 92,124,184
 EX 154
 PV 124,124,188
 s_waitcnt lgkmcnt(15)
 RV 124,213,9736
 SC 142
 v_mfma_f32_16x16x32_bf16 v[136:139], a[148:151], a[32:35], v[208:211]
 EX 155
 QK 136,152,36
 CV 171,154,155
 SC 143
 QK 136,156,40
 EX 140
 QK 136,160,44
 EX 141
 LS 132,144,168
 s_waitcnt lgkmcnt(15)
 CV 172,140,141
 SC 156
 PV 64,180,168
 s_waitcnt lgkmcnt(15)
 EX 142
 PV 68,184,168
 s_waitcnt lgkmcnt(15)
 EX 143
 PV 72,188,168
 s_waitcnt lgkmcnt(15)
 CV 173,142,143
 SC 136
 PV 76,192,168
 s_waitcnt lgkmcnt(14)
 SC 137
 SC 138
 PV 80,196,168
 s_waitcnt lgkmcnt(12)
 EX 136
 PV 84,200,168
 s_waitcnt lgkmcnt(10)
 EX 137
 PV 88,204,168
 s_waitcnt lgkmcnt(8)
 CV 184,136,137
 SC 139
 PV 92,208,168
 EX 138
 v_mfma_f32_16x16x32_bf16 v[140:143], a[148:151], a[48:51], v[208:211]
 EX 139
 QK 140,152,52
 CV 185,138,139
 SC 157
 QK 140,156,56
 EX 156
 QK 140,160,60
 EX 157
 v_mfma_f32_16x16x16_bf16 a[132:135], a[144:145], v[184:185], a[132:135]
 s_waitcnt lgkmcnt(7)
 CV 174,156,157
 SC 158
 SC 159
 PH 64,96,184
 s_waitcnt lgkmcnt(6)
 EX 158
 EX 159
 PH 68,100,184
 CV 175,158,159
 v_accvgpr_read_b32 v229, a132
 v_accvgpr_read_b32 v228, a133
 v_add_f32 v229, v228, v229
 v_add_f32 v229, v238, v229
 v_rcp_f32 v228, v229
 v_subrev_u32 v229, 0x21800000, v229
 PM 64,228,0
 PM 66,228,0
 PM 68,228,0
 PM 70,228,0
 v_max3_u32 v225, v225, v227, v229
 s_waitcnt lgkmcnt(5)
 PH 72,104,184
 s_waitcnt lgkmcnt(4)
 CV 64,64,65
 CV 65,66,67
 CV 66,68,69
 PH 76,108,184
 s_waitcnt lgkmcnt(3)
 CV 67,70,71
 SC 140
 SC 141
 PH 80,112,184
 EX 140
 SC 142
 EX 141
 SC 143
 PM 72,228,0
 PM 74,228,0
 PM 76,228,0
 PM 78,228,0
 s_waitcnt lgkmcnt(2)
 PH 84,116,184
 s_waitcnt lgkmcnt(1)
 CV 72,72,73
 CV 73,74,75
 CV 74,76,77
 PH 88,120,184
 s_waitcnt lgkmcnt(0)
 CV 75,78,79
 XE 68,72,64
 XE 69,73,65
 PH 92,124,184
 XE 70,74,66
 XE 71,75,67
 CV 188,140,141
 LS 132,136,172
 s_not_b64 vcc, vcc
 buffer_store_dwordx4 v[68:71], v220, s[24:27], s39 offen offset:0 nt
 XO 72,64,72
 PM 80,228,0
 PM 82,228,0
 PM 84,228,0
 PM 86,228,0
 PM 88,228,0
 PM 90,228,0
 PM 92,228,0
 PM 94,228,0
 PV 96,180,172
 XO 73,65,73
 XO 74,66,74
 PV 100,184,172
 XO 75,67,75
 CV 80,80,81
 PV 104,188,172
 CV 81,82,83
 CV 82,84,85
 PV 108,192,172
 CV 83,86,87
 CV 88,88,89
 PV 112,196,172
 EX 142
 PV 116,200,172
 buffer_store_dwordx4 v[72:75], v221, s[24:27], s39 offen offset:0 nt
 PV 120,204,172
 EX 143
 PV 124,208,172
 CV 89,90,91
 CV 90,92,93
 CV 91,94,95
 XO 92,80,88
 XO 93,81,89
 XO 94,82,90
 XO 95,83,91
 s_not_b64 vcc, vcc
 XE 80,88,80
 XE 81,89,81
 XE 82,90,82
 XE 83,91,83
 CV 189,142,143
 s_nop 1
 v_mfma_f32_16x16x16_bf16 a[132:135], a[136:137], v[188:189], a[132:135]
 PH 96,96,188
 PH 100,100,188
 PH 104,104,188
 buffer_store_dwordx4 v[92:95], v221, s[24:27], s39 offen offset:128 nt
 PH 108,108,188
 PH 112,112,188
 PH 116,116,188
 PH 120,120,188
 v_accvgpr_read_b32 v231, a134
 v_accvgpr_read_b32 v230, a135
 v_add_f32 v231, v230, v231
 v_add_f32 v231, v239, v231
 v_rcp_f32 v230, v231
 v_subrev_u32 v231, 0x21800000, v231
 PM 96,230,0
 PM 98,230,0
 PM 100,230,0
 PM 102,230,0
 PM 104,230,0
 PM 106,230,0
 PM 108,230,0
 PM 110,230,0
 v_max_u32 v225, v225, v231
 v_cmp_le_u32 s[84:85], s77, v225
 PH 124,124,188
 buffer_store_dwordx4 v[80:83], v220, s[24:27], s39 offen offset:128 nt
 CV 96,96,97
 CV 97,98,99
 CV 98,100,101
 CV 99,102,103
 CV 104,104,105
 CV 105,106,107
 CV 106,108,109
 CV 107,110,111
 XE 100,104,96
 XE 101,105,97
 XE 102,106,98
 XE 103,107,99
 s_not_b64 vcc, vcc
 XO 104,96,104
 XO 105,97,105
 XO 106,98,106
 XO 107,99,107
 v_mul_f32 v112, v230, v112
 v_mul_f32 v113, v230, v113
 v_mul_f32 v114, v230, v114
 v_mul_f32 v115, v230, v115
 v_mul_f32 v116, v230, v116
 v_mul_f32 v117, v230, v117
 v_mul_f32 v118, v230, v118
 v_mul_f32 v119, v230, v119
 CV 112,112,113
 CV 113,114,115
 CV 114,116,117
 CV 115,118,119
 v_mul_f32 v120, v230, v120
 buffer_store_dwordx4 v[100:103], v220, s[24:27], s39 offen offset:256 nt
 v_mul_f32 v121, v230, v121
 v_mul_f32 v122, v230, v122
 v_mul_f32 v123, v230, v123
 v_mul_f32 v124, v230, v124
 v_mul_f32 v125, v230, v125
 v_mul_f32 v126, v230, v126
 v_mul_f32 v127, v230, v127
 CV 120,120,121
 CV 121,122,123
 CV 122,124,125
 CV 123,126,127
 XO 124,112,120
 XO 125,113,121
 XO 126,114,122
 XO 127,115,123
 s_not_b64 vcc, vcc
 XE 112,120,112
 XE 113,121,113
 XE 114,122,114
 XE 115,123,115
 s_cmp_lg_u64 s[84:85], 0
 s_cselect_b32 s92, s76, 0
 s_or_b32 s73, s73, s92
 s_lshl_b32 s76, s76, 1
 buffer_store_dwordx4 v[104:107], v221, s[24:27], s39 offen offset:256 nt
 buffer_store_dwordx4 v[124:127], v221, s[24:27], s39 offen offset:384 nt
 buffer_store_dwordx4 v[112:115], v220, s[24:27], s39 offen offset:384 nt
 s_cmp_lg_u32 s73, 0
 s_cbranch_scc1 L_hop
 s_endpgm
.p2align 12
.fill 592, 4, 0xbf800000
L_W2:
 QZ 128,64,0
 s_cmp_eq_u32 s33, 0x8000
 RV 96,213,8192
 v_add_u32 v251, L_W2-L_pc-16384, v244
 QK 128,68,4
 s_cselect_b32 s32, -2, 1
 RV 98,213,12288
 SC 156
 QK 128,72,8
 s_lshl_b32 s32, s32, 14
 RV 100,213,8200
 v_add_u32 v212, s32, v212
 QK 128,76,12
 s_add_u32 s31, s33, s37
 RV 102,213,12296
 SC 157
 QZ 132,76,28
 s_add_u32 s33, s33, s32
 RV 104,213,8704
 SC 158
 QK 132,72,24
 s_add_u32 s31, s33, s37
 RV 106,213,12800
 SC 159
 QK 132,68,20
 RV 108,213,8712
 SC 128
 QK 132,64,16
 RV 110,213,12808
 SC 129
 QZ 136,64,32
 RV 112,213,9216
 SC 130
 QK 136,68,36
 RV 114,213,13312
 SC 131
 QK 136,72,40
 RV 116,213,9224
 SC 132
 QK 136,76,44
 RV 118,213,13320
 SC 133
 QZ 140,76,60
 RV 120,213,9728
 SC 134
 QK 140,72,56
 RV 122,213,13824
 SC 135
 QK 140,68,52
 RV 124,213,9736
 SC 136
 QK 140,64,48
 RV 126,213,13832
 v_add_u32 v213, s32, v213
 QZ 144,80,0
 s_cmp_eq_u32 s33, 0x8000
 global_load_dword v255, v251, s[64:65]
 SC 137
 QK 144,84,4
 s_cselect_b32 s32, -2, 1
 s_waitcnt vmcnt(9)
 RK 64,223,0
 SC 138
 QK 144,88,8
 s_lshl_b32 s32, s32, 14
 RK 68,223,1024
 SC 139
 QK 144,92,12
 s_add_u32 s33, s33, s32
 RK 72,223,2048
 SC 140
 QZ 148,92,28
 RK 76,223,3072
 SC 141
 QK 148,88,24
 EX 156
 QK 148,84,20
 EX 157
 QK 148,80,16
 s_waitcnt lgkmcnt(4)
 CV 190,156,157
 SC 142
 QZ 152,80,32
 s_barrier
 QK 152,84,36
 RK 148,212,0
 SC 143
 QK 152,88,40
 RK 152,212,512
 SC 144
 QK 152,92,44
 RK 156,212,1024
 SC 145
 RK 160,212,1536
 RK 164,212,4096
 EX 158
 RK 168,212,4608
 EX 159
 RK 172,212,5120
 RK 176,212,5632
 CV 191,158,159
 QZ 156,92,60
 RV 180,213,0
 SC 152
 QK 156,88,56
 RV 182,213,4096
 SC 153
 QK 156,84,52
 RV 184,213,8
 SC 154
 QK 156,80,48
 RV 186,213,4104
 SC 155
 SM 128,176
 RV 188,213,512
 SC 146
 SM 132,184
 RV 190,213,4608
 SC 147
 PV 96,96,188
 RV 192,213,520
 SC 156
 PV 64,96,184
 RV 194,213,4616
 SC 157
 PV 32,96,180
 RV 196,213,1024
 SC 158
 PV 0,96,176
 RV 198,213,5120
 SC 159
 PV 4,100,176
 RV 200,213,1032
 SC 148
 PV 36,100,180
 RV 202,213,5128
 SC 149
 PV 68,100,184
 RV 204,213,1536
 SC 150
 PV 100,100,188
 RV 206,213,5632
 SC 151
 PV 104,104,188
 RV 208,213,1544
 EX 128
 PV 72,104,184
 RV 210,213,5640
 EX 129
 PV 40,104,180
 RK 212,212,8192
 CV 160,128,129
 PV 8,104,176
 RK 216,212,8704
 EX 130
 PV 12,108,176
 RK 220,212,9216
 RK 224,212,9728
 PV 44,108,180
 EX 131
 PV 76,108,184
 RK 228,212,12288
 CV 161,130,131
 PV 108,108,188
 RK 232,212,12800
 RK 236,212,13312
 PV 112,112,188
 EX 132
 PV 80,112,184
 RK 240,212,13824
 v_add_u32 v212, s32, v212
 PV 48,112,180
 RV 96,213,8192
 RV 98,213,12288
 PV 16,112,176
 EX 133
 PV 20,116,176
 RV 100,213,8200
 CV 164,132,133
 PV 52,116,180
 RV 102,213,12296
 RV 104,213,8704
 PV 84,116,184
 EX 134
 PV 116,116,188
 RV 106,213,12800
 RV 108,213,8712
 PV 120,120,188
 EX 135
 PV 88,120,184
 RV 110,213,12808
 CV 165,134,135
 PV 56,120,180
 RV 112,213,9216
 RV 114,213,13312
 PV 24,120,176
 EX 136
 PV 28,124,176
 RV 116,213,9224
 RV 118,213,13320
 PV 60,124,180
 EX 137
 PV 92,124,184
 RV 120,213,9728
 CV 168,136,137
 PV 124,124,188
 s_waitcnt lgkmcnt(15)
 RV 122,213,13824
 RV 124,213,9736
 v_mfma_f32_16x16x32_bf16 v[128:131], a[148:151], a[0:3], v[208:211]
 s_waitcnt lgkmcnt(15)
 EX 138
 QK 128,152,4
 s_waitcnt lgkmcnt(15)
 RV 126,213,13832
 v_add_u32 v213, s32, v213
 QK 128,156,8
 s_waitcnt lgkmcnt(15)
 RK 80,223,4096
 RK 84,223,5120
 QK 128,160,12
 EX 139
 v_mfma_f32_16x16x32_bf16 v[132:135], a[160:163], a[28:31], v[208:211]
 RK 88,223,6144
 CV 169,138,139
 QK 132,156,24
 EX 140
 QK 132,152,20
 EX 141
 QK 132,148,16
 RK 92,223,7168
 CV 172,140,141
 QZ 136,148,32
 EX 142
 QK 136,152,36
 EX 143
 QK 136,156,40
 s_waitcnt vmcnt(1) lgkmcnt(4)
 CV 173,142,143
 SC 128
 QK 136,160,44
 s_barrier
 QZ 140,160,60
 EX 152
 QK 140,156,56
 EX 153
 QK 140,152,52
 CV 170,152,153
 SC 129
 QK 140,148,48
 EX 154
 EX 155
 EX 156
 CV 171,154,155
 QZ 152,164,32
 EX 157
 QK 152,168,36
 CV 174,156,157
 SC 130
 QK 152,172,40
 EX 158
 QK 152,176,44
 EX 159
 EX 144
 CV 175,158,159
 QZ 156,176,60
 EX 145
 QK 156,172,56
 CV 162,144,145
 SC 131
 QK 156,168,52
 EX 146
 QK 156,164,48
 EX 147
 EX 148
 CV 163,146,147
 EX 149
 EX 150
 CV 166,148,149
 EX 151
 EX 128
 CV 167,150,151
 EX 129
 EX 130
 SM 128,160
 CV 176,128,129
 PV 32,180,164
 EX 131
 PV 0,180,160
 CV 177,130,131
 SC 132
 PV 4,184,160
 SC 133
 SC 134
 PV 36,184,164
 EX 132
 PV 40,188,164
 EX 133
 PV 8,188,160
 CV 180,132,133
 SC 135
 PV 12,192,160
 EX 134
 PV 44,192,164
 EX 135
 PV 48,196,164
 CV 181,134,135
 SC 136
 PV 16,196,160
 SC 137
 SC 138
 PV 20,200,160
 EX 136
 PV 52,200,164
 EX 137
 PV 56,204,164
 CV 184,136,137
 SC 139
 PV 24,204,160
 EX 138
 PV 28,208,160
 EX 139
 PV 60,208,164
 CV 185,138,139
 SC 152
 QK 0,246,64
 SC 153
 SC 154
 QK 4,244,64
 RK 64,223,8192
 SC 155
 QK 12,244,68
 EX 152
 QK 8,246,68
 RK 68,223,9216
 SC 140
 QK 16,246,72
 EX 153
 QK 20,244,72
 RK 72,223,10240
 CV 186,152,153
 QK 28,244,76
 EX 154
 QK 24,246,76
 s_waitcnt lgkmcnt(6)
 RK 76,223,11264
 SC 141
 QK 32,246,80
 EX 155
 QK 36,244,80
 s_waitcnt lgkmcnt(6)
 RK 80,223,12288
 CV 187,154,155
 QK 44,244,84
 EX 140
 QK 40,246,84
 s_waitcnt lgkmcnt(6)
 RK 84,223,13312
 SC 142
 QK 48,246,88
 EX 141
 QK 52,244,88
 s_waitcnt lgkmcnt(6)
 RK 88,223,14336
 CV 188,140,141
 QK 60,244,92
 SC 143
 SC 156
 QK 56,246,92
 RK 92,223,15360
 SC 157
 v_mfma_f32_16x16x16_bf16 a[128:131], a[144:145], v[176:177], a[128:131]
 EX 142
 SC 158
 PH 0,96,176
 EX 143
 SC 159
 PH 4,100,176
 EX 156
 CV 189,142,143
 v_accvgpr_read_b32 v225, a128
 v_accvgpr_read_b32 v224, a129
 v_add_f32 v225, v224, v225
 v_add_f32 v225, v236, v225
 v_rcp_f32 v224, v225
 v_subrev_u32 v225, 0x21800000, v225
 PM 0,224,0
 PM 2,224,0
 PM 4,224,0
 PM 6,224,0
 PH 8,104,176
 EX 157
 CV 0,0,1
 PH 12,108,176
 CV 1,2,3
 CV 2,4,5
 CV 3,6,7
 PH 16,112,176
 EX 158
 CV 190,156,157
 EX 159
 PM 8,224,0
 PM 10,224,0
 PM 12,224,0
 PM 14,224,0
 PH 20,116,176
 CV 8,8,9
 CV 9,10,11
 CV 10,12,13
 PH 24,120,176
 CV 11,14,15
 XE 4,8,0
 XE 5,9,1
 PH 28,124,176
 XE 6,10,2
 XE 7,11,3
 CV 191,158,159
 v_mfma_f32_16x16x16_bf16 a[128:131], a[136:137], v[180:181], a[128:131]
 s_not_b64 vcc, vcc
 buffer_store_dwordx4 v[4:7], v220, s[24:27], s38 offen offset:0 nt
 XO 8,0,8
 PM 16,224,0
 PM 18,224,0
 PM 20,224,0
 PM 22,224,0
 PM 24,224,0
 PM 26,224,0
 PM 28,224,0
 PM 30,224,0
 v_accvgpr_read_b32 v227, a130
 v_accvgpr_read_b32 v226, a131
 v_add_f32 v227, v226, v227
 v_add_f32 v227, v237, v227
 v_rcp_f32 v226, v227
 v_subrev_u32 v227, 0x21800000, v227
 PH 32,96,180
 XO 9,1,9
 XO 10,2,10
 XO 11,3,11
 PH 36,100,180
 CV 16,16,17
 CV 17,18,19
 CV 18,20,21
 PH 40,104,180
 CV 19,22,23
 CV 24,24,25
 CV 25,26,27
 PH 44,108,180
 CV 26,28,29
 CV 27,30,31
 XO 28,16,24
 PH 48,112,180
 buffer_store_dwordx4 v[8:11], v221, s[24:27], s38 offen offset:0 nt
 PH 52,116,180
 XO 29,17,25
 XO 30,18,26
 XO 31,19,27
 PH 56,120,180
 s_not_b64 vcc, vcc
 XE 16,24,16
 XE 17,25,17
 PH 60,124,180
 XE 18,26,18
 XE 19,27,19
 SM 132,168
 PV 96,180,172
 PV 64,180,168
 RV 180,213,0
 RV 182,213,4096
 PV 68,184,168
 PV 100,184,172
 buffer_store_dwordx4 v[28:31], v221, s[24:27], s38 offen offset:128 nt
 PM 32,226,0
 PM 34,226,0
 PM 36,226,0
 PM 38,226,0
 PM 40,226,0
 PM 42,226,0
 PM 44,226,0
 PM 46,226,0
 PV 104,188,172
 RV 184,213,8
 CV 32,32,33
 PV 72,188,168
 RV 186,213,4104
 CV 33,34,35
 PV 76,192,168
 RV 188,213,512
 CV 34,36,37
 PV 108,192,172
 RV 190,213,4608
 CV 35,38,39
 PV 112,196,172
 RV 192,213,520
 CV 40,40,41
 PV 80,196,168
 buffer_store_dwordx4 v[16:19], v220, s[24:27], s38 offen offset:128 nt
 PV 84,200,168
 RV 194,213,4616
 CV 41,42,43
 PV 116,200,172
 RV 196,213,1024
 CV 42,44,45
 PV 120,204,172
 RV 198,213,5120
 CV 43,46,47
 PV 88,204,168
 RV 200,213,1032
 XE 36,40,32
 PV 92,208,168
 RV 202,213,5128
 XE 37,41,33
 PV 124,208,172
 RV 204,213,1536
 XE 38,42,34
 QZ 136,212,32
 RV 206,213,5632
 XE 39,43,35
 QK 136,216,36
 s_not_b64 vcc, vcc
 buffer_store_dwordx4 v[36:39], v220, s[24:27], s38 offen offset:256 nt
 XO 40,32,40
 PM 48,226,0
 PM 50,226,0
 PM 52,226,0
 PM 54,226,0
 PM 56,226,0
 PM 58,226,0
 PM 60,226,0
 PM 62,226,0
 QK 136,220,40
 RV 208,213,1544
 XO 41,33,41
 QK 136,224,44
 RV 210,213,5640
 XO 42,34,42
 v_mfma_f32_16x16x32_bf16 v[152:155], a[240:243], a[44:47], v[208:211]
 XO 43,35,43
 CV 48,48,49
 QK 152,236,40
 CV 49,50,51
 CV 50,52,53
 QK 152,232,36
 CV 51,54,55
 CV 56,56,57
 QK 152,228,32
 buffer_store_dwordx4 v[40:43], v221, s[24:27], s38 offen offset:256 nt
 QZ 140,212,48
 CV 57,58,59
 CV 58,60,61
 QK 140,216,52
 CV 59,62,63
 XO 60,48,56
 QK 140,220,56
 XO 61,49,57
 XO 62,50,58
 QK 140,224,60
 XO 63,51,59
 SC 136
 v_mfma_f32_16x16x32_bf16 v[156:159], a[240:243], a[60:63], v[208:211]
 s_not_b64 vcc, vcc
 XE 48,56,48
 XE 49,57,49
 QK 156,236,56
 XE 50,58,50
 XE 51,59,51
 QK 156,232,52
 SC 137
 SC 138
 QK 156,228,48
 s_waitcnt lgkmcnt(15)
 buffer_store_dwordx4 v[60:63], v221, s[24:27], s38 offen offset:384 nt
 QK 64,246,64
 EX 136
 QK 68,244,64
 s_waitcnt lgkmcnt(15)
 EX 137
 QK 76,244,68
 CV 168,136,137
 SC 139
 QK 72,246,68
 s_waitcnt lgkmcnt(15)
 EX 138
 QK 80,246,72
 EX 139
 QK 84,244,72
 s_waitcnt lgkmcnt(15)
 CV 169,138,139
 SC 152
 QK 92,244,76
 SC 153
 SC 154
 QK 88,246,76
 s_waitcnt lgkmcnt(15)
 buffer_store_dwordx4 v[48:51], v220, s[24:27], s38 offen offset:384 nt
 QK 96,246,80
 EX 152
 QK 100,244,80
 s_waitcnt lgkmcnt(15)
 EX 153
 QK 108,244,84
 CV 170,152,153
 SC 155
 QK 104,246,84
 s_waitcnt lgkmcnt(15)
 EX 154
 QK 112,246,88
 EX 155
 QK 116,244,88
 s_waitcnt lgkmcnt(15)
 CV 171,154,155
 SC 140
 QK 124,244,92
 SC 141
 SC 142
 QK 120,246,92
 EX 140
 LS 132,144,184
 EX 141
 PV 64,96,184
 CV 172,140,141
 SC 143
 PV 68,100,184
 EX 142
 PV 72,104,184
 EX 143
 PV 76,108,184
 CV 173,142,143
 SC 156
 PV 80,112,184
 SC 157
 SC 158
 PV 84,116,184
 EX 156
 PV 88,120,184
 EX 157
 PV 92,124,184
 CV 174,156,157
 SC 159
 LS 132,144,168
 s_waitcnt lgkmcnt(14)
 EX 158
 PV 64,180,168
 s_waitcnt lgkmcnt(12)
 EX 159
 PV 68,184,168
 s_waitcnt lgkmcnt(10)
 CV 175,158,159
 PV 72,188,168
 s_waitcnt lgkmcnt(8)
 PV 76,192,168
 s_waitcnt lgkmcnt(6)
 PV 80,196,168
 v_accvgpr_read_b32 v229, a132
 v_accvgpr_read_b32 v228, a133
 v_add_f32 v229, v228, v229
 v_add_f32 v229, v238, v229
 v_rcp_f32 v228, v229
 v_subrev_u32 v229, 0x21800000, v229
 PM 64,228,0
 PM 66,228,0
 PM 68,228,0
 PM 70,228,0
 PM 72,228,0
 PM 74,228,0
 PM 76,228,0
 PM 78,228,0
 v_max3_u32 v225, v225, v227, v229
 s_waitcnt lgkmcnt(4)
 PV 84,200,168
 s_waitcnt lgkmcnt(2)
 CV 64,64,65
 CV 65,66,67
 PV 88,204,168
 s_waitcnt lgkmcnt(0)
 CV 66,68,69
 CV 67,70,71
 PV 92,208,168
 CV 72,72,73
 CV 73,74,75
 LS 132,136,188
 CV 74,76,77
 CV 75,78,79
 PV 96,96,188
 XE 68,72,64
 XE 69,73,65
 PV 100,100,188
 XE 70,74,66
 XE 71,75,67
 PV 104,104,188
 s_not_b64 vcc, vcc
 buffer_store_dwordx4 v[68:71], v220, s[24:27], s39 offen offset:0 nt
 XO 72,64,72
 PM 80,228,0
 PM 82,228,0
 PM 84,228,0
 PM 86,228,0
 PM 88,228,0
 PM 90,228,0
 PM 92,228,0
 PM 94,228,0
 PV 108,108,188
 XO 73,65,73
 XO 74,66,74
 PV 112,112,188
 XO 75,67,75
 CV 80,80,81
 PV 116,116,188
 CV 81,82,83
 CV 82,84,85
 PV 120,120,188
 CV 83,86,87
 CV 88,88,89
 PV 124,124,188
 CV 89,90,91
 CV 90,92,93
 LS 132,136,172
 buffer_store_dwordx4 v[72:75], v221, s[24:27], s39 offen offset:0 nt
 PV 96,180,172
 CV 91,94,95
 XO 92,80,88
 PV 100,184,172
 XO 93,81,89
 XO 94,82,90
 PV 104,188,172
 XO 95,83,91
 v_accvgpr_read_b32 v231, a134
 v_accvgpr_read_b32 v230, a135
 v_add_f32 v231, v230, v231
 v_add_f32 v231, v239, v231
 v_rcp_f32 v230, v231
 v_subrev_u32 v231, 0x21800000, v231
 v_max_u32 v225, v225, v231
 v_cmp_le_u32 s[84:85], s77, v225
 PV 108,192,172
 s_not_b64 vcc, vcc
 XE 80,88,80
 XE 81,89,81
 PV 112,196,172
 s_cmp_lg_u64 s[84:85], 0
 XE 82,90,82
 XE 83,91,83
 PV 116,200,172
 s_cselect_b32 s92, s76, 0
 buffer_store_dwordx4 v[92:95], v221, s[24:27], s39 offen offset:128 nt
 PM 96,230,0
 PM 98,230,0
 PM 100,230,0
 PM 102,230,0
 PM 104,230,0
 PM 106,230,0
 PM 108,230,0
 PM 110,230,0
 PV 120,204,172
 s_or_b32 s73, s73, s92
 CV 96,96,97
 CV 97,98,99
 PV 124,208,172
 s_lshl_b32 s76, s76, 1
 CV 98,100,101
 CV 99,102,103
 CV 104,104,105
 CV 105,106,107
 CV 106,108,109
 CV 107,110,111
 XE 100,104,96
 XE 101,105,97
 XE 102,106,98
 XE 103,107,99
 s_not_b64 vcc, vcc
 XO 104,96,104
 XO 105,97,105
 XO 106,98,106
 XO 107,99,107
 buffer_store_dwordx4 v[80:83], v220, s[24:27], s39 offen offset:128 nt
 buffer_store_dwordx4 v[100:103], v220, s[24:27], s39 offen offset:256 nt
 PM 112,230,0
 PM 114,230,0
 PM 116,230,0
 PM 118,230,0
 CV 112,112,113
 CV 113,114,115
 CV 114,116,117
 CV 115,118,119
 PM 120,230,0
 PM 122,230,0
 PM 124,230,0
 PM 126,230,0
 CV 120,120,121
 CV 121,122,123
 CV 122,124,125
 CV 123,126,127
 XO 124,112,120
 XO 125,113,121
 XO 126,114,122
 XO 127,115,123
 s_not_b64 vcc, vcc
 XE 112,120,112
 XE 113,121,113
 XE 114,122,114
 XE 115,123,115
 buffer_store_dwordx4 v[104:107], v221, s[24:27], s39 offen offset:256 nt
 buffer_store_dwordx4 v[124:127], v221, s[24:27], s39 offen offset:384 nt
 buffer_store_dwordx4 v[112:115], v220, s[24:27], s39 offen offset:384 nt
 s_cmp_lg_u32 s73, 0
 s_cbranch_scc1 L_hop
 s_endpgm
.p2align 12
.fill 592, 4, 0xbf800000
L_W3:
 QZ 128,64,0
 s_cmp_eq_u32 s33, 0x8000
 RV 96,213,8192
 v_add_u32 v251, L_W3-L_pc-24576, v244
 QK 128,68,4
 s_cselect_b32 s32, -2, 1
 RV 98,213,12288
 SC 156
 QK 128,72,8
 s_lshl_b32 s32, s32, 14
 RV 100,213,8200
 v_add_u32 v212, s32, v212
 QK 128,76,12
 s_add_u32 s31, s33, s37
 RV 102,213,12296
 SC 157
 QZ 132,76,28
 s_add_u32 s33, s33, s32
 RV 104,213,8704
 SC 158
 QK 132,72,24
 s_add_u32 s31, s33, s37
 RV 106,213,12800
 SC 159
 QK 132,68,20
 RV 108,213,8712
 SC 128
 QK 132,64,16
 RV 110,213,12808
 SC 129
 QZ 136,64,32
 RV 112,213,9216
 SC 130
 QK 136,68,36
 RV 114,213,13312
 SC 131
 QK 136,72,40
 RV 116,213,9224
 SC 132
 QK 136,76,44
 RV 118,213,13320
 SC 133
 QZ 140,76,60
 RV 120,213,9728
 SC 134
 QK 140,72,56
 RV 122,213,13824
 SC 135
 QK 140,68,52
 RV 124,213,9736
 SC 136
 QK 140,64,48
 RV 126,213,13832
 v_add_u32 v213, s32, v213
 QZ 144,80,0
 s_cmp_eq_u32 s33, 0x8000
 global_load_dword v255, v251, s[64:65]
 SC 137
 QK 144,84,4
 s_cselect_b32 s32, -2, 1
 s_waitcnt vmcnt(9)
 RK 64,223,0
 SC 138
 QK 144,88,8
 s_lshl_b32 s32, s32, 14
 RK 68,223,1024
 SC 139
 QK 144,92,12
 s_add_u32 s33, s33, s32
 RK 72,223,2048
 SC 140
 QZ 148,92,28
 RK 76,223,3072
 SC 141
 QK 148,88,24
 EX 156
 QK 148,84,20
 EX 157
 QK 148,80,16
 s_waitcnt lgkmcnt(4)
 CV 190,156,157
 SC 144
 QZ 152,80,32
 s_barrier
 QK 152,84,36
 RK 148,212,0
 SC 145
 QK 152,88,40
 RK 152,212,512
 SC 146
 QK 152,92,44
 RK 156,212,1024
 SC 147
 RK 160,212,1536
 RK 164,212,4096
 EX 158
 RK 168,212,4608
 EX 159
 RK 172,212,5120
 RK 176,212,5632
 CV 191,158,159
 QZ 156,92,60
 RV 180,213,0
 SC 148
 QK 156,88,56
 RV 182,213,4096
 SC 149
 QK 156,84,52
 RV 184,213,8
 SC 150
 QK 156,80,48
 RV 186,213,4104
 SC 151
 SM 128,176
 RV 188,213,512
 SC 142
 SM 132,184
 RV 190,213,4608
 SC 143
 PV 96,96,188
 RV 192,213,520
 SC 152
 PV 64,96,184
 RV 194,213,4616
 SC 153
 PV 32,96,180
 RV 196,213,1024
 SC 154
 PV 0,96,176
 RV 198,213,5120
 SC 155
 PV 4,100,176
 RV 200,213,1032
 SC 156
 PV 36,100,180
 RV 202,213,5128
 SC 157
 PV 68,100,184
 RV 204,213,1536
 SC 158
 PV 100,100,188
 RV 206,213,5632
 SC 159
 PV 104,104,188
 RV 208,213,1544
 EX 128
 PV 72,104,184
 RV 210,213,5640
 EX 129
 PV 40,104,180
 RK 212,212,8192
 CV 160,128,129
 PV 8,104,176
 RK 216,212,8704
 EX 130
 PV 12,108,176
 RK 220,212,9216
 RK 224,212,9728
 PV 44,108,180
 EX 131
 PV 76,108,184
 RV 96,213,8192
 CV 161,130,131
 PV 108,108,188
 RV 98,213,12288
 v_add_u32 v212, s32, v212
 PV 112,112,188
 RV 100,213,8200
 RV 102,213,12296
 PV 80,112,184
 EX 132
 PV 48,112,180
 RV 104,213,8704
 RV 106,213,12800
 PV 16,112,176
 EX 133
 PV 20,116,176
 RV 108,213,8712
 CV 164,132,133
 PV 52,116,180
 RV 110,213,12808
 RV 112,213,9216
 PV 84,116,184
 EX 134
 PV 116,116,188
 RV 114,213,13312
 RV 116,213,9224
 PV 120,120,188
 EX 135
 PV 88,120,184
 RV 118,213,13320
 CV 165,134,135
 PV 56,120,180
 RK 80,223,4096
 RK 84,223,5120
 PV 24,120,176
 EX 144
 PV 28,124,176
 RV 120,213,9728
 RV 122,213,13824
 PV 60,124,180
 EX 145
 PV 92,124,184
 RK 88,223,6144
 CV 162,144,145
 PV 124,124,188
 s_waitcnt lgkmcnt(15)
 RV 124,213,9736
 RV 126,213,13832
 QZ 128,148,0
 s_waitcnt lgkmcnt(15)
 EX 146
 QK 128,152,4
 s_waitcnt lgkmcnt(15)
 RK 92,223,7168
 v_add_u32 v213, s32, v213
 QK 128,156,8
 s_waitcnt lgkmcnt(15)
 EX 147
 QK 128,160,12
 EX 148
 QZ 132,160,28
 EX 149
 QK 132,156,24
 CV 163,146,147
 CV 166,148,149
 QK 132,152,20
 EX 150
 QK 132,148,16
 s_waitcnt lgkmcnt(15)
 EX 151
 v_mfma_f32_16x16x32_bf16 v[144:147], a[164:167], a[0:3], v[208:211]
 s_waitcnt lgkmcnt(15)
 CV 167,150,151
 SC 128
 QK 144,168,4
 s_waitcnt lgkmcnt(15)
 EX 136
 QK 144,172,8
 s_waitcnt vmcnt(1) lgkmcnt(1)
 EX 137
 QK 144,176,12
 s_barrier
 v_mfma_f32_16x16x32_bf16 v[148:151], a[176:179], a[28:31], v[208:211]
 CV 168,136,137
 SC 129
 QK 148,172,24
 EX 138
 QK 148,168,20
 EX 139
 QK 148,164,16
 CV 169,138,139
 SC 130
 QZ 136,148,32
 EX 140
 QK 136,152,36
 EX 141
 QK 136,156,40
 CV 172,140,141
 SC 131
 QK 136,160,44
 EX 142
 EX 143
 EX 152
 CV 173,142,143
 QZ 140,160,60
 EX 153
 QK 140,156,56
 CV 170,152,153
 SC 144
 QK 140,152,52
 EX 154
 QK 140,148,48
 EX 155
 EX 156
 CV 171,154,155
 QZ 152,164,32
 EX 157
 QK 152,168,36
 CV 174,156,157
 SC 145
 QK 152,172,40
 EX 158
 QK 152,176,44
 EX 159
 EX 128
 CV 175,158,159
 QZ 156,176,60
 EX 129
 QK 156,172,56
 CV 176,128,129
 SC 146
 QK 156,168,52
 EX 130
 QK 156,164,48
 EX 131
 SM 128,160
 CV 177,130,131
 PV 32,180,164
 EX 144
 PV 0,180,160
 EX 145
 PV 4,184,160
 CV 178,144,145
 SC 147
 PV 36,184,164
 EX 146
 PV 40,188,164
 EX 147
 PV 8,188,160
 CV 179,146,147
 SC 132
 PV 12,192,160
 SC 133
 SC 134
 PV 44,192,164
 EX 132
 PV 48,196,164
 EX 133
 PV 16,196,160
 CV 180,132,133
 SC 135
 PV 20,200,160
 EX 134
 PV 52,200,164
 EX 135
 PV 56,204,164
 CV 181,134,135
 SC 148
 PV 24,204,160
 SC 149
 SC 150
 PV 28,208,160
 EX 148
 PV 60,208,164
 EX 149
 QK 0,246,64
 CV 182,148,149
 SC 151
 QK 4,244,64
 RK 64,223,8192
 SC 136
 QK 12,244,68
 EX 150
 QK 8,246,68
 RK 68,223,9216
 SC 137
 QK 16,246,72
 EX 151
 QK 20,244,72
 RK 72,223,10240
 CV 183,150,151
 QK 28,244,76
 EX 136
 QK 24,246,76
 RK 76,223,11264
 SC 138
 QK 32,246,80
 EX 137
 QK 36,244,80
 RK 80,223,12288
 CV 184,136,137
 QK 44,244,84
 SC 139
 SC 140
 QK 40,246,84
 RK 84,223,13312
 SC 141
 QK 48,246,88
 EX 138
 QK 52,244,88
 s_waitcnt lgkmcnt(6)
 RK 88,223,14336
 SC 142
 QK 60,244,92
 EX 139
 QK 56,246,92
 RK 92,223,15360
 CV 185,138,139
 LS 128,144,176
 EX 140
 PV 0,96,176
 EX 141
 PV 4,100,176
 CV 188,140,141
 SC 143
 PV 8,104,176
 EX 142
 v_accvgpr_read_b32 v225, a128
 v_accvgpr_read_b32 v224, a129
 v_add_f32 v225, v224, v225
 v_add_f32 v225, v236, v225
 v_rcp_f32 v224, v225
 v_subrev_u32 v225, 0x21800000, v225
 PM 0,224,0
 PM 2,224,0
 PM 4,224,0
 PM 6,224,0
 PM 8,224,0
 PM 10,224,0
 PV 12,108,176
 CV 0,0,1
 CV 1,2,3
 PV 16,112,176
 CV 2,4,5
 CV 3,6,7
 PV 20,116,176
 CV 8,8,9
 CV 9,10,11
 EX 143
 XE 4,8,0
 PM 12,224,0
 PM 14,224,0
 PV 24,120,176
 CV 10,12,13
 CV 11,14,15
 PV 28,124,176
 XE 5,9,1
 XE 6,10,2
 LS 128,136,180
 XE 7,11,3
 CV 189,142,143
 PV 32,96,180
 s_not_b64 vcc, vcc
 buffer_store_dwordx4 v[4:7], v220, s[24:27], s38 offen offset:0 nt
 XO 8,0,8
 PM 16,224,0
 PM 18,224,0
 PM 20,224,0
 PM 22,224,0
 PM 24,224,0
 PM 26,224,0
 PM 28,224,0
 PM 30,224,0
 v_accvgpr_read_b32 v227, a130
 v_accvgpr_read_b32 v226, a131
 v_add_f32 v227, v226, v227
 v_add_f32 v227, v237, v227
 v_rcp_f32 v226, v227
 v_subrev_u32 v227, 0x21800000, v227
 PV 36,100,180
 XO 9,1,9
 XO 10,2,10
 PV 40,104,180
 XO 11,3,11
 CV 16,16,17
 PV 44,108,180
 CV 17,18,19
 CV 18,20,21
 PV 48,112,180
 buffer_store_dwordx4 v[8:11], v221, s[24:27], s38 offen offset:0 nt
 PV 52,116,180
 CV 19,22,23
 CV 24,24,25
 PV 56,120,180
 CV 25,26,27
 CV 26,28,29
 PV 60,124,180
 CV 27,30,31
 XO 28,16,24
 SM 132,168
 XO 29,17,25
 PV 96,180,172
 XO 30,18,26
 XO 31,19,27
 PV 64,180,168
 s_not_b64 vcc, vcc
 RV 180,213,0
 XE 16,24,16
 PV 68,184,168
 XE 17,25,17
 XE 18,26,18
 PV 100,184,172
 buffer_store_dwordx4 v[28:31], v221, s[24:27], s38 offen offset:128 nt
 XE 19,27,19
 PM 32,226,0
 PM 34,226,0
 PM 36,226,0
 PM 38,226,0
 PM 40,226,0
 PM 42,226,0
 PM 44,226,0
 PM 46,226,0
 PV 104,188,172
 RV 184,213,8
 CV 32,32,33
 PV 72,188,168
 RV 188,213,512
 CV 33,34,35
 PV 76,192,168
 CV 34,36,37
 CV 35,38,39
 PV 108,192,172
 RV 192,213,520
 CV 40,40,41
 PV 112,196,172
 CV 41,42,43
 CV 42,44,45
 PV 80,196,168
 buffer_store_dwordx4 v[16:19], v220, s[24:27], s38 offen offset:128 nt
 PV 84,200,168
 RV 196,213,1024
 CV 43,46,47
 PV 116,200,172
 RV 200,213,1032
 XE 36,40,32
 PV 120,204,172
 XE 37,41,33
 XE 38,42,34
 PV 88,204,168
 RV 204,213,1536
 XE 39,43,35
 PV 92,208,168
 s_not_b64 vcc, vcc
 XO 40,32,40
 XO 41,33,41
 PV 124,208,172
 RV 208,213,1544
 XO 42,34,42
 v_mfma_f32_16x16x32_bf16 v[136:139], a[212:215], a[32:35], v[208:211]
 XO 43,35,43
 SC 152
 QK 136,216,36
 buffer_store_dwordx4 v[36:39], v220, s[24:27], s38 offen offset:256 nt
 SC 153
 PM 48,226,0
 PM 50,226,0
 PM 52,226,0
 PM 54,226,0
 PM 56,226,0
 PM 58,226,0
 PM 60,226,0
 PM 62,226,0
 QK 136,220,40
 CV 48,48,49
 CV 49,50,51
 QK 136,224,44
 CV 50,52,53
 CV 51,54,55
 v_mfma_f32_16x16x32_bf16 v[140:143], a[212:215], a[48:51], v[208:211]
 CV 56,56,57
 CV 57,58,59
 QK 140,216,52
 CV 58,60,61
 CV 59,62,63
 QK 140,220,56
 XO 60,48,56
 XO 61,49,57
 QK 140,224,60
 s_waitcnt lgkmcnt(15)
 buffer_store_dwordx4 v[40:43], v221, s[24:27], s38 offen offset:256 nt
 QK 64,246,64
 XO 62,50,58
 XO 63,51,59
 QK 68,244,64
 s_not_b64 vcc, vcc
 XE 48,56,48
 XE 49,57,49
 s_waitcnt lgkmcnt(14)
 QK 76,244,68
 XE 50,58,50
 XE 51,59,51
 QK 72,246,68
 s_waitcnt lgkmcnt(13)
 EX 152
 QK 80,246,72
 EX 153
 QK 84,244,72
 s_waitcnt lgkmcnt(12)
 CV 186,152,153
 SC 154
 QK 92,244,76
 SC 155
 SC 136
 QK 88,246,76
 s_waitcnt lgkmcnt(11)
 buffer_store_dwordx4 v[60:63], v221, s[24:27], s38 offen offset:384 nt
 QK 96,246,80
 EX 154
 QK 100,244,80
 s_waitcnt lgkmcnt(10)
 EX 155
 QK 108,244,84
 CV 187,154,155
 SC 137
 QK 104,246,84
 s_waitcnt lgkmcnt(9)
 EX 136
 QK 112,246,88
 EX 137
 QK 116,244,88
 s_waitcnt lgkmcnt(8)
 CV 168,136,137
 SC 138
 QK 124,244,92
 SC 139
 SC 156
 QK 120,246,92
 buffer_store_dwordx4 v[48:51], v220, s[24:27], s38 offen offset:384 nt
 LS 132,144,184
 EX 138
 PV 64,96,184
 EX 139
 PV 68,100,184
 CV 169,138,139
 SC 157
 PV 72,104,184
 EX 156
 PV 76,108,184
 EX 157
 PV 80,112,184
 CV 190,156,157
 SC 158
 PV 84,116,184
 SC 159
 SC 140
 PV 88,120,184
 EX 158
 PV 92,124,184
 EX 159
 v_mfma_f32_16x16x16_bf16 a[132:135], a[144:145], v[168:169], a[132:135]
 s_waitcnt lgkmcnt(7)
 CV 191,158,159
 SC 141
 SC 142
 PH 64,180,168
 s_waitcnt lgkmcnt(6)
 EX 140
 SC 143
 PH 68,184,168
 EX 141
 v_accvgpr_read_b32 v229, a132
 v_accvgpr_read_b32 v228, a133
 v_add_f32 v229, v228, v229
 v_add_f32 v229, v238, v229
 v_rcp_f32 v228, v229
 v_subrev_u32 v229, 0x21800000, v229
 PM 64,228,0
 PM 66,228,0
 PM 68,228,0
 PM 70,228,0
 v_max3_u32 v225, v225, v227, v229
 s_waitcnt lgkmcnt(5)
 PH 72,188,168
 s_waitcnt lgkmcnt(4)
 CV 64,64,65
 CV 65,66,67
 CV 66,68,69
 PH 76,192,168
 s_waitcnt lgkmcnt(3)
 CV 67,70,71
 EX 142
 PH 80,196,168
 EX 143
 CV 172,140,141
 CV 173,142,143
 PM 72,228,0
 PM 74,228,0
 PM 76,228,0
 PM 78,228,0
 s_waitcnt lgkmcnt(2)
 PH 84,200,168
 s_waitcnt lgkmcnt(1)
 CV 72,72,73
 CV 73,74,75
 CV 74,76,77
 PH 88,204,168
 s_waitcnt lgkmcnt(0)
 CV 75,78,79
 XE 68,72,64
 XE 69,73,65
 PH 92,208,168
 XE 70,74,66
 XE 71,75,67
 LS 132,136,188
 s_not_b64 vcc, vcc
 buffer_store_dwordx4 v[68:71], v220, s[24:27], s39 offen offset:0 nt
 XO 72,64,72
 PM 80,228,0
 PM 82,228,0
 PM 84,228,0
 PM 86,228,0
 PM 88,228,0
 PM 90,228,0
 PM 92,228,0
 PM 94,228,0
 PV 96,96,188
 XO 73,65,73
 XO 74,66,74
 PV 100,100,188
 XO 75,67,75
 CV 80,80,81
 PV 104,104,188
 CV 81,82,83
 CV 82,84,85
 PV 108,108,188
 CV 83,86,87
 CV 88,88,89
 PV 112,112,188
 CV 89,90,91
 CV 90,92,93
 PV 116,116,188
 buffer_store_dwordx4 v[72:75], v221, s[24:27], s39 offen offset:0 nt
 PV 120,120,188
 CV 91,94,95
 XO 92,80,88
 PV 124,124,188
 XO 93,81,89
 XO 94,82,90
 v_mfma_f32_16x16x16_bf16 a[132:135], a[136:137], v[172:173], a[132:135]
 XO 95,83,91
 PH 96,180,172
 s_not_b64 vcc, vcc
 XE 80,88,80
 XE 81,89,81
 PH 100,184,172
 XE 82,90,82
 XE 83,91,83
 v_accvgpr_read_b32 v231, a134
 v_accvgpr_read_b32 v230, a135
 v_add_f32 v231, v230, v231
 v_add_f32 v231, v239, v231
 v_rcp_f32 v230, v231
 v_subrev_u32 v231, 0x21800000, v231
 v_max_u32 v225, v225, v231
 v_cmp_le_u32 s[84:85], s77, v225
 PH 104,188,172
 PH 108,192,172
 buffer_store_dwordx4 v[92:95], v221, s[24:27], s39 offen offset:128 nt
 PM 96,230,0
 PM 98,230,0
 PM 100,230,0
 PM 102,230,0
 PH 112,196,172
 CV 96,96,97
 CV 97,98,99
 CV 98,100,101
 CV 99,102,103
 PM 104,230,0
 PM 106,230,0
 PM 108,230,0
 PM 110,230,0
 PH 116,200,172
 CV 104,104,105
 CV 105,106,107
 CV 106,108,109
 PH 120,204,172
 s_cmp_lg_u64 s[84:85], 0
 CV 107,110,111
 XE 100,104,96
 PH 124,208,172
 s_cselect_b32 s92, s76, 0
 XE 101,105,97
 XE 102,106,98
 XE 103,107,99
 buffer_store_dwordx4 v[80:83], v220, s[24:27], s39 offen offset:128 nt
 s_not_b64 vcc, vcc
 XO 104,96,104
 XO 105,97,105
 XO 106,98,106
 XO 107,99,107
 v_mul_f32 v112, v230, v112
 v_mul_f32 v113, v230, v113
 v_mul_f32 v114, v230, v114
 v_mul_f32 v115, v230, v115
 v_mul_f32 v116, v230, v116
 v_mul_f32 v117, v230, v117
 v_mul_f32 v118, v230, v118
 v_mul_f32 v119, v230, v119
 CV 112,112,113
 CV 113,114,115
 CV 114,116,117
 CV 115,118,119
 v_mul_f32 v120, v230, v120
 v_mul_f32 v121, v230, v121
 v_mul_f32 v122, v230, v122
 v_mul_f32 v123, v230, v123
 v_mul_f32 v124, v230, v124
 v_mul_f32 v125, v230, v125
 v_mul_f32 v126, v230, v126
 v_mul_f32 v127, v230, v127
 CV 120,120,121
 CV 121,122,123
 CV 122,124,125
 CV 123,126,127
 XO 124,112,120
 buffer_store_dwordx4 v[100:103], v220, s[24:27], s39 offen offset:256 nt
 XO 125,113,121
 XO 126,114,122
 XO 127,115,123
 s_not_b64 vcc, vcc
 XE 112,120,112
 XE 113,121,113
 XE 114,122,114
 XE 115,123,115
 s_or_b32 s73, s73, s92
 s_lshl_b32 s76, s76, 1
 buffer_store_dwordx4 v[104:107], v221, s[24:27], s39 offen offset:256 nt
 buffer_store_dwordx4 v[124:127], v221, s[24:27], s39 offen offset:384 nt
 buffer_store_dwordx4 v[112:115], v220, s[24:27], s39 offen offset:384 nt
 s_cmp_lg_u32 s73, 0
 s_cbranch_scc1 L_hop
 s_endpgm
L_done:
 s_cmp_eq_u32 s73, 0
 s_cbranch_scc1 L_out

L_fb:
    s_mov_b64 s[8:9], s[74:75]
    s_mov_b64 s[12:13], s[86:87]
    s_mov_b64 s[20:21], s[60:61]
    v_mbcnt_lo_u32_b32 v206, -1, 0
    v_mbcnt_hi_u32_b32 v206, -1, v206
    v_and_b32 v207, 15, v206
    v_lshrrev_b32 v206, 4, v206
    v_lshlrev_b32 v246, 4, v206
    v_lshl_add_u32 v247, v207, 12, v246
    v_lshl_add_u32 v246, v207, 11, v246
    v_lshlrev_b32 v206, 2, v206
    v_sub_u32 v249, v207, v206
    s_lshl_b32 s88, s29, 14
    v_subrev_u32 v248, s88, v216
    v_mov_b32 v250, 0xff800000
L_fbjob:
    s_ff1_i32_b32 s46, s73
    s_bitset0_b32 s73, s46
    s_lshr_b32 s88, s2, 3
    s_lshl_b32 s89, s2, 2
    s_lshr_b32 s89, 0x10345612, s89
    s_and_b32 s89, s89, 7
    s_lshl3_add_u32 s88, s88, s89
    s_lshl_b32 s88, s88, 7
    s_add_u32 s88, s88, L_table-L_pc
    s_add_u32 s90, s64, s88
    s_addc_u32 s91, s65, 0
    s_lshl_b32 s88, s46, 4
    s_lshl_b32 s89, s46, 2
    s_add_u32 s89, s89, 96
    s_load_dwordx4 s[40:43], s[90:91], s88
    s_load_dword s44, s[90:91], s89
    s_waitcnt vmcnt(0) lgkmcnt(0)
    s_and_b32 s88, s2, 7
    s_lshl_b32 s88, s88, 8
    s_add_u32 s44, s44, s88
    s_lshl1_add_u32 s40, s88, s40
    s_and_b32 s14, s42, 0xfffff800
    s_mov_b32 s22, s14
    s_and_b32 s26, s43, 0xfffff000
 s_lshl_b32 s91, s29, 16
 s_add_u32 s80, s40, s91
 s_sub_u32 s81, s40, s91
 s_add_u32 s81, s81, 0x70000
 s_and_b32 s10, s43, 0xfffff000
 s_bfe_u32 s79, s43, 0x20008
 s_bitcmp1_b32 s43, 8
 s_cselect_b32 s82, 0x2000, 0
 s_mov_b32 s38, s80
 s_mov_b32 s39, s81
 s_lshr_b32 s88, s44, 11
 s_lshr_b32 s45, s40, 12
 s_sub_u32 s45, s45, s88
 s_add_u32 s45, s45, 159
 s_lshr_b32 s45, s45, 5
 s_lshr_b32 s89, s38, 12
 s_sub_u32 s89, s89, s88
 v_add_u32 v204, s89, v249
 s_lshr_b32 s89, s39, 12
 s_sub_u32 s89, s89, s88
 v_add_u32 v205, s89, v249
 buffer_load_dwordx4 a[0:3], v247, s[8:11], s38 offen offset:0
 buffer_load_dwordx4 a[4:7], v247, s[8:11], s38 offen offset:64
 buffer_load_dwordx4 a[8:11], v247, s[8:11], s38 offen offset:128
 buffer_load_dwordx4 a[12:15], v247, s[8:11], s38 offen offset:192
 v_mov_b32 v192, v250
 v_mov_b32 v196, 0
 buffer_load_dwordx4 a[16:19], v247, s[8:11], s38 offen offset:256
 buffer_load_dwordx4 a[20:23], v247, s[8:11], s38 offen offset:320
 buffer_load_dwordx4 a[24:27], v247, s[8:11], s38 offen offset:384
 buffer_load_dwordx4 a[28:31], v247, s[8:11], s38 offen offset:448
 v_mov_b32 v193, v250
 v_mov_b32 v197, 0
 buffer_load_dwordx4 a[32:35], v247, s[8:11], s39 offen offset:0
 buffer_load_dwordx4 a[36:39], v247, s[8:11], s39 offen offset:64
 buffer_load_dwordx4 a[40:43], v247, s[8:11], s39 offen offset:128
 buffer_load_dwordx4 a[44:47], v247, s[8:11], s39 offen offset:192
 v_mov_b32 v194, v250
 v_mov_b32 v198, 0
 buffer_load_dwordx4 a[48:51], v247, s[8:11], s39 offen offset:256
 buffer_load_dwordx4 a[52:55], v247, s[8:11], s39 offen offset:320
 buffer_load_dwordx4 a[56:59], v247, s[8:11], s39 offen offset:384
 buffer_load_dwordx4 a[60:63], v247, s[8:11], s39 offen offset:448
 v_mov_b32 v195, v250
 v_mov_b32 v199, 0
 v_mov_b64 v[0:1], 0
 v_mov_b64 v[2:3], 0
 v_mov_b64 v[4:5], 0
 v_mov_b64 v[6:7], 0
 v_mov_b64 v[8:9], 0
 v_mov_b64 v[10:11], 0
 v_mov_b64 v[12:13], 0
 v_mov_b64 v[14:15], 0
 v_mov_b64 v[16:17], 0
 v_mov_b64 v[18:19], 0
 v_mov_b64 v[20:21], 0
 v_mov_b64 v[22:23], 0
 v_mov_b64 v[24:25], 0
 v_mov_b64 v[26:27], 0
 v_mov_b64 v[28:29], 0
 v_mov_b64 v[30:31], 0
 v_mov_b64 v[32:33], 0
 v_mov_b64 v[34:35], 0
 v_mov_b64 v[36:37], 0
 v_mov_b64 v[38:39], 0
 v_mov_b64 v[40:41], 0
 v_mov_b64 v[42:43], 0
 v_mov_b64 v[44:45], 0
 v_mov_b64 v[46:47], 0
 v_mov_b64 v[48:49], 0
 v_mov_b64 v[50:51], 0
 v_mov_b64 v[52:53], 0
 v_mov_b64 v[54:55], 0
 v_mov_b64 v[56:57], 0
 v_mov_b64 v[58:59], 0
 v_mov_b64 v[60:61], 0
 v_mov_b64 v[62:63], 0
 v_mov_b64 v[64:65], 0
 v_mov_b64 v[66:67], 0
 v_mov_b64 v[68:69], 0
 v_mov_b64 v[70:71], 0
 v_mov_b64 v[72:73], 0
 v_mov_b64 v[74:75], 0
 v_mov_b64 v[76:77], 0
 v_mov_b64 v[78:79], 0
 v_mov_b64 v[80:81], 0
 v_mov_b64 v[82:83], 0
 v_mov_b64 v[84:85], 0
 v_mov_b64 v[86:87], 0
 v_mov_b64 v[88:89], 0
 v_mov_b64 v[90:91], 0
 v_mov_b64 v[92:93], 0
 v_mov_b64 v[94:95], 0
 v_mov_b64 v[96:97], 0
 v_mov_b64 v[98:99], 0
 v_mov_b64 v[100:101], 0
 v_mov_b64 v[102:103], 0
 v_mov_b64 v[104:105], 0
 v_mov_b64 v[106:107], 0
 v_mov_b64 v[108:109], 0
 v_mov_b64 v[110:111], 0
 v_mov_b64 v[112:113], 0
 v_mov_b64 v[114:115], 0
 v_mov_b64 v[116:117], 0
 v_mov_b64 v[118:119], 0
 v_mov_b64 v[120:121], 0
 v_mov_b64 v[122:123], 0
 v_mov_b64 v[124:125], 0
 v_mov_b64 v[126:127], 0
L_fbstep:
 s_add_u32 s88, s44, 0
 buffer_load_dwordx4 a[64:67], v246, s[12:15], s88 offen offset:0
 buffer_load_dwordx4 a[68:71], v246, s[12:15], s88 offen offset:64
 buffer_load_dwordx4 a[72:75], v246, s[12:15], s88 offen offset:128
 buffer_load_dwordx4 a[76:79], v246, s[12:15], s88 offen offset:192
 s_add_u32 s88, s44, 32768
 buffer_load_dwordx4 a[80:83], v246, s[12:15], s88 offen offset:0
 buffer_load_dwordx4 a[84:87], v246, s[12:15], s88 offen offset:64
 buffer_load_dwordx4 a[88:91], v246, s[12:15], s88 offen offset:128
 buffer_load_dwordx4 a[92:95], v246, s[12:15], s88 offen offset:192
 s_add_u32 s88, s44, 0
 s_add_u32 m0, s78, 0
 s_nop 0
 buffer_load_dwordx4 v248, s[20:23], s88 offen offset:0 lds
 s_add_u32 m0, s78, 896
 s_nop 0
 buffer_load_dwordx4 v248, s[20:23], s88 offen offset:128 lds
 s_add_u32 s88, s44, 16384
 s_add_u32 m0, s78, 2048
 s_nop 0
 buffer_load_dwordx4 v248, s[20:23], s88 offen offset:0 lds
 s_add_u32 m0, s78, 2944
 s_nop 0
 buffer_load_dwordx4 v248, s[20:23], s88 offen offset:128 lds
 s_add_u32 s88, s44, 32768
 s_add_u32 m0, s78, 4096
 s_nop 0
 buffer_load_dwordx4 v248, s[20:23], s88 offen offset:0 lds
 s_add_u32 m0, s78, 4992
 s_nop 0
 buffer_load_dwordx4 v248, s[20:23], s88 offen offset:128 lds
 s_add_u32 s88, s44, 49152
 s_add_u32 m0, s78, 6144
 s_nop 0
 buffer_load_dwordx4 v248, s[20:23], s88 offen offset:0 lds
 s_add_u32 m0, s78, 7040
 s_nop 0
 buffer_load_dwordx4 v248, s[20:23], s88 offen offset:128 lds
 s_waitcnt vmcnt(0)
 RV 96,222,0
 RV 98,222,4096
 RV 100,222,8
 RV 102,222,4104
 RV 104,222,512
 RV 106,222,4608
 RV 108,222,520
 RV 110,222,4616
 RV 112,222,1024
 RV 114,222,5120
 RV 116,222,1032
 RV 118,222,5128
 RV 120,222,1536
 RV 122,222,5632
 RV 124,222,1544
 RV 126,222,5640
 QZ 128,64,0
 QK 128,68,4
 QK 128,72,8
 QK 128,76,12
 QZ 132,76,28
 QK 132,72,24
 QK 132,68,20
 QK 132,64,16
 QZ 136,64,32
 QK 136,68,36
 QK 136,72,40
 QK 136,76,44
 QZ 140,76,60
 QK 140,72,56
 QK 140,68,52
 QK 140,64,48
 QZ 144,80,0
 QK 144,84,4
 QK 144,88,8
 QK 144,92,12
 QZ 148,92,28
 QK 148,88,24
 QK 148,84,20
 QK 148,80,16
 QZ 152,80,32
 QK 152,84,36
 QK 152,88,40
 QK 152,92,44
 QZ 156,92,60
 QK 156,88,56
 QK 156,84,52
 QK 156,80,48
 v_cmp_gt_i32 vcc, 0, v204
 SC 128
 s_nop 0
 v_cndmask_b32 v128, v128, v250, vcc
 v_cmp_gt_i32 vcc, 1, v204
 SC 129
 s_nop 0
 v_cndmask_b32 v129, v129, v250, vcc
 v_cmp_gt_i32 vcc, 2, v204
 SC 130
 s_nop 0
 v_cndmask_b32 v130, v130, v250, vcc
 v_cmp_gt_i32 vcc, 3, v204
 SC 131
 s_nop 0
 v_cndmask_b32 v131, v131, v250, vcc
 v_cmp_gt_i32 vcc, 16, v204
 SC 144
 s_nop 0
 v_cndmask_b32 v144, v144, v250, vcc
 v_cmp_gt_i32 vcc, 17, v204
 SC 145
 s_nop 0
 v_cndmask_b32 v145, v145, v250, vcc
 v_cmp_gt_i32 vcc, 18, v204
 SC 146
 s_nop 0
 v_cndmask_b32 v146, v146, v250, vcc
 v_cmp_gt_i32 vcc, 19, v204
 SC 147
 s_nop 0
 v_cndmask_b32 v147, v147, v250, vcc
 v_mov_b32 v206, v192
 v_max3_f32 v206, v128, v129, v206
 v_max3_f32 v206, v130, v131, v206
 v_max3_f32 v206, v144, v145, v206
 v_max3_f32 v206, v146, v147, v206
 v_mov_b32 v207, v206
 s_nop 1
 SW 206,207
 v_max_f32 v206, v206, v207
 v_mov_b32 v207, v206
 s_nop 1
 v_permlane32_swap_b32 v206, v207
 v_max_f32 v206, v206, v207
 v_sub_f32 v200, v192, v206
 EX 200
 v_mov_b32 v192, v206
 v_mul_f32 v196, v200, v196
 v_sub_f32 v128, v128, v206
 EX 128
 s_nop 0
 v_add_f32 v196, v128, v196
 v_sub_f32 v129, v129, v206
 EX 129
 s_nop 0
 v_add_f32 v196, v129, v196
 v_sub_f32 v130, v130, v206
 EX 130
 s_nop 0
 v_add_f32 v196, v130, v196
 v_sub_f32 v131, v131, v206
 EX 131
 s_nop 0
 v_add_f32 v196, v131, v196
 v_sub_f32 v144, v144, v206
 EX 144
 s_nop 0
 v_add_f32 v196, v144, v196
 v_sub_f32 v145, v145, v206
 EX 145
 s_nop 0
 v_add_f32 v196, v145, v196
 v_sub_f32 v146, v146, v206
 EX 146
 s_nop 0
 v_add_f32 v196, v146, v196
 v_sub_f32 v147, v147, v206
 EX 147
 s_nop 0
 v_add_f32 v196, v147, v196
 CV 160,128,129
 CV 161,130,131
 CV 162,144,145
 CV 163,146,147
 v_mul_f32 v0, v200, v0
 v_mul_f32 v1, v200, v1
 v_mul_f32 v2, v200, v2
 v_mul_f32 v3, v200, v3
 v_mul_f32 v4, v200, v4
 v_mul_f32 v5, v200, v5
 v_mul_f32 v6, v200, v6
 v_mul_f32 v7, v200, v7
 v_mul_f32 v8, v200, v8
 v_mul_f32 v9, v200, v9
 v_mul_f32 v10, v200, v10
 v_mul_f32 v11, v200, v11
 v_mul_f32 v12, v200, v12
 v_mul_f32 v13, v200, v13
 v_mul_f32 v14, v200, v14
 v_mul_f32 v15, v200, v15
 v_mul_f32 v16, v200, v16
 v_mul_f32 v17, v200, v17
 v_mul_f32 v18, v200, v18
 v_mul_f32 v19, v200, v19
 v_mul_f32 v20, v200, v20
 v_mul_f32 v21, v200, v21
 v_mul_f32 v22, v200, v22
 v_mul_f32 v23, v200, v23
 v_mul_f32 v24, v200, v24
 v_mul_f32 v25, v200, v25
 v_mul_f32 v26, v200, v26
 v_mul_f32 v27, v200, v27
 v_mul_f32 v28, v200, v28
 v_mul_f32 v29, v200, v29
 v_mul_f32 v30, v200, v30
 v_mul_f32 v31, v200, v31
 v_cmp_gt_i32 vcc, 0, v204
 SC 132
 s_nop 0
 v_cndmask_b32 v132, v132, v250, vcc
 v_cmp_gt_i32 vcc, 1, v204
 SC 133
 s_nop 0
 v_cndmask_b32 v133, v133, v250, vcc
 v_cmp_gt_i32 vcc, 2, v204
 SC 134
 s_nop 0
 v_cndmask_b32 v134, v134, v250, vcc
 v_cmp_gt_i32 vcc, 3, v204
 SC 135
 s_nop 0
 v_cndmask_b32 v135, v135, v250, vcc
 v_cmp_gt_i32 vcc, 16, v204
 SC 148
 s_nop 0
 v_cndmask_b32 v148, v148, v250, vcc
 v_cmp_gt_i32 vcc, 17, v204
 SC 149
 s_nop 0
 v_cndmask_b32 v149, v149, v250, vcc
 v_cmp_gt_i32 vcc, 18, v204
 SC 150
 s_nop 0
 v_cndmask_b32 v150, v150, v250, vcc
 v_cmp_gt_i32 vcc, 19, v204
 SC 151
 s_nop 0
 v_cndmask_b32 v151, v151, v250, vcc
 v_mov_b32 v206, v193
 v_max3_f32 v206, v132, v133, v206
 v_max3_f32 v206, v134, v135, v206
 v_max3_f32 v206, v148, v149, v206
 v_max3_f32 v206, v150, v151, v206
 v_mov_b32 v207, v206
 s_nop 1
 SW 206,207
 v_max_f32 v206, v206, v207
 v_mov_b32 v207, v206
 s_nop 1
 v_permlane32_swap_b32 v206, v207
 v_max_f32 v206, v206, v207
 v_sub_f32 v200, v193, v206
 EX 200
 v_mov_b32 v193, v206
 v_mul_f32 v197, v200, v197
 v_sub_f32 v132, v132, v206
 EX 132
 s_nop 0
 v_add_f32 v197, v132, v197
 v_sub_f32 v133, v133, v206
 EX 133
 s_nop 0
 v_add_f32 v197, v133, v197
 v_sub_f32 v134, v134, v206
 EX 134
 s_nop 0
 v_add_f32 v197, v134, v197
 v_sub_f32 v135, v135, v206
 EX 135
 s_nop 0
 v_add_f32 v197, v135, v197
 v_sub_f32 v148, v148, v206
 EX 148
 s_nop 0
 v_add_f32 v197, v148, v197
 v_sub_f32 v149, v149, v206
 EX 149
 s_nop 0
 v_add_f32 v197, v149, v197
 v_sub_f32 v150, v150, v206
 EX 150
 s_nop 0
 v_add_f32 v197, v150, v197
 v_sub_f32 v151, v151, v206
 EX 151
 s_nop 0
 v_add_f32 v197, v151, v197
 CV 164,132,133
 CV 165,134,135
 CV 166,148,149
 CV 167,150,151
 v_mul_f32 v32, v200, v32
 v_mul_f32 v33, v200, v33
 v_mul_f32 v34, v200, v34
 v_mul_f32 v35, v200, v35
 v_mul_f32 v36, v200, v36
 v_mul_f32 v37, v200, v37
 v_mul_f32 v38, v200, v38
 v_mul_f32 v39, v200, v39
 v_mul_f32 v40, v200, v40
 v_mul_f32 v41, v200, v41
 v_mul_f32 v42, v200, v42
 v_mul_f32 v43, v200, v43
 v_mul_f32 v44, v200, v44
 v_mul_f32 v45, v200, v45
 v_mul_f32 v46, v200, v46
 v_mul_f32 v47, v200, v47
 v_mul_f32 v48, v200, v48
 v_mul_f32 v49, v200, v49
 v_mul_f32 v50, v200, v50
 v_mul_f32 v51, v200, v51
 v_mul_f32 v52, v200, v52
 v_mul_f32 v53, v200, v53
 v_mul_f32 v54, v200, v54
 v_mul_f32 v55, v200, v55
 v_mul_f32 v56, v200, v56
 v_mul_f32 v57, v200, v57
 v_mul_f32 v58, v200, v58
 v_mul_f32 v59, v200, v59
 v_mul_f32 v60, v200, v60
 v_mul_f32 v61, v200, v61
 v_mul_f32 v62, v200, v62
 v_mul_f32 v63, v200, v63
 v_cmp_gt_i32 vcc, 0, v205
 SC 136
 s_nop 0
 v_cndmask_b32 v136, v136, v250, vcc
 v_cmp_gt_i32 vcc, 1, v205
 SC 137
 s_nop 0
 v_cndmask_b32 v137, v137, v250, vcc
 v_cmp_gt_i32 vcc, 2, v205
 SC 138
 s_nop 0
 v_cndmask_b32 v138, v138, v250, vcc
 v_cmp_gt_i32 vcc, 3, v205
 SC 139
 s_nop 0
 v_cndmask_b32 v139, v139, v250, vcc
 v_cmp_gt_i32 vcc, 16, v205
 SC 152
 s_nop 0
 v_cndmask_b32 v152, v152, v250, vcc
 v_cmp_gt_i32 vcc, 17, v205
 SC 153
 s_nop 0
 v_cndmask_b32 v153, v153, v250, vcc
 v_cmp_gt_i32 vcc, 18, v205
 SC 154
 s_nop 0
 v_cndmask_b32 v154, v154, v250, vcc
 v_cmp_gt_i32 vcc, 19, v205
 SC 155
 s_nop 0
 v_cndmask_b32 v155, v155, v250, vcc
 v_mov_b32 v206, v194
 v_max3_f32 v206, v136, v137, v206
 v_max3_f32 v206, v138, v139, v206
 v_max3_f32 v206, v152, v153, v206
 v_max3_f32 v206, v154, v155, v206
 v_mov_b32 v207, v206
 s_nop 1
 SW 206,207
 v_max_f32 v206, v206, v207
 v_mov_b32 v207, v206
 s_nop 1
 v_permlane32_swap_b32 v206, v207
 v_max_f32 v206, v206, v207
 v_sub_f32 v200, v194, v206
 EX 200
 v_mov_b32 v194, v206
 v_mul_f32 v198, v200, v198
 v_sub_f32 v136, v136, v206
 EX 136
 s_nop 0
 v_add_f32 v198, v136, v198
 v_sub_f32 v137, v137, v206
 EX 137
 s_nop 0
 v_add_f32 v198, v137, v198
 v_sub_f32 v138, v138, v206
 EX 138
 s_nop 0
 v_add_f32 v198, v138, v198
 v_sub_f32 v139, v139, v206
 EX 139
 s_nop 0
 v_add_f32 v198, v139, v198
 v_sub_f32 v152, v152, v206
 EX 152
 s_nop 0
 v_add_f32 v198, v152, v198
 v_sub_f32 v153, v153, v206
 EX 153
 s_nop 0
 v_add_f32 v198, v153, v198
 v_sub_f32 v154, v154, v206
 EX 154
 s_nop 0
 v_add_f32 v198, v154, v198
 v_sub_f32 v155, v155, v206
 EX 155
 s_nop 0
 v_add_f32 v198, v155, v198
 CV 168,136,137
 CV 169,138,139
 CV 170,152,153
 CV 171,154,155
 v_mul_f32 v64, v200, v64
 v_mul_f32 v65, v200, v65
 v_mul_f32 v66, v200, v66
 v_mul_f32 v67, v200, v67
 v_mul_f32 v68, v200, v68
 v_mul_f32 v69, v200, v69
 v_mul_f32 v70, v200, v70
 v_mul_f32 v71, v200, v71
 v_mul_f32 v72, v200, v72
 v_mul_f32 v73, v200, v73
 v_mul_f32 v74, v200, v74
 v_mul_f32 v75, v200, v75
 v_mul_f32 v76, v200, v76
 v_mul_f32 v77, v200, v77
 v_mul_f32 v78, v200, v78
 v_mul_f32 v79, v200, v79
 v_mul_f32 v80, v200, v80
 v_mul_f32 v81, v200, v81
 v_mul_f32 v82, v200, v82
 v_mul_f32 v83, v200, v83
 v_mul_f32 v84, v200, v84
 v_mul_f32 v85, v200, v85
 v_mul_f32 v86, v200, v86
 v_mul_f32 v87, v200, v87
 v_mul_f32 v88, v200, v88
 v_mul_f32 v89, v200, v89
 v_mul_f32 v90, v200, v90
 v_mul_f32 v91, v200, v91
 v_mul_f32 v92, v200, v92
 v_mul_f32 v93, v200, v93
 v_mul_f32 v94, v200, v94
 v_mul_f32 v95, v200, v95
 v_cmp_gt_i32 vcc, 0, v205
 SC 140
 s_nop 0
 v_cndmask_b32 v140, v140, v250, vcc
 v_cmp_gt_i32 vcc, 1, v205
 SC 141
 s_nop 0
 v_cndmask_b32 v141, v141, v250, vcc
 v_cmp_gt_i32 vcc, 2, v205
 SC 142
 s_nop 0
 v_cndmask_b32 v142, v142, v250, vcc
 v_cmp_gt_i32 vcc, 3, v205
 SC 143
 s_nop 0
 v_cndmask_b32 v143, v143, v250, vcc
 v_cmp_gt_i32 vcc, 16, v205
 SC 156
 s_nop 0
 v_cndmask_b32 v156, v156, v250, vcc
 v_cmp_gt_i32 vcc, 17, v205
 SC 157
 s_nop 0
 v_cndmask_b32 v157, v157, v250, vcc
 v_cmp_gt_i32 vcc, 18, v205
 SC 158
 s_nop 0
 v_cndmask_b32 v158, v158, v250, vcc
 v_cmp_gt_i32 vcc, 19, v205
 SC 159
 s_nop 0
 v_cndmask_b32 v159, v159, v250, vcc
 v_mov_b32 v206, v195
 v_max3_f32 v206, v140, v141, v206
 v_max3_f32 v206, v142, v143, v206
 v_max3_f32 v206, v156, v157, v206
 v_max3_f32 v206, v158, v159, v206
 v_mov_b32 v207, v206
 s_nop 1
 SW 206,207
 v_max_f32 v206, v206, v207
 v_mov_b32 v207, v206
 s_nop 1
 v_permlane32_swap_b32 v206, v207
 v_max_f32 v206, v206, v207
 v_sub_f32 v200, v195, v206
 EX 200
 v_mov_b32 v195, v206
 v_mul_f32 v199, v200, v199
 v_sub_f32 v140, v140, v206
 EX 140
 s_nop 0
 v_add_f32 v199, v140, v199
 v_sub_f32 v141, v141, v206
 EX 141
 s_nop 0
 v_add_f32 v199, v141, v199
 v_sub_f32 v142, v142, v206
 EX 142
 s_nop 0
 v_add_f32 v199, v142, v199
 v_sub_f32 v143, v143, v206
 EX 143
 s_nop 0
 v_add_f32 v199, v143, v199
 v_sub_f32 v156, v156, v206
 EX 156
 s_nop 0
 v_add_f32 v199, v156, v199
 v_sub_f32 v157, v157, v206
 EX 157
 s_nop 0
 v_add_f32 v199, v157, v199
 v_sub_f32 v158, v158, v206
 EX 158
 s_nop 0
 v_add_f32 v199, v158, v199
 v_sub_f32 v159, v159, v206
 EX 159
 s_nop 0
 v_add_f32 v199, v159, v199
 CV 172,140,141
 CV 173,142,143
 CV 174,156,157
 CV 175,158,159
 v_mul_f32 v96, v200, v96
 v_mul_f32 v97, v200, v97
 v_mul_f32 v98, v200, v98
 v_mul_f32 v99, v200, v99
 v_mul_f32 v100, v200, v100
 v_mul_f32 v101, v200, v101
 v_mul_f32 v102, v200, v102
 v_mul_f32 v103, v200, v103
 v_mul_f32 v104, v200, v104
 v_mul_f32 v105, v200, v105
 v_mul_f32 v106, v200, v106
 v_mul_f32 v107, v200, v107
 v_mul_f32 v108, v200, v108
 v_mul_f32 v109, v200, v109
 v_mul_f32 v110, v200, v110
 v_mul_f32 v111, v200, v111
 v_mul_f32 v112, v200, v112
 v_mul_f32 v113, v200, v113
 v_mul_f32 v114, v200, v114
 v_mul_f32 v115, v200, v115
 v_mul_f32 v116, v200, v116
 v_mul_f32 v117, v200, v117
 v_mul_f32 v118, v200, v118
 v_mul_f32 v119, v200, v119
 v_mul_f32 v120, v200, v120
 v_mul_f32 v121, v200, v121
 v_mul_f32 v122, v200, v122
 v_mul_f32 v123, v200, v123
 v_mul_f32 v124, v200, v124
 v_mul_f32 v125, v200, v125
 v_mul_f32 v126, v200, v126
 v_mul_f32 v127, v200, v127
 s_waitcnt lgkmcnt(14)
 PV 0,96,160
 PV 32,96,164
 PV 64,96,168
 PV 96,96,172
 s_waitcnt lgkmcnt(12)
 PV 4,100,160
 PV 36,100,164
 PV 68,100,168
 PV 100,100,172
 s_waitcnt lgkmcnt(10)
 PV 8,104,160
 PV 40,104,164
 PV 72,104,168
 PV 104,104,172
 s_waitcnt lgkmcnt(8)
 PV 12,108,160
 PV 44,108,164
 PV 76,108,168
 PV 108,108,172
 s_waitcnt lgkmcnt(6)
 PV 16,112,160
 PV 48,112,164
 PV 80,112,168
 PV 112,112,172
 s_waitcnt lgkmcnt(4)
 PV 20,116,160
 PV 52,116,164
 PV 84,116,168
 PV 116,116,172
 s_waitcnt lgkmcnt(2)
 PV 24,120,160
 PV 56,120,164
 PV 88,120,168
 PV 120,120,172
 s_waitcnt lgkmcnt(0)
 PV 28,124,160
 PV 60,124,164
 PV 92,124,168
 PV 124,124,172
 v_subrev_u32 v204, 32, v204
 v_subrev_u32 v205, 32, v205
 s_nop 7
 s_add_u32 s44, s44, 0x10000
 s_sub_u32 s45, s45, 1
 s_cmp_lg_u32 s45, 0
 s_cbranch_scc1 L_fbstep
 s_mov_b32 vcc_lo, 0x55555555
 s_mov_b32 vcc_hi, 0x55555555
 v_mov_b32 v207, v196
 s_nop 1
 SW 196,207
 v_add_f32 v196, v196, v207
 v_mov_b32 v207, v196
 s_nop 1
 v_permlane32_swap_b32 v196, v207
 v_add_f32 v196, v196, v207
 v_accvgpr_write_b32 a128, v196
 v_accvgpr_write_b32 a129, 0
 s_nop 1
 v_accvgpr_read_b32 v225, a128
 v_accvgpr_read_b32 v224, a129
 v_add_f32 v225, v224, v225
 v_rcp_f32 v224, v225
 v_subrev_u32 v225, 0x21800000, v225
 v_mul_f32 v0, v224, v0
 v_mul_f32 v1, v224, v1
 v_mul_f32 v2, v224, v2
 v_mul_f32 v3, v224, v3
 v_mul_f32 v4, v224, v4
 v_mul_f32 v5, v224, v5
 v_mul_f32 v6, v224, v6
 v_mul_f32 v7, v224, v7
 CV 0,0,1
 CV 1,2,3
 CV 2,4,5
 CV 3,6,7
 v_mul_f32 v8, v224, v8
 v_mul_f32 v9, v224, v9
 v_mul_f32 v10, v224, v10
 v_mul_f32 v11, v224, v11
 v_mul_f32 v12, v224, v12
 v_mul_f32 v13, v224, v13
 v_mul_f32 v14, v224, v14
 v_mul_f32 v15, v224, v15
 CV 8,8,9
 CV 9,10,11
 CV 10,12,13
 CV 11,14,15
 XE 4,8,0
 XE 5,9,1
 XE 6,10,2
 XE 7,11,3
 buffer_store_dwordx4 v[4:7], v220, s[24:27], s38 offen offset:0 nt
 s_not_b64 vcc, vcc
 XO 8,0,8
 XO 9,1,9
 XO 10,2,10
 XO 11,3,11
 buffer_store_dwordx4 v[8:11], v221, s[24:27], s38 offen offset:0 nt
 v_mul_f32 v16, v224, v16
 v_mul_f32 v17, v224, v17
 v_mul_f32 v18, v224, v18
 v_mul_f32 v19, v224, v19
 v_mul_f32 v20, v224, v20
 v_mul_f32 v21, v224, v21
 v_mul_f32 v22, v224, v22
 v_mul_f32 v23, v224, v23
 CV 16,16,17
 CV 17,18,19
 CV 18,20,21
 CV 19,22,23
 v_mul_f32 v24, v224, v24
 v_mul_f32 v25, v224, v25
 v_mul_f32 v26, v224, v26
 v_mul_f32 v27, v224, v27
 v_mul_f32 v28, v224, v28
 v_mul_f32 v29, v224, v29
 v_mul_f32 v30, v224, v30
 v_mul_f32 v31, v224, v31
 CV 24,24,25
 CV 25,26,27
 CV 26,28,29
 CV 27,30,31
 XO 28,16,24
 XO 29,17,25
 XO 30,18,26
 XO 31,19,27
 buffer_store_dwordx4 v[28:31], v221, s[24:27], s38 offen offset:128 nt
 s_not_b64 vcc, vcc
 XE 16,24,16
 XE 17,25,17
 XE 18,26,18
 XE 19,27,19
 buffer_store_dwordx4 v[16:19], v220, s[24:27], s38 offen offset:128 nt
 v_mov_b32 v207, v197
 s_nop 1
 SW 197,207
 v_add_f32 v197, v197, v207
 v_mov_b32 v207, v197
 s_nop 1
 v_permlane32_swap_b32 v197, v207
 v_add_f32 v197, v197, v207
 v_accvgpr_write_b32 a130, v197
 v_accvgpr_write_b32 a131, 0
 s_nop 1
 v_accvgpr_read_b32 v227, a130
 v_accvgpr_read_b32 v226, a131
 v_add_f32 v227, v226, v227
 v_rcp_f32 v226, v227
 v_subrev_u32 v227, 0x21800000, v227
 v_mul_f32 v32, v226, v32
 v_mul_f32 v33, v226, v33
 v_mul_f32 v34, v226, v34
 v_mul_f32 v35, v226, v35
 v_mul_f32 v36, v226, v36
 v_mul_f32 v37, v226, v37
 v_mul_f32 v38, v226, v38
 v_mul_f32 v39, v226, v39
 CV 32,32,33
 CV 33,34,35
 CV 34,36,37
 CV 35,38,39
 v_mul_f32 v40, v226, v40
 v_mul_f32 v41, v226, v41
 v_mul_f32 v42, v226, v42
 v_mul_f32 v43, v226, v43
 v_mul_f32 v44, v226, v44
 v_mul_f32 v45, v226, v45
 v_mul_f32 v46, v226, v46
 v_mul_f32 v47, v226, v47
 CV 40,40,41
 CV 41,42,43
 CV 42,44,45
 CV 43,46,47
 XE 36,40,32
 XE 37,41,33
 XE 38,42,34
 XE 39,43,35
 buffer_store_dwordx4 v[36:39], v220, s[24:27], s38 offen offset:256 nt
 s_not_b64 vcc, vcc
 XO 40,32,40
 XO 41,33,41
 XO 42,34,42
 XO 43,35,43
 buffer_store_dwordx4 v[40:43], v221, s[24:27], s38 offen offset:256 nt
 v_mul_f32 v48, v226, v48
 v_mul_f32 v49, v226, v49
 v_mul_f32 v50, v226, v50
 v_mul_f32 v51, v226, v51
 v_mul_f32 v52, v226, v52
 v_mul_f32 v53, v226, v53
 v_mul_f32 v54, v226, v54
 v_mul_f32 v55, v226, v55
 CV 48,48,49
 CV 49,50,51
 CV 50,52,53
 CV 51,54,55
 v_mul_f32 v56, v226, v56
 v_mul_f32 v57, v226, v57
 v_mul_f32 v58, v226, v58
 v_mul_f32 v59, v226, v59
 v_mul_f32 v60, v226, v60
 v_mul_f32 v61, v226, v61
 v_mul_f32 v62, v226, v62
 v_mul_f32 v63, v226, v63
 CV 56,56,57
 CV 57,58,59
 CV 58,60,61
 CV 59,62,63
 XO 60,48,56
 XO 61,49,57
 XO 62,50,58
 XO 63,51,59
 buffer_store_dwordx4 v[60:63], v221, s[24:27], s38 offen offset:384 nt
 s_not_b64 vcc, vcc
 XE 48,56,48
 XE 49,57,49
 XE 50,58,50
 XE 51,59,51
 buffer_store_dwordx4 v[48:51], v220, s[24:27], s38 offen offset:384 nt
 v_mov_b32 v207, v198
 s_nop 1
 SW 198,207
 v_add_f32 v198, v198, v207
 v_mov_b32 v207, v198
 s_nop 1
 v_permlane32_swap_b32 v198, v207
 v_add_f32 v198, v198, v207
 v_accvgpr_write_b32 a132, v198
 v_accvgpr_write_b32 a133, 0
 s_nop 1
 v_accvgpr_read_b32 v229, a132
 v_accvgpr_read_b32 v228, a133
 v_add_f32 v229, v228, v229
 v_rcp_f32 v228, v229
 v_subrev_u32 v229, 0x21800000, v229
 v_mul_f32 v64, v228, v64
 v_mul_f32 v65, v228, v65
 v_mul_f32 v66, v228, v66
 v_mul_f32 v67, v228, v67
 v_mul_f32 v68, v228, v68
 v_mul_f32 v69, v228, v69
 v_mul_f32 v70, v228, v70
 v_mul_f32 v71, v228, v71
 CV 64,64,65
 CV 65,66,67
 CV 66,68,69
 CV 67,70,71
 v_mul_f32 v72, v228, v72
 v_mul_f32 v73, v228, v73
 v_mul_f32 v74, v228, v74
 v_mul_f32 v75, v228, v75
 v_mul_f32 v76, v228, v76
 v_mul_f32 v77, v228, v77
 v_mul_f32 v78, v228, v78
 v_mul_f32 v79, v228, v79
 CV 72,72,73
 CV 73,74,75
 CV 74,76,77
 CV 75,78,79
 XE 68,72,64
 XE 69,73,65
 XE 70,74,66
 XE 71,75,67
 buffer_store_dwordx4 v[68:71], v220, s[24:27], s39 offen offset:0 nt
 s_not_b64 vcc, vcc
 XO 72,64,72
 XO 73,65,73
 XO 74,66,74
 XO 75,67,75
 buffer_store_dwordx4 v[72:75], v221, s[24:27], s39 offen offset:0 nt
 v_mul_f32 v80, v228, v80
 v_mul_f32 v81, v228, v81
 v_mul_f32 v82, v228, v82
 v_mul_f32 v83, v228, v83
 v_mul_f32 v84, v228, v84
 v_mul_f32 v85, v228, v85
 v_mul_f32 v86, v228, v86
 v_mul_f32 v87, v228, v87
 CV 80,80,81
 CV 81,82,83
 CV 82,84,85
 CV 83,86,87
 v_mul_f32 v88, v228, v88
 v_mul_f32 v89, v228, v89
 v_mul_f32 v90, v228, v90
 v_mul_f32 v91, v228, v91
 v_mul_f32 v92, v228, v92
 v_mul_f32 v93, v228, v93
 v_mul_f32 v94, v228, v94
 v_mul_f32 v95, v228, v95
 CV 88,88,89
 CV 89,90,91
 CV 90,92,93
 CV 91,94,95
 XO 92,80,88
 XO 93,81,89
 XO 94,82,90
 XO 95,83,91
 buffer_store_dwordx4 v[92:95], v221, s[24:27], s39 offen offset:128 nt
 s_not_b64 vcc, vcc
 XE 80,88,80
 XE 81,89,81
 XE 82,90,82
 XE 83,91,83
 buffer_store_dwordx4 v[80:83], v220, s[24:27], s39 offen offset:128 nt
 v_mov_b32 v207, v199
 s_nop 1
 SW 199,207
 v_add_f32 v199, v199, v207
 v_mov_b32 v207, v199
 s_nop 1
 v_permlane32_swap_b32 v199, v207
 v_add_f32 v199, v199, v207
 v_accvgpr_write_b32 a134, v199
 v_accvgpr_write_b32 a135, 0
 s_nop 1
 v_accvgpr_read_b32 v231, a134
 v_accvgpr_read_b32 v230, a135
 v_add_f32 v231, v230, v231
 v_rcp_f32 v230, v231
 v_subrev_u32 v231, 0x21800000, v231
 v_mul_f32 v96, v230, v96
 v_mul_f32 v97, v230, v97
 v_mul_f32 v98, v230, v98
 v_mul_f32 v99, v230, v99
 v_mul_f32 v100, v230, v100
 v_mul_f32 v101, v230, v101
 v_mul_f32 v102, v230, v102
 v_mul_f32 v103, v230, v103
 CV 96,96,97
 CV 97,98,99
 CV 98,100,101
 CV 99,102,103
 v_mul_f32 v104, v230, v104
 v_mul_f32 v105, v230, v105
 v_mul_f32 v106, v230, v106
 v_mul_f32 v107, v230, v107
 v_mul_f32 v108, v230, v108
 v_mul_f32 v109, v230, v109
 v_mul_f32 v110, v230, v110
 v_mul_f32 v111, v230, v111
 CV 104,104,105
 CV 105,106,107
 CV 106,108,109
 CV 107,110,111
 XE 100,104,96
 XE 101,105,97
 XE 102,106,98
 XE 103,107,99
 buffer_store_dwordx4 v[100:103], v220, s[24:27], s39 offen offset:256 nt
 s_not_b64 vcc, vcc
 XO 104,96,104
 XO 105,97,105
 XO 106,98,106
 XO 107,99,107
 buffer_store_dwordx4 v[104:107], v221, s[24:27], s39 offen offset:256 nt
 v_mul_f32 v112, v230, v112
 v_mul_f32 v113, v230, v113
 v_mul_f32 v114, v230, v114
 v_mul_f32 v115, v230, v115
 v_mul_f32 v116, v230, v116
 v_mul_f32 v117, v230, v117
 v_mul_f32 v118, v230, v118
 v_mul_f32 v119, v230, v119
 CV 112,112,113
 CV 113,114,115
 CV 114,116,117
 CV 115,118,119
 v_mul_f32 v120, v230, v120
 v_mul_f32 v121, v230, v121
 v_mul_f32 v122, v230, v122
 v_mul_f32 v123, v230, v123
 v_mul_f32 v124, v230, v124
 v_mul_f32 v125, v230, v125
 v_mul_f32 v126, v230, v126
 v_mul_f32 v127, v230, v127
 CV 120,120,121
 CV 121,122,123
 CV 122,124,125
 CV 123,126,127
 XO 124,112,120
 XO 125,113,121
 XO 126,114,122
 XO 127,115,123
 buffer_store_dwordx4 v[124:127], v221, s[24:27], s39 offen offset:384 nt
 s_not_b64 vcc, vcc
 XE 112,120,112
 XE 113,121,113
 XE 114,122,114
 XE 115,123,115
 buffer_store_dwordx4 v[112:115], v220, s[24:27], s39 offen offset:384 nt
 s_cmp_lg_u32 s73, 0
 s_cbranch_scc1 L_fbjob
L_out:
L_end:
    s_endpgm
.p2align 7
.type L_table,@object
.size L_table, 32768
L_table:
 .long 0x102a000,0x52d000,0x84f0c1,0x109e0c1,0x1414000,0x8f2000,0xa47343,0x148e081,0x77e000,0x3bf000,0x52d000,0x7de200,0,0,0,0,0,0,0,0,0,0,0,0x50f000,0x52d000,0x8f2000,0x3bf000,0,0,0,0,0
 .long 0x600000,0xffff0000,0x3bf0c0,0x680d41,0x300000,0,0x3bf246,0x380001,0x18b3000,0xc59800,0xd4f800,0x1923200,0,0,0,0,0,0,0,0,0,0,0,0x8df000,0,0,0xc59800,0,0,0,0,0
 .long 0x580000,0,0x3bf0c2,0x600041,0x200000,0,0x3bf442,0x280001,0xa5a000,0x52d000,0x84f000,0xaaa200,0,0,0,0,0,0,0,0,0,0,0,0xa32000,0,0,0x52d000,0,0,0,0,0
 .long 0x580000,0,0x3bf0c3,0x600041,0x1a23000,0xc59800,0xd4fc40,0x1a9f081,0x77e000,0x3bf000,0x52d000,0x7de200,0,0,0,0,0,0,0,0,0,0,0,0xa32000,0,0xc59800,0x3bf000,0,0,0,0,0
 .long 0x102a000,0x52d000,0x84f0c2,0x109e0c1,0x95e000,0x3af000,0x52d342,0x9de101,0x77e000,0x3bf000,0x52d000,0x7de200,0,0,0,0,0,0,0,0,0,0,0,0x8df000,0x52d000,0x3bf000,0x3bf000,0,0,0,0,0
 .long 0x600000,0xffff0000,0x3bf0c0,0x680d41,0x300000,0,0x3bf246,0x380001,0,0,0x3bf000,0x80200,0,0,0,0,0,0,0,0,0,0,0,0x8df000,0,0,0,0,0,0,0,0
 .long 0x102a000,0x52d000,0x84f0c1,0x109e0c1,0x1414000,0x8f2000,0xa47343,0x148e081,0x77e000,0x3bf000,0x52d000,0x7de200,0,0,0,0,0,0,0,0,0,0,0,0x50f000,0x52d000,0x8f2000,0x3bf000,0,0,0,0,0
 .fill 32, 4, 0
 .long 0x680000,0,0x3bf0c0,0x700841,0x280000,0,0x3bf144,0x300001,0x10ee000,0x83f000,0x8f2000,0x116e181,0,0,0,0,0,0,0,0,0,0,0,0x8df000,0,0,0x84f000,0,0,0,0,0
 .long 0x580000,0,0x3bf0c0,0x600043,0x180000,0,0x3bf440,0x200001,0x1214000,0x8f2000,0xa47000,0x1294080,0,0,0,0,0,0,0,0,0,0,0,0xa32000,0,0,0x8f2000,0,0,0,0,0
 .long 0x680000,0xffff0000,0x3bf0c0,0x700941,0x1e2f000,0xd3f800,0xf9214d,0x1eaf181,0,0,0,0,0,0,0,0,0,0,0,0,0,0,0,0x8df000,0,0xd4f800,0,0,0,0,0,0
 .long 0x102a000,0x51d000,0x84f0c0,0x109edc1,0x173e000,0xa47000,0xc59b45,0x17be081,0x14be000,0xa47000,0xc59800,0x153e080,0,0,0,0,0,0,0,0,0,0,0,0x83d000,0x52d000,0xa47000,0xa47000,0,0,0,0,0
 .long 0xfaa000,0x51d000,0x84f0c0,0x102a1c3,0xc2a000,0x51d000,0x84f542,0xcaa181,0x1aaf000,0xd3f800,0xf92000,0x1b2f380,0,0,0,0,0,0,0,0,0,0,0,0xa32000,0x52d000,0x52d000,0xd4f800,0,0,0,0,0
 .long 0xfaa000,0x51d000,0x84f0c0,0x102a1c2,0x95e000,0x3af000,0x52d542,0x9de101,0x14be000,0xa47000,0xc59800,0x153e080,0,0,0,0,0,0,0,0,0,0,0,0x83d000,0x52d000,0x3bf000,0xa47000,0,0,0,0,0
 .long 0x680000,0,0x3bf0c0,0x700841,0x280000,0,0x3bf144,0x300001,0x10ee000,0x83f000,0x8f2000,0x116e181,0,0,0,0,0,0,0,0,0,0,0,0x8df000,0,0,0x84f000,0,0,0,0,0
 .fill 32, 4, 0
 .long 0x600000,0xffff0000,0x3bf0c0,0x680144,0x9de000,0x3af000,0x52d248,0xa5a101,0,0,0,0,0,0,0,0,0,0,0,0,0,0,0,0x83d000,0,0x3bf000,0,0,0,0,0,0
 .long 0xf2a000,0x51d000,0x84f000,0xfaa193,0,0,0,0,0,0,0,0,0,0,0,0,0,0,0,0,0,0,0,0,0x52d000,0,0,0,0,0,0,0
 .long 0x102a000,0x51d000,0x84f0c0,0x109e1c2,0x95e000,0x3af000,0x52d342,0x9de101,0x7de000,0x3af000,0x52d000,0x85e101,0,0,0,0,0,0,0,0,0,0,0,0x83d000,0x52d000,0x3bf000,0x3bf000,0,0,0,0,0
 .long 0xf2a000,0x51d000,0x84f000,0xfaa193,0,0,0,0,0,0,0,0,0,0,0,0,0,0,0,0,0,0,0,0,0x52d000,0,0,0,0,0,0,0
 .long 0x1caf000,0xd3f800,0xf920c0,0x1d2f184,0x1394000,0x8f2000,0xa470c2,0x1414080,0x1214000,0x8f2000,0xa47000,0x1294080,0,0,0,0,0,0,0,0,0,0,0,0x83d000,0xd4f800,0x8f2000,0x8f2000,0,0,0,0,0
 .long 0x700000,0xffff0000,0x3bf0c0,0x77e142,0x163e000,0xa47000,0xc59841,0x16be081,0x7de000,0x3af000,0x52d000,0x85e101,0,0,0,0,0,0,0,0,0,0,0,0x3a0000,0,0xa47000,0x3bf000,0,0,0,0,0
 .long 0x600000,0xffff0000,0x3bf0c0,0x680144,0x9de000,0x3af000,0x52d248,0xa5a101,0,0,0,0,0,0,0,0,0,0,0,0,0,0,0,0x83d000,0,0x3bf000,0,0,0,0,0,0
 .fill 32, 4, 0
 .long 0x500000,0,0x3bf000,0x580013,0,0,0,0,0,0,0,0,0,0,0,0,0,0,0,0,0,0,0,0,0,0,0,0,0,0,0,0
 .long 0xe2a000,0x51d000,0x84f0c4,0xeaa187,0x80000,0,0x3bf000,0x100001,0,0,0,0,0,0,0,0,0,0,0,0,0,0,0,0x3a0000,0x52d000,0,0,0,0,0,0,0
 .long 0x183e000,0xa47000,0xc598c3,0x18b3087,0x85e000,0x3af000,0x52d000,0x8de103,0,0,0,0,0,0,0,0,0,0,0,0,0,0,0,0x3a0000,0xa47000,0x3bf000,0,0,0,0,0,0
 .long 0x163e000,0xa47000,0xc598c0,0x16be082,0x1314000,0x8f2000,0xa470c0,0x1394080,0x85e000,0x3af000,0x52d000,0x8de103,0,0,0,0,0,0,0,0,0,0,0,0x3a0000,0xa47000,0x8f2000,0x3bf000,0,0,0,0,0
 .long 0x500000,0,0x3bf000,0x580013,0,0,0,0,0,0,0,0,0,0,0,0,0,0,0,0,0,0,0,0,0,0,0,0,0,0,0,0
 .long 0x380000,0,0x3bf0c2,0x400007,0x85e000,0x3af000,0x52d000,0x8de103,0,0,0,0,0,0,0,0,0,0,0,0,0,0,0,0x8bf000,0,0x3bf000,0,0,0,0,0,0
 .long 0x500000,0,0x3bf000,0x580013,0,0,0,0,0,0,0,0,0,0,0,0,0,0,0,0,0,0,0,0,0,0,0,0,0,0,0,0
 .fill 32, 4, 0
 .long 0x580000,0,0x3bf0c1,0x600043,0x1394000,0x8f2000,0xa47441,0x1414081,0xa5a000,0x52d000,0x84f000,0xaaa200,0,0,0,0,0,0,0,0,0,0,0,0x3a0000,0,0x8f2000,0x52d000,0,0,0,0,0
 .long 0x700000,0xffff0000,0x3bf0c0,0x77e142,0xcaa000,0x51d000,0x84f044,0xd2a181,0x11e4000,0x8f2000,0xa47000,0x1214280,0,0,0,0,0,0,0,0,0,0,0,0x83d000,0,0x52d000,0x8f2000,0,0,0,0,0
 .long 0x700000,0xffff0000,0x3bf0c0,0x77e141,0x1d2f000,0xd3f800,0xf92045,0x1daf181,0x109e000,0x84f000,0x8f2000,0x10ee200,0,0,0,0,0,0,0,0,0,0,0,0xa12000,0,0xd4f800,0x84f000,0,0,0,0,0
 .long 0x680000,0,0x3bf0c0,0x700441,0x9de000,0x3af000,0x52d144,0xa5a101,0x109e000,0x84f000,0x8f2000,0x10ee200,0,0,0,0,0,0,0,0,0,0,0,0xa12000,0,0x3bf000,0x84f000,0,0,0,0,0
 .long 0x680000,0,0x3bf0c0,0x700841,0xd2a000,0x51d000,0x84f146,0xdaa181,0x109e000,0x84f000,0x8f2000,0x10ee200,0,0,0,0,0,0,0,0,0,0,0,0x3a0000,0,0x52d000,0x84f000,0,0,0,0,0
 .long 0x580000,0xffff0000,0x3bf0c0,0x600142,0xcaa000,0x51d000,0x84f444,0xd2a181,0x1a9f000,0xd4f800,0xf92000,0x1aaf280,0,0,0,0,0,0,0,0,0,0,0,0xcf9800,0,0x52d000,0xd4f800,0,0,0,0,0
 .long 0x580000,0,0x3bf0c1,0x600043,0x1394000,0x8f2000,0xa47441,0x1414081,0xa5a000,0x52d000,0x84f000,0xaaa200,0,0,0,0,0,0,0,0,0,0,0,0x3a0000,0,0x8f2000,0x52d000,0,0,0,0,0
 .fill 32, 4, 0
 .long 0xe2a000,0x51d000,0x84f0c6,0xeaa185,0x153e000,0xa47000,0xc59800,0x15be082,0,0,0,0,0,0,0,0,0,0,0,0,0,0,0,0x4ef000,0x52d000,0xa47000,0,0,0,0,0,0
 .long 0x680000,0xffff0000,0x3bf0c0,0x700541,0x9de000,0x3af000,0x52d144,0xa5a101,0x1aaf000,0xd3f800,0xf92000,0x1b2f380,0,0,0,0,0,0,0,0,0,0,0,0x8bf000,0,0x3bf000,0xd4f800,0,0,0,0,0
 .long 0x600000,0xffff0000,0x3bf0c0,0x680143,0x163e000,0xa47000,0xc59a41,0x16be081,0xaaa000,0x51d000,0x84f000,0xb2a181,0,0,0,0,0,0,0,0,0,0,0,0x8bf000,0,0xa47000,0x52d000,0,0,0,0,0
 .long 0x600000,0,0x3bf0c0,0x680c41,0xdaa000,0x51d000,0x84f24c,0xe2a181,0,0,0,0,0,0,0,0,0,0,0,0,0,0,0,0x8df000,0,0x52d000,0,0,0,0,0,0
 .long 0x600000,0xffff0000,0x3bf0c0,0x680d41,0x9de000,0x3af000,0x52d244,0xa5a101,0x1294000,0x8f2000,0xa47000,0x1314082,0,0,0,0,0,0,0,0,0,0,0,0x8bf000,0,0x3bf000,0x8f2000,0,0,0,0,0
 .long 0x680000,0xffff0000,0x3bf0c0,0x700541,0x1414000,0x8f2000,0xa47143,0x148e081,0xaaa000,0x51d000,0x84f000,0xb2a181,0,0,0,0,0,0,0,0,0,0,0,0x81d000,0,0x8f2000,0x52d000,0,0,0,0,0
 .long 0xe2a000,0x51d000,0x84f0c6,0xeaa185,0x153e000,0xa47000,0xc59800,0x15be082,0,0,0,0,0,0,0,0,0,0,0,0,0,0,0,0x4ef000,0x52d000,0xa47000,0,0,0,0,0,0
 .fill 32, 4, 0
 .long 0x700000,0,0x3bf0c0,0x77e041,0x300000,0,0x3bf04a,0x380001,0,0,0,0,0,0,0,0,0,0,0,0,0,0,0,0x8bf000,0,0,0,0,0,0,0,0
 .long 0x16be000,0xa47000,0xc598c0,0x173e084,0x1414000,0x8f2000,0xa47000,0x148e088,0,0,0,0,0,0,0,0,0,0,0,0,0,0,0,0xa12000,0xa47000,0x8f2000,0,0,0,0,0,0
 .long 0x480000,0,0x3bf0c6,0x500007,0x1aaf000,0xd3f800,0xf92000,0x1b2f380,0,0,0,0,0,0,0,0,0,0,0,0,0,0,0,0x81d000,0,0xd4f800,0,0,0,0,0,0
 .long 0x1e2f000,0xd3f800,0xf920c3,0x1eaf187,0x153e000,0xa47000,0xc59800,0x15be082,0,0,0,0,0,0,0,0,0,0,0,0,0,0,0,0x81d000,0xd4f800,0xa47000,0,0,0,0,0,0
 .long 0xe2a000,0x51d000,0x84f0c4,0xeaa187,0x153e000,0xa47000,0xc59800,0x15be082,0,0,0,0,0,0,0,0,0,0,0,0,0,0,0,0xa12000,0x52d000,0xa47000,0,0,0,0,0,0
 .long 0x102a000,0x52d000,0x84f0c0,0x109e0c4,0x200000,0,0x3bf346,0x280001,0,0,0,0,0,0,0,0,0,0,0,0,0,0,0,0x380000,0x52d000,0,0,0,0,0,0,0
 .long 0x700000,0,0x3bf0c0,0x77e041,0x300000,0,0x3bf04a,0x380001,0,0,0,0,0,0,0,0,0,0,0,0,0,0,0,0x8bf000,0,0,0,0,0,0,0,0
 .fill 32, 4, 0
 .long 0x1e2f000,0xd3f800,0xf920c9,0x1eaf181,0x85e000,0x3af000,0x52d000,0x8de103,0,0,0,0,0,0,0,0,0,0,0,0,0,0,0,0x81d000,0xd4f800,0x3bf000,0,0,0,0,0,0
 .long 0xdaa000,0x51d000,0x84f0c8,0xe2a181,0x100000,0,0x3bf000,0x180003,0,0,0,0,0,0,0,0,0,0,0,0,0,0,0,0x380000,0x52d000,0,0,0,0,0,0,0
 .long 0xcaa000,0x51d000,0x84f0c4,0xd2a181,0x15be000,0xa47000,0xc598c0,0x163e080,0x80000,0,0x3bf000,0x100001,0,0,0,0,0,0,0,0,0,0,0,0x380000,0x52d000,0xa47000,0,0,0,0,0,0
 .long 0x16be000,0xa47000,0xc598c3,0x173e081,0x15be000,0xa47000,0xc598c0,0x163e080,0x7de000,0x3af000,0x52d000,0x85e101,0,0,0,0,0,0,0,0,0,0,0,0x380000,0xa47000,0xa47000,0x3bf000,0,0,0,0,0
 .long 0x1e2f000,0xd3f800,0xf920c9,0x1eaf181,0x85e000,0x3af000,0x52d000,0x8de103,0,0,0,0,0,0,0,0,0,0,0,0,0,0,0,0x81d000,0xd4f800,0x3bf000,0,0,0,0,0,0
 .long 0x1d2f000,0xd3f800,0xf920c5,0x1daf181,0x153e000,0xa47000,0xc598c0,0x15be880,0x80000,0,0x3bf000,0x100001,0,0,0,0,0,0,0,0,0,0,0,0x89f000,0xd4f800,0xa47000,0,0,0,0,0,0
 .long 0x1e2f000,0xd3f800,0xf920c9,0x1eaf181,0x85e000,0x3af000,0x52d000,0x8de103,0,0,0,0,0,0,0,0,0,0,0,0,0,0,0,0x81d000,0xd4f800,0x3bf000,0,0,0,0,0,0
 .fill 32, 4, 0
 .long 0xfaa000,0x51d000,0x84f0c0,0x102a1c3,0x200000,0,0x3bf542,0x280001,0x109e000,0x84f000,0x8f2000,0x10ee200,0,0,0,0,0,0,0,0,0,0,0,0x380000,0x52d000,0,0x84f000,0,0,0,0,0
 .long 0xfaa000,0x52d000,0x84f0c0,0x102a0c4,0x1a23000,0xc59800,0xd4fd40,0x1a9f081,0x109e000,0x84f000,0x8f2000,0x10ee200,0,0,0,0,0,0,0,0,0,0,0,0x81d000,0x52d000,0xc59800,0x84f000,0,0,0,0,0
 .long 0xfaa000,0x52d000,0x84f0c0,0x102a0c1,0x9de000,0x3af000,0x52d544,0xa5a101,0,0,0x3bf000,0x80200,0,0,0,0,0,0,0,0,0,0,0,0x9f2000,0x52d000,0x3bf000,0,0,0,0,0,0
 .long 0x700000,0,0x3bf0c0,0x77e042,0x95e000,0x3af000,0x52d042,0x9de101,0xa5a000,0x52d000,0x84f000,0xaaa200,0,0,0,0,0,0,0,0,0,0,0,0xd39800,0,0x3bf000,0x52d000,0,0,0,0,0
 .long 0x1daf000,0xd3f800,0xf920c3,0x1e2f185,0x1314000,0x8f2000,0xa470c0,0x1394080,0x1a9f000,0xd4f800,0xf92000,0x1aaf280,0,0,0,0,0,0,0,0,0,0,0,0x380000,0xd4f800,0x8f2000,0xd4f800,0,0,0,0,0
 .long 0x9de000,0x3af000,0x52d0c0,0xa5a105,0x1394000,0x8f2000,0xa470c2,0x1414080,0x148e000,0xa47000,0xc59800,0x14be280,0,0,0,0,0,0,0,0,0,0,0,0xcd9800,0x3bf000,0x8f2000,0xa47000,0,0,0,0,0
 .long 0xfaa000,0x51d000,0x84f0c0,0x102a1c3,0x200000,0,0x3bf542,0x280001,0x109e000,0x84f000,0x8f2000,0x10ee200,0,0,0,0,0,0,0,0,0,0,0,0x380000,0x52d000,0,0x84f000,0,0,0,0,0
 .fill 32, 4, 0
 .long 0x173e000,0xa47000,0xc598c0,0x17be086,0x1314000,0x8f2000,0xa470c0,0x1394080,0x14be000,0xa47000,0xc59800,0x153e080,0,0,0,0,0,0,0,0,0,0,0,0x4cf000,0xa47000,0x8f2000,0xa47000,0,0,0,0,0
 .long 0x102a000,0x52d000,0x84f0c0,0x109e0c3,0xbaa000,0x51d000,0x84f340,0xc2a181,0xaaa000,0x51d000,0x84f000,0xb2a181,0,0,0,0,0,0,0,0,0,0,0,0x89f000,0x52d000,0x52d000,0x52d000,0,0,0,0,0
 .long 0x1caf000,0xd3f800,0xf920c0,0x1d2f184,0xc2a000,0x51d000,0x84f0c2,0xcaa181,0x14be000,0xa47000,0xc59800,0x153e080,0,0,0,0,0,0,0,0,0,0,0,0x89f000,0xd4f800,0x52d000,0xa47000,0,0,0,0,0
 .long 0xfaa000,0x52d000,0x84f0c0,0x102a0c3,0x1414000,0x8f2000,0xa47547,0x148e081,0,0,0,0,0,0,0,0,0,0,0,0,0,0,0,0x9f2000,0x52d000,0x8f2000,0,0,0,0,0,0
 .long 0x700000,0,0x3bf0c0,0x77e041,0x200000,0,0x3bf042,0x280001,0x10ee000,0x83f000,0x8f2000,0x116e181,0,0,0,0,0,0,0,0,0,0,0,0x89f000,0,0,0x84f000,0,0,0,0,0
 .long 0x1daf000,0xd3f800,0xf920c1,0x1e2f187,0xbaa000,0x51d000,0x84f000,0xc2a185,0,0,0,0,0,0,0,0,0,0,0,0,0,0,0,0x7fd000,0xd4f800,0x52d000,0,0,0,0,0,0
 .long 0x173e000,0xa47000,0xc598c0,0x17be086,0x1314000,0x8f2000,0xa470c0,0x1394080,0x14be000,0xa47000,0xc59800,0x153e080,0,0,0,0,0,0,0,0,0,0,0,0x4cf000,0xa47000,0x8f2000,0xa47000,0,0,0,0,0
 .fill 32, 4, 0
 .long 0x183e000,0xa47000,0xc598c9,0x18b3081,0x116e000,0x83f000,0x8f2000,0x11e4183,0,0,0,0,0,0,0,0,0,0,0,0,0,0,0,0xa32000,0xa47000,0x84f000,0,0,0,0,0,0
 .long 0x1caf000,0xd3f800,0xf920c3,0x1d2f181,0x1baf000,0xd3f800,0xf920c0,0x1c2f581,0x1b2f000,0xd3f800,0xf92000,0x1baf182,0,0,0,0,0,0,0,0,0,0,0,0xd39800,0xd4f800,0xd4f800,0xd4f800,0,0,0,0,0
 .long 0x1eaf000,0xd3f800,0xf920cb,0x1f24181,0x1b2f000,0xd3f800,0xf92000,0x1baf182,0,0,0,0,0,0,0,0,0,0,0,0,0,0,0,0x7fd000,0xd4f800,0xd4f800,0,0,0,0,0,0
 .long 0x1eaf000,0xd3f800,0xf920cb,0x1f24181,0x1214000,0x8f2000,0xa47000,0x1294080,0,0,0,0,0,0,0,0,0,0,0,0,0,0,0,0x50f000,0xd4f800,0x8f2000,0,0,0,0,0,0
 .long 0xeaa000,0x51d000,0x84f0cc,0xf2a181,0x14be000,0xa47000,0xc59800,0x153e080,0,0,0,0,0,0,0,0,0,0,0,0,0,0,0,0x7fd000,0x52d000,0xa47000,0,0,0,0,0,0
 .long 0xf2a000,0x51d000,0x84f000,0xfaa193,0,0,0,0,0,0,0,0,0,0,0,0,0,0,0,0,0,0,0,0,0x52d000,0,0,0,0,0,0,0
 .long 0x183e000,0xa47000,0xc598c9,0x18b3081,0x116e000,0x83f000,0x8f2000,0x11e4183,0,0,0,0,0,0,0,0,0,0,0,0,0,0,0,0xa32000,0xa47000,0x84f000,0,0,0,0,0,0
 .fill 32, 4, 0
 .long 0xb2a000,0x51d000,0x84f0c0,0xbaa981,0x102a000,0x63d000,0x84f380,0x109e189,0,0,0,0,0,0,0,0,0,0,0,0,0,0,0,0xd39800,0x52d000,0x52d000,0,0,0,0,0,0
 .long 0x1c2f000,0xd3f800,0xf920c0,0x1caf182,0xfaa000,0x67d000,0x84f580,0x102a185,0,0,0,0,0,0,0,0,0,0,0,0,0,0,0,0x360000,0xd4f800,0x52d000,0,0,0,0,0,0
 .long 0x153e000,0xa47000,0xc598c0,0x15bec81,0x102a000,0x63d000,0x84f380,0x109e089,0,0,0,0,0,0,0,0,0,0,0,0,0,0,0,0x360000,0xa47000,0x52d000,0,0,0,0,0,0
 .long 0x102a000,0x5bd000,0x84f380,0x109e08d,0,0,0,0,0,0,0,0,0,0,0,0,0,0,0,0,0,0,0,0,0x52d000,0,0,0,0,0,0,0
 .long 0x100000,0,0x3bf0c0,0x180801,0x102a000,0x65d000,0x84f380,0x109e188,0,0,0,0,0,0,0,0,0,0,0,0,0,0,0,0x360000,0,0x52d000,0,0,0,0,0,0
 .long 0x100000,0,0x3bf0c0,0x180801,0xfaa000,0x63d000,0x84f580,0x102a087,0,0,0,0,0,0,0,0,0,0,0,0,0,0,0,0x360000,0,0x52d000,0,0,0,0,0,0
 .long 0xb2a000,0x51d000,0x84f0c0,0xbaa981,0x102a000,0x63d000,0x84f380,0x109e189,0,0,0,0,0,0,0,0,0,0,0,0,0,0,0,0xd39800,0x52d000,0x52d000,0,0,0,0,0,0
 .fill 32, 4, 0
 .long 0x1daf000,0xd3f800,0xf920c1,0x1e2f187,0x15be000,0xa47000,0xc598c0,0x163e080,0x11e4000,0x8f2000,0xa47000,0x1214280,0,0,0,0,0,0,0,0,0,0,0,0x89f000,0xd4f800,0xa47000,0x8f2000,0,0,0,0,0
 .long 0x480000,0,0x3bf0c6,0x500007,0x148e000,0xa47000,0xc59800,0x14be280,0,0,0,0,0,0,0,0,0,0,0,0,0,0,0,0x7fd000,0,0xa47000,0,0,0,0,0,0
 .long 0xf2a000,0x51d000,0x84f0c8,0xfaa187,0x11e4000,0x8f2000,0xa47000,0x1214280,0,0,0,0,0,0,0,0,0,0,0,0,0,0,0,0x50f000,0x52d000,0x8f2000,0,0,0,0,0,0
 .long 0x480000,0,0x3bf0c6,0x500007,0x148e000,0xa47000,0xc59800,0x14be280,0,0,0,0,0,0,0,0,0,0,0,0,0,0,0,0x8bf000,0,0xa47000,0,0,0,0,0,0
 .long 0xdaa000,0x51d000,0x84f0c2,0xe2a187,0x19a3000,0xc59800,0xd4f8c0,0x1a23480,0x148e000,0xa47000,0xc59800,0x14be280,0,0,0,0,0,0,0,0,0,0,0,0x9f2000,0x52d000,0xc59800,0xa47000,0,0,0,0,0
 .long 0x17be000,0xa47000,0xc598c1,0x183e087,0x19a3000,0xc59800,0xd4f8c0,0x1a23480,0x11e4000,0x8f2000,0xa47000,0x1214280,0,0,0,0,0,0,0,0,0,0,0,0x87f000,0xa47000,0xc59800,0x8f2000,0,0,0,0,0
 .long 0x1daf000,0xd3f800,0xf920c1,0x1e2f187,0x15be000,0xa47000,0xc598c0,0x163e080,0x11e4000,0x8f2000,0xa47000,0x1214280,0,0,0,0,0,0,0,0,0,0,0,0x89f000,0xd4f800,0xa47000,0x8f2000,0,0,0,0,0
 .fill 32, 4, 0
 .long 0x1caf000,0xd3f800,0xf920c3,0x1d2f181,0x1c2f000,0xd3f800,0xf920c1,0x1caf181,0xaaa000,0x51d000,0x84f000,0xb2a181,0,0,0,0,0,0,0,0,0,0,0,0x7fd000,0xd4f800,0xd4f800,0x52d000,0,0,0,0,0
 .long 0x183e000,0xa47000,0xc598c9,0x18b3081,0x153e000,0xa47000,0xc59800,0x15be082,0,0,0,0,0,0,0,0,0,0,0,0,0,0,0,0x87f000,0xa47000,0xa47000,0,0,0,0,0,0
 .long 0x380000,0,0x3bf0c8,0x400001,0x1314000,0x8f2000,0xa47000,0x1394084,0,0,0,0,0,0,0,0,0,0,0,0,0,0,0,0x9d2000,0,0x8f2000,0,0,0,0,0,0
 .long 0x1caf000,0xd3f800,0xf920c3,0x1d2f181,0x180000,0,0x3bf0c1,0x200000,0x1aaf000,0xd3f800,0xf92000,0x1b2f380,0,0,0,0,0,0,0,0,0,0,0,0x7fd000,0xd4f800,0,0xd4f800,0,0,0,0,0
 .long 0x580000,0xffff0000,0x3bf0c3,0x600141,0x1414000,0x8f2000,0xa47447,0x148e081,0,0,0,0,0,0,0,0,0,0,0,0,0,0,0,0x87f000,0,0x8f2000,0,0,0,0,0,0
 .long 0x16be000,0xa47000,0xc598c3,0x173e081,0x180000,0,0x3bf0c1,0x200000,0x1214000,0x8f2000,0xa47000,0x1294080,0,0,0,0,0,0,0,0,0,0,0,0xcb9800,0xa47000,0,0x8f2000,0,0,0,0,0
 .long 0x1caf000,0xd3f800,0xf920c3,0x1d2f181,0x1c2f000,0xd3f800,0xf920c1,0x1caf181,0xaaa000,0x51d000,0x84f000,0xb2a181,0,0,0,0,0,0,0,0,0,0,0,0x7fd000,0xd4f800,0xd4f800,0x52d000,0,0,0,0,0
 .fill 32, 4, 0
 .long 0xeaa000,0x51d000,0x84f0ca,0xf2a183,0x1214000,0x8f2000,0xa47000,0x1294080,0,0,0,0,0,0,0,0,0,0,0,0,0,0,0,0x360000,0x52d000,0x8f2000,0,0,0,0,0,0
 .long 0x163e000,0xa47000,0xc598c0,0x16be082,0x1394000,0x8f2000,0xa470c2,0x1414080,0x1923000,0xc59800,0xd4f800,0x19a3081,0,0,0,0,0,0,0,0,0,0,0,0x50f000,0xa47000,0x8f2000,0xc59800,0,0,0,0,0
 .long 0x16be000,0xa47000,0xc598c1,0x173e083,0x1a23000,0xc59800,0xd4f8c1,0x1a9f080,0x1923000,0xc59800,0xd4f800,0x19a3081,0,0,0,0,0,0,0,0,0,0,0,0x87f000,0xa47000,0xc59800,0xc59800,0,0,0,0,0
 .long 0x17be000,0xa47000,0xc598c5,0x183e083,0x1baf000,0xd3f800,0xf92000,0x1c2f184,0,0,0,0,0,0,0,0,0,0,0,0,0,0,0,0x360000,0xa47000,0xd4f800,0,0,0,0,0,0
 .long 0x183e000,0xa47000,0xc598c7,0x18b3083,0x116e000,0x83f000,0x8f2000,0x11e4183,0,0,0,0,0,0,0,0,0,0,0,0,0,0,0,0xd39800,0xa47000,0x84f000,0,0,0,0,0,0
 .long 0xdaa000,0x51d000,0x84f0c6,0xe2a183,0x1baf000,0xd3f800,0xf92000,0x1c2f184,0,0,0,0,0,0,0,0,0,0,0,0,0,0,0,0x7dd000,0x52d000,0xd4f800,0,0,0,0,0,0
 .long 0xeaa000,0x51d000,0x84f0ca,0xf2a183,0x1214000,0x8f2000,0xa47000,0x1294080,0,0,0,0,0,0,0,0,0,0,0,0,0,0,0,0x360000,0x52d000,0x8f2000,0,0,0,0,0,0
 .fill 32, 4, 0
 .long 0x180000,0,0x3bf0c0,0x200001,0xfaa000,0x65d000,0x84f580,0x102a086,0,0,0,0,0,0,0,0,0,0,0,0,0,0,0,0x4af000,0,0x52d000,0,0,0,0,0,0
 .long 0xb2a000,0x51d000,0x84f0c0,0xbaa981,0x102a000,0x65d000,0x84f380,0x109e188,0,0,0,0,0,0,0,0,0,0,0,0,0,0,0,0xd19800,0x52d000,0x52d000,0,0,0,0,0,0
 .long 0x1baf000,0xd3f800,0xf920c0,0x1c2f581,0xfaa000,0x61d000,0x84f580,0x102a188,0,0,0,0,0,0,0,0,0,0,0,0,0,0,0,0x7dd000,0xd4f800,0x52d000,0,0,0,0,0,0
 .long 0xbaa000,0x51d000,0x84f0c0,0xc2a181,0xfaa000,0x65d000,0x84f580,0x102a186,0,0,0,0,0,0,0,0,0,0,0,0,0,0,0,0xd19800,0x52d000,0x52d000,0,0,0,0,0,0
 .long 0x1a22e00,0xc59700,0xd4f8c0,0x1a9f081,0xfaa000,0x65d000,0x84f580,0x102a086,0,0,0,0,0,0,0,0,0,0,0,0,0,0,0,0x7dd000,0xc59700,0x52d000,0,0,0,0,0,0
 .long 0x15be000,0xa47000,0xc598c0,0x163e481,0x102a000,0x67d000,0x84f380,0x109e187,0,0,0,0,0,0,0,0,0,0,0,0,0,0,0,0xa32000,0xa47000,0x52d000,0,0,0,0,0,0
 .long 0x180000,0,0x3bf0c0,0x200001,0xfaa000,0x65d000,0x84f580,0x102a086,0,0,0,0,0,0,0,0,0,0,0,0,0,0,0,0x4af000,0,0x52d000,0,0,0,0,0,0
 .fill 32, 4, 0
 .long 0xdaa000,0x51d000,0x84f0c8,0xe2a181,0x19a3000,0xc59800,0xd4f8c0,0x1a23480,0x1a9f000,0xd4f800,0xf92000,0x1aaf280,0,0,0,0,0,0,0,0,0,0,0,0xa12000,0x52d000,0xc59800,0xd4f800,0,0,0,0,0
 .long 0x1daf000,0xd3f800,0xf920c7,0x1e2f181,0x19a3000,0xc59800,0xd4f8c0,0x1a23480,0x1a9f000,0xd4f800,0xf92000,0x1aaf280,0,0,0,0,0,0,0,0,0,0,0,0x340000,0xd4f800,0xc59800,0xd4f800,0,0,0,0,0
 .long 0x500a00,0x500,0x3bf0ce,0x580001,0x1a9f000,0xd4f800,0xf92000,0x1aaf280,0,0,0,0,0,0,0,0,0,0,0,0,0,0,0,0x340000,0x500,0xd4f800,0,0,0,0,0,0
 .long 0x300000,0,0x3bf0c6,0x380001,0x100000,0,0x3bf0c0,0x180400,0x1a9f000,0xd4f800,0xf92000,0x1aaf280,0,0,0,0,0,0,0,0,0,0,0,0x9d2000,0,0,0xd4f800,0,0,0,0,0
 .long 0xf2a000,0x51d000,0x84f0ce,0xfaa181,0x11e4000,0x8f2000,0xa47000,0x1214280,0,0,0,0,0,0,0,0,0,0,0,0,0,0,0,0x340000,0x52d000,0x8f2000,0,0,0,0,0,0
 .long 0x173e000,0xa47000,0xc598c5,0x17be081,0x1314000,0x8f2000,0xa470c0,0x1394080,0xa5a000,0x52d000,0x84f000,0xaaa200,0,0,0,0,0,0,0,0,0,0,0,0xf7f800,0xa47000,0x8f2000,0x52d000,0,0,0,0,0
 .long 0xdaa000,0x51d000,0x84f0c8,0xe2a181,0x19a3000,0xc59800,0xd4f8c0,0x1a23480,0x1a9f000,0xd4f800,0xf92000,0x1aaf280,0,0,0,0,0,0,0,0,0,0,0,0xa12000,0x52d000,0xc59800,0xd4f800,0,0,0,0,0
 .fill 32, 4, 0
 .long 0x480000,0,0x3bf0ca,0x500003,0x1aaf000,0xd3f800,0xf92000,0x1b2f380,0,0,0,0,0,0,0,0,0,0,0,0,0,0,0,0xd19800,0,0xd4f800,0,0,0,0,0,0
 .long 0x1e2f000,0xd3f800,0xf920c7,0x1eaf183,0x116e000,0x83f000,0x8f2000,0x11e4183,0,0,0,0,0,0,0,0,0,0,0,0,0,0,0,0xf7f800,0xd4f800,0x84f000,0,0,0,0,0,0
 .long 0xdaa000,0x51d000,0x84f0c6,0xe2a183,0xbaa000,0x51d000,0x84f000,0xc2a185,0,0,0,0,0,0,0,0,0,0,0,0,0,0,0,0x4ef000,0x52d000,0x52d000,0,0,0,0,0,0
 .long 0x400000,0,0x3bf0c8,0x480003,0x10ee000,0x83f000,0x8f2000,0x116e181,0,0,0,0,0,0,0,0,0,0,0,0,0,0,0,0xf7f800,0,0x84f000,0,0,0,0,0,0
 .long 0x300000,0,0x3bf0c4,0x380003,0x1c2f000,0xd3f800,0xf92000,0x1caf186,0,0,0,0,0,0,0,0,0,0,0,0,0,0,0,0x9d2000,0,0xd4f800,0,0,0,0,0,0
 .long 0x1e2f000,0xd3f800,0xf920c7,0x1eaf183,0x116e000,0x83f000,0x8f2000,0x11e4183,0,0,0,0,0,0,0,0,0,0,0,0,0,0,0,0x340000,0xd4f800,0x84f000,0,0,0,0,0,0
 .long 0x480000,0,0x3bf0ca,0x500003,0x1aaf000,0xd3f800,0xf92000,0x1b2f380,0,0,0,0,0,0,0,0,0,0,0,0,0,0,0,0xd19800,0,0xd4f800,0,0,0,0,0,0
 .fill 32, 4, 0
 .long 0x17be000,0xa47000,0xc598c3,0x183e085,0x8de000,0x3af000,0x52d000,0x95e105,0,0,0,0,0,0,0,0,0,0,0,0,0,0,0,0x87f000,0xa47000,0x3bf000,0,0,0,0,0,0
 .long 0xd2a000,0x51d000,0x84f0c2,0xdaa185,0x1294000,0x8f2000,0xa470c0,0x1314880,0x14be000,0xa47000,0xc59800,0x153e080,0,0,0,0,0,0,0,0,0,0,0,0x7dd000,0x52d000,0x8f2000,0xa47000,0,0,0,0,0
 .long 0xeaa000,0x51d000,0x84f0c8,0xf2a185,0x10ee000,0x83f000,0x8f2000,0x116e181,0,0,0,0,0,0,0,0,0,0,0,0,0,0,0,0x9b2000,0x52d000,0x84f000,0,0,0,0,0,0
 .long 0x183e000,0xa47000,0xc598c5,0x18b3085,0x1b2f000,0xd3f800,0xf92000,0x1baf182,0,0,0,0,0,0,0,0,0,0,0,0,0,0,0,0x4ef000,0xa47000,0xd4f800,0,0,0,0,0,0
 .long 0x1eaf000,0xd3f800,0xf920c7,0x1f24185,0x1923000,0xc59800,0xd4f800,0x19a3081,0,0,0,0,0,0,0,0,0,0,0,0,0,0,0,0x85f000,0xd4f800,0xc59800,0,0,0,0,0,0
 .long 0x183e000,0xa47000,0xc598c5,0x18b3085,0x1294000,0x8f2000,0xa47000,0x1314082,0,0,0,0,0,0,0,0,0,0,0,0,0,0,0,0x85f000,0xa47000,0x8f2000,0,0,0,0,0,0
 .long 0x17be000,0xa47000,0xc598c3,0x183e085,0x8de000,0x3af000,0x52d000,0x95e105,0,0,0,0,0,0,0,0,0,0,0,0,0,0,0,0x87f000,0xa47000,0x3bf000,0,0,0,0,0,0
 .fill 32, 4, 0
 .long 0x680000,0xc0000,0x3bf180,0x70000e,0,0,0,0,0,0,0,0,0,0,0,0,0,0,0,0,0,0,0,0,0,0,0,0,0,0,0,0
 .long 0x600000,0x80000,0x3bf280,0x68010e,0,0,0,0,0,0,0,0,0,0,0,0,0,0,0,0,0,0,0,0,0,0,0,0,0,0,0,0
 .long 0x180000,0,0x3bf0c0,0x200001,0x580000,0x140000,0x3bf480,0x600006,0,0,0,0,0,0,0,0,0,0,0,0,0,0,0,0x85f000,0,0,0,0,0,0,0,0
 .long 0x8de000,0x3af000,0x52d0c0,0x95e101,0x580000,0x160000,0x3bf480,0x600005,0,0,0,0,0,0,0,0,0,0,0,0,0,0,0,0x89f000,0x3bf000,0,0,0,0,0,0,0
 .long 0x680000,0xc0000,0x3bf180,0x70000e,0,0,0,0,0,0,0,0,0,0,0,0,0,0,0,0,0,0,0,0,0,0,0,0,0,0,0,0
 .long 0x600000,0x80000,0x3bf280,0x68010e,0,0,0,0,0,0,0,0,0,0,0,0,0,0,0,0,0,0,0,0,0,0,0,0,0,0,0,0
 .long 0x680000,0xc0000,0x3bf180,0x70000e,0,0,0,0,0,0,0,0,0,0,0,0,0,0,0,0,0,0,0,0,0,0,0,0,0,0,0,0
 .fill 32, 4, 0
 .long 0xf2a000,0x51d000,0x84f0cc,0xfaa183,0x148e000,0xa47000,0xc59800,0x14be280,0,0,0,0,0,0,0,0,0,0,0,0,0,0,0,0x7dd000,0x52d000,0xa47000,0,0,0,0,0,0
 .long 0xeaa000,0x51d000,0x84f0ca,0xf2a183,0xa5a000,0x52d000,0x84f000,0xaaa200,0,0,0,0,0,0,0,0,0,0,0,0,0,0,0,0x85f000,0x52d000,0x52d000,0,0,0,0,0,0
 .long 0x500000,0,0x3bf0cc,0x580003,0x148e000,0xa47000,0xc59800,0x14be280,0,0,0,0,0,0,0,0,0,0,0,0,0,0,0,0xd39800,0,0xa47000,0,0,0,0,0,0
 .long 0x1daf000,0xd3f800,0xf920c5,0x1e2f183,0x116e000,0x83f000,0x8f20c0,0x11e4981,0x11e4000,0x8f2000,0xa47000,0x1214280,0,0,0,0,0,0,0,0,0,0,0,0x7dd000,0xd4f800,0x84f000,0x8f2000,0,0,0,0,0
 .long 0x480000,0,0x3bf0ca,0x500003,0xa5a000,0x52d000,0x84f000,0xaaa200,0,0,0,0,0,0,0,0,0,0,0,0,0,0,0,0xf7f800,0,0x52d000,0,0,0,0,0,0
 .long 0x480000,0,0x3bf0ca,0x500003,0x77e000,0x3bf000,0x52d000,0x7de200,0,0,0,0,0,0,0,0,0,0,0,0,0,0,0,0xc99800,0,0x3bf000,0,0,0,0,0,0
 .long 0xf2a000,0x51d000,0x84f0cc,0xfaa183,0x148e000,0xa47000,0xc59800,0x14be280,0,0,0,0,0,0,0,0,0,0,0,0,0,0,0,0x7dd000,0x52d000,0xa47000,0,0,0,0,0,0
 .fill 32, 4, 0
 .long 0x380000,0,0x3bf0c4,0x400005,0x1baf000,0xd3f800,0xf92000,0x1c2f184,0,0,0,0,0,0,0,0,0,0,0,0,0,0,0,0x340000,0,0xd4f800,0,0,0,0,0,0
 .long 0x17be000,0xa47000,0xc598c3,0x183e085,0x1314000,0x8f2000,0xa47000,0x1394084,0,0,0,0,0,0,0,0,0,0,0,0,0,0,0,0x9f2000,0xa47000,0x8f2000,0,0,0,0,0,0
 .long 0x280000,0,0x3bf0c0,0x300005,0x1414000,0x8f2000,0xa47000,0x148e088,0,0,0,0,0,0,0,0,0,0,0,0,0,0,0,0x7bd000,0,0x8f2000,0,0,0,0,0,0
 .long 0xc2a000,0x51d000,0x84f0c0,0xcaa183,0x1c2f000,0xd3f800,0xf920c1,0x1caf181,0xaaa000,0x51d000,0x84f000,0xb2a181,0,0,0,0,0,0,0,0,0,0,0,0x340000,0x52d000,0xd4f800,0x52d000,0,0,0,0,0
 .long 0x280000,0,0x3bf0c0,0x300005,0x15be000,0xa47000,0xc598c0,0x163e080,0xaaa000,0x51d000,0x84f000,0xb2a181,0,0,0,0,0,0,0,0,0,0,0,0xd19800,0,0xa47000,0x52d000,0,0,0,0,0
 .long 0xeaa000,0x51d000,0x84f0c8,0xf2a185,0x1aaf000,0xd3f800,0xf92000,0x1b2f380,0,0,0,0,0,0,0,0,0,0,0,0,0,0,0,0x7bd000,0x52d000,0xd4f800,0,0,0,0,0,0
 .long 0x380000,0,0x3bf0c4,0x400005,0x1baf000,0xd3f800,0xf92000,0x1c2f184,0,0,0,0,0,0,0,0,0,0,0,0,0,0,0,0x340000,0,0xd4f800,0,0,0,0,0,0
 .fill 32, 4, 0
 .long 0xcaa000,0x51d000,0x84f0c0,0xd2a185,0xbaa000,0x51d000,0x84f0c0,0xc2a181,0x7de000,0x3af000,0x52d000,0x85e101,0,0,0,0,0,0,0,0,0,0,0,0x48f000,0x52d000,0x52d000,0x3bf000,0,0,0,0,0
 .long 0x400000,0,0x3bf0c4,0x480007,0x7de000,0x3af000,0x52d000,0x85e101,0,0,0,0,0,0,0,0,0,0,0,0,0,0,0,0x4ef000,0,0x3bf000,0,0,0,0,0,0
 .long 0xd2a000,0x51d000,0x84f0c0,0xdaa187,0x100000,0,0x3bf0c0,0x180400,0x1214000,0x8f2000,0xa47000,0x1294080,0,0,0,0,0,0,0,0,0,0,0,0xf7f800,0x52d000,0,0x8f2000,0,0,0,0,0
 .long 0x1d2f000,0xd3f800,0xf920c0,0x1daf186,0x1394000,0x8f2000,0xa47000,0x1414086,0,0,0,0,0,0,0,0,0,0,0,0,0,0,0,0xcf9800,0xd4f800,0x8f2000,0,0,0,0,0,0
 .long 0x1d2f000,0xd3f800,0xf920c0,0x1daf186,0xb2a000,0x51d000,0x84f0c0,0xbaa981,0x80000,0,0x3bf000,0x100001,0,0,0,0,0,0,0,0,0,0,0,0x7bd000,0xd4f800,0x52d000,0,0,0,0,0,0
 .long 0x1eaf000,0xd3f800,0xf920c5,0x1f24187,0x10ee000,0x83f000,0x8f2000,0x116e181,0,0,0,0,0,0,0,0,0,0,0,0,0,0,0,0xa12000,0xd4f800,0x84f000,0,0,0,0,0,0
 .long 0xcaa000,0x51d000,0x84f0c0,0xd2a185,0xbaa000,0x51d000,0x84f0c0,0xc2a181,0x7de000,0x3af000,0x52d000,0x85e101,0,0,0,0,0,0,0,0,0,0,0,0x48f000,0x52d000,0x52d000,0x3bf000,0,0,0,0,0
 .fill 32, 4, 0
 .long 0x100000,0,0x3bf0c0,0x180801,0x600000,0x140000,0x3bf280,0x680108,0,0,0,0,0,0,0,0,0,0,0,0,0,0,0,0x9f2000,0,0,0,0,0,0,0,0
 .long 0x15be000,0xa47000,0xc598c0,0x163e481,0x580000,0x140000,0x3bf480,0x600006,0,0,0,0,0,0,0,0,0,0,0,0,0,0,0,0xcf9800,0xa47000,0,0,0,0,0,0,0
 .long 0x680000,0xa0000,0x3bf180,0x70010f,0,0,0,0,0,0,0,0,0,0,0,0,0,0,0,0,0,0,0,0,0,0,0,0,0,0,0,0
 .long 0x680000,0xe0000,0x3bf180,0x70000d,0,0,0,0,0,0,0,0,0,0,0,0,0,0,0,0,0,0,0,0,0,0,0,0,0,0,0,0
 .long 0x600000,0x80000,0x3bf280,0x68010e,0,0,0,0,0,0,0,0,0,0,0,0,0,0,0,0,0,0,0,0,0,0,0,0,0,0,0,0
 .long 0x700000,0x100000,0x3bf080,0x77e10e,0,0,0,0,0,0,0,0,0,0,0,0,0,0,0,0,0,0,0,0,0,0,0,0,0,0,0,0
 .long 0x100000,0,0x3bf0c0,0x180801,0x600000,0x140000,0x3bf280,0x680108,0,0,0,0,0,0,0,0,0,0,0,0,0,0,0,0x9f2000,0,0,0,0,0,0,0,0
 .fill 32, 4, 0
 .long 0x16be000,0xa47000,0xc598c0,0x173e084,0xc2a000,0x51d000,0x84f0c2,0xcaa181,0x18b3000,0xc59800,0xd4f800,0x1923200,0,0,0,0,0,0,0,0,0,0,0,0xcf9800,0xa47000,0x52d000,0xc59800,0,0,0,0,0
 .long 0x200000,0,0x3bf0c0,0x280003,0x95e000,0x3af000,0x52d0c2,0x9de101,0x77e000,0x3bf000,0x52d000,0x7de200,0,0,0,0,0,0,0,0,0,0,0,0x320000,0,0x3bf000,0x3bf000,0,0,0,0,0
 .long 0x173e000,0xa47000,0xc598c1,0x17be085,0x8de000,0x3af000,0x52d0c0,0x95e101,0x77e000,0x3bf000,0x52d000,0x7de200,0,0,0,0,0,0,0,0,0,0,0,0x320000,0xa47000,0x3bf000,0x3bf000,0,0,0,0,0
 .long 0xeaa000,0x51d000,0x84f0c8,0xf2a185,0,0,0x3bf000,0x80200,0,0,0,0,0,0,0,0,0,0,0,0,0,0,0,0xf5f800,0x52d000,0,0,0,0,0,0,0
 .long 0xcaa000,0x51d000,0x84f0c0,0xd2a185,0x163e000,0xa47000,0xc598c2,0x16be080,0x18b3000,0xc59800,0xd4f800,0x1923200,0,0,0,0,0,0,0,0,0,0,0,0x320000,0x52d000,0xa47000,0xc59800,0,0,0,0,0
 .long 0x280000,0,0x3bf0c0,0x300005,0x8de000,0x3af000,0x52d0c0,0x95e101,0x109e000,0x84f000,0x8f2000,0x10ee200,0,0,0,0,0,0,0,0,0,0,0,0x320000,0,0x3bf000,0x84f000,0,0,0,0,0
 .long 0x16be000,0xa47000,0xc598c0,0x173e084,0xc2a000,0x51d000,0x84f0c2,0xcaa181,0x18b3000,0xc59800,0xd4f800,0x1923200,0,0,0,0,0,0,0,0,0,0,0,0xcf9800,0xa47000,0x52d000,0xc59800,0,0,0,0,0
 .fill 32, 4, 0
 .long 0xd2a000,0x51d000,0x84f0c0,0xdaa187,0x1294000,0x8f2000,0xa470c0,0x1314880,0x1923000,0xc59800,0xd4f800,0x19a3081,0,0,0,0,0,0,0,0,0,0,0,0x85f000,0x52d000,0x8f2000,0xc59800,0,0,0,0,0
 .long 0x1d2f000,0xd3f800,0xf920c0,0x1daf186,0xc2a000,0x51d000,0x84f000,0xcaa187,0,0,0,0,0,0,0,0,0,0,0,0,0,0,0,0xf5f800,0xd4f800,0x52d000,0,0,0,0,0,0
 .long 0x300000,0,0x3bf0c0,0x380007,0x1394000,0x8f2000,0xa47000,0x1414086,0,0,0,0,0,0,0,0,0,0,0,0,0,0,0,0x4cf000,0,0x8f2000,0,0,0,0,0,0
 .long 0x380000,0,0x3bf0c2,0x400007,0xb2a000,0x51d000,0x84f000,0xbaa183,0,0,0,0,0,0,0,0,0,0,0,0,0,0,0,0x4cf000,0,0x52d000,0,0,0,0,0,0
 .long 0x380000,0,0x3bf0c2,0x400007,0x1baf000,0xd3f800,0xf92000,0x1c2f184,0,0,0,0,0,0,0,0,0,0,0,0,0,0,0,0x9b2000,0,0xd4f800,0,0,0,0,0,0
 .long 0xd2a000,0x51d000,0x84f0c0,0xdaa187,0x1c2f000,0xd3f800,0xf92000,0x1caf186,0,0,0,0,0,0,0,0,0,0,0,0,0,0,0,0xf5f800,0x52d000,0xd4f800,0,0,0,0,0,0
 .long 0xd2a000,0x51d000,0x84f0c0,0xdaa187,0x1294000,0x8f2000,0xa470c0,0x1314880,0x1923000,0xc59800,0xd4f800,0x19a3081,0,0,0,0,0,0,0,0,0,0,0,0x85f000,0x52d000,0x8f2000,0xc59800,0,0,0,0,0
 .fill 32, 4, 0
 .long 0x1eaf000,0xd3f800,0xf920cb,0x1f24181,0x80000,0,0x3bf000,0x100001,0,0,0,0,0,0,0,0,0,0,0,0,0,0,0,0xf7f800,0xd4f800,0,0,0,0,0,0,0
 .long 0x500000,0,0x3bf000,0x580013,0,0,0,0,0,0,0,0,0,0,0,0,0,0,0,0,0,0,0,0,0,0,0,0,0,0,0,0
 .long 0xe2a000,0x51d000,0x84f0ca,0xeaa181,0x116e000,0x83f000,0x8f2000,0x11e4183,0,0,0,0,0,0,0,0,0,0,0,0,0,0,0,0x992000,0x52d000,0x84f000,0,0,0,0,0,0
 .long 0xe2a000,0x51d000,0x84f0ca,0xeaa181,0x80000,0,0x3bf000,0x100001,0,0,0,0,0,0,0,0,0,0,0,0,0,0,0,0x87f000,0x52d000,0,0,0,0,0,0,0
 .long 0x17be000,0xa47000,0xc598c7,0x183e081,0x8de000,0x3af000,0x52d000,0x95e105,0,0,0,0,0,0,0,0,0,0,0,0,0,0,0,0x84f000,0xa47000,0x3bf000,0,0,0,0,0,0
 .long 0xe2a000,0x51d000,0x84f0ca,0xeaa181,0x1b2f000,0xd3f800,0xf92000,0x1baf182,0,0,0,0,0,0,0,0,0,0,0,0,0,0,0,0x84f000,0x52d000,0xd4f800,0,0,0,0,0,0
 .long 0x1eaf000,0xd3f800,0xf920cb,0x1f24181,0x80000,0,0x3bf000,0x100001,0,0,0,0,0,0,0,0,0,0,0,0,0,0,0,0xf7f800,0xd4f800,0,0,0,0,0,0,0
 .fill 32, 4, 0
 .long 0x163e000,0xa47000,0xc598c0,0x16be082,0x580000,0x160000,0x3bf480,0x600005,0,0,0,0,0,0,0,0,0,0,0,0,0,0,0,0x7bd000,0xa47000,0,0,0,0,0,0,0
 .long 0x700000,0x100000,0x3bf080,0x77e10e,0,0,0,0,0,0,0,0,0,0,0,0,0,0,0,0,0,0,0,0,0,0,0,0,0,0,0,0
 .long 0x700000,0xe0000,0x3bf080,0x77e10f,0,0,0,0,0,0,0,0,0,0,0,0,0,0,0,0,0,0,0,0,0,0,0,0,0,0,0,0
 .long 0x600000,0xa0000,0x3bf280,0x68000d,0,0,0,0,0,0,0,0,0,0,0,0,0,0,0,0,0,0,0,0,0,0,0,0,0,0,0,0
 .long 0x700000,0x100000,0x3bf080,0x77e00e,0,0,0,0,0,0,0,0,0,0,0,0,0,0,0,0,0,0,0,0,0,0,0,0,0,0,0,0
 .long 0xb2a000,0x51d000,0x84f0c0,0xbaa981,0x580000,0x100000,0x3bf480,0x600108,0,0,0,0,0,0,0,0,0,0,0,0,0,0,0,0xc79800,0x52d000,0,0,0,0,0,0,0
 .long 0x163e000,0xa47000,0xc598c0,0x16be082,0x580000,0x160000,0x3bf480,0x600005,0,0,0,0,0,0,0,0,0,0,0,0,0,0,0,0x7bd000,0xa47000,0,0,0,0,0,0,0
 .fill 32, 4, 0
 .long 0x1d2f000,0xd3f800,0xf920c0,0x1daf186,0x1a23000,0xc59800,0xd4f8c1,0x1a9f080,0,0,0x3bf000,0x80200,0,0,0,0,0,0,0,0,0,0,0,0x320000,0xd4f800,0xc59800,0,0,0,0,0,0
 .long 0x280000,0,0x3bf0c0,0x300005,0x8de000,0x3af000,0x52d0c0,0x95e101,0,0,0x3bf000,0x80200,0,0,0,0,0,0,0,0,0,0,0,0x7bd000,0,0x3bf000,0,0,0,0,0,0
 .long 0x17be000,0xa47000,0xc598c1,0x183e087,0x19a3000,0xc59800,0xd4f8c0,0x1a23480,0x18b3000,0xc59800,0xd4f800,0x1923200,0,0,0,0,0,0,0,0,0,0,0,0x84f000,0xa47000,0xc59800,0xc59800,0,0,0,0,0
 .long 0xd2a000,0x51d000,0x84f0c0,0xdaa187,0x19a3000,0xc59800,0xd4f8c0,0x1a23480,0x18b3000,0xc59800,0xd4f800,0x1923200,0,0,0,0,0,0,0,0,0,0,0,0x7bd000,0x52d000,0xc59800,0xc59800,0,0,0,0,0
 .long 0x173e000,0xa47000,0xc598c0,0x17be086,0xbaa000,0x51d000,0x84f0c0,0xc2a181,0,0,0x3bf000,0x80200,0,0,0,0,0,0,0,0,0,0,0,0xf5f800,0xa47000,0x52d000,0,0,0,0,0,0
 .long 0x1caf000,0xd3f800,0xf920c0,0x1d2f184,0xc2a000,0x51d000,0x84f0c2,0xcaa181,0x18b3000,0xc59800,0xd4f800,0x1923200,0,0,0,0,0,0,0,0,0,0,0,0xc47000,0xd4f800,0x52d000,0xc59800,0,0,0,0,0
 .long 0x1d2f000,0xd3f800,0xf920c0,0x1daf186,0x1a23000,0xc59800,0xd4f8c1,0x1a9f080,0,0,0x3bf000,0x80200,0,0,0,0,0,0,0,0,0,0,0,0x320000,0xd4f800,0xc59800,0,0,0,0,0,0
 .fill 32, 4, 0
 .long 0x400000,0,0x3bf0ca,0x480001,0x1b2f000,0xd3f800,0xf92000,0x1baf182,0,0,0,0,0,0,0,0,0,0,0,0,0,0,0,0x46f000,0,0xd4f800,0,0,0,0,0,0
 .long 0x1eaf000,0xd3f800,0xf920cb,0x1f24181,0x10ee000,0x83f000,0x8f2000,0x116e181,0,0,0,0,0,0,0,0,0,0,0,0,0,0,0,0x84f000,0xd4f800,0x84f000,0,0,0,0,0,0
 .long 0x400000,0,0x3bf0ca,0x480001,0x1294000,0x8f2000,0xa47000,0x1314082,0,0,0,0,0,0,0,0,0,0,0,0,0,0,0,0xd19800,0,0x8f2000,0,0,0,0,0,0
 .long 0x280000,0,0x3bf0c4,0x300001,0x1294000,0x8f2000,0xa470c0,0x1314880,0x1923000,0xc59800,0xd4f800,0x19a3081,0,0,0,0,0,0,0,0,0,0,0,0xc47000,0,0x8f2000,0xc59800,0,0,0,0,0
 .long 0x400000,0,0x3bf0ca,0x480001,0x1b2f000,0xd3f800,0xf92000,0x1baf182,0,0,0,0,0,0,0,0,0,0,0,0,0,0,0,0x50f000,0,0xd4f800,0,0,0,0,0,0
 .long 0x400000,0,0x3bf0ca,0x480001,0x1923000,0xc59800,0xd4f800,0x19a3081,0,0,0,0,0,0,0,0,0,0,0,0,0,0,0,0x79d000,0,0xc59800,0,0,0,0,0,0
 .long 0x400000,0,0x3bf0ca,0x480001,0x1b2f000,0xd3f800,0xf92000,0x1baf182,0,0,0,0,0,0,0,0,0,0,0,0,0,0,0,0x46f000,0,0xd4f800,0,0,0,0,0,0
 .fill 32, 4, 0
 .long 0x173e200,0xa47100,0xc598c3,0x17be083,0x95e000,0x3af000,0x52d000,0x9de107,0,0,0,0,0,0,0,0,0,0,0,0,0,0,0,0x9d2000,0xa47100,0x3bf000,0,0,0,0,0,0
 .long 0x380000,0,0x3bf0c6,0x400003,0x85e000,0x3af000,0x52d000,0x8de103,0,0,0,0,0,0,0,0,0,0,0,0,0,0,0,0x9d2000,0,0x3bf000,0,0,0,0,0,0
 .long 0x1daf000,0xd3f800,0xf920c5,0x1e2f183,0x1c2f000,0xd3f800,0xf92000,0x1caf186,0,0,0,0,0,0,0,0,0,0,0,0,0,0,0,0x79d000,0xd4f800,0xd4f800,0,0,0,0,0,0
 .long 0xcaa000,0x51d000,0x84f0c2,0xd2a183,0x200000,0,0x3bf000,0x280007,0,0,0,0,0,0,0,0,0,0,0,0,0,0,0,0x320000,0x52d000,0,0,0,0,0,0,0
 .long 0x16be000,0xa47000,0xc598c1,0x173e083,0x1a23000,0xc59800,0xd4f8c1,0x1a9f080,0x7de000,0x3af000,0x52d000,0x85e101,0,0,0,0,0,0,0,0,0,0,0,0xcf9800,0xa47000,0xc59800,0x3bf000,0,0,0,0,0
 .long 0x500000,0,0x3bf000,0x580013,0,0,0,0,0,0,0,0,0,0,0,0,0,0,0,0,0,0,0,0,0,0,0,0,0,0,0,0
 .long 0x173de00,0xa46f00,0xc598c3,0x17be083,0x95e000,0x3af000,0x52d000,0x9de107,0,0,0,0,0,0,0,0,0,0,0,0,0,0,0,0x9d2000,0xa46f00,0x3bf000,0,0,0,0,0,0
 .fill 32, 4, 0
 .long 0x700000,0x100000,0x3bf080,0x77e00e,0,0,0,0,0,0,0,0,0,0,0,0,0,0,0,0,0,0,0,0,0,0,0,0,0,0,0,0
 .long 0x680000,0xc0000,0x3bf180,0x70010e,0,0,0,0,0,0,0,0,0,0,0,0,0,0,0,0,0,0,0,0,0,0,0,0,0,0,0,0
 .long 0xb2a000,0x51d000,0x84f0c0,0xbaa981,0x600000,0x120000,0x3bf280,0x680109,0,0,0,0,0,0,0,0,0,0,0,0,0,0,0,0xf5f800,0x52d000,0,0,0,0,0,0,0
 .long 0x700000,0x120000,0x3bf080,0x77e00d,0,0,0,0,0,0,0,0,0,0,0,0,0,0,0,0,0,0,0,0,0,0,0,0,0,0,0,0
 .long 0x180000,0,0x3bf0c0,0x200001,0x580000,0x140000,0x3bf480,0x600106,0,0,0,0,0,0,0,0,0,0,0,0,0,0,0,0x79d000,0,0,0,0,0,0,0,0
 .long 0x680000,0xc0000,0x3bf180,0x70010e,0,0,0,0,0,0,0,0,0,0,0,0,0,0,0,0,0,0,0,0,0,0,0,0,0,0,0,0
 .long 0x700000,0x100000,0x3bf080,0x77e00e,0,0,0,0,0,0,0,0,0,0,0,0,0,0,0,0,0,0,0,0,0,0,0,0,0,0,0,0
 .fill 32, 4, 0
.section .rodata,"a"
.p2align 6
.amdhsa_kernel standalone__ragged_sequences_varlen_flash_attn__ragged_kernel
  .amdhsa_next_free_vgpr 512
  .amdhsa_next_free_sgpr 102
  .amdhsa_accum_offset 256
  .amdhsa_group_segment_fixed_size 0
  .amdhsa_kernarg_size 56
  .amdhsa_user_sgpr_count 2
  .amdhsa_user_sgpr_kernarg_segment_ptr 1
  .amdhsa_system_sgpr_workgroup_id_x 1
.end_amdhsa_kernel
```
